```python
import torch

def _softmax(x, axis=-1):
    return torch.softmax(x, dim=axis)

def _gelu(x):
    return torch.nn.functional.gelu(x, approximate='tanh')

def _silu(x):
    return torch.nn.functional.silu(x)

def _sigmoid(x):
    return torch.sigmoid(x)

def _layernorm(x, axis=-1, eps=1e-05):
    m = x.mean(dim=axis, keepdim=True)
    v = x.var(dim=axis, keepdim=True, unbiased=False)
    return (x - m) / torch.sqrt(v + eps)

def _scatter_add(tgt, idx, src, axis=0):
    return tgt.clone().index_add_(axis, idx, src)

def _segment_sum(src, seg, n):
    out = torch.zeros((n,) + src.shape[1:], dtype=src.dtype)
    return out.index_add_(0, seg, src)

def _pad(x, pw):
    flat = tuple((v for pair in reversed(pw) for v in pair))
    return torch.nn.functional.pad(x, flat)
kernel_name = 'adaLN_cond__mha_block__geglu_ffn__prompt'

def setup_inputs():

    _w = lambda a: (lambda t: t.to(torch.bfloat16) if t.is_floating_point() else t)(torch.as_tensor(a))

    def _A_setup():
        B, S, D, H = (1, 2048, 1024, 32)
        return {'x': _w((lambda *s: torch.randn(*s, dtype=torch.bfloat16) * 0.05)(B, S, D)), 'wqkv': _w((lambda *s: torch.randn(*s, dtype=torch.bfloat16) * 0.05)(D, 3 * D)), 'wo': _w((lambda *s: torch.randn(*s, dtype=torch.bfloat16) * 0.05)(D, D))}
    _A_in = _A_setup()

    def _B_setup():
        B, S, D, F = (1, 2048, 1024, 3584)
        return {'x': _w((lambda *s: torch.randn(*s, dtype=torch.bfloat16) * 0.05)(B, S, D)), 'w_gate': _w((lambda *s: torch.randn(*s, dtype=torch.bfloat16) * 0.05)(D, F)), 'w_up': _w((lambda *s: torch.randn(*s, dtype=torch.bfloat16) * 0.05)(D, F)), 'w_down': _w((lambda *s: torch.randn(*s, dtype=torch.bfloat16) * 0.05)(F, D))}
    _B_in = _B_setup()
    return {'A_x': _A_in['x'], 'A_wqkv': _A_in['wqkv'], 'A_wo': _A_in['wo'], 'B_x': _B_in['x'], 'B_w_gate': _B_in['w_gate'], 'B_w_up': _B_in['w_up'], 'B_w_down': _B_in['w_down'], 'c': _w((lambda *s: torch.randn(*s, dtype=torch.bfloat16) * 0.1)(1, 1024) * 8.0), 'w_mod': _w((lambda *s: torch.randn(*s, dtype=torch.bfloat16) * 0.1)(1024, 6 * 1024) * 1024 ** (-0.5) * 8.0)}

def reference(A_x, A_wqkv, A_wo, B_x, B_w_gate, B_w_up, B_w_down, c, w_mod):

    def _A_ref(x, wqkv, wo):
        B, S, D = x.shape
        H = 32
        Dh = D // H
        qkv = (lambda x, *d: x.permute(*d))((x @ wqkv).reshape(B, S, 3, H, Dh), 2, 0, 3, 1, 4)
        q, k, v = (qkv[0], qkv[1], qkv[2])
        scores = torch.einsum('bhqd,bhkd->bhqk', q, k) * Dh ** (-0.5)
        p = _softmax(scores, axis=-1)
        o = torch.einsum('bhqk,bhkd->bhqd', p, v)
        return (lambda x, *d: x.permute(*d))(o, 0, 2, 1, 3).reshape(B, S, D) @ wo

    def _B_ref(x, w_gate, w_up, w_down):
        return _gelu(x @ w_gate) * (x @ w_up) @ w_down
    x = A_x
    mod = (_silu(c) @ w_mod).reshape(c.shape[0], 6, 1, -1)
    sa, ca, ga, sb, cb, gb = (mod[:, 0].clone(), mod[:, 1].clone(), mod[:, 2].clone(), mod[:, 3].clone(), mod[:, 4].clone(), mod[:, 5].clone())
    h = _layernorm(x, axis=-1) * (1 + ca) + sa
    x = x + ga * _A_ref(h, A_wqkv, A_wo)
    h = _layernorm(x, axis=-1) * (1 + cb) + sb
    x = x + gb * _B_ref(h, B_w_gate, B_w_up, B_w_down)
    return x
```

```asm
; @launch kernel=pre_kernel grid=(256,1,1) block=(512,1,1) lds=67584
; @launch kernel=mlp_kernel grid=(256,1,1) block=(256,1,1) lds=163840
.amdgcn_target "amdgcn-amd-amdhsa--gfx950"
.text
.globl pre_kernel
.p2align 8
.type pre_kernel,@function
pre_kernel:
    s_cmp_ge_u32 s2, 256
    s_cbranch_scc1 pre_kernel_end
    s_getpc_b64 s[88:89]
pre_kernel_pc1:
    s_add_u32 s88, s88, pre_kernel_top-pre_kernel_pc1
    s_addc_u32 s89, s89, 0
    s_mov_b32 s90, mlp_kernel_end-pre_kernel_top+4
    s_cmp_lt_u32 s2, 256
    s_cselect_b32 s90, s90, 0
    s_mov_b32 s91, 0x20000
    s_lshr_b32 s3, s2, 3
    s_mul_i32 s3, s3, 3072
    v_lshlrev_b32 v108, 7, v0
    v_mov_b32 v109, 0x80000000
    v_cmp_gt_u32 vcc, 24, v0
    s_nop 1
    v_cndmask_b32 v108, v109, v108, vcc
    buffer_load_dword v109, v108, s[88:91], s3 offen
pre_kernel_top:
    s_load_dwordx2 s[40:41], s[0:1], 56
    s_load_dwordx2 s[42:43], s[0:1], 64
    s_load_dwordx2 s[44:45], s[0:1], 88
    s_load_dwordx2 s[46:47], s[0:1], 8
    s_load_dwordx2 s[48:49], s[0:1], 0
    s_load_dwordx2 s[62:63], s[0:1], 80
    s_load_dwordx2 s[64:65], s[0:1], 16
    v_lshrrev_b32 v2, 6, v0
    v_and_b32 v1, 63, v0
    v_readfirstlane_b32 s26, v2
    s_sub_u32 s27, s2, 128
    s_cmp_lt_u32 s27, 128
    s_cbranch_scc1 pre_side
    s_and_b32 s32, s2, 1
    s_lshr_b32 s33, s2, 1
    s_cmp_ge_u32 s33, 32
    s_cselect_b32 s34, 16, 0
    s_add_u32 s33, s33, s34
    s_cmp_ge_u32 s33, 160
    s_mov_b32 s34, 112
    s_cselect_b32 s34, 80, s34
    s_cmp_ge_u32 s33, 144
    s_cselect_b32 s34, s34, 0
    s_sub_u32 s33, s33, s34
    s_lshl_b32 s52, s32, 9
    s_mov_b32 s51, 12288
    s_mul_i32 s50, s52, s51
    s_lshl_b32 s34, s33, 7
    s_add_u32 s50, s50, s34
    s_mul_i32 s53, s32, 24576
    s_lshl_b32 s34, s33, 8
    s_add_u32 s53, s53, s34
    s_mov_b32 s54, 0
    s_waitcnt lgkmcnt(0)
    s_mov_b32 s8, s42
    s_mov_b32 s9, s43
    s_mov_b32 s10, 12582912
    s_mov_b32 s11, 0x20000
    s_mov_b32 s12, s40
    s_mov_b32 s13, s41
    s_mov_b32 s14, 2048
    s_mov_b32 s15, 0x20000
    s_mov_b32 s16, s44
    s_mov_b32 s17, s45
    s_mov_b32 s18, 49152
    s_mov_b32 s19, 0x20000
    s_lshl_b32 s55, s26, 6
    s_add_u32 s56, s52, s55
    v_add_lshl_u32 v4, v1, s56, 1
    buffer_load_ushort v100, v4, s[12:15], 0 offen offset:0
    v_lshrrev_b32 v5, 3, v1
    v_and_b32 v6, 7, v1
    v_bfe_u32 v7, v1, 4, 1
    v_lshlrev_b32 v7, 2, v7
    v_xor_b32 v6, v6, v7
    v_add_u32 v5, s55, v5
    v_mul_lo_u32 v5, v5, s51
    v_lshl_add_u32 v5, v6, 4, v5
    s_lshl_b32 s57, s26, 13
    s_lshl_b32 s59, s51, 3
    s_add_u32 m0, s57, 0
    s_nop 0
    buffer_load_dwordx4 v5, s[8:11], s50 offen nt lds
    s_add_u32 s50, s50, s59
    s_add_u32 m0, s57, 1024
    s_nop 0
    buffer_load_dwordx4 v5, s[8:11], s50 offen nt lds
    s_add_u32 s50, s50, s59
    s_add_u32 m0, s57, 2048
    s_nop 0
    buffer_load_dwordx4 v5, s[8:11], s50 offen nt lds
    s_add_u32 s50, s50, s59
    s_add_u32 m0, s57, 3072
    s_nop 0
    buffer_load_dwordx4 v5, s[8:11], s50 offen nt lds
    s_add_u32 s50, s50, s59
    s_add_u32 m0, s57, 4096
    s_nop 0
    buffer_load_dwordx4 v5, s[8:11], s50 offen nt lds
    s_add_u32 s50, s50, s59
    s_add_u32 m0, s57, 5120
    s_nop 0
    buffer_load_dwordx4 v5, s[8:11], s50 offen nt lds
    s_add_u32 s50, s50, s59
    s_add_u32 m0, s57, 6144
    s_nop 0
    buffer_load_dwordx4 v5, s[8:11], s50 offen nt lds
    s_add_u32 s50, s50, s59
    s_add_u32 m0, s57, 7168
    s_nop 0
    buffer_load_dwordx4 v5, s[8:11], s50 offen nt lds
    s_add_u32 s50, s50, s59
    v_lshrrev_b32 v12, 5, v1
    v_bfe_u32 v13, v1, 4, 1
    v_bfe_u32 v14, v1, 2, 2
    v_and_b32 v15, 3, v1
    v_lshl_add_u32 v16, v12, 3, v14
    v_lshlrev_b32 v16, 7, v16
    v_lshl_add_u32 v16, v13, 5, v16
    v_lshl_add_u32 v16, v15, 3, v16
    v_lshrrev_b32 v17, 1, v14
    v_lshlrev_b32 v17, 6, v17
    v_add_u32 v18, v16, v17
    v_sub_u32 v19, v16, v17
    v_add_u32 v19, 64, v19
    v_add_u32 v18, s57, v18
    v_add_u32 v19, s57, v19
    s_lshl_b32 s58, s26, 8
    s_add_u32 s58, s58, 0x10000
    v_lshl_add_u32 v6, v1, 1, s58
    v_and_b32 v7, 31, v1
    v_lshrrev_b32 v12, 5, v1
    v_lshlrev_b32 v12, 4, v12
    v_lshl_add_u32 v12, v7, 7, v12
    v_add_u32 v12, s58, v12
    s_waitcnt vmcnt(8)
    v_lshlrev_b32 v100, 16, v100
    v_mul_f32 v101, 0xbfb8aa3b, v100
    v_exp_f32 v101, v101
    s_nop 0
    v_add_f32 v101, 1.0, v101
    v_rcp_f32 v101, v101
    s_nop 0
    v_mul_f32 v100, v100, v101
    v_cvt_pk_bf16_f32 v100, v100, v100
    ds_write_b16 v6, v100 offset:0
    v_mov_b32 v20, 0
    v_mov_b32 v21, 0
    v_mov_b32 v22, 0
    v_mov_b32 v23, 0
    v_mov_b32 v24, 0
    v_mov_b32 v25, 0
    v_mov_b32 v26, 0
    v_mov_b32 v27, 0
    v_mov_b32 v28, 0
    v_mov_b32 v29, 0
    v_mov_b32 v30, 0
    v_mov_b32 v31, 0
    v_mov_b32 v32, 0
    v_mov_b32 v33, 0
    v_mov_b32 v34, 0
    v_mov_b32 v35, 0
    v_cmp_gt_u32 vcc, 1, v7
    s_waitcnt vmcnt(0) lgkmcnt(0)
    s_and_saveexec_b64 s[60:61], vcc
    ds_read_b128 v[20:23], v12 offset:0
    ds_read_b128 v[24:27], v12 offset:32
    ds_read_b128 v[28:31], v12 offset:64
    ds_read_b128 v[32:35], v12 offset:96
    s_mov_b64 exec, s[60:61]
    ds_read_b64_tr_b16 v[36:37], v18 offset:0
    ds_read_b64_tr_b16 v[38:39], v18 offset:512
    ds_read_b64_tr_b16 v[40:41], v19 offset:0
    ds_read_b64_tr_b16 v[42:43], v19 offset:512
    ds_read_b64_tr_b16 v[44:45], v18 offset:2048
    ds_read_b64_tr_b16 v[46:47], v18 offset:2560
    ds_read_b64_tr_b16 v[48:49], v19 offset:2048
    ds_read_b64_tr_b16 v[50:51], v19 offset:2560
    ds_read_b64_tr_b16 v[52:53], v18 offset:4096
    ds_read_b64_tr_b16 v[54:55], v18 offset:4608
    ds_read_b64_tr_b16 v[56:57], v19 offset:4096
    ds_read_b64_tr_b16 v[58:59], v19 offset:4608
    ds_read_b64_tr_b16 v[60:61], v18 offset:6144
    ds_read_b64_tr_b16 v[62:63], v18 offset:6656
    ds_read_b64_tr_b16 v[64:65], v19 offset:6144
    ds_read_b64_tr_b16 v[66:67], v19 offset:6656
    s_waitcnt lgkmcnt(12)
    v_mfma_f32_32x32x16_bf16 v[68:83], v[20:23], v[36:39], 0
    v_mfma_f32_32x32x16_bf16 v[84:99], v[20:23], v[40:43], 0
    s_waitcnt lgkmcnt(8)
    v_mfma_f32_32x32x16_bf16 v[68:83], v[24:27], v[44:47], v[68:83]
    v_mfma_f32_32x32x16_bf16 v[84:99], v[24:27], v[48:51], v[84:99]
    s_waitcnt lgkmcnt(4)
    v_mfma_f32_32x32x16_bf16 v[68:83], v[28:31], v[52:55], v[68:83]
    v_mfma_f32_32x32x16_bf16 v[84:99], v[28:31], v[56:59], v[84:99]
    s_waitcnt lgkmcnt(0)
    v_mfma_f32_32x32x16_bf16 v[68:83], v[32:35], v[60:63], v[68:83]
    v_mfma_f32_32x32x16_bf16 v[84:99], v[32:35], v[64:67], v[84:99]
    v_lshl_add_u32 v6, v1, 2, s57
    v_cmp_gt_u32 vcc, 32, v1
    s_and_saveexec_b64 s[60:61], vcc
    s_nop 7
    ds_write_b32 v6, v68 offset:0
    ds_write_b32 v6, v84 offset:128
    s_mov_b64 exec, s[60:61]
    s_waitcnt lgkmcnt(0)
    s_barrier
    s_cmp_ge_u32 s26, 1
    s_cbranch_scc1 pre_kernel_end
    s_lshl_b32 s57, s26, 8
    v_lshl_add_u32 v6, v1, 2, s57
    ds_read_b32 v8, v6 offset:0
    ds_read_b32 v9, v6 offset:8192
    ds_read_b32 v10, v6 offset:16384
    ds_read_b32 v11, v6 offset:24576
    ds_read_b32 v12, v6 offset:32768
    ds_read_b32 v13, v6 offset:40960
    ds_read_b32 v14, v6 offset:49152
    ds_read_b32 v15, v6 offset:57344
    s_mul_i32 s57, s26, s54
    s_add_u32 s53, s53, s57
    v_lshlrev_b32 v6, 2, v1
    s_waitcnt lgkmcnt(0)
    v_add_f32 v8, v8, v12
    v_add_f32 v9, v9, v13
    v_add_f32 v10, v10, v14
    v_add_f32 v11, v11, v15
    v_add_f32 v8, v8, v10
    v_add_f32 v9, v9, v11
    v_add_f32 v8, v8, v9
    buffer_store_dword v8, v6, s[16:19], s53 offen
    s_endpgm
pre_side:
    s_lshl_b32 s32, s27, 9
    v_add_u32 v3, s32, v0
    v_lshrrev_b32 v1, 5, v0
    v_and_b32 v2, 31, v0
    s_lshl_b32 s24, s27, 4
    v_add_u32 v4, s24, v1
    v_lshlrev_b32 v4, 11, v4
    v_lshl_add_u32 v4, v2, 4, v4
    s_waitcnt lgkmcnt(0)
    s_mov_b32 s4, s48
    s_mov_b32 s5, s49
    s_mov_b32 s6, 4194304
    s_mov_b32 s7, 0x20000
    s_add_u32 s12, s44, 5242880
    s_addc_u32 s13, s45, 0
    s_mov_b32 s14, 4849664
    s_mov_b32 s15, 0x20000
    buffer_load_dwordx4 v[8:11], v4, s[4:7], 0 offen offset:0 nt
    buffer_load_dwordx4 v[12:15], v4, s[4:7], 0 offen offset:512 nt
    buffer_load_dwordx4 v[16:19], v4, s[4:7], 0 offen offset:1024 nt
    buffer_load_dwordx4 v[20:23], v4, s[4:7], 0 offen offset:1536 nt
    s_add_u32 s20, s44, 720896
    s_addc_u32 s21, s45, 0
    s_mov_b32 s22, 294912
    s_mov_b32 s23, 0x20000
    v_lshlrev_b32 v76, 4, v0
    v_mov_b32 v77, 0x80000000
    v_cmp_gt_u32 vcc, 144, v0
    s_nop 1
    v_cndmask_b32 v76, v77, v76, vcc
    s_mul_i32 s35, s27, 2304
    v_mov_b32 v78, 0
    v_mov_b32 v79, 0
    v_mov_b32 v80, 0
    v_mov_b32 v81, 0
    buffer_store_dwordx4 v[78:81], v76, s[20:23], s35 offen sc1
    s_mov_b32 s20, s64
    s_mov_b32 s21, s65
    s_mov_b32 s22, 2097152
    s_mov_b32 s23, 0x20000
    v_subrev_u32 v84, 49152, v3
    v_cmp_gt_u32 vcc, 16384, v84
    v_and_b32 v85, 7, v84
    v_lshrrev_b32 v84, 3, v84
    v_lshrrev_b32 v86, 1, v84
    v_and_b32 v87, 1, v84
    v_lshlrev_b32 v87, 10, v87
    v_mul_u32_u24 v86, 2048, v86
    v_add3_u32 v86, v86, v87, 0
    v_lshl_add_u32 v86, v85, 4, v86
    v_add_u32 v86, 384, v86
    v_mov_b32 v87, 0x80000000
    v_cndmask_b32 v86, v87, v86, vcc
    v_lshlrev_b32 v84, 8, v84
    v_lshl_add_u32 v84, v85, 4, v84
    v_add_u32 v84, 0, v84
    v_cndmask_b32 v84, v87, v84, vcc
    buffer_load_dwordx4 v[88:91], v86, s[20:23], 0 offen
    s_mov_b32 s20, s46
    s_mov_b32 s21, s47
    s_mov_b32 s22, 6291456
    s_mov_b32 s23, 0x20000
    v_subrev_u32 v64, 0, v3
    v_cmp_gt_u32 vcc, 49152, v64
    v_and_b32 v65, 7, v64
    v_lshrrev_b32 v64, 3, v64
    v_mul_u32_u24 v66, 10923, v64
    v_lshrrev_b32 v66, 16, v66
    v_mul_u32_u24 v67, 6, v66
    v_sub_u32 v67, v64, v67
    v_lshlrev_b32 v68, 11, v67
    v_add_u32 v67, 5, v67
    v_lshrrev_b32 v67, 3, v67
    v_mul_u32_u24 v67, 5120, v67
    v_sub_u32 v67, v68, v67
    v_mul_u32_u24 v66, 6144, v66
    v_add3_u32 v66, v66, v67, 0
    v_lshl_add_u32 v66, v65, 4, v66
    v_add_u32 v66, 384, v66
    v_mov_b32 v67, 0x80000000
    v_cndmask_b32 v66, v67, v66, vcc
    v_lshlrev_b32 v64, 8, v64
    v_lshl_add_u32 v64, v65, 4, v64
    v_add_u32 v64, 0, v64
    v_cndmask_b32 v64, v67, v64, vcc
    buffer_load_dwordx4 v[68:71], v66, s[20:23], 0 offen
    s_mul_i32 s35, s27, 49152
    s_add_u32 s35, s35, 0
    v_lshlrev_b32 v72, 7, v0
    v_mov_b32 v73, 0x80000000
    v_cmp_gt_u32 vcc, 384, v0
    s_nop 1
    v_cndmask_b32 v72, v73, v72, vcc
    buffer_load_dword v73, v72, s[20:23], s35 offen
    s_lshr_b32 s25, s27, 1
    s_lshl_b32 s25, s25, 3
    s_and_b32 s26, s27, 1
    s_lshl_b32 s26, s26, 1
    s_add_u32 s25, s25, s26
    v_bfe_u32 v26, v0, 4, 1
    v_lshl_add_u32 v26, v26, 2, s25
    v_bfe_u32 v27, v0, 3, 1
    v_add_u32 v26, v26, v27
    v_mul_u32_u24 v27, 9363, v26
    v_lshrrev_b32 v27, 16, v27
    v_add_u32 v25, v26, v27
    v_mul_u32_u24 v27, 7, v27
    v_sub_u32 v27, v26, v27
    v_add_u32 v27, 5, v27
    v_lshrrev_b32 v27, 3, v27
    v_add_lshl_u32 v25, v25, v27, 7
    v_and_b32 v26, 7, v0
    v_lshl_add_u32 v25, v26, 4, v25
    s_mov_b32 s25, 75776
    v_mul_lo_u32 v27, v1, s25
    v_add_u32 v25, v25, v27
    v_lshrrev_b32 v27, 4, v0
    v_mul_u32_u24 v27, 272, v27
    v_and_b32 v26, 15, v0
    v_lshl_add_u32 v27, v26, 4, v27
    v_mul_u32_u24 v28, 272, v2
    v_lshl_add_u32 v28, v1, 4, v28
    v_and_b32 v29, 1, v2
    v_mul_u32_u24 v29, 264, v29
    v_sub_u32 v28, v28, v29
    s_waitcnt vmcnt(3)
    v_lshlrev_b32 v32, 16, v8
    v_and_b32 v33, 0xffff0000, v8
    v_lshlrev_b32 v34, 16, v9
    v_and_b32 v35, 0xffff0000, v9
    v_lshlrev_b32 v36, 16, v10
    v_and_b32 v37, 0xffff0000, v10
    v_lshlrev_b32 v38, 16, v11
    v_and_b32 v39, 0xffff0000, v11
    v_lshlrev_b32 v40, 16, v12
    v_and_b32 v41, 0xffff0000, v12
    v_lshlrev_b32 v42, 16, v13
    v_and_b32 v43, 0xffff0000, v13
    v_lshlrev_b32 v44, 16, v14
    v_and_b32 v45, 0xffff0000, v14
    v_lshlrev_b32 v46, 16, v15
    v_and_b32 v47, 0xffff0000, v15
    v_lshlrev_b32 v48, 16, v16
    v_and_b32 v49, 0xffff0000, v16
    v_lshlrev_b32 v50, 16, v17
    v_and_b32 v51, 0xffff0000, v17
    v_lshlrev_b32 v52, 16, v18
    v_and_b32 v53, 0xffff0000, v18
    v_lshlrev_b32 v54, 16, v19
    v_and_b32 v55, 0xffff0000, v19
    v_lshlrev_b32 v56, 16, v20
    v_and_b32 v57, 0xffff0000, v20
    v_lshlrev_b32 v58, 16, v21
    v_and_b32 v59, 0xffff0000, v21
    v_lshlrev_b32 v60, 16, v22
    v_and_b32 v61, 0xffff0000, v22
    v_lshlrev_b32 v62, 16, v23
    v_and_b32 v63, 0xffff0000, v23
    v_add_f32 v6, v32, v33
    v_add_f32 v7, v34, v35
    v_add_f32 v6, v6, v36
    v_add_f32 v7, v7, v37
    v_add_f32 v6, v6, v38
    v_add_f32 v7, v7, v39
    v_add_f32 v6, v6, v40
    v_add_f32 v7, v7, v41
    v_add_f32 v6, v6, v42
    v_add_f32 v7, v7, v43
    v_add_f32 v6, v6, v44
    v_add_f32 v7, v7, v45
    v_add_f32 v6, v6, v46
    v_add_f32 v7, v7, v47
    v_add_f32 v6, v6, v48
    v_add_f32 v7, v7, v49
    v_add_f32 v6, v6, v50
    v_add_f32 v7, v7, v51
    v_add_f32 v6, v6, v52
    v_add_f32 v7, v7, v53
    v_add_f32 v6, v6, v54
    v_add_f32 v7, v7, v55
    v_add_f32 v6, v6, v56
    v_add_f32 v7, v7, v57
    v_add_f32 v6, v6, v58
    v_add_f32 v7, v7, v59
    v_add_f32 v6, v6, v60
    v_add_f32 v7, v7, v61
    v_add_f32 v6, v6, v62
    v_add_f32 v7, v7, v63
    v_add_f32 v6, v6, v7
    s_nop 1
    v_add_f32_dpp v6, v6, v6 quad_perm:[1,0,3,2] row_mask:0xf bank_mask:0xf
    s_nop 1
    v_add_f32_dpp v6, v6, v6 quad_perm:[2,3,0,1] row_mask:0xf bank_mask:0xf
    s_nop 1
    v_add_f32_dpp v6, v6, v6 row_half_mirror row_mask:0xf bank_mask:0xf
    s_nop 1
    v_add_f32_dpp v6, v6, v6 row_mirror row_mask:0xf bank_mask:0xf
    v_mov_b32 v7, v6
    s_nop 1
    v_permlane16_swap_b32 v6, v7
    v_add_f32 v6, v6, v7
    v_mul_f32 v6, 0x3a800000, v6
    v_sub_f32 v32, v32, v6
    v_sub_f32 v33, v33, v6
    v_sub_f32 v34, v34, v6
    v_sub_f32 v35, v35, v6
    v_sub_f32 v36, v36, v6
    v_sub_f32 v37, v37, v6
    v_sub_f32 v38, v38, v6
    v_sub_f32 v39, v39, v6
    v_sub_f32 v40, v40, v6
    v_sub_f32 v41, v41, v6
    v_sub_f32 v42, v42, v6
    v_sub_f32 v43, v43, v6
    v_sub_f32 v44, v44, v6
    v_sub_f32 v45, v45, v6
    v_sub_f32 v46, v46, v6
    v_sub_f32 v47, v47, v6
    v_sub_f32 v48, v48, v6
    v_sub_f32 v49, v49, v6
    v_sub_f32 v50, v50, v6
    v_sub_f32 v51, v51, v6
    v_sub_f32 v52, v52, v6
    v_sub_f32 v53, v53, v6
    v_sub_f32 v54, v54, v6
    v_sub_f32 v55, v55, v6
    v_sub_f32 v56, v56, v6
    v_sub_f32 v57, v57, v6
    v_sub_f32 v58, v58, v6
    v_sub_f32 v59, v59, v6
    v_sub_f32 v60, v60, v6
    v_sub_f32 v61, v61, v6
    v_sub_f32 v62, v62, v6
    v_sub_f32 v63, v63, v6
    v_mul_f32 v6, v32, v32
    v_mul_f32 v7, v33, v33
    v_fmac_f32 v6, v34, v34
    v_fmac_f32 v7, v35, v35
    v_fmac_f32 v6, v36, v36
    v_fmac_f32 v7, v37, v37
    v_fmac_f32 v6, v38, v38
    v_fmac_f32 v7, v39, v39
    v_fmac_f32 v6, v40, v40
    v_fmac_f32 v7, v41, v41
    v_fmac_f32 v6, v42, v42
    v_fmac_f32 v7, v43, v43
    v_fmac_f32 v6, v44, v44
    v_fmac_f32 v7, v45, v45
    v_fmac_f32 v6, v46, v46
    v_fmac_f32 v7, v47, v47
    v_fmac_f32 v6, v48, v48
    v_fmac_f32 v7, v49, v49
    v_fmac_f32 v6, v50, v50
    v_fmac_f32 v7, v51, v51
    v_fmac_f32 v6, v52, v52
    v_fmac_f32 v7, v53, v53
    v_fmac_f32 v6, v54, v54
    v_fmac_f32 v7, v55, v55
    v_fmac_f32 v6, v56, v56
    v_fmac_f32 v7, v57, v57
    v_fmac_f32 v6, v58, v58
    v_fmac_f32 v7, v59, v59
    v_fmac_f32 v6, v60, v60
    v_fmac_f32 v7, v61, v61
    v_fmac_f32 v6, v62, v62
    v_fmac_f32 v7, v63, v63
    v_add_f32 v6, v6, v7
    s_nop 1
    v_add_f32_dpp v6, v6, v6 quad_perm:[1,0,3,2] row_mask:0xf bank_mask:0xf
    s_nop 1
    v_add_f32_dpp v6, v6, v6 quad_perm:[2,3,0,1] row_mask:0xf bank_mask:0xf
    s_nop 1
    v_add_f32_dpp v6, v6, v6 row_half_mirror row_mask:0xf bank_mask:0xf
    s_nop 1
    v_add_f32_dpp v6, v6, v6 row_mirror row_mask:0xf bank_mask:0xf
    v_mov_b32 v7, v6
    s_nop 1
    v_permlane16_swap_b32 v6, v7
    v_add_f32 v6, v6, v7
    v_mov_b32 v7, 0x3727c5ac
    v_fmac_f32 v7, 0x3a800000, v6
    v_rsq_f32 v6, v7
    s_nop 0
    v_mul_f32 v32, v32, v6
    v_mul_f32 v33, v33, v6
    v_mul_f32 v34, v34, v6
    v_mul_f32 v35, v35, v6
    v_mul_f32 v36, v36, v6
    v_mul_f32 v37, v37, v6
    v_mul_f32 v38, v38, v6
    v_mul_f32 v39, v39, v6
    v_cvt_pk_f16_f32 v8, v32, v33
    v_cvt_pk_f16_f32 v9, v34, v35
    v_cvt_pk_f16_f32 v10, v36, v37
    v_cvt_pk_f16_f32 v11, v38, v39
    ds_write_b64 v28, v[8:9] offset:0
    ds_write_b64 v28, v[10:11] offset:272
    v_mul_f32 v40, v40, v6
    v_mul_f32 v41, v41, v6
    v_mul_f32 v42, v42, v6
    v_mul_f32 v43, v43, v6
    v_mul_f32 v44, v44, v6
    v_mul_f32 v45, v45, v6
    v_mul_f32 v46, v46, v6
    v_mul_f32 v47, v47, v6
    v_cvt_pk_f16_f32 v12, v40, v41
    v_cvt_pk_f16_f32 v13, v42, v43
    v_cvt_pk_f16_f32 v14, v44, v45
    v_cvt_pk_f16_f32 v15, v46, v47
    ds_write_b64 v28, v[12:13] offset:8704
    ds_write_b64 v28, v[14:15] offset:8976
    v_mul_f32 v48, v48, v6
    v_mul_f32 v49, v49, v6
    v_mul_f32 v50, v50, v6
    v_mul_f32 v51, v51, v6
    v_mul_f32 v52, v52, v6
    v_mul_f32 v53, v53, v6
    v_mul_f32 v54, v54, v6
    v_mul_f32 v55, v55, v6
    v_cvt_pk_f16_f32 v16, v48, v49
    v_cvt_pk_f16_f32 v17, v50, v51
    v_cvt_pk_f16_f32 v18, v52, v53
    v_cvt_pk_f16_f32 v19, v54, v55
    ds_write_b64 v28, v[16:17] offset:17408
    ds_write_b64 v28, v[18:19] offset:17680
    v_mul_f32 v56, v56, v6
    v_mul_f32 v57, v57, v6
    v_mul_f32 v58, v58, v6
    v_mul_f32 v59, v59, v6
    v_mul_f32 v60, v60, v6
    v_mul_f32 v61, v61, v6
    v_mul_f32 v62, v62, v6
    v_mul_f32 v63, v63, v6
    v_cvt_pk_f16_f32 v20, v56, v57
    v_cvt_pk_f16_f32 v21, v58, v59
    v_cvt_pk_f16_f32 v22, v60, v61
    v_cvt_pk_f16_f32 v23, v62, v63
    ds_write_b64 v28, v[20:21] offset:26112
    ds_write_b64 v28, v[22:23] offset:26384
    s_waitcnt lgkmcnt(0)
    s_barrier
    ds_read_b128 v[32:35], v27 offset:0
    ds_read_b128 v[36:39], v27 offset:8704
    ds_read_b128 v[40:43], v27 offset:17408
    ds_read_b128 v[44:47], v27 offset:26112
    s_mov_b32 s25, 0
    s_waitcnt lgkmcnt(3)
    buffer_store_dwordx4 v[32:35], v25, s[12:15], s25 offen sc1
    s_mov_b32 s25, 1212416
    s_waitcnt lgkmcnt(2)
    buffer_store_dwordx4 v[36:39], v25, s[12:15], s25 offen sc1
    s_mov_b32 s25, 2424832
    s_waitcnt lgkmcnt(1)
    buffer_store_dwordx4 v[40:43], v25, s[12:15], s25 offen sc1
    s_mov_b32 s25, 3637248
    s_waitcnt lgkmcnt(0)
    buffer_store_dwordx4 v[44:47], v25, s[12:15], s25 offen sc1
    s_waitcnt vmcnt(5)
    s_add_u32 s20, s44, 1048576
    s_addc_u32 s21, s45, 0
    s_mov_b32 s22, 1572864
    s_mov_b32 s23, 0x20000
    buffer_store_dwordx4 v[68:71], v64, s[20:23], 0 offen sc1
    s_add_u32 s20, s44, 2621440
    s_addc_u32 s21, s45, 0
    s_mov_b32 s22, 524288
    s_mov_b32 s23, 0x20000
    buffer_store_dwordx4 v[88:91], v84, s[20:23], 0 offen sc1
pre_kernel_end:
    s_endpgm
.text
.globl mlp_kernel
.p2align 8
.type mlp_kernel,@function
mlp_kernel:
    s_cmp_ge_u32 s2, 256
    s_cbranch_scc1 mlp_kernel_end
    s_load_dwordx2 s[38:39], s[0:1], 88
    s_load_dwordx2 s[60:61], s[0:1], 8
    s_load_dwordx2 s[62:63], s[0:1], 0
    v_lshrrev_b32 v2, 6, v0
    v_and_b32 v1, 63, v0
    v_readfirstlane_b32 s26, v2
    s_and_b32 s32, s2, 7
    s_lshr_b32 s33, s2, 3
    s_lshr_b32 s34, s32, 2
    s_and_b32 s35, s32, 3
    s_and_b32 s40, s33, 7
    s_lshr_b32 s41, s33, 3
    s_mul_i32 s34, s34, 8
    s_add_u32 s40, s40, s34
    s_mul_i32 s35, s35, 4
    s_add_u32 s41, s41, s35
    s_lshl_b32 s42, s40, 2
    s_add_u32 s42, s42, s26
    s_mul_i32 s42, s42, 1
    s_lshl_b32 s56, s41, 2
    s_add_u32 s56, s56, s26
    s_mul_i32 s57, s56, 75776
    s_lshl_b32 s56, s56, 6
    v_lshrrev_b32 v24, 5, v1
    v_lshl_add_u32 v24, v24, 4, s56
    s_lshl_b32 s58, s40, 2
    s_add_u32 s33, s58, 0
    v_lshrrev_b32 v16, 3, v1
    v_lshl_add_u32 v16, s33, 3, v16
    v_mul_u32_u24 v17, 9363, v16
    v_lshrrev_b32 v17, 16, v17
    v_add_u32 v20, v16, v17
    v_mul_u32_u24 v17, 7, v17
    v_sub_u32 v17, v16, v17
    v_add_u32 v17, 5, v17
    v_lshrrev_b32 v17, 3, v17
    v_add_lshl_u32 v20, v20, v17, 7
    v_and_b32 v16, 7, v1
    v_lshl_add_u32 v20, v16, 4, v20
    s_add_u32 s33, s58, 1
    v_lshrrev_b32 v16, 3, v1
    v_lshl_add_u32 v16, s33, 3, v16
    v_mul_u32_u24 v17, 9363, v16
    v_lshrrev_b32 v17, 16, v17
    v_add_u32 v21, v16, v17
    v_mul_u32_u24 v17, 7, v17
    v_sub_u32 v17, v16, v17
    v_add_u32 v17, 5, v17
    v_lshrrev_b32 v17, 3, v17
    v_add_lshl_u32 v21, v21, v17, 7
    v_and_b32 v16, 7, v1
    v_lshl_add_u32 v21, v16, 4, v21
    s_add_u32 s33, s58, 2
    v_lshrrev_b32 v16, 3, v1
    v_lshl_add_u32 v16, s33, 3, v16
    v_mul_u32_u24 v17, 9363, v16
    v_lshrrev_b32 v17, 16, v17
    v_add_u32 v22, v16, v17
    v_mul_u32_u24 v17, 7, v17
    v_sub_u32 v17, v16, v17
    v_add_u32 v17, 5, v17
    v_lshrrev_b32 v17, 3, v17
    v_add_lshl_u32 v22, v22, v17, 7
    v_and_b32 v16, 7, v1
    v_lshl_add_u32 v22, v16, 4, v22
    s_add_u32 s33, s58, 3
    v_lshrrev_b32 v16, 3, v1
    v_lshl_add_u32 v16, s33, 3, v16
    v_mul_u32_u24 v17, 9363, v16
    v_lshrrev_b32 v17, 16, v17
    v_add_u32 v23, v16, v17
    v_mul_u32_u24 v17, 7, v17
    v_sub_u32 v17, v16, v17
    v_add_u32 v17, 5, v17
    v_lshrrev_b32 v17, 3, v17
    v_add_lshl_u32 v23, v23, v17, 7
    v_and_b32 v16, 7, v1
    v_lshl_add_u32 v23, v16, 4, v23
    s_waitcnt lgkmcnt(0)
    s_add_u32 s12, s38, 5242880
    s_addc_u32 s13, s39, 0
    s_mov_b32 s14, 4849664
    s_mov_b32 s15, 0x20000
    s_mov_b32 s20, s38
    s_mov_b32 s21, s39
    s_mov_b32 s22, 49152
    s_mov_b32 s23, 0x20000
    s_mov_b32 s32, 4096
    buffer_load_dwordx4 v[144:147], v24, s[20:23], s32 offen offset:0
    buffer_load_dwordx4 v[148:151], v24, s[20:23], s32 offen offset:32
    s_mov_b32 s32, 0
    buffer_load_dwordx4 v[152:155], v24, s[20:23], s32 offen offset:0
    buffer_load_dwordx4 v[156:159], v24, s[20:23], s32 offen offset:32
    s_mov_b32 s32, 28672
    buffer_load_dwordx4 v[160:163], v24, s[20:23], s32 offen offset:0
    buffer_load_dwordx4 v[164:167], v24, s[20:23], s32 offen offset:32
    s_mov_b32 s32, 24576
    buffer_load_dwordx4 v[168:171], v24, s[20:23], s32 offen offset:0
    buffer_load_dwordx4 v[172:175], v24, s[20:23], s32 offen offset:32
    buffer_load_dwordx4 v[128:131], v20, s[12:15], s57 offen
    buffer_load_dwordx4 v[132:135], v21, s[12:15], s57 offen
    buffer_load_dwordx4 v[136:139], v22, s[12:15], s57 offen
    buffer_load_dwordx4 v[140:143], v23, s[12:15], s57 offen
    s_and_b32 s32, s41, 7
    s_lshr_b32 s33, s41, 3
    s_mul_i32 s33, s33, 768
    s_lshl_b32 s34, s41, 7
    s_mov_b32 s35, 6144
    s_mov_b32 s43, 2048
    s_cmp_eq_u32 s32, 3
    s_cselect_b32 s33, s33, s34
    s_cselect_b32 s35, 1536, s35
    s_cselect_b32 s43, 256, s43
    s_lshl_b32 s47, s35, 6
    s_lshl_b32 s34, s35, 3
    s_lshl_b32 s32, s26, 4
    v_lshrrev_b32 v16, 3, v1
    v_and_b32 v17, 7, v1
    v_and_b32 v18, 6, v16
    v_xor_b32 v17, v17, v18
    v_add_u32 v16, s32, v16
    v_mul_lo_u32 v16, v16, s35
    v_lshl_add_u32 v16, v17, 4, v16
    v_add_u32 v3, s33, v16
    v_add_u32 v4, s34, v3
    v_add_u32 v5, s43, v3
    v_add_u32 v6, s43, v4
    v_add_u32 v7, s43, v5
    v_add_u32 v8, s43, v6
    s_lshl_b32 s45, s26, 11
    s_add_u32 s45, s45, 0
    s_mov_b32 s43, 0
    s_add_u32 s44, s45, 0
    s_add_u32 s46, s45, 98304
    s_add_u32 s32, s38, 1048576
    s_addc_u32 s33, s39, 0
    s_cmp_eq_u32 s47, 98304
    s_cselect_b32 s8, s32, s60
    s_cselect_b32 s9, s33, s61
    s_mul_i32 s10, s47, 16
    s_mov_b32 s11, 0x20000
    s_add_u32 m0, s44, 0
    s_nop 0
    buffer_load_dwordx4 v3, s[8:11], s43 offen lds
    s_add_u32 m0, s44, 1024
    s_nop 0
    buffer_load_dwordx4 v4, s[8:11], s43 offen lds
    s_add_u32 m0, s44, 8192
    s_nop 0
    buffer_load_dwordx4 v5, s[8:11], s43 offen lds
    s_add_u32 m0, s44, 9216
    s_nop 0
    buffer_load_dwordx4 v6, s[8:11], s43 offen lds
    s_add_u32 m0, s44, 16384
    s_nop 0
    buffer_load_dwordx4 v7, s[8:11], s43 offen lds
    s_add_u32 m0, s44, 17408
    s_nop 0
    buffer_load_dwordx4 v8, s[8:11], s43 offen lds
    s_add_u32 s43, s43, s47
    s_add_u32 s44, s44, 24576
    s_cmp_eq_u32 s44, s46
    s_cselect_b32 s44, s45, s44
    s_add_u32 s16, s38, 28311552
    s_addc_u32 s17, s39, 0
    s_mov_b32 s18, 4849664
    s_mov_b32 s19, 0x20000
    s_waitcnt vmcnt(10)
    v_add_f32 v144, v144, v160
    v_add_f32 v145, v145, v161
    v_add_f32 v146, v146, v162
    v_add_f32 v147, v147, v163
    v_add_f32 v148, v148, v164
    v_add_f32 v149, v149, v165
    v_add_f32 v150, v150, v166
    v_add_f32 v151, v151, v167
    v_add_f32 v152, v152, v168
    v_add_f32 v153, v153, v169
    v_add_f32 v154, v154, v170
    v_add_f32 v155, v155, v171
    v_add_f32 v156, v156, v172
    v_add_f32 v157, v157, v173
    v_add_f32 v158, v158, v174
    v_add_f32 v159, v159, v175
    v_cvt_pk_bf16_f32 v160, v144, v145
    v_cvt_pk_bf16_f32 v161, v146, v147
    v_cvt_pk_bf16_f32 v162, v148, v149
    v_cvt_pk_bf16_f32 v163, v150, v151
    v_cvt_pk_bf16_f32 v164, v152, v153
    v_cvt_pk_bf16_f32 v165, v154, v155
    v_cvt_pk_bf16_f32 v166, v156, v157
    v_cvt_pk_bf16_f32 v167, v158, v159
    v_lshlrev_b32 v144, 16, v160
    v_and_b32 v145, 0xffff0000, v160
    v_lshlrev_b32 v146, 16, v161
    v_and_b32 v147, 0xffff0000, v161
    v_lshlrev_b32 v148, 16, v162
    v_and_b32 v149, 0xffff0000, v162
    v_lshlrev_b32 v150, 16, v163
    v_and_b32 v151, 0xffff0000, v163
    v_lshlrev_b32 v152, 16, v164
    v_and_b32 v153, 0xffff0000, v164
    v_lshlrev_b32 v154, 16, v165
    v_and_b32 v155, 0xffff0000, v165
    v_lshlrev_b32 v156, 16, v166
    v_and_b32 v157, 0xffff0000, v166
    v_lshlrev_b32 v158, 16, v167
    v_and_b32 v159, 0xffff0000, v167
    v_add_f32 v144, 1.0, v144
    v_add_f32 v145, 1.0, v145
    v_add_f32 v146, 1.0, v146
    v_add_f32 v147, 1.0, v147
    v_add_f32 v148, 1.0, v148
    v_add_f32 v149, 1.0, v149
    v_add_f32 v150, 1.0, v150
    v_add_f32 v151, 1.0, v151
    v_cvt_pk_bf16_f32 v160, v144, v145
    v_cvt_pk_bf16_f32 v161, v146, v147
    v_cvt_pk_bf16_f32 v162, v148, v149
    v_cvt_pk_bf16_f32 v163, v150, v151
    v_lshlrev_b32 v144, 16, v160
    v_and_b32 v145, 0xffff0000, v160
    v_lshlrev_b32 v146, 16, v161
    v_and_b32 v147, 0xffff0000, v161
    v_lshlrev_b32 v148, 16, v162
    v_and_b32 v149, 0xffff0000, v162
    v_lshlrev_b32 v150, 16, v163
    v_and_b32 v151, 0xffff0000, v163
    s_waitcnt vmcnt(9)
    v_fma_mix_f32 v176, v128, v144, v152 op_sel_hi:[1,0,0]
    v_fma_mix_f32 v177, v128, v145, v153 op_sel:[1,0,0] op_sel_hi:[1,0,0]
    v_fma_mix_f32 v178, v129, v146, v154 op_sel_hi:[1,0,0]
    v_fma_mix_f32 v179, v129, v147, v155 op_sel:[1,0,0] op_sel_hi:[1,0,0]
    v_fma_mix_f32 v180, v130, v148, v156 op_sel_hi:[1,0,0]
    v_fma_mix_f32 v181, v130, v149, v157 op_sel:[1,0,0] op_sel_hi:[1,0,0]
    v_fma_mix_f32 v182, v131, v150, v158 op_sel_hi:[1,0,0]
    v_fma_mix_f32 v183, v131, v151, v159 op_sel:[1,0,0] op_sel_hi:[1,0,0]
    v_cvt_pk_bf16_f32 v184, v176, v177
    v_cvt_pk_bf16_f32 v185, v178, v179
    v_cvt_pk_bf16_f32 v186, v180, v181
    v_cvt_pk_bf16_f32 v187, v182, v183
    buffer_store_dwordx4 v[184:187], v20, s[16:19], s57 offen sc1
    s_waitcnt vmcnt(9)
    v_fma_mix_f32 v176, v132, v144, v152 op_sel_hi:[1,0,0]
    v_fma_mix_f32 v177, v132, v145, v153 op_sel:[1,0,0] op_sel_hi:[1,0,0]
    v_fma_mix_f32 v178, v133, v146, v154 op_sel_hi:[1,0,0]
    v_fma_mix_f32 v179, v133, v147, v155 op_sel:[1,0,0] op_sel_hi:[1,0,0]
    v_fma_mix_f32 v180, v134, v148, v156 op_sel_hi:[1,0,0]
    v_fma_mix_f32 v181, v134, v149, v157 op_sel:[1,0,0] op_sel_hi:[1,0,0]
    v_fma_mix_f32 v182, v135, v150, v158 op_sel_hi:[1,0,0]
    v_fma_mix_f32 v183, v135, v151, v159 op_sel:[1,0,0] op_sel_hi:[1,0,0]
    v_cvt_pk_bf16_f32 v188, v176, v177
    v_cvt_pk_bf16_f32 v189, v178, v179
    v_cvt_pk_bf16_f32 v190, v180, v181
    v_cvt_pk_bf16_f32 v191, v182, v183
    buffer_store_dwordx4 v[188:191], v21, s[16:19], s57 offen sc1
    s_waitcnt vmcnt(9)
    v_fma_mix_f32 v176, v136, v144, v152 op_sel_hi:[1,0,0]
    v_fma_mix_f32 v177, v136, v145, v153 op_sel:[1,0,0] op_sel_hi:[1,0,0]
    v_fma_mix_f32 v178, v137, v146, v154 op_sel_hi:[1,0,0]
    v_fma_mix_f32 v179, v137, v147, v155 op_sel:[1,0,0] op_sel_hi:[1,0,0]
    v_fma_mix_f32 v180, v138, v148, v156 op_sel_hi:[1,0,0]
    v_fma_mix_f32 v181, v138, v149, v157 op_sel:[1,0,0] op_sel_hi:[1,0,0]
    v_fma_mix_f32 v182, v139, v150, v158 op_sel_hi:[1,0,0]
    v_fma_mix_f32 v183, v139, v151, v159 op_sel:[1,0,0] op_sel_hi:[1,0,0]
    v_cvt_pk_bf16_f32 v192, v176, v177
    v_cvt_pk_bf16_f32 v193, v178, v179
    v_cvt_pk_bf16_f32 v194, v180, v181
    v_cvt_pk_bf16_f32 v195, v182, v183
    buffer_store_dwordx4 v[192:195], v22, s[16:19], s57 offen sc1
    s_waitcnt vmcnt(9)
    v_fma_mix_f32 v176, v140, v144, v152 op_sel_hi:[1,0,0]
    v_fma_mix_f32 v177, v140, v145, v153 op_sel:[1,0,0] op_sel_hi:[1,0,0]
    v_fma_mix_f32 v178, v141, v146, v154 op_sel_hi:[1,0,0]
    v_fma_mix_f32 v179, v141, v147, v155 op_sel:[1,0,0] op_sel_hi:[1,0,0]
    v_fma_mix_f32 v180, v142, v148, v156 op_sel_hi:[1,0,0]
    v_fma_mix_f32 v181, v142, v149, v157 op_sel:[1,0,0] op_sel_hi:[1,0,0]
    v_fma_mix_f32 v182, v143, v150, v158 op_sel_hi:[1,0,0]
    v_fma_mix_f32 v183, v143, v151, v159 op_sel:[1,0,0] op_sel_hi:[1,0,0]
    v_cvt_pk_bf16_f32 v196, v176, v177
    v_cvt_pk_bf16_f32 v197, v178, v179
    v_cvt_pk_bf16_f32 v198, v180, v181
    v_cvt_pk_bf16_f32 v199, v182, v183
    buffer_store_dwordx4 v[196:199], v23, s[16:19], s57 offen sc1
    s_lshl_b32 s57, s40, 4
    s_add_u32 s57, s57, 2048
    s_add_u32 s56, s57, s41
    v_bfe_u32 v18, v1, 4, 1
    v_bfe_u32 v19, v1, 3, 1
    v_lshl_add_u32 v18, v18, 2, v19
    s_lshl_b32 s32, s42, 3
    v_add_u32 v18, s32, v18
    v_lshrrev_b32 v19, 5, v1
    v_mul_u32_u24 v19, 75776, v19
    v_and_b32 v16, 7, v1
    v_lshl_add_u32 v19, v16, 4, v19
    v_add_u32 v16, 0, v18
    v_mul_u32_u24 v17, 9363, v16
    v_lshrrev_b32 v17, 16, v17
    v_add_u32 v14, v16, v17
    v_mul_u32_u24 v17, 7, v17
    v_sub_u32 v17, v16, v17
    v_add_u32 v17, 5, v17
    v_lshrrev_b32 v17, 3, v17
    v_add_lshl_u32 v14, v14, v17, 7
    v_add_u32 v14, v14, v19
    v_add_u32 v16, 2, v18
    v_mul_u32_u24 v17, 9363, v16
    v_lshrrev_b32 v17, 16, v17
    v_add_u32 v15, v16, v17
    v_mul_u32_u24 v17, 7, v17
    v_sub_u32 v17, v16, v17
    v_add_u32 v17, 5, v17
    v_lshrrev_b32 v17, 3, v17
    v_add_lshl_u32 v15, v15, v17, 7
    v_add_u32 v15, v15, v19
    s_mov_b32 s27, 0
    s_add_u32 s4, s38, 28311552
    s_addc_u32 s5, s39, 0
    s_mov_b32 s6, 4849664
    s_mov_b32 s7, 0x20000
    s_add_u32 s12, s38, 720896
    s_addc_u32 s13, s39, 0
    s_mov_b32 s14, 294912
    s_mov_b32 s15, 0x20000
    s_lshl_b32 s32, s56, 7
    s_lshl_b32 s59, s57, 7
    v_mov_b32 v30, 1
    v_mov_b32 v31, s32
    s_waitcnt vmcnt(0)
    s_barrier
    s_cmp_lg_u32 s26, 0
    s_cbranch_scc1 hl_nf
    s_mov_b64 exec, 1
    buffer_store_dword v30, v31, s[12:15], 0 offen sc1
    s_mov_b64 exec, -1
hl_nf:
    s_add_u32 m0, s44, 0
    s_nop 0
    buffer_load_dwordx4 v3, s[8:11], s43 offen lds
    s_add_u32 m0, s44, 1024
    s_nop 0
    buffer_load_dwordx4 v4, s[8:11], s43 offen lds
    s_add_u32 m0, s44, 8192
    s_nop 0
    buffer_load_dwordx4 v5, s[8:11], s43 offen lds
    s_add_u32 m0, s44, 9216
    s_nop 0
    buffer_load_dwordx4 v6, s[8:11], s43 offen lds
    s_add_u32 m0, s44, 16384
    s_nop 0
    buffer_load_dwordx4 v7, s[8:11], s43 offen lds
    s_add_u32 m0, s44, 17408
    s_nop 0
    buffer_load_dwordx4 v8, s[8:11], s43 offen lds
    s_add_u32 s43, s43, s47
    s_add_u32 s44, s44, 24576
    s_cmp_eq_u32 s44, s46
    s_cselect_b32 s44, s45, s44
    v_lshrrev_b32 v16, 5, v1
    v_bfe_u32 v17, v1, 2, 3
    v_lshl_add_u32 v16, v16, 4, v17
    v_and_b32 v18, 3, v1
    v_lshlrev_b32 v16, 7, v16
    v_lshl_add_u32 v16, v18, 3, v16
    v_lshrrev_b32 v17, 1, v17
    v_lshl_add_u32 v9, v17, 5, v16
    s_mov_b32 s37, 73728
    s_getpc_b64 s[68:69]
mlp_kernel_pc1:
    s_add_u32 s68, s68, qkv_epi-mlp_kernel_pc1
    s_addc_u32 s69, s69, 0
    s_mov_b32 s70, mlp_kernel_end-qkv_epi+4
    s_cmp_lt_u32 s2, 256
    s_cselect_b32 s70, s70, 0
    s_mov_b32 s71, 0x20000
    s_lshr_b32 s32, s2, 3
    s_lshl_b32 s32, s32, 2
    s_add_u32 s32, s32, s26
    s_lshl_b32 s32, s32, 9
    v_lshrrev_b32 v2, 2, v1
    v_lshlrev_b32 v2, 20, v2
    v_lshl_add_u32 v2, v1, 7, v2
    v_add_u32 v2, s32, v2
    s_add_u32 s37, s37, 24576
    s_cmp_eq_u32 s37, 98304
    s_cselect_b32 s37, 0, s37
    v_add_u32 v10, s37, v9
    v_xor_b32 v11, 32, v10
    v_xor_b32 v12, 64, v10
    v_xor_b32 v13, 96, v10
    ds_read_b64_tr_b16 v[120:121], v10 offset:0
    ds_read_b64_tr_b16 v[122:123], v10 offset:1024
    ds_read_b64_tr_b16 v[124:125], v11 offset:0
    ds_read_b64_tr_b16 v[126:127], v11 offset:1024
    ds_read_b64_tr_b16 v[128:129], v12 offset:0
    ds_read_b64_tr_b16 v[130:131], v12 offset:1024
    ds_read_b64_tr_b16 v[132:133], v13 offset:0
    ds_read_b64_tr_b16 v[134:135], v13 offset:1024
    ds_read_b64_tr_b16 v[136:137], v10 offset:8192
    ds_read_b64_tr_b16 v[138:139], v10 offset:9216
    ds_read_b64_tr_b16 v[140:141], v11 offset:8192
    ds_read_b64_tr_b16 v[142:143], v11 offset:9216
    ds_read_b64_tr_b16 v[144:145], v12 offset:8192
    ds_read_b64_tr_b16 v[146:147], v12 offset:9216
    ds_read_b64_tr_b16 v[148:149], v13 offset:8192
    ds_read_b64_tr_b16 v[150:151], v13 offset:9216
    ds_read_b64_tr_b16 v[152:153], v10 offset:16384
    ds_read_b64_tr_b16 v[154:155], v10 offset:17408
    ds_read_b64_tr_b16 v[156:157], v11 offset:16384
    ds_read_b64_tr_b16 v[158:159], v11 offset:17408
    ds_read_b64_tr_b16 v[160:161], v12 offset:16384
    ds_read_b64_tr_b16 v[162:163], v12 offset:17408
    ds_read_b64_tr_b16 v[164:165], v13 offset:16384
    ds_read_b64_tr_b16 v[166:167], v13 offset:17408
    s_cmp_lg_u32 s26, 0
    s_cbranch_scc1 hl_go
    v_and_b32 v30, 15, v1
    v_lshlrev_b32 v30, 7, v30
    v_add_u32 v30, s59, v30
hl_poll:
    buffer_load_dword v31, v30, s[12:15], 0 offen sc1
    s_waitcnt vmcnt(0)
    v_cmp_eq_u32 vcc, 1, v31
    s_cmp_eq_u64 vcc, -1
    s_cbranch_scc0 hl_poll
hl_go:
    s_waitcnt vmcnt(0)
    s_barrier
    buffer_load_dwordx4 v[168:171], v14, s[4:7], s27 offen sc1
    buffer_load_dwordx4 v[172:175], v15, s[4:7], s27 offen sc1
    s_add_u32 s27, s27, 151552
    buffer_load_dwordx4 v[176:179], v14, s[4:7], s27 offen sc1
    buffer_load_dwordx4 v[180:183], v15, s[4:7], s27 offen sc1
    s_add_u32 s27, s27, 151552
    s_waitcnt vmcnt(2) lgkmcnt(12)
    v_mfma_f32_16x16x32_bf16 v[24:27], v[120:123], v[168:171], 0
    buffer_load_dwordx4 v[184:187], v14, s[4:7], s27 offen sc1
    v_mfma_f32_16x16x32_bf16 v[28:31], v[120:123], v[172:175], 0
    buffer_load_dwordx4 v[188:191], v15, s[4:7], s27 offen sc1
    v_mfma_f32_16x16x32_bf16 v[32:35], v[124:127], v[168:171], 0
    ds_read_b64_tr_b16 v[120:121], v10 offset:4096
    s_add_u32 s27, s27, 151552
    v_mfma_f32_16x16x32_bf16 v[36:39], v[124:127], v[172:175], 0
    ds_read_b64_tr_b16 v[122:123], v10 offset:5120
    s_add_u32 m0, s44, 0
    v_mfma_f32_16x16x32_bf16 v[40:43], v[128:131], v[168:171], 0
    ds_read_b64_tr_b16 v[124:125], v11 offset:4096
    buffer_load_dwordx4 v3, s[8:11], s43 offen lds
    v_mfma_f32_16x16x32_bf16 v[44:47], v[128:131], v[172:175], 0
    ds_read_b64_tr_b16 v[126:127], v11 offset:5120
    v_mfma_f32_16x16x32_bf16 v[48:51], v[132:135], v[168:171], 0
    ds_read_b64_tr_b16 v[128:129], v12 offset:4096
    s_add_u32 m0, s44, 1024
    v_mfma_f32_16x16x32_bf16 v[52:55], v[132:135], v[172:175], 0
    ds_read_b64_tr_b16 v[130:131], v12 offset:5120
    buffer_load_dwordx4 v4, s[8:11], s43 offen lds
    v_mfma_f32_16x16x32_bf16 v[56:59], v[136:139], v[168:171], 0
    ds_read_b64_tr_b16 v[132:133], v13 offset:4096
    s_add_u32 m0, s44, 8192
    v_mfma_f32_16x16x32_bf16 v[60:63], v[136:139], v[172:175], 0
    ds_read_b64_tr_b16 v[134:135], v13 offset:5120
    buffer_load_dwordx4 v5, s[8:11], s43 offen lds
    v_mfma_f32_16x16x32_bf16 v[64:67], v[140:143], v[168:171], 0
    ds_read_b64_tr_b16 v[136:137], v10 offset:12288
    s_add_u32 m0, s44, 9216
    v_mfma_f32_16x16x32_bf16 v[68:71], v[140:143], v[172:175], 0
    s_waitcnt lgkmcnt(9)
    ds_read_b64_tr_b16 v[138:139], v10 offset:13312
    v_mfma_f32_16x16x32_bf16 v[72:75], v[144:147], v[168:171], 0
    ds_read_b64_tr_b16 v[140:141], v11 offset:12288
    buffer_load_dwordx4 v6, s[8:11], s43 offen lds
    v_mfma_f32_16x16x32_bf16 v[76:79], v[144:147], v[172:175], 0
    ds_read_b64_tr_b16 v[142:143], v11 offset:13312
    s_add_u32 m0, s44, 16384
    v_mfma_f32_16x16x32_bf16 v[80:83], v[148:151], v[168:171], 0
    ds_read_b64_tr_b16 v[144:145], v12 offset:12288
    buffer_load_dwordx4 v7, s[8:11], s43 offen lds
    v_mfma_f32_16x16x32_bf16 v[84:87], v[148:151], v[172:175], 0
    ds_read_b64_tr_b16 v[146:147], v12 offset:13312
    s_add_u32 m0, s44, 17408
    v_mfma_f32_16x16x32_bf16 v[88:91], v[168:171], v[152:155], 0
    ds_read_b64_tr_b16 v[148:149], v13 offset:12288
    buffer_load_dwordx4 v8, s[8:11], s43 offen lds
    v_mfma_f32_16x16x32_bf16 v[92:95], v[172:175], v[152:155], 0
    ds_read_b64_tr_b16 v[150:151], v13 offset:13312
    v_mfma_f32_16x16x32_bf16 v[96:99], v[168:171], v[156:159], 0
    ds_read_b64_tr_b16 v[152:153], v10 offset:20480
    s_add_u32 s43, s43, s47
    v_mfma_f32_16x16x32_bf16 v[100:103], v[172:175], v[156:159], 0
    ds_read_b64_tr_b16 v[154:155], v10 offset:21504
    s_add_u32 s44, s44, 24576
    v_mfma_f32_16x16x32_bf16 v[104:107], v[168:171], v[160:163], 0
    ds_read_b64_tr_b16 v[156:157], v11 offset:20480
    s_cmp_eq_u32 s44, s46
    s_cselect_b32 s44, s45, s44
    v_mfma_f32_16x16x32_bf16 v[108:111], v[172:175], v[160:163], 0
    ds_read_b64_tr_b16 v[158:159], v11 offset:21504
    s_add_u32 s37, s37, 24576
    v_mfma_f32_16x16x32_bf16 v[112:115], v[168:171], v[164:167], 0
    ds_read_b64_tr_b16 v[160:161], v12 offset:20480
    s_cmp_eq_u32 s37, 98304
    s_cselect_b32 s37, 0, s37
    v_mfma_f32_16x16x32_bf16 v[116:119], v[172:175], v[164:167], 0
    s_waitcnt vmcnt(8) lgkmcnt(9)
    ds_read_b64_tr_b16 v[162:163], v12 offset:21504
    v_mfma_f32_16x16x32_bf16 v[24:27], v[120:123], v[176:179], v[24:27]
    ds_read_b64_tr_b16 v[164:165], v13 offset:20480
    v_mfma_f32_16x16x32_bf16 v[28:31], v[120:123], v[180:183], v[28:31]
    ds_read_b64_tr_b16 v[166:167], v13 offset:21504
    s_barrier
    v_add_u32 v10, s37, v9
    v_xor_b32 v11, 32, v10
    v_xor_b32 v12, 64, v10
    v_xor_b32 v13, 96, v10
    v_mfma_f32_16x16x32_bf16 v[32:35], v[124:127], v[176:179], v[32:35]
    ds_read_b64_tr_b16 v[120:121], v10 offset:0
    v_mfma_f32_16x16x32_bf16 v[36:39], v[124:127], v[180:183], v[36:39]
    ds_read_b64_tr_b16 v[122:123], v10 offset:1024
    buffer_load_dwordx4 v[192:195], v14, s[4:7], s27 offen sc1
    v_mfma_f32_16x16x32_bf16 v[40:43], v[128:131], v[176:179], v[40:43]
    ds_read_b64_tr_b16 v[124:125], v11 offset:0
    buffer_load_dwordx4 v[196:199], v15, s[4:7], s27 offen sc1
    v_mfma_f32_16x16x32_bf16 v[44:47], v[128:131], v[180:183], v[44:47]
    ds_read_b64_tr_b16 v[126:127], v11 offset:1024
    v_mfma_f32_16x16x32_bf16 v[48:51], v[132:135], v[176:179], v[48:51]
    ds_read_b64_tr_b16 v[128:129], v12 offset:0
    s_add_u32 s27, s27, 151552
    v_mfma_f32_16x16x32_bf16 v[52:55], v[132:135], v[180:183], v[52:55]
    ds_read_b64_tr_b16 v[130:131], v12 offset:1024
    v_mfma_f32_16x16x32_bf16 v[56:59], v[136:139], v[176:179], v[56:59]
    ds_read_b64_tr_b16 v[132:133], v13 offset:0
    buffer_load_dwordx4 v[168:171], v14, s[4:7], s27 offen sc1
    v_mfma_f32_16x16x32_bf16 v[60:63], v[136:139], v[180:183], v[60:63]
    ds_read_b64_tr_b16 v[134:135], v13 offset:1024
    v_mfma_f32_16x16x32_bf16 v[64:67], v[140:143], v[176:179], v[64:67]
    ds_read_b64_tr_b16 v[136:137], v10 offset:8192
    buffer_load_dwordx4 v[172:175], v15, s[4:7], s27 offen sc1
    v_mfma_f32_16x16x32_bf16 v[68:71], v[140:143], v[180:183], v[68:71]
    s_waitcnt lgkmcnt(9)
    ds_read_b64_tr_b16 v[138:139], v10 offset:9216
    s_add_u32 s27, s27, 151552
    v_mfma_f32_16x16x32_bf16 v[72:75], v[144:147], v[176:179], v[72:75]
    ds_read_b64_tr_b16 v[140:141], v11 offset:8192
    v_mfma_f32_16x16x32_bf16 v[76:79], v[144:147], v[180:183], v[76:79]
    ds_read_b64_tr_b16 v[142:143], v11 offset:9216
    s_add_u32 m0, s44, 0
    v_mfma_f32_16x16x32_bf16 v[80:83], v[148:151], v[176:179], v[80:83]
    ds_read_b64_tr_b16 v[144:145], v12 offset:8192
    v_mfma_f32_16x16x32_bf16 v[84:87], v[148:151], v[180:183], v[84:87]
    ds_read_b64_tr_b16 v[146:147], v12 offset:9216
    buffer_load_dwordx4 v3, s[8:11], s43 offen lds
    v_mfma_f32_16x16x32_bf16 v[88:91], v[176:179], v[152:155], v[88:91]
    ds_read_b64_tr_b16 v[148:149], v13 offset:8192
    v_mfma_f32_16x16x32_bf16 v[92:95], v[180:183], v[152:155], v[92:95]
    ds_read_b64_tr_b16 v[150:151], v13 offset:9216
    s_add_u32 m0, s44, 1024
    v_mfma_f32_16x16x32_bf16 v[96:99], v[176:179], v[156:159], v[96:99]
    ds_read_b64_tr_b16 v[152:153], v10 offset:16384
    buffer_load_dwordx4 v4, s[8:11], s43 offen lds
    v_mfma_f32_16x16x32_bf16 v[100:103], v[180:183], v[156:159], v[100:103]
    ds_read_b64_tr_b16 v[154:155], v10 offset:17408
    v_mfma_f32_16x16x32_bf16 v[104:107], v[176:179], v[160:163], v[104:107]
    ds_read_b64_tr_b16 v[156:157], v11 offset:16384
    s_add_u32 m0, s44, 8192
    v_mfma_f32_16x16x32_bf16 v[108:111], v[180:183], v[160:163], v[108:111]
    ds_read_b64_tr_b16 v[158:159], v11 offset:17408
    v_mfma_f32_16x16x32_bf16 v[112:115], v[176:179], v[164:167], v[112:115]
    ds_read_b64_tr_b16 v[160:161], v12 offset:16384
    buffer_load_dwordx4 v5, s[8:11], s43 offen lds
    v_mfma_f32_16x16x32_bf16 v[116:119], v[180:183], v[164:167], v[116:119]
    s_waitcnt vmcnt(13) lgkmcnt(9)
    ds_read_b64_tr_b16 v[162:163], v12 offset:17408
    v_mfma_f32_16x16x32_bf16 v[24:27], v[120:123], v[184:187], v[24:27]
    ds_read_b64_tr_b16 v[164:165], v13 offset:16384
    s_add_u32 m0, s44, 9216
    v_mfma_f32_16x16x32_bf16 v[28:31], v[120:123], v[188:191], v[28:31]
    ds_read_b64_tr_b16 v[166:167], v13 offset:17408
    buffer_load_dwordx4 v6, s[8:11], s43 offen lds
    v_mfma_f32_16x16x32_bf16 v[32:35], v[124:127], v[184:187], v[32:35]
    ds_read_b64_tr_b16 v[120:121], v10 offset:4096
    v_mfma_f32_16x16x32_bf16 v[36:39], v[124:127], v[188:191], v[36:39]
    ds_read_b64_tr_b16 v[122:123], v10 offset:5120
    s_add_u32 m0, s44, 16384
    v_mfma_f32_16x16x32_bf16 v[40:43], v[128:131], v[184:187], v[40:43]
    ds_read_b64_tr_b16 v[124:125], v11 offset:4096
    v_mfma_f32_16x16x32_bf16 v[44:47], v[128:131], v[188:191], v[44:47]
    ds_read_b64_tr_b16 v[126:127], v11 offset:5120
    buffer_load_dwordx4 v7, s[8:11], s43 offen lds
    v_mfma_f32_16x16x32_bf16 v[48:51], v[132:135], v[184:187], v[48:51]
    ds_read_b64_tr_b16 v[128:129], v12 offset:4096
    s_add_u32 m0, s44, 17408
    v_mfma_f32_16x16x32_bf16 v[52:55], v[132:135], v[188:191], v[52:55]
    ds_read_b64_tr_b16 v[130:131], v12 offset:5120
    v_mfma_f32_16x16x32_bf16 v[56:59], v[136:139], v[184:187], v[56:59]
    ds_read_b64_tr_b16 v[132:133], v13 offset:4096
    buffer_load_dwordx4 v8, s[8:11], s43 offen lds
    v_mfma_f32_16x16x32_bf16 v[60:63], v[136:139], v[188:191], v[60:63]
    ds_read_b64_tr_b16 v[134:135], v13 offset:5120
    v_mfma_f32_16x16x32_bf16 v[64:67], v[140:143], v[184:187], v[64:67]
    ds_read_b64_tr_b16 v[136:137], v10 offset:12288
    s_add_u32 s43, s43, s47
    v_mfma_f32_16x16x32_bf16 v[68:71], v[140:143], v[188:191], v[68:71]
    s_waitcnt lgkmcnt(9)
    ds_read_b64_tr_b16 v[138:139], v10 offset:13312
    v_mfma_f32_16x16x32_bf16 v[72:75], v[144:147], v[184:187], v[72:75]
    ds_read_b64_tr_b16 v[140:141], v11 offset:12288
    s_add_u32 s44, s44, 24576
    v_mfma_f32_16x16x32_bf16 v[76:79], v[144:147], v[188:191], v[76:79]
    ds_read_b64_tr_b16 v[142:143], v11 offset:13312
    s_cmp_eq_u32 s44, s46
    s_cselect_b32 s44, s45, s44
    v_mfma_f32_16x16x32_bf16 v[80:83], v[148:151], v[184:187], v[80:83]
    ds_read_b64_tr_b16 v[144:145], v12 offset:12288
    v_mfma_f32_16x16x32_bf16 v[84:87], v[148:151], v[188:191], v[84:87]
    ds_read_b64_tr_b16 v[146:147], v12 offset:13312
    buffer_load_dwordx4 v[176:179], v14, s[4:7], s27 offen sc1
    v_mfma_f32_16x16x32_bf16 v[88:91], v[184:187], v[152:155], v[88:91]
    ds_read_b64_tr_b16 v[148:149], v13 offset:12288
    v_mfma_f32_16x16x32_bf16 v[92:95], v[188:191], v[152:155], v[92:95]
    ds_read_b64_tr_b16 v[150:151], v13 offset:13312
    buffer_load_dwordx4 v[180:183], v15, s[4:7], s27 offen sc1
    v_mfma_f32_16x16x32_bf16 v[96:99], v[184:187], v[156:159], v[96:99]
    ds_read_b64_tr_b16 v[152:153], v10 offset:20480
    s_add_u32 s27, s27, 151552
    v_mfma_f32_16x16x32_bf16 v[100:103], v[188:191], v[156:159], v[100:103]
    ds_read_b64_tr_b16 v[154:155], v10 offset:21504
    v_mfma_f32_16x16x32_bf16 v[104:107], v[184:187], v[160:163], v[104:107]
    ds_read_b64_tr_b16 v[156:157], v11 offset:20480
    s_add_u32 s37, s37, 24576
    v_mfma_f32_16x16x32_bf16 v[108:111], v[188:191], v[160:163], v[108:111]
    ds_read_b64_tr_b16 v[158:159], v11 offset:21504
    v_mfma_f32_16x16x32_bf16 v[112:115], v[184:187], v[164:167], v[112:115]
    ds_read_b64_tr_b16 v[160:161], v12 offset:20480
    s_cmp_eq_u32 s37, 98304
    s_cselect_b32 s37, 0, s37
    v_mfma_f32_16x16x32_bf16 v[116:119], v[188:191], v[164:167], v[116:119]
    s_waitcnt vmcnt(10) lgkmcnt(9)
    ds_read_b64_tr_b16 v[162:163], v12 offset:21504
    v_mfma_f32_16x16x32_bf16 v[24:27], v[120:123], v[192:195], v[24:27]
    ds_read_b64_tr_b16 v[164:165], v13 offset:20480
    v_mfma_f32_16x16x32_bf16 v[28:31], v[120:123], v[196:199], v[28:31]
    ds_read_b64_tr_b16 v[166:167], v13 offset:21504
    s_barrier
    v_add_u32 v10, s37, v9
    v_xor_b32 v11, 32, v10
    v_xor_b32 v12, 64, v10
    v_xor_b32 v13, 96, v10
    v_mfma_f32_16x16x32_bf16 v[32:35], v[124:127], v[192:195], v[32:35]
    ds_read_b64_tr_b16 v[120:121], v10 offset:0
    v_mfma_f32_16x16x32_bf16 v[36:39], v[124:127], v[196:199], v[36:39]
    ds_read_b64_tr_b16 v[122:123], v10 offset:1024
    buffer_load_dwordx4 v[184:187], v14, s[4:7], s27 offen sc1
    v_mfma_f32_16x16x32_bf16 v[40:43], v[128:131], v[192:195], v[40:43]
    ds_read_b64_tr_b16 v[124:125], v11 offset:0
    v_mfma_f32_16x16x32_bf16 v[44:47], v[128:131], v[196:199], v[44:47]
    ds_read_b64_tr_b16 v[126:127], v11 offset:1024
    buffer_load_dwordx4 v[188:191], v15, s[4:7], s27 offen sc1
    v_mfma_f32_16x16x32_bf16 v[48:51], v[132:135], v[192:195], v[48:51]
    ds_read_b64_tr_b16 v[128:129], v12 offset:0
    v_mfma_f32_16x16x32_bf16 v[52:55], v[132:135], v[196:199], v[52:55]
    ds_read_b64_tr_b16 v[130:131], v12 offset:1024
    s_add_u32 s27, s27, 151552
    v_mfma_f32_16x16x32_bf16 v[56:59], v[136:139], v[192:195], v[56:59]
    ds_read_b64_tr_b16 v[132:133], v13 offset:0
    v_mfma_f32_16x16x32_bf16 v[60:63], v[136:139], v[196:199], v[60:63]
    ds_read_b64_tr_b16 v[134:135], v13 offset:1024
    v_mfma_f32_16x16x32_bf16 v[64:67], v[140:143], v[192:195], v[64:67]
    ds_read_b64_tr_b16 v[136:137], v10 offset:8192
    s_add_u32 m0, s44, 0
    v_mfma_f32_16x16x32_bf16 v[68:71], v[140:143], v[196:199], v[68:71]
    s_waitcnt lgkmcnt(9)
    ds_read_b64_tr_b16 v[138:139], v10 offset:9216
    v_mfma_f32_16x16x32_bf16 v[72:75], v[144:147], v[192:195], v[72:75]
    ds_read_b64_tr_b16 v[140:141], v11 offset:8192
    buffer_load_dwordx4 v3, s[8:11], s43 offen lds
    v_mfma_f32_16x16x32_bf16 v[76:79], v[144:147], v[196:199], v[76:79]
    ds_read_b64_tr_b16 v[142:143], v11 offset:9216
    v_mfma_f32_16x16x32_bf16 v[80:83], v[148:151], v[192:195], v[80:83]
    ds_read_b64_tr_b16 v[144:145], v12 offset:8192
    s_add_u32 m0, s44, 1024
    v_mfma_f32_16x16x32_bf16 v[84:87], v[148:151], v[196:199], v[84:87]
    ds_read_b64_tr_b16 v[146:147], v12 offset:9216
    v_mfma_f32_16x16x32_bf16 v[88:91], v[192:195], v[152:155], v[88:91]
    ds_read_b64_tr_b16 v[148:149], v13 offset:8192
    v_mfma_f32_16x16x32_bf16 v[92:95], v[196:199], v[152:155], v[92:95]
    ds_read_b64_tr_b16 v[150:151], v13 offset:9216
    buffer_load_dwordx4 v4, s[8:11], s43 offen lds
    v_mfma_f32_16x16x32_bf16 v[96:99], v[192:195], v[156:159], v[96:99]
    ds_read_b64_tr_b16 v[152:153], v10 offset:16384
    v_mfma_f32_16x16x32_bf16 v[100:103], v[196:199], v[156:159], v[100:103]
    ds_read_b64_tr_b16 v[154:155], v10 offset:17408
    s_add_u32 m0, s44, 8192
    v_mfma_f32_16x16x32_bf16 v[104:107], v[192:195], v[160:163], v[104:107]
    ds_read_b64_tr_b16 v[156:157], v11 offset:16384
    v_mfma_f32_16x16x32_bf16 v[108:111], v[196:199], v[160:163], v[108:111]
    ds_read_b64_tr_b16 v[158:159], v11 offset:17408
    buffer_load_dwordx4 v5, s[8:11], s43 offen lds
    v_mfma_f32_16x16x32_bf16 v[112:115], v[192:195], v[164:167], v[112:115]
    ds_read_b64_tr_b16 v[160:161], v12 offset:16384
    v_mfma_f32_16x16x32_bf16 v[116:119], v[196:199], v[164:167], v[116:119]
    s_waitcnt vmcnt(13) lgkmcnt(9)
    ds_read_b64_tr_b16 v[162:163], v12 offset:17408
    ds_read_b64_tr_b16 v[164:165], v13 offset:16384
    ds_read_b64_tr_b16 v[166:167], v13 offset:17408
    s_mov_b32 s36, 7
.p2align 6
qkv_loop:
    v_mfma_f32_16x16x32_bf16 v[24:27], v[120:123], v[168:171], v[24:27]
    s_add_u32 m0, s44, 9216
    v_mfma_f32_16x16x32_bf16 v[28:31], v[120:123], v[172:175], v[28:31]
    buffer_load_dwordx4 v6, s[8:11], s43 offen lds
    v_mfma_f32_16x16x32_bf16 v[32:35], v[124:127], v[168:171], v[32:35]
    ds_read_b64_tr_b16 v[120:121], v10 offset:4096
    v_mfma_f32_16x16x32_bf16 v[36:39], v[124:127], v[172:175], v[36:39]
    ds_read_b64_tr_b16 v[122:123], v10 offset:5120
    s_add_u32 m0, s44, 16384
    v_mfma_f32_16x16x32_bf16 v[40:43], v[128:131], v[168:171], v[40:43]
    ds_read_b64_tr_b16 v[124:125], v11 offset:4096
    v_mfma_f32_16x16x32_bf16 v[44:47], v[128:131], v[172:175], v[44:47]
    ds_read_b64_tr_b16 v[126:127], v11 offset:5120
    buffer_load_dwordx4 v7, s[8:11], s43 offen lds
    v_mfma_f32_16x16x32_bf16 v[48:51], v[132:135], v[168:171], v[48:51]
    ds_read_b64_tr_b16 v[128:129], v12 offset:4096
    s_add_u32 m0, s44, 17408
    v_mfma_f32_16x16x32_bf16 v[52:55], v[132:135], v[172:175], v[52:55]
    ds_read_b64_tr_b16 v[130:131], v12 offset:5120
    v_mfma_f32_16x16x32_bf16 v[56:59], v[136:139], v[168:171], v[56:59]
    ds_read_b64_tr_b16 v[132:133], v13 offset:4096
    buffer_load_dwordx4 v8, s[8:11], s43 offen lds
    v_mfma_f32_16x16x32_bf16 v[60:63], v[136:139], v[172:175], v[60:63]
    ds_read_b64_tr_b16 v[134:135], v13 offset:5120
    v_mfma_f32_16x16x32_bf16 v[64:67], v[140:143], v[168:171], v[64:67]
    ds_read_b64_tr_b16 v[136:137], v10 offset:12288
    s_add_u32 s43, s43, s47
    v_mfma_f32_16x16x32_bf16 v[68:71], v[140:143], v[172:175], v[68:71]
    s_waitcnt lgkmcnt(9)
    ds_read_b64_tr_b16 v[138:139], v10 offset:13312
    v_mfma_f32_16x16x32_bf16 v[72:75], v[144:147], v[168:171], v[72:75]
    ds_read_b64_tr_b16 v[140:141], v11 offset:12288
    s_add_u32 s44, s44, 24576
    v_mfma_f32_16x16x32_bf16 v[76:79], v[144:147], v[172:175], v[76:79]
    ds_read_b64_tr_b16 v[142:143], v11 offset:13312
    s_cmp_eq_u32 s44, s46
    s_cselect_b32 s44, s45, s44
    v_mfma_f32_16x16x32_bf16 v[80:83], v[148:151], v[168:171], v[80:83]
    ds_read_b64_tr_b16 v[144:145], v12 offset:12288
    v_mfma_f32_16x16x32_bf16 v[84:87], v[148:151], v[172:175], v[84:87]
    ds_read_b64_tr_b16 v[146:147], v12 offset:13312
    buffer_load_dwordx4 v[192:195], v14, s[4:7], s27 offen sc1
    v_mfma_f32_16x16x32_bf16 v[88:91], v[168:171], v[152:155], v[88:91]
    ds_read_b64_tr_b16 v[148:149], v13 offset:12288
    v_mfma_f32_16x16x32_bf16 v[92:95], v[172:175], v[152:155], v[92:95]
    ds_read_b64_tr_b16 v[150:151], v13 offset:13312
    buffer_load_dwordx4 v[196:199], v15, s[4:7], s27 offen sc1
    v_mfma_f32_16x16x32_bf16 v[96:99], v[168:171], v[156:159], v[96:99]
    ds_read_b64_tr_b16 v[152:153], v10 offset:20480
    s_add_u32 s27, s27, 151552
    v_mfma_f32_16x16x32_bf16 v[100:103], v[172:175], v[156:159], v[100:103]
    ds_read_b64_tr_b16 v[154:155], v10 offset:21504
    v_mfma_f32_16x16x32_bf16 v[104:107], v[168:171], v[160:163], v[104:107]
    ds_read_b64_tr_b16 v[156:157], v11 offset:20480
    s_add_u32 s37, s37, 24576
    v_mfma_f32_16x16x32_bf16 v[108:111], v[172:175], v[160:163], v[108:111]
    ds_read_b64_tr_b16 v[158:159], v11 offset:21504
    v_mfma_f32_16x16x32_bf16 v[112:115], v[168:171], v[164:167], v[112:115]
    ds_read_b64_tr_b16 v[160:161], v12 offset:20480
    s_cmp_eq_u32 s37, 98304
    s_cselect_b32 s37, 0, s37
    v_mfma_f32_16x16x32_bf16 v[116:119], v[172:175], v[164:167], v[116:119]
    s_waitcnt vmcnt(10) lgkmcnt(9)
    ds_read_b64_tr_b16 v[162:163], v12 offset:21504
    v_mfma_f32_16x16x32_bf16 v[24:27], v[120:123], v[176:179], v[24:27]
    ds_read_b64_tr_b16 v[164:165], v13 offset:20480
    v_mfma_f32_16x16x32_bf16 v[28:31], v[120:123], v[180:183], v[28:31]
    ds_read_b64_tr_b16 v[166:167], v13 offset:21504
    s_barrier
    v_add_u32 v10, s37, v9
    v_xor_b32 v11, 32, v10
    v_xor_b32 v12, 64, v10
    v_xor_b32 v13, 96, v10
    v_mfma_f32_16x16x32_bf16 v[32:35], v[124:127], v[176:179], v[32:35]
    ds_read_b64_tr_b16 v[120:121], v10 offset:0
    v_mfma_f32_16x16x32_bf16 v[36:39], v[124:127], v[180:183], v[36:39]
    ds_read_b64_tr_b16 v[122:123], v10 offset:1024
    buffer_load_dwordx4 v[168:171], v14, s[4:7], s27 offen sc1
    v_mfma_f32_16x16x32_bf16 v[40:43], v[128:131], v[176:179], v[40:43]
    ds_read_b64_tr_b16 v[124:125], v11 offset:0
    v_mfma_f32_16x16x32_bf16 v[44:47], v[128:131], v[180:183], v[44:47]
    ds_read_b64_tr_b16 v[126:127], v11 offset:1024
    buffer_load_dwordx4 v[172:175], v15, s[4:7], s27 offen sc1
    v_mfma_f32_16x16x32_bf16 v[48:51], v[132:135], v[176:179], v[48:51]
    ds_read_b64_tr_b16 v[128:129], v12 offset:0
    v_mfma_f32_16x16x32_bf16 v[52:55], v[132:135], v[180:183], v[52:55]
    ds_read_b64_tr_b16 v[130:131], v12 offset:1024
    s_add_u32 s27, s27, 151552
    v_mfma_f32_16x16x32_bf16 v[56:59], v[136:139], v[176:179], v[56:59]
    ds_read_b64_tr_b16 v[132:133], v13 offset:0
    v_mfma_f32_16x16x32_bf16 v[60:63], v[136:139], v[180:183], v[60:63]
    ds_read_b64_tr_b16 v[134:135], v13 offset:1024
    s_add_u32 m0, s44, 0
    v_mfma_f32_16x16x32_bf16 v[64:67], v[140:143], v[176:179], v[64:67]
    ds_read_b64_tr_b16 v[136:137], v10 offset:8192
    v_mfma_f32_16x16x32_bf16 v[68:71], v[140:143], v[180:183], v[68:71]
    s_waitcnt lgkmcnt(9)
    ds_read_b64_tr_b16 v[138:139], v10 offset:9216
    buffer_load_dwordx4 v3, s[8:11], s43 offen lds
    v_mfma_f32_16x16x32_bf16 v[72:75], v[144:147], v[176:179], v[72:75]
    ds_read_b64_tr_b16 v[140:141], v11 offset:8192
    v_mfma_f32_16x16x32_bf16 v[76:79], v[144:147], v[180:183], v[76:79]
    ds_read_b64_tr_b16 v[142:143], v11 offset:9216
    s_add_u32 m0, s44, 1024
    v_mfma_f32_16x16x32_bf16 v[80:83], v[148:151], v[176:179], v[80:83]
    ds_read_b64_tr_b16 v[144:145], v12 offset:8192
    v_mfma_f32_16x16x32_bf16 v[84:87], v[148:151], v[180:183], v[84:87]
    ds_read_b64_tr_b16 v[146:147], v12 offset:9216
    buffer_load_dwordx4 v4, s[8:11], s43 offen lds
    v_mfma_f32_16x16x32_bf16 v[88:91], v[176:179], v[152:155], v[88:91]
    ds_read_b64_tr_b16 v[148:149], v13 offset:8192
    v_mfma_f32_16x16x32_bf16 v[92:95], v[180:183], v[152:155], v[92:95]
    ds_read_b64_tr_b16 v[150:151], v13 offset:9216
    s_add_u32 m0, s44, 8192
    v_mfma_f32_16x16x32_bf16 v[96:99], v[176:179], v[156:159], v[96:99]
    ds_read_b64_tr_b16 v[152:153], v10 offset:16384
    v_mfma_f32_16x16x32_bf16 v[100:103], v[180:183], v[156:159], v[100:103]
    ds_read_b64_tr_b16 v[154:155], v10 offset:17408
    buffer_load_dwordx4 v5, s[8:11], s43 offen lds
    v_mfma_f32_16x16x32_bf16 v[104:107], v[176:179], v[160:163], v[104:107]
    ds_read_b64_tr_b16 v[156:157], v11 offset:16384
    v_mfma_f32_16x16x32_bf16 v[108:111], v[180:183], v[160:163], v[108:111]
    ds_read_b64_tr_b16 v[158:159], v11 offset:17408
    buffer_load_dword v0, v2, s[68:71], 0 offen
    v_mfma_f32_16x16x32_bf16 v[112:115], v[176:179], v[164:167], v[112:115]
    ds_read_b64_tr_b16 v[160:161], v12 offset:16384
    v_mfma_f32_16x16x32_bf16 v[116:119], v[180:183], v[164:167], v[116:119]
    s_waitcnt vmcnt(14) lgkmcnt(9)
    ds_read_b64_tr_b16 v[162:163], v12 offset:17408
    v_mfma_f32_16x16x32_bf16 v[24:27], v[120:123], v[184:187], v[24:27]
    ds_read_b64_tr_b16 v[164:165], v13 offset:16384
    s_add_u32 m0, s44, 9216
    v_mfma_f32_16x16x32_bf16 v[28:31], v[120:123], v[188:191], v[28:31]
    ds_read_b64_tr_b16 v[166:167], v13 offset:17408
    buffer_load_dwordx4 v6, s[8:11], s43 offen lds
    v_mfma_f32_16x16x32_bf16 v[32:35], v[124:127], v[184:187], v[32:35]
    ds_read_b64_tr_b16 v[120:121], v10 offset:4096
    v_mfma_f32_16x16x32_bf16 v[36:39], v[124:127], v[188:191], v[36:39]
    ds_read_b64_tr_b16 v[122:123], v10 offset:5120
    s_add_u32 m0, s44, 16384
    v_mfma_f32_16x16x32_bf16 v[40:43], v[128:131], v[184:187], v[40:43]
    ds_read_b64_tr_b16 v[124:125], v11 offset:4096
    v_mfma_f32_16x16x32_bf16 v[44:47], v[128:131], v[188:191], v[44:47]
    ds_read_b64_tr_b16 v[126:127], v11 offset:5120
    buffer_load_dwordx4 v7, s[8:11], s43 offen lds
    v_mfma_f32_16x16x32_bf16 v[48:51], v[132:135], v[184:187], v[48:51]
    ds_read_b64_tr_b16 v[128:129], v12 offset:4096
    s_add_u32 m0, s44, 17408
    v_mfma_f32_16x16x32_bf16 v[52:55], v[132:135], v[188:191], v[52:55]
    ds_read_b64_tr_b16 v[130:131], v12 offset:5120
    v_mfma_f32_16x16x32_bf16 v[56:59], v[136:139], v[184:187], v[56:59]
    ds_read_b64_tr_b16 v[132:133], v13 offset:4096
    buffer_load_dwordx4 v8, s[8:11], s43 offen lds
    v_mfma_f32_16x16x32_bf16 v[60:63], v[136:139], v[188:191], v[60:63]
    ds_read_b64_tr_b16 v[134:135], v13 offset:5120
    v_mfma_f32_16x16x32_bf16 v[64:67], v[140:143], v[184:187], v[64:67]
    ds_read_b64_tr_b16 v[136:137], v10 offset:12288
    s_add_u32 s43, s43, s47
    v_mfma_f32_16x16x32_bf16 v[68:71], v[140:143], v[188:191], v[68:71]
    s_waitcnt lgkmcnt(9)
    ds_read_b64_tr_b16 v[138:139], v10 offset:13312
    v_mfma_f32_16x16x32_bf16 v[72:75], v[144:147], v[184:187], v[72:75]
    ds_read_b64_tr_b16 v[140:141], v11 offset:12288
    s_add_u32 s44, s44, 24576
    v_mfma_f32_16x16x32_bf16 v[76:79], v[144:147], v[188:191], v[76:79]
    ds_read_b64_tr_b16 v[142:143], v11 offset:13312
    s_cmp_eq_u32 s44, s46
    s_cselect_b32 s44, s45, s44
    v_mfma_f32_16x16x32_bf16 v[80:83], v[148:151], v[184:187], v[80:83]
    ds_read_b64_tr_b16 v[144:145], v12 offset:12288
    v_mfma_f32_16x16x32_bf16 v[84:87], v[148:151], v[188:191], v[84:87]
    ds_read_b64_tr_b16 v[146:147], v12 offset:13312
    buffer_load_dwordx4 v[176:179], v14, s[4:7], s27 offen sc1
    v_mfma_f32_16x16x32_bf16 v[88:91], v[184:187], v[152:155], v[88:91]
    ds_read_b64_tr_b16 v[148:149], v13 offset:12288
    v_mfma_f32_16x16x32_bf16 v[92:95], v[188:191], v[152:155], v[92:95]
    ds_read_b64_tr_b16 v[150:151], v13 offset:13312
    buffer_load_dwordx4 v[180:183], v15, s[4:7], s27 offen sc1
    v_mfma_f32_16x16x32_bf16 v[96:99], v[184:187], v[156:159], v[96:99]
    ds_read_b64_tr_b16 v[152:153], v10 offset:20480
    s_add_u32 s27, s27, 151552
    v_mfma_f32_16x16x32_bf16 v[100:103], v[188:191], v[156:159], v[100:103]
    ds_read_b64_tr_b16 v[154:155], v10 offset:21504
    v_mfma_f32_16x16x32_bf16 v[104:107], v[184:187], v[160:163], v[104:107]
    ds_read_b64_tr_b16 v[156:157], v11 offset:20480
    s_add_u32 s37, s37, 24576
    v_mfma_f32_16x16x32_bf16 v[108:111], v[188:191], v[160:163], v[108:111]
    ds_read_b64_tr_b16 v[158:159], v11 offset:21504
    v_mfma_f32_16x16x32_bf16 v[112:115], v[184:187], v[164:167], v[112:115]
    ds_read_b64_tr_b16 v[160:161], v12 offset:20480
    s_cmp_eq_u32 s37, 98304
    s_cselect_b32 s37, 0, s37
    v_mfma_f32_16x16x32_bf16 v[116:119], v[188:191], v[164:167], v[116:119]
    s_waitcnt vmcnt(11) lgkmcnt(9)
    ds_read_b64_tr_b16 v[162:163], v12 offset:21504
    v_mfma_f32_16x16x32_bf16 v[24:27], v[120:123], v[192:195], v[24:27]
    ds_read_b64_tr_b16 v[164:165], v13 offset:20480
    v_mfma_f32_16x16x32_bf16 v[28:31], v[120:123], v[196:199], v[28:31]
    ds_read_b64_tr_b16 v[166:167], v13 offset:21504
    s_barrier
    v_add_u32 v10, s37, v9
    v_xor_b32 v11, 32, v10
    v_xor_b32 v12, 64, v10
    v_xor_b32 v13, 96, v10
    v_mfma_f32_16x16x32_bf16 v[32:35], v[124:127], v[192:195], v[32:35]
    ds_read_b64_tr_b16 v[120:121], v10 offset:0
    v_mfma_f32_16x16x32_bf16 v[36:39], v[124:127], v[196:199], v[36:39]
    ds_read_b64_tr_b16 v[122:123], v10 offset:1024
    buffer_load_dwordx4 v[184:187], v14, s[4:7], s27 offen sc1
    v_mfma_f32_16x16x32_bf16 v[40:43], v[128:131], v[192:195], v[40:43]
    ds_read_b64_tr_b16 v[124:125], v11 offset:0
    v_mfma_f32_16x16x32_bf16 v[44:47], v[128:131], v[196:199], v[44:47]
    ds_read_b64_tr_b16 v[126:127], v11 offset:1024
    buffer_load_dwordx4 v[188:191], v15, s[4:7], s27 offen sc1
    v_mfma_f32_16x16x32_bf16 v[48:51], v[132:135], v[192:195], v[48:51]
    ds_read_b64_tr_b16 v[128:129], v12 offset:0
    v_mfma_f32_16x16x32_bf16 v[52:55], v[132:135], v[196:199], v[52:55]
    ds_read_b64_tr_b16 v[130:131], v12 offset:1024
    s_add_u32 s27, s27, 151552
    v_mfma_f32_16x16x32_bf16 v[56:59], v[136:139], v[192:195], v[56:59]
    ds_read_b64_tr_b16 v[132:133], v13 offset:0
    v_mfma_f32_16x16x32_bf16 v[60:63], v[136:139], v[196:199], v[60:63]
    ds_read_b64_tr_b16 v[134:135], v13 offset:1024
    s_add_u32 m0, s44, 0
    v_mfma_f32_16x16x32_bf16 v[64:67], v[140:143], v[192:195], v[64:67]
    ds_read_b64_tr_b16 v[136:137], v10 offset:8192
    v_mfma_f32_16x16x32_bf16 v[68:71], v[140:143], v[196:199], v[68:71]
    s_waitcnt lgkmcnt(9)
    ds_read_b64_tr_b16 v[138:139], v10 offset:9216
    buffer_load_dwordx4 v3, s[8:11], s43 offen lds
    v_mfma_f32_16x16x32_bf16 v[72:75], v[144:147], v[192:195], v[72:75]
    ds_read_b64_tr_b16 v[140:141], v11 offset:8192
    v_mfma_f32_16x16x32_bf16 v[76:79], v[144:147], v[196:199], v[76:79]
    ds_read_b64_tr_b16 v[142:143], v11 offset:9216
    s_add_u32 m0, s44, 1024
    v_mfma_f32_16x16x32_bf16 v[80:83], v[148:151], v[192:195], v[80:83]
    ds_read_b64_tr_b16 v[144:145], v12 offset:8192
    v_mfma_f32_16x16x32_bf16 v[84:87], v[148:151], v[196:199], v[84:87]
    ds_read_b64_tr_b16 v[146:147], v12 offset:9216
    buffer_load_dwordx4 v4, s[8:11], s43 offen lds
    v_mfma_f32_16x16x32_bf16 v[88:91], v[192:195], v[152:155], v[88:91]
    ds_read_b64_tr_b16 v[148:149], v13 offset:8192
    v_mfma_f32_16x16x32_bf16 v[92:95], v[196:199], v[152:155], v[92:95]
    ds_read_b64_tr_b16 v[150:151], v13 offset:9216
    s_add_u32 m0, s44, 8192
    v_mfma_f32_16x16x32_bf16 v[96:99], v[192:195], v[156:159], v[96:99]
    ds_read_b64_tr_b16 v[152:153], v10 offset:16384
    v_mfma_f32_16x16x32_bf16 v[100:103], v[196:199], v[156:159], v[100:103]
    ds_read_b64_tr_b16 v[154:155], v10 offset:17408
    buffer_load_dwordx4 v5, s[8:11], s43 offen lds
    v_mfma_f32_16x16x32_bf16 v[104:107], v[192:195], v[160:163], v[104:107]
    ds_read_b64_tr_b16 v[156:157], v11 offset:16384
    v_mfma_f32_16x16x32_bf16 v[108:111], v[196:199], v[160:163], v[108:111]
    ds_read_b64_tr_b16 v[158:159], v11 offset:17408
    s_sub_u32 s36, s36, 1
    s_cmp_lg_u32 s36, 0
    v_mfma_f32_16x16x32_bf16 v[112:115], v[192:195], v[164:167], v[112:115]
    ds_read_b64_tr_b16 v[160:161], v12 offset:16384
    v_mfma_f32_16x16x32_bf16 v[116:119], v[196:199], v[164:167], v[116:119]
    s_waitcnt vmcnt(14) lgkmcnt(9)
    ds_read_b64_tr_b16 v[162:163], v12 offset:17408
    ds_read_b64_tr_b16 v[164:165], v13 offset:16384
    ds_read_b64_tr_b16 v[166:167], v13 offset:17408
    s_cbranch_scc1 qkv_loop
qkv_epi:
    s_add_u32 s12, s38, 10485760
    s_addc_u32 s13, s39, 0
    s_mov_b32 s14, 4194304
    s_mov_b32 s15, 0x20000
    s_add_u32 s16, s38, 14680064
    s_addc_u32 s17, s39, 0
    s_mov_b32 s18, 8388608
    s_mov_b32 s19, 0x20000
    v_and_b32 v16, 15, v1
    v_lshrrev_b32 v17, 5, v1
    v_lshl_add_u32 v16, v17, 4, v16
    v_bfe_u32 v17, v1, 4, 1
    v_lshl_add_u32 v16, v17, 5, v16
    v_lshlrev_b32 v16, 4, v16
    s_lshl_b32 s32, s41, 7
    s_add_u32 s32, s32, s42
    s_lshl_b32 s33, s32, 11
    s_lshl_b32 s34, s32, 12
    s_add_u32 s35, s33, 131072
    s_add_u32 s56, s34, 262144
    v_mul_f32 v24, 0x3e8293ee, v24
    v_mul_f32 v25, 0x3e8293ee, v25
    v_mul_f32 v26, 0x3e8293ee, v26
    v_mul_f32 v27, 0x3e8293ee, v27
    v_mul_f32 v28, 0x3e8293ee, v28
    v_mul_f32 v29, 0x3e8293ee, v29
    v_mul_f32 v30, 0x3e8293ee, v30
    v_mul_f32 v31, 0x3e8293ee, v31
    v_cvt_pk_bf16_f32 v24, v24, v25
    v_cvt_pk_bf16_f32 v25, v26, v27
    v_cvt_pk_bf16_f32 v26, v28, v29
    v_cvt_pk_bf16_f32 v27, v30, v31
    v_mul_f32 v32, 0x3e8293ee, v32
    v_mul_f32 v33, 0x3e8293ee, v33
    v_mul_f32 v34, 0x3e8293ee, v34
    v_mul_f32 v35, 0x3e8293ee, v35
    v_mul_f32 v36, 0x3e8293ee, v36
    v_mul_f32 v37, 0x3e8293ee, v37
    v_mul_f32 v38, 0x3e8293ee, v38
    v_mul_f32 v39, 0x3e8293ee, v39
    v_cvt_pk_bf16_f32 v32, v32, v33
    v_cvt_pk_bf16_f32 v33, v34, v35
    v_cvt_pk_bf16_f32 v34, v36, v37
    v_cvt_pk_bf16_f32 v35, v38, v39
    v_permlane32_swap_b32 v24, v26
    v_permlane32_swap_b32 v25, v27
    buffer_store_dwordx4 v[24:27], v16, s[12:15], s33 offen offset:0 sc1
    v_mul_f32 v40, 0x3e8293ee, v40
    v_mul_f32 v41, 0x3e8293ee, v41
    v_mul_f32 v42, 0x3e8293ee, v42
    v_mul_f32 v43, 0x3e8293ee, v43
    v_mul_f32 v44, 0x3e8293ee, v44
    v_mul_f32 v45, 0x3e8293ee, v45
    v_mul_f32 v46, 0x3e8293ee, v46
    v_mul_f32 v47, 0x3e8293ee, v47
    v_cvt_pk_bf16_f32 v40, v40, v41
    v_cvt_pk_bf16_f32 v41, v42, v43
    v_cvt_pk_bf16_f32 v42, v44, v45
    v_cvt_pk_bf16_f32 v43, v46, v47
    v_permlane32_swap_b32 v32, v34
    v_permlane32_swap_b32 v33, v35
    buffer_store_dwordx4 v[32:35], v16, s[12:15], s33 offen offset:1024 sc1
    v_mul_f32 v48, 0x3e8293ee, v48
    v_mul_f32 v49, 0x3e8293ee, v49
    v_mul_f32 v50, 0x3e8293ee, v50
    v_mul_f32 v51, 0x3e8293ee, v51
    v_mul_f32 v52, 0x3e8293ee, v52
    v_mul_f32 v53, 0x3e8293ee, v53
    v_mul_f32 v54, 0x3e8293ee, v54
    v_mul_f32 v55, 0x3e8293ee, v55
    v_cvt_pk_bf16_f32 v48, v48, v49
    v_cvt_pk_bf16_f32 v49, v50, v51
    v_cvt_pk_bf16_f32 v50, v52, v53
    v_cvt_pk_bf16_f32 v51, v54, v55
    v_permlane32_swap_b32 v40, v42
    v_permlane32_swap_b32 v41, v43
    buffer_store_dwordx4 v[40:43], v16, s[12:15], s35 offen offset:0 sc1
    v_cvt_pk_bf16_f32 v56, v56, v57
    v_cvt_pk_bf16_f32 v57, v58, v59
    v_cvt_pk_bf16_f32 v58, v60, v61
    v_cvt_pk_bf16_f32 v59, v62, v63
    v_permlane32_swap_b32 v48, v50
    v_permlane32_swap_b32 v49, v51
    buffer_store_dwordx4 v[48:51], v16, s[12:15], s35 offen offset:1024 sc1
    v_cvt_pk_bf16_f32 v64, v64, v65
    v_cvt_pk_bf16_f32 v65, v66, v67
    v_cvt_pk_bf16_f32 v66, v68, v69
    v_cvt_pk_bf16_f32 v67, v70, v71
    v_permlane32_swap_b32 v56, v58
    v_permlane32_swap_b32 v57, v59
    buffer_store_dwordx4 v[56:59], v16, s[16:19], s34 offen offset:0 sc1
    v_cvt_pk_bf16_f32 v72, v72, v73
    v_cvt_pk_bf16_f32 v73, v74, v75
    v_cvt_pk_bf16_f32 v74, v76, v77
    v_cvt_pk_bf16_f32 v75, v78, v79
    v_permlane32_swap_b32 v64, v66
    v_permlane32_swap_b32 v65, v67
    buffer_store_dwordx4 v[64:67], v16, s[16:19], s34 offen offset:1024 sc1
    v_cvt_pk_bf16_f32 v80, v80, v81
    v_cvt_pk_bf16_f32 v81, v82, v83
    v_cvt_pk_bf16_f32 v82, v84, v85
    v_cvt_pk_bf16_f32 v83, v86, v87
    v_permlane32_swap_b32 v72, v74
    v_permlane32_swap_b32 v73, v75
    buffer_store_dwordx4 v[72:75], v16, s[16:19], s56 offen offset:0 sc1
    v_cvt_pk_bf16_f32 v88, v88, v89
    v_cvt_pk_bf16_f32 v89, v90, v91
    v_cvt_pk_bf16_f32 v90, v96, v97
    v_cvt_pk_bf16_f32 v91, v98, v99
    v_permlane32_swap_b32 v80, v82
    v_permlane32_swap_b32 v81, v83
    buffer_store_dwordx4 v[80:83], v16, s[16:19], s56 offen offset:1024 sc1
    v_cvt_pk_bf16_f32 v92, v92, v93
    v_cvt_pk_bf16_f32 v93, v94, v95
    v_cvt_pk_bf16_f32 v94, v100, v101
    v_cvt_pk_bf16_f32 v95, v102, v103
    v_permlane32_swap_b32 v88, v90
    v_permlane32_swap_b32 v89, v91
    buffer_store_dwordx4 v[88:91], v16, s[16:19], s34 offen offset:2048 sc1
    v_cvt_pk_bf16_f32 v104, v104, v105
    v_cvt_pk_bf16_f32 v105, v106, v107
    v_cvt_pk_bf16_f32 v106, v112, v113
    v_cvt_pk_bf16_f32 v107, v114, v115
    v_permlane32_swap_b32 v92, v94
    v_permlane32_swap_b32 v93, v95
    buffer_store_dwordx4 v[92:95], v16, s[16:19], s34 offen offset:3072 sc1
    v_cvt_pk_bf16_f32 v108, v108, v109
    v_cvt_pk_bf16_f32 v109, v110, v111
    v_cvt_pk_bf16_f32 v110, v116, v117
    v_cvt_pk_bf16_f32 v111, v118, v119
    v_permlane32_swap_b32 v104, v106
    v_permlane32_swap_b32 v105, v107
    buffer_store_dwordx4 v[104:107], v16, s[16:19], s56 offen offset:2048 sc1
    v_permlane32_swap_b32 v108, v110
    v_permlane32_swap_b32 v109, v111
    buffer_store_dwordx4 v[108:111], v16, s[16:19], s56 offen offset:3072 sc1
    v_lshl_add_u32 v0, s26, 6, v1
    s_load_dwordx2 s[60:61], s[0:1], 16
    s_load_dwordx2 s[62:63], s[0:1], 0
    s_load_dwordx2 s[64:65], s[0:1], 32
    s_load_dwordx2 s[66:67], s[0:1], 40
    s_lshl_b32 s100, s41, 4
    s_add_u32 s100, s100, s40
    s_add_u32 s100, s100, 1792
    s_and_b32 s59, s2, 3
    s_lshl_b32 s59, s59, 2
    s_bfe_u32 s32, s2, 0x20004
    s_add_u32 s59, s59, s32
    s_lshl_b32 s59, s59, 4
    s_add_u32 s59, s59, 1792
    s_waitcnt vmcnt(12)
    s_load_dwordx2 s[98:99], s[0:1], 48
    s_load_dwordx2 s[24:25], s[0:1], 56
    s_load_dwordx2 s[34:35], s[0:1], 64
    s_and_b32 s32, s2, 7
    s_lshr_b32 s33, s2, 3
    s_and_b32 s48, s32, 3
    s_lshl_b32 s48, s48, 3
    s_and_b32 s49, s33, 7
    s_add_u32 s48, s48, s49
    s_lshr_b32 s49, s32, 2
    s_lshl_b32 s49, s49, 2
    s_lshr_b32 s33, s33, 3
    s_add_u32 s49, s49, s33
    s_lshl_b32 s55, s49, 5
    s_add_u32 s55, s55, s48
    v_lshlrev_b32 v2, 4, v1
    s_lshl_b32 s50, s49, 2
    s_add_u32 s50, s50, s26
    s_lshl_b32 s50, s50, 1
    s_lshl_b32 s51, s26, 12
    s_lshl_b32 s36, s48, 6
    s_add_u32 s36, s36, s50
    s_lshl_b32 s36, s36, 11
    s_lshl_b32 s32, s48, 18
    s_add_u32 s28, s38, s32
    s_addc_u32 s29, s39, 0
    s_add_u32 s28, s28, 14680064
    s_addc_u32 s29, s29, 0
    s_mov_b32 s30, 0x40000
    s_mov_b32 s31, 0x20000
    s_mov_b32 s52, s51
    s_add_u32 s16, s38, 10485760
    s_addc_u32 s17, s39, 0
    s_mov_b32 s18, 4194304
    s_mov_b32 s19, 0x20000
    s_waitcnt lgkmcnt(0)
    s_and_b32 s53, s55, 1
    s_lshr_b32 s54, s55, 1
    s_cmp_ge_u32 s54, 56
    s_cselect_b32 s4, s66, s64
    s_cselect_b32 s5, s67, s65
    s_cselect_b32 s32, 56, 0
    s_mov_b32 s57, 7168
    s_cmp_ge_u32 s54, 112
    s_cselect_b32 s4, s34, s4
    s_cselect_b32 s5, s35, s5
    s_cselect_b32 s32, 80, s32
    s_cselect_b32 s57, 12288, s57
    s_lshl_b32 s6, s57, 10
    s_mov_b32 s7, 0x20000
    s_sub_u32 s32, s54, s32
    s_lshl_b32 s33, s53, 9
    s_lshl_b32 s37, s26, 7
    s_add_u32 s33, s33, s37
    s_mul_i32 s27, s33, s57
    s_lshl_b32 s32, s32, 7
    s_add_u32 s27, s27, s32
    s_lshl_b32 s56, s26, 14
    s_add_u32 s56, s56, 69632
    v_lshrrev_b32 v176, 3, v1
    v_and_b32 v177, 7, v1
    v_bfe_u32 v178, v1, 4, 1
    v_lshlrev_b32 v178, 2, v178
    v_xor_b32 v177, v177, v178
    v_mul_lo_u32 v176, v176, s57
    v_lshl_add_u32 v195, v177, 4, v176
    s_lshl_b32 s32, s57, 3
    s_sub_u32 s32, s32, 1024
    v_add_u32 v196, s32, v195
    s_lshl_b32 s57, s57, 4
    s_cmp_ge_u32 s54, 112
    s_cbranch_scc1 att_vs
    s_mov_b32 s20, s38
    s_mov_b32 s21, s39
    s_mov_b32 s22, 49152
    s_mov_b32 s23, 0x20000
    v_add_lshl_u32 v176, v1, s33, 2
    s_mov_b32 s32, 16384
    buffer_load_dword v200, v176, s[20:23], s32 offen offset:0
    buffer_load_dword v204, v176, s[20:23], s32 offen offset:256
    s_mov_b32 s32, 40960
    buffer_load_dword v201, v176, s[20:23], s32 offen offset:0
    buffer_load_dword v205, v176, s[20:23], s32 offen offset:256
    s_mov_b32 s32, 12288
    buffer_load_dword v202, v176, s[20:23], s32 offen offset:0
    buffer_load_dword v206, v176, s[20:23], s32 offen offset:256
    s_mov_b32 s32, 36864
    buffer_load_dword v203, v176, s[20:23], s32 offen offset:0
    buffer_load_dword v207, v176, s[20:23], s32 offen offset:256
    s_branch att_vd
att_vs:
    s_mov_b32 s20, s24
    s_mov_b32 s21, s25
    s_mov_b32 s22, 2048
    s_mov_b32 s23, 0x20000
    v_add_lshl_u32 v176, v1, s33, 1
    buffer_load_ushort v200, v176, s[20:23], 0 offen offset:0
    buffer_load_ushort v204, v176, s[20:23], 0 offen offset:128
    buffer_load_ushort v201, v176, s[20:23], 0 offen offset:0
    buffer_load_ushort v205, v176, s[20:23], 0 offen offset:128
    buffer_load_ushort v202, v176, s[20:23], 0 offen offset:0
    buffer_load_ushort v206, v176, s[20:23], 0 offen offset:128
    buffer_load_ushort v203, v176, s[20:23], 0 offen offset:0
    buffer_load_ushort v207, v176, s[20:23], 0 offen offset:128
att_vd:
    s_mov_b32 s20, s24
    s_mov_b32 s21, s25
    s_mov_b32 s22, 2048
    s_mov_b32 s23, 0x20000
    s_lshr_b32 s32, s55, 4
    s_lshl_b32 s32, s32, 6
    s_lshl_b32 s33, s26, 4
    s_add_u32 s32, s32, s33
    v_add_lshl_u32 v176, v1, s32, 1
    buffer_load_ushort v198, v176, s[20:23], 0 offen
    s_mul_i32 s101, s32, 12288
    s_and_b32 s32, s55, 15
    s_lshl_b32 s32, s32, 7
    s_add_u32 s101, s101, s32
    s_add_u32 s101, s101, 10240
    s_mov_b32 s20, s34
    s_mov_b32 s21, s35
    s_mov_b32 s22, 12582912
    s_mov_b32 s23, 0x20000
    v_lshrrev_b32 v176, 3, v1
    v_and_b32 v177, 7, v1
    v_bfe_u32 v178, v1, 4, 1
    v_lshlrev_b32 v178, 2, v178
    v_xor_b32 v177, v177, v178
    v_mul_u32_u24 v176, 12288, v176
    v_lshl_add_u32 v197, v177, 4, v176
    s_and_b32 s32, s2, 7
    s_lshr_b32 s33, s2, 3
    s_lshr_b32 s34, s32, 1
    s_and_b32 s35, s32, 1
    s_and_b32 s40, s33, 3
    s_lshr_b32 s41, s33, 2
    s_mul_i32 s34, s34, 4
    s_add_u32 s40, s40, s34
    s_mul_i32 s35, s35, 8
    s_add_u32 s41, s41, s35
    s_lshl_b32 s42, s40, 2
    s_add_u32 s42, s42, s26
    s_mul_i32 s42, s42, 1
    s_and_b32 s32, s41, 7
    s_lshr_b32 s33, s41, 3
    s_mul_i32 s33, s33, 256
    s_lshl_b32 s34, s41, 7
    s_mov_b32 s35, 2048
    s_mov_b32 s43, 2048
    s_cmp_eq_u32 s32, 3
    s_cselect_b32 s33, s33, s34
    s_cselect_b32 s35, 512, s35
    s_cselect_b32 s43, 0, s43
    s_lshl_b32 s47, s35, 6
    s_lshl_b32 s34, s35, 3
    s_lshl_b32 s32, s26, 4
    v_lshrrev_b32 v176, 3, v1
    v_and_b32 v177, 7, v1
    v_and_b32 v178, 6, v176
    v_xor_b32 v177, v177, v178
    v_add_u32 v176, s32, v176
    v_mul_lo_u32 v176, v176, s35
    v_lshl_add_u32 v176, v177, 4, v176
    v_add_u32 v192, s33, v176
    v_add_u32 v193, s34, v192
    s_lshl_b32 s45, s26, 11
    s_add_u32 s45, s45, 0
    s_mov_b32 s43, 0
    s_add_u32 s44, s45, 73728
    s_add_u32 s46, s45, 139264
    s_add_u32 s32, s38, 2621440
    s_addc_u32 s33, s39, 0
    s_cmp_eq_u32 s47, 32768
    s_cselect_b32 s8, s32, s60
    s_cselect_b32 s9, s33, s61
    s_mul_i32 s10, s47, 16
    s_mov_b32 s11, 0x20000
    v_lshrrev_b32 v176, 3, v1
    v_and_b32 v194, 7, v1
    v_xor_b32 v194, v194, v176
    v_lshlrev_b32 v194, 4, v194
    v_lshl_add_u32 v194, v176, 11, v194
    s_lshl_b32 s24, s42, 16
    s_lshl_b32 s32, s41, 7
    s_add_u32 s24, s24, s32
    s_lshl_b32 s25, s26, 11
    s_add_u32 s25, s25, 135168
    v_lshrrev_b32 v176, 3, v1
    v_lshl_add_u32 v176, s50, 3, v176
    v_mul_u32_u24 v177, 9363, v176
    v_lshrrev_b32 v177, 16, v177
    v_add_u32 v3, v176, v177
    v_mul_u32_u24 v177, 7, v177
    v_sub_u32 v177, v176, v177
    v_add_u32 v177, 5, v177
    v_lshrrev_b32 v177, 3, v177
    v_add_lshl_u32 v3, v3, v177, 7
    v_and_b32 v176, 7, v1
    v_lshl_add_u32 v3, v176, 4, v3
    s_add_u32 s33, s50, 1
    v_lshrrev_b32 v176, 3, v1
    v_lshl_add_u32 v176, s33, 3, v176
    v_mul_u32_u24 v177, 9363, v176
    v_lshrrev_b32 v177, 16, v177
    v_add_u32 v4, v176, v177
    v_mul_u32_u24 v177, 7, v177
    v_sub_u32 v177, v176, v177
    v_add_u32 v177, 5, v177
    v_lshrrev_b32 v177, 3, v177
    v_add_lshl_u32 v4, v4, v177, 7
    v_and_b32 v176, 7, v1
    v_lshl_add_u32 v4, v176, 4, v4
    s_getpc_b64 s[68:69]
mlp_kernel_pc2:
    s_add_u32 s68, s68, attn_epi-mlp_kernel_pc2
    s_addc_u32 s69, s69, 0
    s_mov_b32 s70, mlp_kernel_end-attn_epi+4
    s_cmp_lt_u32 s2, 256
    s_cselect_b32 s70, s70, 0
    s_mov_b32 s71, 0x20000
    s_lshr_b32 s32, s2, 3
    s_lshl_b32 s32, s32, 2
    s_add_u32 s32, s32, s26
    s_lshl_b32 s32, s32, 9
    v_lshrrev_b32 v180, 2, v1
    v_lshlrev_b32 v180, 20, v180
    v_lshl_add_u32 v180, v1, 7, v180
    v_add_u32 v180, s32, v180
    s_lshl_b32 s32, s2, 2
    s_add_u32 s32, s32, s26
    s_mul_i32 s3, s32, 1792
    s_lshl_b32 s58, s32, 9
    v_lshlrev_b32 v182, 7, v1
    v_mov_b32 v184, 0x80000000
    v_cmp_gt_u32 vcc, 4, v1
    s_nop 1
    v_cndmask_b32 v183, v184, v182, vcc
    v_cmp_gt_u32 vcc, 14, v1
    s_nop 1
    v_cndmask_b32 v182, v184, v182, vcc
    v_bfe_u32 v176, v1, 2, 1
    v_cmp_eq_u32 vcc, 0, v176
    v_mov_b32 v177, 0x3f803f80
    s_nop 0
    v_cndmask_b32 v24, 0, v177, vcc
    v_mov_b32 v25, v24
    v_xor_b32 v26, v177, v24
    v_mov_b32 v27, v26
    v_and_b32 v176, 1, v1
    v_mul_u32_u24 v176, 0xaaaa, v176
    v_add_u32 v28, 0x4444, v176
    v_mov_b32 v96, 0
    v_mov_b32 v97, 0
    v_mov_b32 v98, 0
    v_mov_b32 v99, 0
    v_mov_b32 v100, 0
    v_mov_b32 v101, 0
    v_mov_b32 v102, 0
    v_mov_b32 v103, 0
    v_mov_b32 v104, 0
    v_mov_b32 v105, 0
    v_mov_b32 v106, 0
    v_mov_b32 v107, 0
    v_mov_b32 v108, 0
    v_mov_b32 v109, 0
    v_mov_b32 v110, 0
    v_mov_b32 v111, 0
    v_mov_b32 v112, 0
    v_mov_b32 v113, 0
    v_mov_b32 v114, 0
    v_mov_b32 v115, 0
    v_mov_b32 v116, 0
    v_mov_b32 v117, 0
    v_mov_b32 v118, 0
    v_mov_b32 v119, 0
    v_mov_b32 v120, 0
    v_mov_b32 v121, 0
    v_mov_b32 v122, 0
    v_mov_b32 v123, 0
    v_mov_b32 v124, 0
    v_mov_b32 v125, 0
    v_mov_b32 v126, 0
    v_mov_b32 v127, 0
    v_mov_b32 v128, 0
    v_mov_b32 v144, 0
    v_mov_b32 v168, 0
    v_mov_b32 v129, 0
    v_mov_b32 v145, 0
    v_mov_b32 v169, 0
    v_mov_b32 v130, 0
    v_mov_b32 v146, 0
    v_mov_b32 v170, 0
    v_mov_b32 v131, 0
    v_mov_b32 v147, 0
    v_mov_b32 v171, 0
    v_mov_b32 v132, 0
    v_mov_b32 v148, 0
    v_mov_b32 v172, 0
    v_mov_b32 v133, 0
    v_mov_b32 v149, 0
    v_mov_b32 v173, 0
    v_mov_b32 v134, 0
    v_mov_b32 v150, 0
    v_mov_b32 v174, 0
    v_mov_b32 v135, 0
    v_mov_b32 v151, 0
    v_mov_b32 v175, 0
    v_accvgpr_write_b32 a0, 0
    v_accvgpr_write_b32 a1, 0
    v_accvgpr_write_b32 a2, 0
    v_accvgpr_write_b32 a3, 0
    v_accvgpr_write_b32 a4, 0
    v_accvgpr_write_b32 a5, 0
    v_accvgpr_write_b32 a6, 0
    v_accvgpr_write_b32 a7, 0
    v_accvgpr_write_b32 a8, 0
    v_accvgpr_write_b32 a9, 0
    v_accvgpr_write_b32 a10, 0
    v_accvgpr_write_b32 a11, 0
    v_accvgpr_write_b32 a12, 0
    v_accvgpr_write_b32 a13, 0
    v_accvgpr_write_b32 a14, 0
    v_accvgpr_write_b32 a15, 0
    v_accvgpr_write_b32 a80, 0
    v_accvgpr_write_b32 a81, 0
    v_accvgpr_write_b32 a82, 0
    v_accvgpr_write_b32 a83, 0
    v_lshrrev_b32 v224, 5, v1
    v_bfe_u32 v225, v1, 4, 1
    v_bfe_u32 v226, v1, 2, 2
    v_and_b32 v227, 3, v1
    v_lshl_add_u32 v228, v224, 3, v226
    v_lshlrev_b32 v228, 7, v228
    v_lshl_add_u32 v228, v225, 5, v228
    v_lshl_add_u32 v228, v227, 3, v228
    v_lshrrev_b32 v229, 1, v226
    v_lshlrev_b32 v229, 6, v229
    v_add_u32 v232, v228, v229
    v_sub_u32 v233, v228, v229
    v_add_u32 v233, 64, v233
    v_add_u32 v239, s25, v232
    v_add_u32 v240, s25, v233
    v_add_u32 v232, s56, v232
    v_add_u32 v233, s56, v233
    s_lshl_b32 s33, s26, 9
    s_add_u32 s33, s33, 161792
    v_lshl_add_u32 v234, v1, 1, s33
    v_and_b32 v235, 31, v1
    v_lshrrev_b32 v236, 5, v1
    v_lshlrev_b32 v236, 4, v236
    v_lshl_add_u32 v236, v235, 7, v236
    v_add_u32 v236, s33, v236
    s_lshl_b32 s32, s2, 8
    v_add_u32 v224, s32, v0
    v_subrev_u32 v208, 0, v224
    v_cmp_gt_u32 vcc, 57344, v208
    v_and_b32 v209, 7, v208
    v_lshrrev_b32 v208, 3, v208
    v_lshrrev_b32 v210, 1, v208
    v_and_b32 v211, 1, v208
    v_lshlrev_b32 v211, 10, v211
    v_mul_u32_u24 v210, 2048, v210
    v_add3_u32 v210, v210, v211, 0
    v_lshl_add_u32 v210, v209, 4, v210
    v_add_u32 v210, 256, v210
    v_mov_b32 v211, 0x80000000
    v_cndmask_b32 v210, v211, v210, vcc
    v_lshlrev_b32 v208, 9, v208
    v_lshl_add_u32 v208, v209, 4, v208
    v_add_u32 v208, 0, v208
    v_cndmask_b32 v208, v211, v208, vcc
    v_subrev_u32 v216, 0, v224
    v_cmp_gt_u32 vcc, 57344, v216
    v_and_b32 v217, 7, v216
    v_lshrrev_b32 v216, 3, v216
    v_lshrrev_b32 v218, 1, v216
    v_and_b32 v219, 1, v216
    v_lshlrev_b32 v219, 10, v219
    v_mul_u32_u24 v218, 2048, v218
    v_add3_u32 v218, v218, v219, 0
    v_lshl_add_u32 v218, v217, 4, v218
    v_add_u32 v218, 384, v218
    v_mov_b32 v219, 0x80000000
    v_cndmask_b32 v218, v219, v218, vcc
    v_lshlrev_b32 v216, 9, v216
    v_lshl_add_u32 v216, v217, 4, v216
    v_add_u32 v216, 256, v216
    v_cndmask_b32 v216, v219, v216, vcc
    s_add_u32 s12, s38, 720896
    s_addc_u32 s13, s39, 0
    s_mov_b32 s14, 294912
    s_mov_b32 s15, 0x20000
    s_lshl_b32 s32, s100, 7
    s_lshl_b32 s59, s59, 7
    v_mov_b32 v30, 1
    v_mov_b32 v31, s32
    s_waitcnt vmcnt(0)
    s_barrier
    s_cmp_lg_u32 s26, 0
    s_cbranch_scc1 hq_nf
    s_mov_b64 exec, 1
    buffer_store_dword v30, v31, s[12:15], 0 offen sc1
    s_mov_b64 exec, -1
hq_nf:
    s_cmp_ge_u32 s54, 112
    s_cbranch_scc1 att_ps
    v_add_f32 v200, v200, v201
    v_add_f32 v202, v202, v203
    v_cvt_pk_bf16_f32 v200, v200, v200
    v_and_b32 v200, 0xffff0000, v200
    v_add_f32 v200, 1.0, v200
    v_add_f32 v204, v204, v205
    v_add_f32 v206, v206, v207
    v_cvt_pk_bf16_f32 v204, v204, v204
    v_and_b32 v204, 0xffff0000, v204
    v_add_f32 v204, 1.0, v204
    s_mul_i32 s100, s53, 57344
    s_lshl_b32 s32, s54, 8
    s_add_u32 s100, s100, s32
    s_mul_i32 s32, s26, 28672
    s_add_u32 s100, s100, s32
    s_add_u32 s100, s100, 65536
    s_mov_b32 s37, 2
    s_branch att_pd
att_ps:
    v_lshlrev_b32 v200, 16, v200
    v_mul_f32 v201, 0xbfb8aa3b, v200
    v_exp_f32 v201, v201
    s_nop 0
    v_add_f32 v201, 1.0, v201
    v_rcp_f32 v201, v201
    s_nop 0
    v_mul_f32 v200, v200, v201
    v_lshlrev_b32 v204, 16, v204
    v_mul_f32 v205, 0xbfb8aa3b, v204
    v_exp_f32 v205, v205
    s_nop 0
    v_add_f32 v205, 1.0, v205
    v_rcp_f32 v205, v205
    s_nop 0
    v_mul_f32 v204, v204, v205
    s_mul_i32 s100, s53, 24576
    s_sub_u32 s32, s54, 80
    s_lshl_b32 s32, s32, 8
    s_add_u32 s100, s100, s32
    s_mov_b32 s37, 1
att_pd:
    v_cvt_pk_bf16_f32 v200, v200, v200
    v_cvt_pk_bf16_f32 v202, v202, v202
    ds_write_b16 v234, v200 offset:0
    ds_write_b16 v234, v202 offset:128
    v_cvt_pk_bf16_f32 v204, v204, v204
    v_cvt_pk_bf16_f32 v206, v206, v206
    ds_write_b16 v234, v204 offset:256
    ds_write_b16 v234, v206 offset:384
    v_lshlrev_b32 v198, 16, v198
    v_mul_f32 v199, 0xbfb8aa3b, v198
    v_exp_f32 v199, v199
    s_nop 0
    v_add_f32 v199, 1.0, v199
    v_rcp_f32 v199, v199
    s_nop 0
    v_mul_f32 v198, v198, v199
    v_cvt_pk_bf16_f32 v198, v198, v198
    v_subrev_u32 v234, 4096, v234
    ds_write_b16 v234, v198
    v_subrev_u32 v241, 4096, v236
    s_sub_u32 s33, s33, 94208
    v_lshl_add_u32 v234, v1, 2, s33
    v_add_u32 v242, 92160, v234
    s_lshl_b32 s33, s26, 8
    s_add_u32 s33, s33, 67584
    s_lshl_b32 s32, s55, 8
    s_add_u32 s32, s32, 196608
    s_cmp_eq_u32 s26, 2
    s_cselect_b32 s33, 159744, s33
    s_cselect_b32 s100, s32, s100
    s_cselect_b32 s37, 3, s37
    v_lshl_add_u32 v238, v1, 2, s33
    v_lshlrev_b32 v237, 2, v1
    s_cmp_lg_u32 s26, 0
    s_cbranch_scc1 hq_go
    v_and_b32 v30, 15, v1
    v_lshlrev_b32 v30, 7, v30
    v_add_u32 v30, s59, v30
hq_poll:
    buffer_load_dword v31, v30, s[12:15], 0 offen sc1
    s_waitcnt vmcnt(0)
    v_cmp_eq_u32 vcc, 1, v31
    s_cmp_eq_u64 vcc, -1
    s_cbranch_scc0 hq_poll
hq_go:
    s_waitcnt vmcnt(0)
    s_barrier
    buffer_load_dwordx4 v[152:155], v2, s[28:31], 0 offen sc1
    buffer_load_dwordx4 v[156:159], v2, s[28:31], 0 offen offset:1024 sc1
    buffer_load_dwordx4 v[8:11], v2, s[16:19], s36 offen offset:0 sc1
    buffer_load_dwordx4 v[12:15], v2, s[16:19], s36 offen offset:1024 sc1
    buffer_load_dwordx4 v[16:19], v2, s[16:19], s36 offen offset:2048 sc1
    buffer_load_dwordx4 v[20:23], v2, s[16:19], s36 offen offset:3072 sc1
    s_add_u32 m0, s51, 0
    s_nop 0
    buffer_load_dwordx4 v2, s[28:31], s52 offen offset:0 sc1 lds
    buffer_load_dwordx4 v2, s[28:31], s52 offen offset:1024 sc1 lds
    buffer_load_dwordx4 v2, s[28:31], s52 offen offset:2048 sc1 lds
    buffer_load_dwordx4 v2, s[28:31], s52 offen offset:3072 sc1 lds
    s_add_u32 s52, s52, 16384
    s_mov_b32 s12, s98
    s_mov_b32 s13, s99
    s_mov_b32 s14, 7340032
    s_mov_b32 s15, 0x20000
    s_add_u32 s16, s60, 1048576
    s_addc_u32 s17, s61, 0
    s_mov_b32 s18, 1048576
    s_mov_b32 s19, 0x20000
    s_add_u32 m0, s51, 16384
    s_nop 0
    buffer_load_dwordx4 v2, s[28:31], s52 offen offset:0 sc1 lds
    buffer_load_dwordx4 v2, s[28:31], s52 offen offset:1024 sc1 lds
    buffer_load_dwordx4 v2, s[28:31], s52 offen offset:2048 sc1 lds
    buffer_load_dwordx4 v2, s[28:31], s52 offen offset:3072 sc1 lds
    s_add_u32 s52, s52, 16384
    s_waitcnt vmcnt(8)
    v_mfma_f32_32x32x16_bf16 v[64:79], v[152:155], v[8:11], 0
    v_mfma_f32_32x32x16_bf16 v[64:79], v[156:159], v[12:15], v[64:79]
    v_mfma_f32_32x32x16_bf16 v[80:95], v[152:155], v[16:19], 0
    v_mfma_f32_32x32x16_bf16 v[80:95], v[156:159], v[20:23], v[80:95]
    s_nop 9
    v_mov_b32 v176, v64
    v_max3_f32 v176, v64, v65, v176
    v_max3_f32 v176, v66, v67, v176
    v_max3_f32 v176, v68, v69, v176
    v_max3_f32 v176, v70, v71, v176
    v_max3_f32 v176, v72, v73, v176
    v_max3_f32 v176, v74, v75, v176
    v_max3_f32 v176, v76, v77, v176
    v_max3_f32 v176, v78, v79, v176
    v_mov_b32 v177, v176
    s_nop 1
    v_permlane32_swap_b32 v176, v177
    v_max_f32 v176, v176, v177
    v_sub_f32 v32, 0, v176
    v_sub_f32 v33, 0, v176
    v_sub_f32 v34, 0, v176
    v_sub_f32 v35, 0, v176
    v_sub_f32 v36, 0, v176
    v_sub_f32 v37, 0, v176
    v_sub_f32 v38, 0, v176
    v_sub_f32 v39, 0, v176
    v_sub_f32 v40, 0, v176
    v_sub_f32 v41, 0, v176
    v_sub_f32 v42, 0, v176
    v_sub_f32 v43, 0, v176
    v_sub_f32 v44, 0, v176
    v_sub_f32 v45, 0, v176
    v_sub_f32 v46, 0, v176
    v_sub_f32 v47, 0, v176
    v_sub_f32 v64, v64, v176
    v_sub_f32 v65, v65, v176
    v_sub_f32 v66, v66, v176
    v_sub_f32 v67, v67, v176
    v_sub_f32 v68, v68, v176
    v_sub_f32 v69, v69, v176
    v_sub_f32 v70, v70, v176
    v_sub_f32 v71, v71, v176
    v_sub_f32 v72, v72, v176
    v_sub_f32 v73, v73, v176
    v_sub_f32 v74, v74, v176
    v_sub_f32 v75, v75, v176
    v_sub_f32 v76, v76, v176
    v_sub_f32 v77, v77, v176
    v_sub_f32 v78, v78, v176
    v_sub_f32 v79, v79, v176
    s_add_u32 m0, s51, 32768
    s_nop 0
    buffer_load_dwordx4 v2, s[28:31], s52 offen offset:0 sc1 lds
    buffer_load_dwordx4 v2, s[28:31], s52 offen offset:1024 sc1 lds
    buffer_load_dwordx4 v2, s[28:31], s52 offen offset:2048 sc1 lds
    buffer_load_dwordx4 v2, s[28:31], s52 offen offset:3072 sc1 lds
    s_add_u32 s52, s52, 16384
    v_mov_b32 v176, v80
    v_max3_f32 v176, v80, v81, v176
    v_max3_f32 v176, v82, v83, v176
    v_max3_f32 v176, v84, v85, v176
    v_max3_f32 v176, v86, v87, v176
    v_max3_f32 v176, v88, v89, v176
    v_max3_f32 v176, v90, v91, v176
    v_max3_f32 v176, v92, v93, v176
    v_max3_f32 v176, v94, v95, v176
    v_mov_b32 v177, v176
    s_nop 1
    v_permlane32_swap_b32 v176, v177
    v_max_f32 v176, v176, v177
    v_sub_f32 v48, 0, v176
    v_sub_f32 v49, 0, v176
    v_sub_f32 v50, 0, v176
    v_sub_f32 v51, 0, v176
    v_sub_f32 v52, 0, v176
    v_sub_f32 v53, 0, v176
    v_sub_f32 v54, 0, v176
    v_sub_f32 v55, 0, v176
    v_sub_f32 v56, 0, v176
    v_sub_f32 v57, 0, v176
    v_sub_f32 v58, 0, v176
    v_sub_f32 v59, 0, v176
    v_sub_f32 v60, 0, v176
    v_sub_f32 v61, 0, v176
    v_sub_f32 v62, 0, v176
    v_sub_f32 v63, 0, v176
    s_mov_b32 m0, s56
    s_sub_u32 s52, s52, 16384
    buffer_load_dwordx4 v195, s[4:7], s27 offen lds
    buffer_load_dwordx4 v196, s[4:7], s27 offen offset:1024 lds
    s_add_u32 s56, s56, 2048
    s_add_u32 s27, s27, s57
    s_mov_b32 m0, s56
    s_nop 0
    buffer_load_dwordx4 v195, s[4:7], s27 offen lds
    buffer_load_dwordx4 v196, s[4:7], s27 offen offset:1024 lds
    s_waitcnt vmcnt(12)
    s_barrier
    ds_read_b128 v[160:163], v2 offset:2048
    ds_read_b128 v[164:167], v2 offset:3072
    s_mov_b32 s36, 2
.p2align 6
attn_loop0:
    v_mfma_f32_32x32x16_bf16 v[80:95], v[152:155], v[16:19], v[48:63]
    ds_read_b128 v[152:155], v2 offset:4096
    v_exp_f32 v64, v64
    v_exp_f32 v65, v65
    v_exp_f32 v66, v66
    v_exp_f32 v67, v67
    v_cvt_pk_bf16_f32 v136, v64, v65
    v_mfma_f32_32x32x16_bf16 v[80:95], v[156:159], v[20:23], v[80:95]
    ds_read_b128 v[156:159], v2 offset:5120
    v_exp_f32 v68, v68
    v_exp_f32 v69, v69
    v_exp_f32 v70, v70
    v_cvt_pk_bf16_f32 v137, v66, v67
    v_cvt_pk_bf16_f32 v138, v68, v69
    v_mfma_f32_32x32x16_bf16 v[112:127], v[168:171], v[144:147], v[112:127]
    s_add_u32 m0, s51, 49152
    v_exp_f32 v71, v71
    v_exp_f32 v72, v72
    v_exp_f32 v73, v73
    v_cvt_pk_bf16_f32 v139, v70, v71
    v_cvt_pk_bf16_f32 v140, v72, v73
    v_mfma_f32_32x32x16_bf16 v[112:127], v[172:175], v[148:151], v[112:127]
    s_waitcnt lgkmcnt(1)
    v_exp_f32 v74, v74
    v_exp_f32 v75, v75
    v_exp_f32 v76, v76
    v_cvt_pk_bf16_f32 v141, v74, v75
    v_smfmac_f32_16x16x64_bf16 v[132:135], v[24:27], v[144:151], v28
    ds_read_b128 v[168:171], v2 offset:6144
    v_exp_f32 v77, v77
    v_exp_f32 v78, v78
    v_exp_f32 v79, v79
    v_cvt_pk_bf16_f32 v142, v76, v77
    v_cvt_pk_bf16_f32 v143, v78, v79
    v_mfma_f32_32x32x16_bf16 v[64:79], v[152:155], v[8:11], v[32:47]
    s_waitcnt lgkmcnt(1)
    v_exp_f32 v80, v80
    v_exp_f32 v81, v81
    v_exp_f32 v82, v82
    v_exp_f32 v83, v83
    v_cvt_pk_bf16_f32 v144, v80, v81
    v_mfma_f32_32x32x16_bf16 v[64:79], v[156:159], v[12:15], v[64:79]
    s_add_u32 s52, s52, 16384
    v_exp_f32 v84, v84
    v_exp_f32 v85, v85
    v_exp_f32 v86, v86
    v_cvt_pk_bf16_f32 v145, v82, v83
    v_cvt_pk_bf16_f32 v146, v84, v85
    v_mfma_f32_32x32x16_bf16 v[96:111], v[160:163], v[136:139], v[96:111]
    s_waitcnt vmcnt(7)
    v_exp_f32 v87, v87
    v_exp_f32 v88, v88
    v_exp_f32 v89, v89
    v_cvt_pk_bf16_f32 v147, v86, v87
    v_cvt_pk_bf16_f32 v148, v88, v89
    v_mfma_f32_32x32x16_bf16 v[96:111], v[164:167], v[140:143], v[96:111]
    s_barrier
    v_exp_f32 v90, v90
    v_exp_f32 v91, v91
    v_exp_f32 v92, v92
    v_cvt_pk_bf16_f32 v149, v90, v91
    v_smfmac_f32_16x16x64_bf16 v[128:131], v[24:27], v[136:143], v28
    ds_read_b128 v[172:175], v2 offset:7168
    v_exp_f32 v93, v93
    v_exp_f32 v94, v94
    v_exp_f32 v95, v95
    v_cvt_pk_bf16_f32 v150, v92, v93
    v_cvt_pk_bf16_f32 v151, v94, v95
    v_mfma_f32_32x32x16_bf16 v[80:95], v[152:155], v[16:19], v[48:63]
    ds_read_b128 v[152:155], v2 offset:8192
    v_exp_f32 v64, v64
    v_exp_f32 v65, v65
    v_exp_f32 v66, v66
    v_exp_f32 v67, v67
    v_cvt_pk_bf16_f32 v136, v64, v65
    v_mfma_f32_32x32x16_bf16 v[80:95], v[156:159], v[20:23], v[80:95]
    ds_read_b128 v[156:159], v2 offset:9216
    v_exp_f32 v68, v68
    v_exp_f32 v69, v69
    v_exp_f32 v70, v70
    v_cvt_pk_bf16_f32 v137, v66, v67
    v_cvt_pk_bf16_f32 v138, v68, v69
    v_mfma_f32_32x32x16_bf16 v[112:127], v[160:163], v[144:147], v[112:127]
    buffer_load_dwordx4 v2, s[28:31], s52 offen offset:0 sc1 lds
    v_exp_f32 v71, v71
    v_exp_f32 v72, v72
    v_exp_f32 v73, v73
    v_cvt_pk_bf16_f32 v139, v70, v71
    v_cvt_pk_bf16_f32 v140, v72, v73
    v_mfma_f32_32x32x16_bf16 v[112:127], v[164:167], v[148:151], v[112:127]
    s_waitcnt lgkmcnt(1)
    s_add_u32 s27, s27, s57
    v_exp_f32 v74, v74
    v_exp_f32 v75, v75
    v_exp_f32 v76, v76
    v_cvt_pk_bf16_f32 v141, v74, v75
    v_smfmac_f32_16x16x64_bf16 v[132:135], v[24:27], v[144:151], v28
    ds_read_b128 v[160:163], v2 offset:10240
    v_exp_f32 v77, v77
    v_exp_f32 v78, v78
    v_exp_f32 v79, v79
    v_cvt_pk_bf16_f32 v142, v76, v77
    v_cvt_pk_bf16_f32 v143, v78, v79
    v_mfma_f32_32x32x16_bf16 v[64:79], v[152:155], v[8:11], v[32:47]
    s_waitcnt lgkmcnt(1)
    v_exp_f32 v80, v80
    v_exp_f32 v81, v81
    v_exp_f32 v82, v82
    v_exp_f32 v83, v83
    v_cvt_pk_bf16_f32 v144, v80, v81
    v_mfma_f32_32x32x16_bf16 v[64:79], v[156:159], v[12:15], v[64:79]
    buffer_load_dwordx4 v2, s[28:31], s52 offen offset:1024 sc1 lds
    v_exp_f32 v84, v84
    v_exp_f32 v85, v85
    v_exp_f32 v86, v86
    v_cvt_pk_bf16_f32 v145, v82, v83
    v_cvt_pk_bf16_f32 v146, v84, v85
    v_mfma_f32_32x32x16_bf16 v[96:111], v[168:171], v[136:139], v[96:111]
    s_add_u32 s56, s56, 2048
    v_exp_f32 v87, v87
    v_exp_f32 v88, v88
    v_exp_f32 v89, v89
    v_cvt_pk_bf16_f32 v147, v86, v87
    v_cvt_pk_bf16_f32 v148, v88, v89
    v_mfma_f32_32x32x16_bf16 v[96:111], v[172:175], v[140:143], v[96:111]
    buffer_load_dwordx4 v2, s[28:31], s52 offen offset:2048 sc1 lds
    v_exp_f32 v90, v90
    v_exp_f32 v91, v91
    v_exp_f32 v92, v92
    v_cvt_pk_bf16_f32 v149, v90, v91
    v_smfmac_f32_16x16x64_bf16 v[128:131], v[24:27], v[136:143], v28
    ds_read_b128 v[164:167], v2 offset:11264
    v_exp_f32 v93, v93
    v_exp_f32 v94, v94
    v_exp_f32 v95, v95
    v_cvt_pk_bf16_f32 v150, v92, v93
    v_cvt_pk_bf16_f32 v151, v94, v95
    v_mfma_f32_32x32x16_bf16 v[80:95], v[152:155], v[16:19], v[48:63]
    ds_read_b128 v[152:155], v2 offset:12288
    v_exp_f32 v64, v64
    v_exp_f32 v65, v65
    v_exp_f32 v66, v66
    v_exp_f32 v67, v67
    v_cvt_pk_bf16_f32 v136, v64, v65
    v_mfma_f32_32x32x16_bf16 v[80:95], v[156:159], v[20:23], v[80:95]
    ds_read_b128 v[156:159], v2 offset:13312
    v_exp_f32 v68, v68
    v_exp_f32 v69, v69
    v_exp_f32 v70, v70
    v_cvt_pk_bf16_f32 v137, v66, v67
    v_cvt_pk_bf16_f32 v138, v68, v69
    v_mfma_f32_32x32x16_bf16 v[112:127], v[168:171], v[144:147], v[112:127]
    buffer_load_dwordx4 v2, s[28:31], s52 offen offset:3072 sc1 lds
    v_exp_f32 v71, v71
    v_exp_f32 v72, v72
    v_exp_f32 v73, v73
    v_cvt_pk_bf16_f32 v139, v70, v71
    v_cvt_pk_bf16_f32 v140, v72, v73
    v_mfma_f32_32x32x16_bf16 v[112:127], v[172:175], v[148:151], v[112:127]
    s_waitcnt lgkmcnt(1)
    s_mov_b32 m0, s56
    v_exp_f32 v74, v74
    v_exp_f32 v75, v75
    v_exp_f32 v76, v76
    v_cvt_pk_bf16_f32 v141, v74, v75
    v_smfmac_f32_16x16x64_bf16 v[132:135], v[24:27], v[144:151], v28
    ds_read_b128 v[168:171], v2 offset:14336
    v_exp_f32 v77, v77
    v_exp_f32 v78, v78
    v_exp_f32 v79, v79
    v_cvt_pk_bf16_f32 v142, v76, v77
    v_cvt_pk_bf16_f32 v143, v78, v79
    v_mfma_f32_32x32x16_bf16 v[64:79], v[152:155], v[8:11], v[32:47]
    s_waitcnt lgkmcnt(1)
    v_exp_f32 v80, v80
    v_exp_f32 v81, v81
    v_exp_f32 v82, v82
    v_exp_f32 v83, v83
    v_cvt_pk_bf16_f32 v144, v80, v81
    v_mfma_f32_32x32x16_bf16 v[64:79], v[156:159], v[12:15], v[64:79]
    buffer_load_dwordx4 v195, s[4:7], s27 offen lds
    v_exp_f32 v84, v84
    v_exp_f32 v85, v85
    v_exp_f32 v86, v86
    v_cvt_pk_bf16_f32 v145, v82, v83
    v_cvt_pk_bf16_f32 v146, v84, v85
    v_mfma_f32_32x32x16_bf16 v[96:111], v[160:163], v[136:139], v[96:111]
    v_exp_f32 v87, v87
    v_exp_f32 v88, v88
    v_exp_f32 v89, v89
    v_cvt_pk_bf16_f32 v147, v86, v87
    v_cvt_pk_bf16_f32 v148, v88, v89
    v_mfma_f32_32x32x16_bf16 v[96:111], v[164:167], v[140:143], v[96:111]
    buffer_load_dwordx4 v196, s[4:7], s27 offen offset:1024 lds
    v_exp_f32 v90, v90
    v_exp_f32 v91, v91
    v_exp_f32 v92, v92
    v_cvt_pk_bf16_f32 v149, v90, v91
    v_smfmac_f32_16x16x64_bf16 v[128:131], v[24:27], v[136:143], v28
    ds_read_b128 v[172:175], v2 offset:15360
    v_exp_f32 v93, v93
    v_exp_f32 v94, v94
    v_exp_f32 v95, v95
    v_cvt_pk_bf16_f32 v150, v92, v93
    v_cvt_pk_bf16_f32 v151, v94, v95
    v_mfma_f32_32x32x16_bf16 v[80:95], v[152:155], v[16:19], v[48:63]
    ds_read_b128 v[152:155], v2 offset:16384
    v_exp_f32 v64, v64
    v_exp_f32 v65, v65
    v_exp_f32 v66, v66
    v_exp_f32 v67, v67
    v_cvt_pk_bf16_f32 v136, v64, v65
    v_mfma_f32_32x32x16_bf16 v[80:95], v[156:159], v[20:23], v[80:95]
    ds_read_b128 v[156:159], v2 offset:17408
    v_exp_f32 v68, v68
    v_exp_f32 v69, v69
    v_exp_f32 v70, v70
    v_cvt_pk_bf16_f32 v137, v66, v67
    v_cvt_pk_bf16_f32 v138, v68, v69
    v_mfma_f32_32x32x16_bf16 v[112:127], v[160:163], v[144:147], v[112:127]
    s_mov_b32 m0, s25
    v_exp_f32 v71, v71
    v_exp_f32 v72, v72
    v_exp_f32 v73, v73
    v_cvt_pk_bf16_f32 v139, v70, v71
    v_cvt_pk_bf16_f32 v140, v72, v73
    v_mfma_f32_32x32x16_bf16 v[112:127], v[164:167], v[148:151], v[112:127]
    s_waitcnt lgkmcnt(1)
    v_exp_f32 v74, v74
    v_exp_f32 v75, v75
    v_exp_f32 v76, v76
    v_cvt_pk_bf16_f32 v141, v74, v75
    v_smfmac_f32_16x16x64_bf16 v[132:135], v[24:27], v[144:151], v28
    ds_read_b128 v[160:163], v2 offset:18432
    v_exp_f32 v77, v77
    v_exp_f32 v78, v78
    v_exp_f32 v79, v79
    v_cvt_pk_bf16_f32 v142, v76, v77
    v_cvt_pk_bf16_f32 v143, v78, v79
    v_mfma_f32_32x32x16_bf16 v[64:79], v[152:155], v[8:11], v[32:47]
    s_waitcnt lgkmcnt(1)
    v_exp_f32 v80, v80
    v_exp_f32 v81, v81
    v_exp_f32 v82, v82
    v_exp_f32 v83, v83
    v_cvt_pk_bf16_f32 v144, v80, v81
    v_mfma_f32_32x32x16_bf16 v[64:79], v[156:159], v[12:15], v[64:79]
    buffer_load_dwordx4 v197, s[20:23], s101 offen nt lds
    v_exp_f32 v84, v84
    v_exp_f32 v85, v85
    v_exp_f32 v86, v86
    v_cvt_pk_bf16_f32 v145, v82, v83
    v_cvt_pk_bf16_f32 v146, v84, v85
    v_mfma_f32_32x32x16_bf16 v[96:111], v[168:171], v[136:139], v[96:111]
    s_add_u32 s101, s101, 98304
    v_exp_f32 v87, v87
    v_exp_f32 v88, v88
    v_exp_f32 v89, v89
    v_cvt_pk_bf16_f32 v147, v86, v87
    v_cvt_pk_bf16_f32 v148, v88, v89
    v_mfma_f32_32x32x16_bf16 v[96:111], v[172:175], v[140:143], v[96:111]
    s_add_u32 s25, s25, 1024
    v_exp_f32 v90, v90
    v_exp_f32 v91, v91
    v_exp_f32 v92, v92
    v_cvt_pk_bf16_f32 v149, v90, v91
    v_smfmac_f32_16x16x64_bf16 v[128:131], v[24:27], v[136:143], v28
    ds_read_b128 v[164:167], v2 offset:19456
    v_exp_f32 v93, v93
    v_exp_f32 v94, v94
    v_exp_f32 v95, v95
    v_cvt_pk_bf16_f32 v150, v92, v93
    v_cvt_pk_bf16_f32 v151, v94, v95
    v_mfma_f32_32x32x16_bf16 v[80:95], v[152:155], v[16:19], v[48:63]
    ds_read_b128 v[152:155], v2 offset:20480
    v_exp_f32 v64, v64
    v_exp_f32 v65, v65
    v_exp_f32 v66, v66
    v_exp_f32 v67, v67
    v_cvt_pk_bf16_f32 v136, v64, v65
    v_mfma_f32_32x32x16_bf16 v[80:95], v[156:159], v[20:23], v[80:95]
    ds_read_b128 v[156:159], v2 offset:21504
    v_exp_f32 v68, v68
    v_exp_f32 v69, v69
    v_exp_f32 v70, v70
    v_cvt_pk_bf16_f32 v137, v66, v67
    v_cvt_pk_bf16_f32 v138, v68, v69
    v_mfma_f32_32x32x16_bf16 v[112:127], v[168:171], v[144:147], v[112:127]
    s_add_u32 m0, s51, 0
    v_exp_f32 v71, v71
    v_exp_f32 v72, v72
    v_exp_f32 v73, v73
    v_cvt_pk_bf16_f32 v139, v70, v71
    v_cvt_pk_bf16_f32 v140, v72, v73
    v_mfma_f32_32x32x16_bf16 v[112:127], v[172:175], v[148:151], v[112:127]
    s_waitcnt lgkmcnt(1)
    v_exp_f32 v74, v74
    v_exp_f32 v75, v75
    v_exp_f32 v76, v76
    v_cvt_pk_bf16_f32 v141, v74, v75
    v_smfmac_f32_16x16x64_bf16 v[132:135], v[24:27], v[144:151], v28
    ds_read_b128 v[168:171], v2 offset:22528
    v_exp_f32 v77, v77
    v_exp_f32 v78, v78
    v_exp_f32 v79, v79
    v_cvt_pk_bf16_f32 v142, v76, v77
    v_cvt_pk_bf16_f32 v143, v78, v79
    v_mfma_f32_32x32x16_bf16 v[64:79], v[152:155], v[8:11], v[32:47]
    s_waitcnt lgkmcnt(1)
    v_exp_f32 v80, v80
    v_exp_f32 v81, v81
    v_exp_f32 v82, v82
    v_exp_f32 v83, v83
    v_cvt_pk_bf16_f32 v144, v80, v81
    v_mfma_f32_32x32x16_bf16 v[64:79], v[156:159], v[12:15], v[64:79]
    s_add_u32 s52, s52, 16384
    v_exp_f32 v84, v84
    v_exp_f32 v85, v85
    v_exp_f32 v86, v86
    v_cvt_pk_bf16_f32 v145, v82, v83
    v_cvt_pk_bf16_f32 v146, v84, v85
    v_mfma_f32_32x32x16_bf16 v[96:111], v[160:163], v[136:139], v[96:111]
    s_waitcnt vmcnt(8)
    v_exp_f32 v87, v87
    v_exp_f32 v88, v88
    v_exp_f32 v89, v89
    v_cvt_pk_bf16_f32 v147, v86, v87
    v_cvt_pk_bf16_f32 v148, v88, v89
    v_mfma_f32_32x32x16_bf16 v[96:111], v[164:167], v[140:143], v[96:111]
    s_barrier
    v_exp_f32 v90, v90
    v_exp_f32 v91, v91
    v_exp_f32 v92, v92
    v_cvt_pk_bf16_f32 v149, v90, v91
    v_smfmac_f32_16x16x64_bf16 v[128:131], v[24:27], v[136:143], v28
    ds_read_b128 v[172:175], v2 offset:23552
    v_exp_f32 v93, v93
    v_exp_f32 v94, v94
    v_exp_f32 v95, v95
    v_cvt_pk_bf16_f32 v150, v92, v93
    v_cvt_pk_bf16_f32 v151, v94, v95
    v_mfma_f32_32x32x16_bf16 v[80:95], v[152:155], v[16:19], v[48:63]
    ds_read_b128 v[152:155], v2 offset:24576
    v_exp_f32 v64, v64
    v_exp_f32 v65, v65
    v_exp_f32 v66, v66
    v_exp_f32 v67, v67
    v_cvt_pk_bf16_f32 v136, v64, v65
    v_mfma_f32_32x32x16_bf16 v[80:95], v[156:159], v[20:23], v[80:95]
    ds_read_b128 v[156:159], v2 offset:25600
    v_exp_f32 v68, v68
    v_exp_f32 v69, v69
    v_exp_f32 v70, v70
    v_cvt_pk_bf16_f32 v137, v66, v67
    v_cvt_pk_bf16_f32 v138, v68, v69
    v_mfma_f32_32x32x16_bf16 v[112:127], v[160:163], v[144:147], v[112:127]
    buffer_load_dwordx4 v2, s[28:31], s52 offen offset:0 sc1 lds
    v_exp_f32 v71, v71
    v_exp_f32 v72, v72
    v_exp_f32 v73, v73
    v_cvt_pk_bf16_f32 v139, v70, v71
    v_cvt_pk_bf16_f32 v140, v72, v73
    v_mfma_f32_32x32x16_bf16 v[112:127], v[164:167], v[148:151], v[112:127]
    s_waitcnt lgkmcnt(1)
    s_add_u32 s27, s27, s57
    v_exp_f32 v74, v74
    v_exp_f32 v75, v75
    v_exp_f32 v76, v76
    v_cvt_pk_bf16_f32 v141, v74, v75
    v_smfmac_f32_16x16x64_bf16 v[132:135], v[24:27], v[144:151], v28
    ds_read_b128 v[160:163], v2 offset:26624
    v_exp_f32 v77, v77
    v_exp_f32 v78, v78
    v_exp_f32 v79, v79
    v_cvt_pk_bf16_f32 v142, v76, v77
    v_cvt_pk_bf16_f32 v143, v78, v79
    v_mfma_f32_32x32x16_bf16 v[64:79], v[152:155], v[8:11], v[32:47]
    s_waitcnt lgkmcnt(1)
    v_exp_f32 v80, v80
    v_exp_f32 v81, v81
    v_exp_f32 v82, v82
    v_exp_f32 v83, v83
    v_cvt_pk_bf16_f32 v144, v80, v81
    v_mfma_f32_32x32x16_bf16 v[64:79], v[156:159], v[12:15], v[64:79]
    buffer_load_dwordx4 v2, s[28:31], s52 offen offset:1024 sc1 lds
    v_exp_f32 v84, v84
    v_exp_f32 v85, v85
    v_exp_f32 v86, v86
    v_cvt_pk_bf16_f32 v145, v82, v83
    v_cvt_pk_bf16_f32 v146, v84, v85
    v_mfma_f32_32x32x16_bf16 v[96:111], v[168:171], v[136:139], v[96:111]
    s_add_u32 s56, s56, 2048
    v_exp_f32 v87, v87
    v_exp_f32 v88, v88
    v_exp_f32 v89, v89
    v_cvt_pk_bf16_f32 v147, v86, v87
    v_cvt_pk_bf16_f32 v148, v88, v89
    v_mfma_f32_32x32x16_bf16 v[96:111], v[172:175], v[140:143], v[96:111]
    buffer_load_dwordx4 v2, s[28:31], s52 offen offset:2048 sc1 lds
    v_exp_f32 v90, v90
    v_exp_f32 v91, v91
    v_exp_f32 v92, v92
    v_cvt_pk_bf16_f32 v149, v90, v91
    v_smfmac_f32_16x16x64_bf16 v[128:131], v[24:27], v[136:143], v28
    ds_read_b128 v[164:167], v2 offset:27648
    v_exp_f32 v93, v93
    v_exp_f32 v94, v94
    v_exp_f32 v95, v95
    v_cvt_pk_bf16_f32 v150, v92, v93
    v_cvt_pk_bf16_f32 v151, v94, v95
    v_mfma_f32_32x32x16_bf16 v[80:95], v[152:155], v[16:19], v[48:63]
    ds_read_b128 v[152:155], v2 offset:28672
    v_exp_f32 v64, v64
    v_exp_f32 v65, v65
    v_exp_f32 v66, v66
    v_exp_f32 v67, v67
    v_cvt_pk_bf16_f32 v136, v64, v65
    v_mfma_f32_32x32x16_bf16 v[80:95], v[156:159], v[20:23], v[80:95]
    ds_read_b128 v[156:159], v2 offset:29696
    v_exp_f32 v68, v68
    v_exp_f32 v69, v69
    v_exp_f32 v70, v70
    v_cvt_pk_bf16_f32 v137, v66, v67
    v_cvt_pk_bf16_f32 v138, v68, v69
    v_mfma_f32_32x32x16_bf16 v[112:127], v[168:171], v[144:147], v[112:127]
    buffer_load_dwordx4 v2, s[28:31], s52 offen offset:3072 sc1 lds
    v_exp_f32 v71, v71
    v_exp_f32 v72, v72
    v_exp_f32 v73, v73
    v_cvt_pk_bf16_f32 v139, v70, v71
    v_cvt_pk_bf16_f32 v140, v72, v73
    v_mfma_f32_32x32x16_bf16 v[112:127], v[172:175], v[148:151], v[112:127]
    s_waitcnt lgkmcnt(1)
    s_mov_b32 m0, s56
    v_exp_f32 v74, v74
    v_exp_f32 v75, v75
    v_exp_f32 v76, v76
    v_cvt_pk_bf16_f32 v141, v74, v75
    v_smfmac_f32_16x16x64_bf16 v[132:135], v[24:27], v[144:151], v28
    ds_read_b128 v[168:171], v2 offset:30720
    v_exp_f32 v77, v77
    v_exp_f32 v78, v78
    v_exp_f32 v79, v79
    v_cvt_pk_bf16_f32 v142, v76, v77
    v_cvt_pk_bf16_f32 v143, v78, v79
    v_mfma_f32_32x32x16_bf16 v[64:79], v[152:155], v[8:11], v[32:47]
    s_waitcnt lgkmcnt(1)
    v_exp_f32 v80, v80
    v_exp_f32 v81, v81
    v_exp_f32 v82, v82
    v_exp_f32 v83, v83
    v_cvt_pk_bf16_f32 v144, v80, v81
    v_mfma_f32_32x32x16_bf16 v[64:79], v[156:159], v[12:15], v[64:79]
    buffer_load_dwordx4 v195, s[4:7], s27 offen lds
    v_exp_f32 v84, v84
    v_exp_f32 v85, v85
    v_exp_f32 v86, v86
    v_cvt_pk_bf16_f32 v145, v82, v83
    v_cvt_pk_bf16_f32 v146, v84, v85
    v_mfma_f32_32x32x16_bf16 v[96:111], v[160:163], v[136:139], v[96:111]
    v_exp_f32 v87, v87
    v_exp_f32 v88, v88
    v_exp_f32 v89, v89
    v_cvt_pk_bf16_f32 v147, v86, v87
    v_cvt_pk_bf16_f32 v148, v88, v89
    v_mfma_f32_32x32x16_bf16 v[96:111], v[164:167], v[140:143], v[96:111]
    buffer_load_dwordx4 v196, s[4:7], s27 offen offset:1024 lds
    v_exp_f32 v90, v90
    v_exp_f32 v91, v91
    v_exp_f32 v92, v92
    v_cvt_pk_bf16_f32 v149, v90, v91
    v_smfmac_f32_16x16x64_bf16 v[128:131], v[24:27], v[136:143], v28
    ds_read_b128 v[172:175], v2 offset:31744
    v_exp_f32 v93, v93
    v_exp_f32 v94, v94
    v_exp_f32 v95, v95
    v_cvt_pk_bf16_f32 v150, v92, v93
    v_cvt_pk_bf16_f32 v151, v94, v95
    v_mfma_f32_32x32x16_bf16 v[80:95], v[152:155], v[16:19], v[48:63]
    ds_read_b128 v[152:155], v2 offset:32768
    v_exp_f32 v64, v64
    v_exp_f32 v65, v65
    v_exp_f32 v66, v66
    v_exp_f32 v67, v67
    v_cvt_pk_bf16_f32 v136, v64, v65
    v_mfma_f32_32x32x16_bf16 v[80:95], v[156:159], v[20:23], v[80:95]
    ds_read_b128 v[156:159], v2 offset:33792
    v_exp_f32 v68, v68
    v_exp_f32 v69, v69
    v_exp_f32 v70, v70
    v_cvt_pk_bf16_f32 v137, v66, v67
    v_cvt_pk_bf16_f32 v138, v68, v69
    v_mfma_f32_32x32x16_bf16 v[112:127], v[160:163], v[144:147], v[112:127]
    v_exp_f32 v71, v71
    v_exp_f32 v72, v72
    v_exp_f32 v73, v73
    v_cvt_pk_bf16_f32 v139, v70, v71
    v_cvt_pk_bf16_f32 v140, v72, v73
    v_mfma_f32_32x32x16_bf16 v[112:127], v[164:167], v[148:151], v[112:127]
    s_waitcnt lgkmcnt(1)
    v_exp_f32 v74, v74
    v_exp_f32 v75, v75
    v_exp_f32 v76, v76
    v_cvt_pk_bf16_f32 v141, v74, v75
    v_smfmac_f32_16x16x64_bf16 v[132:135], v[24:27], v[144:151], v28
    ds_read_b128 v[160:163], v2 offset:34816
    v_exp_f32 v77, v77
    v_exp_f32 v78, v78
    v_exp_f32 v79, v79
    v_cvt_pk_bf16_f32 v142, v76, v77
    v_cvt_pk_bf16_f32 v143, v78, v79
    v_mfma_f32_32x32x16_bf16 v[64:79], v[152:155], v[8:11], v[32:47]
    s_waitcnt lgkmcnt(1)
    v_exp_f32 v80, v80
    v_exp_f32 v81, v81
    v_exp_f32 v82, v82
    v_exp_f32 v83, v83
    v_cvt_pk_bf16_f32 v144, v80, v81
    v_mfma_f32_32x32x16_bf16 v[64:79], v[156:159], v[12:15], v[64:79]
    buffer_load_dword v181, v182, s[12:15], s3 offen
    v_exp_f32 v84, v84
    v_exp_f32 v85, v85
    v_exp_f32 v86, v86
    v_cvt_pk_bf16_f32 v145, v82, v83
    v_cvt_pk_bf16_f32 v146, v84, v85
    v_mfma_f32_32x32x16_bf16 v[96:111], v[168:171], v[136:139], v[96:111]
    s_add_u32 s3, s3, 1835008
    v_exp_f32 v87, v87
    v_exp_f32 v88, v88
    v_exp_f32 v89, v89
    v_cvt_pk_bf16_f32 v147, v86, v87
    v_cvt_pk_bf16_f32 v148, v88, v89
    v_mfma_f32_32x32x16_bf16 v[96:111], v[172:175], v[140:143], v[96:111]
    buffer_load_dword v181, v180, s[68:71], 0 offen
    v_exp_f32 v90, v90
    v_exp_f32 v91, v91
    v_exp_f32 v92, v92
    v_cvt_pk_bf16_f32 v149, v90, v91
    v_smfmac_f32_16x16x64_bf16 v[128:131], v[24:27], v[136:143], v28
    ds_read_b128 v[164:167], v2 offset:35840
    v_exp_f32 v93, v93
    v_exp_f32 v94, v94
    v_exp_f32 v95, v95
    v_cvt_pk_bf16_f32 v150, v92, v93
    v_cvt_pk_bf16_f32 v151, v94, v95
    v_mfma_f32_32x32x16_bf16 v[80:95], v[152:155], v[16:19], v[48:63]
    ds_read_b128 v[152:155], v2 offset:36864
    v_exp_f32 v64, v64
    v_exp_f32 v65, v65
    v_exp_f32 v66, v66
    v_exp_f32 v67, v67
    v_cvt_pk_bf16_f32 v136, v64, v65
    v_mfma_f32_32x32x16_bf16 v[80:95], v[156:159], v[20:23], v[80:95]
    ds_read_b128 v[156:159], v2 offset:37888
    v_exp_f32 v68, v68
    v_exp_f32 v69, v69
    v_exp_f32 v70, v70
    v_cvt_pk_bf16_f32 v137, v66, v67
    v_cvt_pk_bf16_f32 v138, v68, v69
    v_mfma_f32_32x32x16_bf16 v[112:127], v[168:171], v[144:147], v[112:127]
    s_add_u32 m0, s51, 16384
    v_exp_f32 v71, v71
    v_exp_f32 v72, v72
    v_exp_f32 v73, v73
    v_cvt_pk_bf16_f32 v139, v70, v71
    v_cvt_pk_bf16_f32 v140, v72, v73
    v_mfma_f32_32x32x16_bf16 v[112:127], v[172:175], v[148:151], v[112:127]
    s_waitcnt lgkmcnt(1)
    v_exp_f32 v74, v74
    v_exp_f32 v75, v75
    v_exp_f32 v76, v76
    v_cvt_pk_bf16_f32 v141, v74, v75
    v_smfmac_f32_16x16x64_bf16 v[132:135], v[24:27], v[144:151], v28
    ds_read_b128 v[168:171], v2 offset:38912
    v_exp_f32 v77, v77
    v_exp_f32 v78, v78
    v_exp_f32 v79, v79
    v_cvt_pk_bf16_f32 v142, v76, v77
    v_cvt_pk_bf16_f32 v143, v78, v79
    v_mfma_f32_32x32x16_bf16 v[64:79], v[152:155], v[8:11], v[32:47]
    s_waitcnt lgkmcnt(1)
    v_exp_f32 v80, v80
    v_exp_f32 v81, v81
    v_exp_f32 v82, v82
    v_exp_f32 v83, v83
    v_cvt_pk_bf16_f32 v144, v80, v81
    v_mfma_f32_32x32x16_bf16 v[64:79], v[156:159], v[12:15], v[64:79]
    s_add_u32 s52, s52, 16384
    v_exp_f32 v84, v84
    v_exp_f32 v85, v85
    v_exp_f32 v86, v86
    v_cvt_pk_bf16_f32 v145, v82, v83
    v_cvt_pk_bf16_f32 v146, v84, v85
    v_mfma_f32_32x32x16_bf16 v[96:111], v[160:163], v[136:139], v[96:111]
    s_waitcnt vmcnt(11)
    v_exp_f32 v87, v87
    v_exp_f32 v88, v88
    v_exp_f32 v89, v89
    v_cvt_pk_bf16_f32 v147, v86, v87
    v_cvt_pk_bf16_f32 v148, v88, v89
    v_mfma_f32_32x32x16_bf16 v[96:111], v[164:167], v[140:143], v[96:111]
    s_barrier
    v_exp_f32 v90, v90
    v_exp_f32 v91, v91
    v_exp_f32 v92, v92
    v_cvt_pk_bf16_f32 v149, v90, v91
    v_smfmac_f32_16x16x64_bf16 v[128:131], v[24:27], v[136:143], v28
    ds_read_b128 v[172:175], v2 offset:39936
    v_exp_f32 v93, v93
    v_exp_f32 v94, v94
    v_exp_f32 v95, v95
    v_cvt_pk_bf16_f32 v150, v92, v93
    v_cvt_pk_bf16_f32 v151, v94, v95
    v_mfma_f32_32x32x16_bf16 v[80:95], v[152:155], v[16:19], v[48:63]
    ds_read_b128 v[152:155], v2 offset:40960
    v_exp_f32 v64, v64
    v_exp_f32 v65, v65
    v_exp_f32 v66, v66
    v_exp_f32 v67, v67
    v_cvt_pk_bf16_f32 v136, v64, v65
    v_mfma_f32_32x32x16_bf16 v[80:95], v[156:159], v[20:23], v[80:95]
    ds_read_b128 v[156:159], v2 offset:41984
    v_exp_f32 v68, v68
    v_exp_f32 v69, v69
    v_exp_f32 v70, v70
    v_cvt_pk_bf16_f32 v137, v66, v67
    v_cvt_pk_bf16_f32 v138, v68, v69
    v_mfma_f32_32x32x16_bf16 v[112:127], v[160:163], v[144:147], v[112:127]
    buffer_load_dwordx4 v2, s[28:31], s52 offen offset:0 sc1 lds
    v_exp_f32 v71, v71
    v_exp_f32 v72, v72
    v_exp_f32 v73, v73
    v_cvt_pk_bf16_f32 v139, v70, v71
    v_cvt_pk_bf16_f32 v140, v72, v73
    v_mfma_f32_32x32x16_bf16 v[112:127], v[164:167], v[148:151], v[112:127]
    s_waitcnt lgkmcnt(1)
    s_add_u32 s27, s27, s57
    v_exp_f32 v74, v74
    v_exp_f32 v75, v75
    v_exp_f32 v76, v76
    v_cvt_pk_bf16_f32 v141, v74, v75
    v_smfmac_f32_16x16x64_bf16 v[132:135], v[24:27], v[144:151], v28
    ds_read_b128 v[160:163], v2 offset:43008
    v_exp_f32 v77, v77
    v_exp_f32 v78, v78
    v_exp_f32 v79, v79
    v_cvt_pk_bf16_f32 v142, v76, v77
    v_cvt_pk_bf16_f32 v143, v78, v79
    v_mfma_f32_32x32x16_bf16 v[64:79], v[152:155], v[8:11], v[32:47]
    s_waitcnt lgkmcnt(1)
    v_exp_f32 v80, v80
    v_exp_f32 v81, v81
    v_exp_f32 v82, v82
    v_exp_f32 v83, v83
    v_cvt_pk_bf16_f32 v144, v80, v81
    v_mfma_f32_32x32x16_bf16 v[64:79], v[156:159], v[12:15], v[64:79]
    buffer_load_dwordx4 v2, s[28:31], s52 offen offset:1024 sc1 lds
    v_exp_f32 v84, v84
    v_exp_f32 v85, v85
    v_exp_f32 v86, v86
    v_cvt_pk_bf16_f32 v145, v82, v83
    v_cvt_pk_bf16_f32 v146, v84, v85
    v_mfma_f32_32x32x16_bf16 v[96:111], v[168:171], v[136:139], v[96:111]
    s_add_u32 s56, s56, 2048
    v_exp_f32 v87, v87
    v_exp_f32 v88, v88
    v_exp_f32 v89, v89
    v_cvt_pk_bf16_f32 v147, v86, v87
    v_cvt_pk_bf16_f32 v148, v88, v89
    v_mfma_f32_32x32x16_bf16 v[96:111], v[172:175], v[140:143], v[96:111]
    buffer_load_dwordx4 v2, s[28:31], s52 offen offset:2048 sc1 lds
    v_exp_f32 v90, v90
    v_exp_f32 v91, v91
    v_exp_f32 v92, v92
    v_cvt_pk_bf16_f32 v149, v90, v91
    v_smfmac_f32_16x16x64_bf16 v[128:131], v[24:27], v[136:143], v28
    ds_read_b128 v[164:167], v2 offset:44032
    v_exp_f32 v93, v93
    v_exp_f32 v94, v94
    v_exp_f32 v95, v95
    v_cvt_pk_bf16_f32 v150, v92, v93
    v_cvt_pk_bf16_f32 v151, v94, v95
    v_mfma_f32_32x32x16_bf16 v[80:95], v[152:155], v[16:19], v[48:63]
    ds_read_b128 v[152:155], v2 offset:45056
    v_exp_f32 v64, v64
    v_exp_f32 v65, v65
    v_exp_f32 v66, v66
    v_exp_f32 v67, v67
    v_cvt_pk_bf16_f32 v136, v64, v65
    v_mfma_f32_32x32x16_bf16 v[80:95], v[156:159], v[20:23], v[80:95]
    ds_read_b128 v[156:159], v2 offset:46080
    v_exp_f32 v68, v68
    v_exp_f32 v69, v69
    v_exp_f32 v70, v70
    v_cvt_pk_bf16_f32 v137, v66, v67
    v_cvt_pk_bf16_f32 v138, v68, v69
    v_mfma_f32_32x32x16_bf16 v[112:127], v[168:171], v[144:147], v[112:127]
    buffer_load_dwordx4 v2, s[28:31], s52 offen offset:3072 sc1 lds
    v_exp_f32 v71, v71
    v_exp_f32 v72, v72
    v_exp_f32 v73, v73
    v_cvt_pk_bf16_f32 v139, v70, v71
    v_cvt_pk_bf16_f32 v140, v72, v73
    v_mfma_f32_32x32x16_bf16 v[112:127], v[172:175], v[148:151], v[112:127]
    s_waitcnt lgkmcnt(1)
    s_mov_b32 m0, s56
    v_exp_f32 v74, v74
    v_exp_f32 v75, v75
    v_exp_f32 v76, v76
    v_cvt_pk_bf16_f32 v141, v74, v75
    v_smfmac_f32_16x16x64_bf16 v[132:135], v[24:27], v[144:151], v28
    ds_read_b128 v[168:171], v2 offset:47104
    v_exp_f32 v77, v77
    v_exp_f32 v78, v78
    v_exp_f32 v79, v79
    v_cvt_pk_bf16_f32 v142, v76, v77
    v_cvt_pk_bf16_f32 v143, v78, v79
    v_mfma_f32_32x32x16_bf16 v[64:79], v[152:155], v[8:11], v[32:47]
    s_waitcnt lgkmcnt(1)
    v_exp_f32 v80, v80
    v_exp_f32 v81, v81
    v_exp_f32 v82, v82
    v_exp_f32 v83, v83
    v_cvt_pk_bf16_f32 v144, v80, v81
    v_mfma_f32_32x32x16_bf16 v[64:79], v[156:159], v[12:15], v[64:79]
    buffer_load_dwordx4 v195, s[4:7], s27 offen lds
    v_exp_f32 v84, v84
    v_exp_f32 v85, v85
    v_exp_f32 v86, v86
    v_cvt_pk_bf16_f32 v145, v82, v83
    v_cvt_pk_bf16_f32 v146, v84, v85
    v_mfma_f32_32x32x16_bf16 v[96:111], v[160:163], v[136:139], v[96:111]
    v_exp_f32 v87, v87
    v_exp_f32 v88, v88
    v_exp_f32 v89, v89
    v_cvt_pk_bf16_f32 v147, v86, v87
    v_cvt_pk_bf16_f32 v148, v88, v89
    v_mfma_f32_32x32x16_bf16 v[96:111], v[164:167], v[140:143], v[96:111]
    buffer_load_dwordx4 v196, s[4:7], s27 offen offset:1024 lds
    v_exp_f32 v90, v90
    v_exp_f32 v91, v91
    v_exp_f32 v92, v92
    v_cvt_pk_bf16_f32 v149, v90, v91
    v_smfmac_f32_16x16x64_bf16 v[128:131], v[24:27], v[136:143], v28
    ds_read_b128 v[172:175], v2 offset:48128
    v_exp_f32 v93, v93
    v_exp_f32 v94, v94
    v_exp_f32 v95, v95
    v_cvt_pk_bf16_f32 v150, v92, v93
    v_cvt_pk_bf16_f32 v151, v94, v95
    v_mfma_f32_32x32x16_bf16 v[80:95], v[152:155], v[16:19], v[48:63]
    ds_read_b128 v[152:155], v2 offset:49152
    v_exp_f32 v64, v64
    v_exp_f32 v65, v65
    v_exp_f32 v66, v66
    v_exp_f32 v67, v67
    v_cvt_pk_bf16_f32 v136, v64, v65
    v_mfma_f32_32x32x16_bf16 v[80:95], v[156:159], v[20:23], v[80:95]
    ds_read_b128 v[156:159], v2 offset:50176
    v_exp_f32 v68, v68
    v_exp_f32 v69, v69
    v_exp_f32 v70, v70
    v_cvt_pk_bf16_f32 v137, v66, v67
    v_cvt_pk_bf16_f32 v138, v68, v69
    v_mfma_f32_32x32x16_bf16 v[112:127], v[160:163], v[144:147], v[112:127]
    v_exp_f32 v71, v71
    v_exp_f32 v72, v72
    v_exp_f32 v73, v73
    v_cvt_pk_bf16_f32 v139, v70, v71
    v_cvt_pk_bf16_f32 v140, v72, v73
    v_mfma_f32_32x32x16_bf16 v[112:127], v[164:167], v[148:151], v[112:127]
    s_waitcnt lgkmcnt(1)
    v_exp_f32 v74, v74
    v_exp_f32 v75, v75
    v_exp_f32 v76, v76
    v_cvt_pk_bf16_f32 v141, v74, v75
    v_smfmac_f32_16x16x64_bf16 v[132:135], v[24:27], v[144:151], v28
    ds_read_b128 v[160:163], v2 offset:51200
    v_exp_f32 v77, v77
    v_exp_f32 v78, v78
    v_exp_f32 v79, v79
    v_cvt_pk_bf16_f32 v142, v76, v77
    v_cvt_pk_bf16_f32 v143, v78, v79
    v_mfma_f32_32x32x16_bf16 v[64:79], v[152:155], v[8:11], v[32:47]
    s_waitcnt lgkmcnt(1)
    v_exp_f32 v80, v80
    v_exp_f32 v81, v81
    v_exp_f32 v82, v82
    v_exp_f32 v83, v83
    v_cvt_pk_bf16_f32 v144, v80, v81
    v_mfma_f32_32x32x16_bf16 v[64:79], v[156:159], v[12:15], v[64:79]
    v_exp_f32 v84, v84
    v_exp_f32 v85, v85
    v_exp_f32 v86, v86
    v_cvt_pk_bf16_f32 v145, v82, v83
    v_cvt_pk_bf16_f32 v146, v84, v85
    v_mfma_f32_32x32x16_bf16 v[96:111], v[168:171], v[136:139], v[96:111]
    v_exp_f32 v87, v87
    v_exp_f32 v88, v88
    v_exp_f32 v89, v89
    v_cvt_pk_bf16_f32 v147, v86, v87
    v_cvt_pk_bf16_f32 v148, v88, v89
    v_mfma_f32_32x32x16_bf16 v[96:111], v[172:175], v[140:143], v[96:111]
    v_exp_f32 v90, v90
    v_exp_f32 v91, v91
    v_exp_f32 v92, v92
    v_cvt_pk_bf16_f32 v149, v90, v91
    v_smfmac_f32_16x16x64_bf16 v[128:131], v[24:27], v[136:143], v28
    ds_read_b128 v[164:167], v2 offset:52224
    v_exp_f32 v93, v93
    v_exp_f32 v94, v94
    v_exp_f32 v95, v95
    v_cvt_pk_bf16_f32 v150, v92, v93
    v_cvt_pk_bf16_f32 v151, v94, v95
    v_mfma_f32_32x32x16_bf16 v[80:95], v[152:155], v[16:19], v[48:63]
    ds_read_b128 v[152:155], v2 offset:53248
    v_exp_f32 v64, v64
    v_exp_f32 v65, v65
    v_exp_f32 v66, v66
    v_exp_f32 v67, v67
    v_cvt_pk_bf16_f32 v136, v64, v65
    v_mfma_f32_32x32x16_bf16 v[80:95], v[156:159], v[20:23], v[80:95]
    ds_read_b128 v[156:159], v2 offset:54272
    v_exp_f32 v68, v68
    v_exp_f32 v69, v69
    v_exp_f32 v70, v70
    v_cvt_pk_bf16_f32 v137, v66, v67
    v_cvt_pk_bf16_f32 v138, v68, v69
    v_mfma_f32_32x32x16_bf16 v[112:127], v[168:171], v[144:147], v[112:127]
    s_add_u32 m0, s51, 32768
    v_exp_f32 v71, v71
    v_exp_f32 v72, v72
    v_exp_f32 v73, v73
    v_cvt_pk_bf16_f32 v139, v70, v71
    v_cvt_pk_bf16_f32 v140, v72, v73
    v_mfma_f32_32x32x16_bf16 v[112:127], v[172:175], v[148:151], v[112:127]
    s_waitcnt lgkmcnt(1)
    v_exp_f32 v74, v74
    v_exp_f32 v75, v75
    v_exp_f32 v76, v76
    v_cvt_pk_bf16_f32 v141, v74, v75
    v_smfmac_f32_16x16x64_bf16 v[132:135], v[24:27], v[144:151], v28
    ds_read_b128 v[168:171], v2 offset:55296
    v_exp_f32 v77, v77
    v_exp_f32 v78, v78
    v_exp_f32 v79, v79
    v_cvt_pk_bf16_f32 v142, v76, v77
    v_cvt_pk_bf16_f32 v143, v78, v79
    v_mfma_f32_32x32x16_bf16 v[64:79], v[152:155], v[8:11], v[32:47]
    s_waitcnt lgkmcnt(1)
    v_exp_f32 v80, v80
    v_exp_f32 v81, v81
    v_exp_f32 v82, v82
    v_exp_f32 v83, v83
    v_cvt_pk_bf16_f32 v144, v80, v81
    v_mfma_f32_32x32x16_bf16 v[64:79], v[156:159], v[12:15], v[64:79]
    s_add_u32 s52, s52, 16384
    v_exp_f32 v84, v84
    v_exp_f32 v85, v85
    v_exp_f32 v86, v86
    v_cvt_pk_bf16_f32 v145, v82, v83
    v_cvt_pk_bf16_f32 v146, v84, v85
    v_mfma_f32_32x32x16_bf16 v[96:111], v[160:163], v[136:139], v[96:111]
    s_waitcnt vmcnt(10)
    v_exp_f32 v87, v87
    v_exp_f32 v88, v88
    v_exp_f32 v89, v89
    v_cvt_pk_bf16_f32 v147, v86, v87
    v_cvt_pk_bf16_f32 v148, v88, v89
    v_mfma_f32_32x32x16_bf16 v[96:111], v[164:167], v[140:143], v[96:111]
    s_barrier
    v_exp_f32 v90, v90
    v_exp_f32 v91, v91
    v_exp_f32 v92, v92
    v_cvt_pk_bf16_f32 v149, v90, v91
    v_smfmac_f32_16x16x64_bf16 v[128:131], v[24:27], v[136:143], v28
    ds_read_b128 v[172:175], v2 offset:56320
    v_exp_f32 v93, v93
    v_exp_f32 v94, v94
    v_exp_f32 v95, v95
    v_cvt_pk_bf16_f32 v150, v92, v93
    v_cvt_pk_bf16_f32 v151, v94, v95
    v_mfma_f32_32x32x16_bf16 v[80:95], v[152:155], v[16:19], v[48:63]
    ds_read_b128 v[152:155], v2 offset:57344
    v_exp_f32 v64, v64
    v_exp_f32 v65, v65
    v_exp_f32 v66, v66
    v_exp_f32 v67, v67
    v_cvt_pk_bf16_f32 v136, v64, v65
    v_mfma_f32_32x32x16_bf16 v[80:95], v[156:159], v[20:23], v[80:95]
    ds_read_b128 v[156:159], v2 offset:58368
    v_exp_f32 v68, v68
    v_exp_f32 v69, v69
    v_exp_f32 v70, v70
    v_cvt_pk_bf16_f32 v137, v66, v67
    v_cvt_pk_bf16_f32 v138, v68, v69
    v_mfma_f32_32x32x16_bf16 v[112:127], v[160:163], v[144:147], v[112:127]
    buffer_load_dwordx4 v2, s[28:31], s52 offen offset:0 sc1 lds
    v_exp_f32 v71, v71
    v_exp_f32 v72, v72
    v_exp_f32 v73, v73
    v_cvt_pk_bf16_f32 v139, v70, v71
    v_cvt_pk_bf16_f32 v140, v72, v73
    v_mfma_f32_32x32x16_bf16 v[112:127], v[164:167], v[148:151], v[112:127]
    s_waitcnt lgkmcnt(1)
    v_exp_f32 v74, v74
    v_exp_f32 v75, v75
    v_exp_f32 v76, v76
    v_cvt_pk_bf16_f32 v141, v74, v75
    v_smfmac_f32_16x16x64_bf16 v[132:135], v[24:27], v[144:151], v28
    ds_read_b128 v[160:163], v2 offset:59392
    v_exp_f32 v77, v77
    v_exp_f32 v78, v78
    v_exp_f32 v79, v79
    v_cvt_pk_bf16_f32 v142, v76, v77
    v_cvt_pk_bf16_f32 v143, v78, v79
    v_mfma_f32_32x32x16_bf16 v[64:79], v[152:155], v[8:11], v[32:47]
    s_waitcnt lgkmcnt(1)
    v_exp_f32 v80, v80
    v_exp_f32 v81, v81
    v_exp_f32 v82, v82
    v_exp_f32 v83, v83
    v_cvt_pk_bf16_f32 v144, v80, v81
    v_mfma_f32_32x32x16_bf16 v[64:79], v[156:159], v[12:15], v[64:79]
    buffer_load_dwordx4 v2, s[28:31], s52 offen offset:1024 sc1 lds
    v_exp_f32 v84, v84
    v_exp_f32 v85, v85
    v_exp_f32 v86, v86
    v_cvt_pk_bf16_f32 v145, v82, v83
    v_cvt_pk_bf16_f32 v146, v84, v85
    v_mfma_f32_32x32x16_bf16 v[96:111], v[168:171], v[136:139], v[96:111]
    v_exp_f32 v87, v87
    v_exp_f32 v88, v88
    v_exp_f32 v89, v89
    v_cvt_pk_bf16_f32 v147, v86, v87
    v_cvt_pk_bf16_f32 v148, v88, v89
    v_mfma_f32_32x32x16_bf16 v[96:111], v[172:175], v[140:143], v[96:111]
    buffer_load_dwordx4 v2, s[28:31], s52 offen offset:2048 sc1 lds
    v_exp_f32 v90, v90
    v_exp_f32 v91, v91
    v_exp_f32 v92, v92
    v_cvt_pk_bf16_f32 v149, v90, v91
    v_smfmac_f32_16x16x64_bf16 v[128:131], v[24:27], v[136:143], v28
    ds_read_b128 v[164:167], v2 offset:60416
    v_exp_f32 v93, v93
    v_exp_f32 v94, v94
    v_exp_f32 v95, v95
    v_cvt_pk_bf16_f32 v150, v92, v93
    v_cvt_pk_bf16_f32 v151, v94, v95
    v_mfma_f32_32x32x16_bf16 v[80:95], v[152:155], v[16:19], v[48:63]
    ds_read_b128 v[152:155], v2 offset:61440
    v_exp_f32 v64, v64
    v_exp_f32 v65, v65
    v_exp_f32 v66, v66
    v_exp_f32 v67, v67
    v_cvt_pk_bf16_f32 v136, v64, v65
    v_mfma_f32_32x32x16_bf16 v[80:95], v[156:159], v[20:23], v[80:95]
    ds_read_b128 v[156:159], v2 offset:62464
    v_exp_f32 v68, v68
    v_exp_f32 v69, v69
    v_exp_f32 v70, v70
    v_cvt_pk_bf16_f32 v137, v66, v67
    v_cvt_pk_bf16_f32 v138, v68, v69
    v_mfma_f32_32x32x16_bf16 v[112:127], v[168:171], v[144:147], v[112:127]
    buffer_load_dwordx4 v2, s[28:31], s52 offen offset:3072 sc1 lds
    v_exp_f32 v71, v71
    v_exp_f32 v72, v72
    v_exp_f32 v73, v73
    v_cvt_pk_bf16_f32 v139, v70, v71
    v_cvt_pk_bf16_f32 v140, v72, v73
    v_mfma_f32_32x32x16_bf16 v[112:127], v[172:175], v[148:151], v[112:127]
    s_waitcnt lgkmcnt(1)
    v_exp_f32 v74, v74
    v_exp_f32 v75, v75
    v_exp_f32 v76, v76
    v_cvt_pk_bf16_f32 v141, v74, v75
    v_smfmac_f32_16x16x64_bf16 v[132:135], v[24:27], v[144:151], v28
    ds_read_b128 v[168:171], v2 offset:63488
    v_exp_f32 v77, v77
    v_exp_f32 v78, v78
    v_exp_f32 v79, v79
    v_cvt_pk_bf16_f32 v142, v76, v77
    v_cvt_pk_bf16_f32 v143, v78, v79
    v_mfma_f32_32x32x16_bf16 v[64:79], v[152:155], v[8:11], v[32:47]
    s_waitcnt lgkmcnt(1)
    v_exp_f32 v80, v80
    v_exp_f32 v81, v81
    v_exp_f32 v82, v82
    v_exp_f32 v83, v83
    v_cvt_pk_bf16_f32 v144, v80, v81
    v_mfma_f32_32x32x16_bf16 v[64:79], v[156:159], v[12:15], v[64:79]
    buffer_load_dword v181, v183, s[16:19], s58 offen
    v_exp_f32 v84, v84
    v_exp_f32 v85, v85
    v_exp_f32 v86, v86
    v_cvt_pk_bf16_f32 v145, v82, v83
    v_cvt_pk_bf16_f32 v146, v84, v85
    v_mfma_f32_32x32x16_bf16 v[96:111], v[160:163], v[136:139], v[96:111]
    s_add_u32 s58, s58, 524288
    v_exp_f32 v87, v87
    v_exp_f32 v88, v88
    v_exp_f32 v89, v89
    v_cvt_pk_bf16_f32 v147, v86, v87
    v_cvt_pk_bf16_f32 v148, v88, v89
    v_mfma_f32_32x32x16_bf16 v[96:111], v[164:167], v[140:143], v[96:111]
    v_exp_f32 v90, v90
    v_exp_f32 v91, v91
    v_exp_f32 v92, v92
    v_cvt_pk_bf16_f32 v149, v90, v91
    v_smfmac_f32_16x16x64_bf16 v[128:131], v[24:27], v[136:143], v28
    ds_read_b128 v[172:175], v2 offset:64512
    v_exp_f32 v93, v93
    v_exp_f32 v94, v94
    v_exp_f32 v95, v95
    v_cvt_pk_bf16_f32 v150, v92, v93
    v_cvt_pk_bf16_f32 v151, v94, v95
    v_mfma_f32_32x32x16_bf16 v[80:95], v[152:155], v[16:19], v[48:63]
    ds_read_b128 v[152:155], v2 offset:0
    v_exp_f32 v64, v64
    v_exp_f32 v65, v65
    v_exp_f32 v66, v66
    v_exp_f32 v67, v67
    v_cvt_pk_bf16_f32 v136, v64, v65
    v_mfma_f32_32x32x16_bf16 v[80:95], v[156:159], v[20:23], v[80:95]
    ds_read_b128 v[156:159], v2 offset:1024
    v_exp_f32 v68, v68
    v_exp_f32 v69, v69
    v_exp_f32 v70, v70
    v_cvt_pk_bf16_f32 v137, v66, v67
    v_cvt_pk_bf16_f32 v138, v68, v69
    v_mfma_f32_32x32x16_bf16 v[112:127], v[160:163], v[144:147], v[112:127]
    v_exp_f32 v71, v71
    v_exp_f32 v72, v72
    v_exp_f32 v73, v73
    v_cvt_pk_bf16_f32 v139, v70, v71
    v_cvt_pk_bf16_f32 v140, v72, v73
    v_mfma_f32_32x32x16_bf16 v[112:127], v[164:167], v[148:151], v[112:127]
    s_waitcnt lgkmcnt(1)
    v_exp_f32 v74, v74
    v_exp_f32 v75, v75
    v_exp_f32 v76, v76
    v_cvt_pk_bf16_f32 v141, v74, v75
    v_smfmac_f32_16x16x64_bf16 v[132:135], v[24:27], v[144:151], v28
    ds_read_b128 v[160:163], v2 offset:2048
    v_exp_f32 v77, v77
    v_exp_f32 v78, v78
    v_exp_f32 v79, v79
    v_cvt_pk_bf16_f32 v142, v76, v77
    v_cvt_pk_bf16_f32 v143, v78, v79
    v_mfma_f32_32x32x16_bf16 v[64:79], v[152:155], v[8:11], v[32:47]
    s_waitcnt lgkmcnt(1)
    v_exp_f32 v80, v80
    v_exp_f32 v81, v81
    v_exp_f32 v82, v82
    v_exp_f32 v83, v83
    v_cvt_pk_bf16_f32 v144, v80, v81
    v_mfma_f32_32x32x16_bf16 v[64:79], v[156:159], v[12:15], v[64:79]
    v_exp_f32 v84, v84
    v_exp_f32 v85, v85
    v_exp_f32 v86, v86
    v_cvt_pk_bf16_f32 v145, v82, v83
    v_cvt_pk_bf16_f32 v146, v84, v85
    v_mfma_f32_32x32x16_bf16 v[96:111], v[168:171], v[136:139], v[96:111]
    v_exp_f32 v87, v87
    v_exp_f32 v88, v88
    v_exp_f32 v89, v89
    v_cvt_pk_bf16_f32 v147, v86, v87
    v_cvt_pk_bf16_f32 v148, v88, v89
    v_mfma_f32_32x32x16_bf16 v[96:111], v[172:175], v[140:143], v[96:111]
    v_exp_f32 v90, v90
    v_exp_f32 v91, v91
    v_exp_f32 v92, v92
    v_cvt_pk_bf16_f32 v149, v90, v91
    v_smfmac_f32_16x16x64_bf16 v[128:131], v[24:27], v[136:143], v28
    ds_read_b128 v[164:167], v2 offset:3072
    v_exp_f32 v93, v93
    v_exp_f32 v94, v94
    v_exp_f32 v95, v95
    v_cvt_pk_bf16_f32 v150, v92, v93
    v_cvt_pk_bf16_f32 v151, v94, v95
    s_sub_u32 s36, s36, 1
    s_cmp_lg_u32 s36, 0
    s_cbranch_scc1 attn_loop0
    s_mov_b32 s16, s38
    s_mov_b32 s17, s39
    s_mov_b32 s18, 0
    s_mov_b32 s19, 0x20000
    s_mov_b32 s20, s62
    s_mov_b32 s21, s63
    s_mov_b32 s22, 4194304
    s_mov_b32 s23, 0x20000
    s_cmp_lt_u32 s26, s37
    s_cselect_b32 s18, 720896, 0
    s_lshl_b32 s25, s26, 12
    s_add_u32 s25, s25, 139264
    v_cmp_gt_u32 vcc, 2, v235
    s_waitcnt vmcnt(5)
    s_and_saveexec_b64 s[34:35], vcc
    ds_read_b128 a[80:83], v241
    ds_read_b128 a[0:3], v236 offset:0
    ds_read_b128 a[4:7], v236 offset:32
    ds_read_b128 a[8:11], v236 offset:64
    ds_read_b128 a[12:15], v236 offset:96
    s_mov_b64 exec, s[34:35]
    ds_read_b64_tr_b16 a[116:117], v239 offset:0
    ds_read_b64_tr_b16 a[118:119], v239 offset:512
    ds_read_b64_tr_b16 a[120:121], v240 offset:0
    ds_read_b64_tr_b16 a[122:123], v240 offset:512
    ds_read_b64_tr_b16 a[16:17], v232 offset:0
    ds_read_b64_tr_b16 a[18:19], v232 offset:512
    ds_read_b64_tr_b16 a[20:21], v233 offset:0
    ds_read_b64_tr_b16 a[22:23], v233 offset:512
    ds_read_b64_tr_b16 a[24:25], v232 offset:2048
    ds_read_b64_tr_b16 a[26:27], v232 offset:2560
    ds_read_b64_tr_b16 a[28:29], v233 offset:2048
    ds_read_b64_tr_b16 a[30:31], v233 offset:2560
    ds_read_b64_tr_b16 a[32:33], v232 offset:4096
    ds_read_b64_tr_b16 a[34:35], v232 offset:4608
    ds_read_b64_tr_b16 a[36:37], v233 offset:4096
    ds_read_b64_tr_b16 a[38:39], v233 offset:4608
    ds_read_b64_tr_b16 a[40:41], v232 offset:6144
    ds_read_b64_tr_b16 a[42:43], v232 offset:6656
    ds_read_b64_tr_b16 a[44:45], v233 offset:6144
    ds_read_b64_tr_b16 a[46:47], v233 offset:6656
    buffer_load_dwordx4 v[212:215], v210, s[12:15], 0 offen
    buffer_load_dwordx4 v[220:223], v218, s[12:15], 0 offen
    s_waitcnt lgkmcnt(12)
    v_mfma_f32_32x32x16_bf16 a[84:99], a[80:83], a[116:119], 0
    v_mfma_f32_32x32x16_bf16 a[100:115], a[80:83], a[120:123], 0
    v_mfma_f32_32x32x16_bf16 a[48:63], a[0:3], a[16:19], 0
    v_mfma_f32_32x32x16_bf16 a[64:79], a[0:3], a[20:23], 0
    s_waitcnt lgkmcnt(8)
    v_mfma_f32_32x32x16_bf16 a[48:63], a[4:7], a[24:27], a[48:63]
    v_mfma_f32_32x32x16_bf16 a[64:79], a[4:7], a[28:31], a[64:79]
    s_waitcnt lgkmcnt(4)
    v_mfma_f32_32x32x16_bf16 a[48:63], a[8:11], a[32:35], a[48:63]
    v_mfma_f32_32x32x16_bf16 a[64:79], a[8:11], a[36:39], a[64:79]
    s_waitcnt lgkmcnt(0)
    v_mfma_f32_32x32x16_bf16 a[48:63], a[12:15], a[40:43], a[48:63]
    v_mfma_f32_32x32x16_bf16 a[64:79], a[12:15], a[44:47], a[64:79]
    s_and_saveexec_b64 s[34:35], vcc
    ds_read_b128 a[0:3], v236 offset:256
    ds_read_b128 a[4:7], v236 offset:288
    ds_read_b128 a[8:11], v236 offset:320
    ds_read_b128 a[12:15], v236 offset:352
    s_mov_b64 exec, s[34:35]
    ds_read_b64_tr_b16 a[16:17], v232 offset:8192
    ds_read_b64_tr_b16 a[18:19], v232 offset:8704
    ds_read_b64_tr_b16 a[20:21], v233 offset:8192
    ds_read_b64_tr_b16 a[22:23], v233 offset:8704
    ds_read_b64_tr_b16 a[24:25], v232 offset:10240
    ds_read_b64_tr_b16 a[26:27], v232 offset:10752
    ds_read_b64_tr_b16 a[28:29], v233 offset:10240
    ds_read_b64_tr_b16 a[30:31], v233 offset:10752
    ds_read_b64_tr_b16 a[32:33], v232 offset:12288
    ds_read_b64_tr_b16 a[34:35], v232 offset:12800
    ds_read_b64_tr_b16 a[36:37], v233 offset:12288
    ds_read_b64_tr_b16 a[38:39], v233 offset:12800
    ds_read_b64_tr_b16 a[40:41], v232 offset:14336
    ds_read_b64_tr_b16 a[42:43], v232 offset:14848
    ds_read_b64_tr_b16 a[44:45], v233 offset:14336
    ds_read_b64_tr_b16 a[46:47], v233 offset:14848
    s_waitcnt lgkmcnt(12)
    v_mfma_f32_32x32x16_bf16 a[48:63], a[0:3], a[16:19], a[48:63]
    v_mfma_f32_32x32x16_bf16 a[64:79], a[0:3], a[20:23], a[64:79]
    s_waitcnt lgkmcnt(8)
    v_mfma_f32_32x32x16_bf16 a[48:63], a[4:7], a[24:27], a[48:63]
    v_mfma_f32_32x32x16_bf16 a[64:79], a[4:7], a[28:31], a[64:79]
    s_waitcnt lgkmcnt(4)
    v_mfma_f32_32x32x16_bf16 a[48:63], a[8:11], a[32:35], a[48:63]
    v_mfma_f32_32x32x16_bf16 a[64:79], a[8:11], a[36:39], a[64:79]
    s_waitcnt lgkmcnt(0)
    v_mfma_f32_32x32x16_bf16 a[48:63], a[12:15], a[40:43], a[48:63]
    v_mfma_f32_32x32x16_bf16 a[64:79], a[12:15], a[44:47], a[64:79]
    s_mov_b32 exec_hi, 0
    ds_write_b32 v242, a84 offset:0
    ds_write_b32 v242, a100 offset:128
    s_nop 7
    ds_write_b32 v234, a48 offset:0
    ds_write_b32 v234, a49 offset:256
    ds_write_b32 v234, a64 offset:128
    ds_write_b32 v234, a65 offset:384
    s_mov_b32 exec_hi, -1
    s_waitcnt lgkmcnt(0)
    s_barrier
    ds_read_b32 v224, v238 offset:0
    ds_read_b32 v225, v238 offset:512
    ds_read_b32 v226, v238 offset:1024
    ds_read_b32 v227, v238 offset:1536
    s_add_u32 m0, s44, 0
    s_nop 0
    buffer_load_dwordx4 v192, s[8:11], s43 offen lds
    s_add_u32 m0, s44, 1024
    s_nop 0
    buffer_load_dwordx4 v193, s[8:11], s43 offen lds
    s_add_u32 s43, s43, s47
    s_add_u32 s44, s44, 8192
    s_add_u32 m0, s44, 0
    s_nop 0
    buffer_load_dwordx4 v192, s[8:11], s43 offen lds
    s_add_u32 m0, s44, 1024
    s_nop 0
    buffer_load_dwordx4 v193, s[8:11], s43 offen lds
    v_subrev_u32 v195, 1024, v193
    s_waitcnt lgkmcnt(0)
    v_add_f32 v224, v224, v225
    v_add_f32 v226, v226, v227
    v_add_f32 v224, v224, v226
    buffer_store_dword v224, v237, s[16:19], s100 offen sc1
    s_mov_b32 s36, 2
.p2align 6
attn_loop1:
    v_mfma_f32_32x32x16_bf16 v[80:95], v[152:155], v[16:19], v[48:63]
    ds_read_b128 v[152:155], v2 offset:4096
    v_exp_f32 v64, v64
    v_exp_f32 v65, v65
    v_exp_f32 v66, v66
    v_exp_f32 v67, v67
    v_cvt_pk_bf16_f32 v136, v64, v65
    v_mfma_f32_32x32x16_bf16 v[80:95], v[156:159], v[20:23], v[80:95]
    ds_read_b128 v[156:159], v2 offset:5120
    v_exp_f32 v68, v68
    v_exp_f32 v69, v69
    v_exp_f32 v70, v70
    v_cvt_pk_bf16_f32 v137, v66, v67
    v_cvt_pk_bf16_f32 v138, v68, v69
    v_mfma_f32_32x32x16_bf16 v[112:127], v[168:171], v[144:147], v[112:127]
    s_add_u32 m0, s51, 49152
    v_exp_f32 v71, v71
    v_exp_f32 v72, v72
    v_exp_f32 v73, v73
    v_cvt_pk_bf16_f32 v139, v70, v71
    v_cvt_pk_bf16_f32 v140, v72, v73
    v_mfma_f32_32x32x16_bf16 v[112:127], v[172:175], v[148:151], v[112:127]
    s_waitcnt lgkmcnt(1)
    v_exp_f32 v74, v74
    v_exp_f32 v75, v75
    v_exp_f32 v76, v76
    v_cvt_pk_bf16_f32 v141, v74, v75
    v_smfmac_f32_16x16x64_bf16 v[132:135], v[24:27], v[144:151], v28
    ds_read_b128 v[168:171], v2 offset:6144
    v_exp_f32 v77, v77
    v_exp_f32 v78, v78
    v_exp_f32 v79, v79
    v_cvt_pk_bf16_f32 v142, v76, v77
    v_cvt_pk_bf16_f32 v143, v78, v79
    v_mfma_f32_32x32x16_bf16 v[64:79], v[152:155], v[8:11], v[32:47]
    s_waitcnt lgkmcnt(1)
    v_exp_f32 v80, v80
    v_exp_f32 v81, v81
    v_exp_f32 v82, v82
    v_exp_f32 v83, v83
    v_cvt_pk_bf16_f32 v144, v80, v81
    v_mfma_f32_32x32x16_bf16 v[64:79], v[156:159], v[12:15], v[64:79]
    s_add_u32 s52, s52, 16384
    v_exp_f32 v84, v84
    v_exp_f32 v85, v85
    v_exp_f32 v86, v86
    v_cvt_pk_bf16_f32 v145, v82, v83
    v_cvt_pk_bf16_f32 v146, v84, v85
    v_mfma_f32_32x32x16_bf16 v[96:111], v[160:163], v[136:139], v[96:111]
    s_waitcnt vmcnt(7)
    v_exp_f32 v87, v87
    v_exp_f32 v88, v88
    v_exp_f32 v89, v89
    v_cvt_pk_bf16_f32 v147, v86, v87
    v_cvt_pk_bf16_f32 v148, v88, v89
    v_mfma_f32_32x32x16_bf16 v[96:111], v[164:167], v[140:143], v[96:111]
    s_barrier
    v_exp_f32 v90, v90
    v_exp_f32 v91, v91
    v_exp_f32 v92, v92
    v_cvt_pk_bf16_f32 v149, v90, v91
    v_smfmac_f32_16x16x64_bf16 v[128:131], v[24:27], v[136:143], v28
    ds_read_b128 v[172:175], v2 offset:7168
    v_exp_f32 v93, v93
    v_exp_f32 v94, v94
    v_exp_f32 v95, v95
    v_cvt_pk_bf16_f32 v150, v92, v93
    v_cvt_pk_bf16_f32 v151, v94, v95
    v_mfma_f32_32x32x16_bf16 v[80:95], v[152:155], v[16:19], v[48:63]
    ds_read_b128 v[152:155], v2 offset:8192
    v_exp_f32 v64, v64
    v_exp_f32 v65, v65
    v_exp_f32 v66, v66
    v_exp_f32 v67, v67
    v_cvt_pk_bf16_f32 v136, v64, v65
    v_mfma_f32_32x32x16_bf16 v[80:95], v[156:159], v[20:23], v[80:95]
    ds_read_b128 v[156:159], v2 offset:9216
    v_exp_f32 v68, v68
    v_exp_f32 v69, v69
    v_exp_f32 v70, v70
    v_cvt_pk_bf16_f32 v137, v66, v67
    v_cvt_pk_bf16_f32 v138, v68, v69
    v_mfma_f32_32x32x16_bf16 v[112:127], v[160:163], v[144:147], v[112:127]
    buffer_load_dwordx4 v2, s[28:31], s52 offen offset:0 sc1 lds
    v_exp_f32 v71, v71
    v_exp_f32 v72, v72
    v_exp_f32 v73, v73
    v_cvt_pk_bf16_f32 v139, v70, v71
    v_cvt_pk_bf16_f32 v140, v72, v73
    v_mfma_f32_32x32x16_bf16 v[112:127], v[164:167], v[148:151], v[112:127]
    s_waitcnt lgkmcnt(1)
    s_add_u32 s43, s43, s47
    v_exp_f32 v74, v74
    v_exp_f32 v75, v75
    v_exp_f32 v76, v76
    v_cvt_pk_bf16_f32 v141, v74, v75
    v_smfmac_f32_16x16x64_bf16 v[132:135], v[24:27], v[144:151], v28
    ds_read_b128 v[160:163], v2 offset:10240
    v_exp_f32 v77, v77
    v_exp_f32 v78, v78
    v_exp_f32 v79, v79
    v_cvt_pk_bf16_f32 v142, v76, v77
    v_cvt_pk_bf16_f32 v143, v78, v79
    v_mfma_f32_32x32x16_bf16 v[64:79], v[152:155], v[8:11], v[32:47]
    s_waitcnt lgkmcnt(1)
    v_exp_f32 v80, v80
    v_exp_f32 v81, v81
    v_exp_f32 v82, v82
    v_exp_f32 v83, v83
    v_cvt_pk_bf16_f32 v144, v80, v81
    v_mfma_f32_32x32x16_bf16 v[64:79], v[156:159], v[12:15], v[64:79]
    buffer_load_dwordx4 v2, s[28:31], s52 offen offset:1024 sc1 lds
    v_exp_f32 v84, v84
    v_exp_f32 v85, v85
    v_exp_f32 v86, v86
    v_cvt_pk_bf16_f32 v145, v82, v83
    v_cvt_pk_bf16_f32 v146, v84, v85
    v_mfma_f32_32x32x16_bf16 v[96:111], v[168:171], v[136:139], v[96:111]
    s_add_u32 s44, s44, 8192
    v_exp_f32 v87, v87
    v_exp_f32 v88, v88
    v_exp_f32 v89, v89
    v_cvt_pk_bf16_f32 v147, v86, v87
    v_cvt_pk_bf16_f32 v148, v88, v89
    v_mfma_f32_32x32x16_bf16 v[96:111], v[172:175], v[140:143], v[96:111]
    buffer_load_dwordx4 v2, s[28:31], s52 offen offset:2048 sc1 lds
    v_exp_f32 v90, v90
    v_exp_f32 v91, v91
    v_exp_f32 v92, v92
    v_cvt_pk_bf16_f32 v149, v90, v91
    v_smfmac_f32_16x16x64_bf16 v[128:131], v[24:27], v[136:143], v28
    ds_read_b128 v[164:167], v2 offset:11264
    v_exp_f32 v93, v93
    v_exp_f32 v94, v94
    v_exp_f32 v95, v95
    v_cvt_pk_bf16_f32 v150, v92, v93
    v_cvt_pk_bf16_f32 v151, v94, v95
    v_mfma_f32_32x32x16_bf16 v[80:95], v[152:155], v[16:19], v[48:63]
    ds_read_b128 v[152:155], v2 offset:12288
    v_exp_f32 v64, v64
    v_exp_f32 v65, v65
    v_exp_f32 v66, v66
    v_exp_f32 v67, v67
    v_cvt_pk_bf16_f32 v136, v64, v65
    v_mfma_f32_32x32x16_bf16 v[80:95], v[156:159], v[20:23], v[80:95]
    ds_read_b128 v[156:159], v2 offset:13312
    v_exp_f32 v68, v68
    v_exp_f32 v69, v69
    v_exp_f32 v70, v70
    v_cvt_pk_bf16_f32 v137, v66, v67
    v_cvt_pk_bf16_f32 v138, v68, v69
    v_mfma_f32_32x32x16_bf16 v[112:127], v[168:171], v[144:147], v[112:127]
    buffer_load_dwordx4 v2, s[28:31], s52 offen offset:3072 sc1 lds
    v_exp_f32 v71, v71
    v_exp_f32 v72, v72
    v_exp_f32 v73, v73
    v_cvt_pk_bf16_f32 v139, v70, v71
    v_cvt_pk_bf16_f32 v140, v72, v73
    v_mfma_f32_32x32x16_bf16 v[112:127], v[172:175], v[148:151], v[112:127]
    s_waitcnt lgkmcnt(1)
    s_add_u32 m0, s44, 0
    v_exp_f32 v74, v74
    v_exp_f32 v75, v75
    v_exp_f32 v76, v76
    v_cvt_pk_bf16_f32 v141, v74, v75
    v_smfmac_f32_16x16x64_bf16 v[132:135], v[24:27], v[144:151], v28
    ds_read_b128 v[168:171], v2 offset:14336
    v_exp_f32 v77, v77
    v_exp_f32 v78, v78
    v_exp_f32 v79, v79
    v_cvt_pk_bf16_f32 v142, v76, v77
    v_cvt_pk_bf16_f32 v143, v78, v79
    v_mfma_f32_32x32x16_bf16 v[64:79], v[152:155], v[8:11], v[32:47]
    s_waitcnt lgkmcnt(1)
    v_exp_f32 v80, v80
    v_exp_f32 v81, v81
    v_exp_f32 v82, v82
    v_exp_f32 v83, v83
    v_cvt_pk_bf16_f32 v144, v80, v81
    v_mfma_f32_32x32x16_bf16 v[64:79], v[156:159], v[12:15], v[64:79]
    buffer_load_dwordx4 v192, s[8:11], s43 offen lds
    v_exp_f32 v84, v84
    v_exp_f32 v85, v85
    v_exp_f32 v86, v86
    v_cvt_pk_bf16_f32 v145, v82, v83
    v_cvt_pk_bf16_f32 v146, v84, v85
    v_mfma_f32_32x32x16_bf16 v[96:111], v[160:163], v[136:139], v[96:111]
    v_exp_f32 v87, v87
    v_exp_f32 v88, v88
    v_exp_f32 v89, v89
    v_cvt_pk_bf16_f32 v147, v86, v87
    v_cvt_pk_bf16_f32 v148, v88, v89
    v_mfma_f32_32x32x16_bf16 v[96:111], v[164:167], v[140:143], v[96:111]
    buffer_load_dwordx4 v195, s[8:11], s43 offen offset:1024 lds
    v_exp_f32 v90, v90
    v_exp_f32 v91, v91
    v_exp_f32 v92, v92
    v_cvt_pk_bf16_f32 v149, v90, v91
    v_smfmac_f32_16x16x64_bf16 v[128:131], v[24:27], v[136:143], v28
    ds_read_b128 v[172:175], v2 offset:15360
    v_exp_f32 v93, v93
    v_exp_f32 v94, v94
    v_exp_f32 v95, v95
    v_cvt_pk_bf16_f32 v150, v92, v93
    v_cvt_pk_bf16_f32 v151, v94, v95
    v_mfma_f32_32x32x16_bf16 v[80:95], v[152:155], v[16:19], v[48:63]
    ds_read_b128 v[152:155], v2 offset:16384
    v_exp_f32 v64, v64
    v_exp_f32 v65, v65
    v_exp_f32 v66, v66
    v_exp_f32 v67, v67
    v_cvt_pk_bf16_f32 v136, v64, v65
    v_mfma_f32_32x32x16_bf16 v[80:95], v[156:159], v[20:23], v[80:95]
    ds_read_b128 v[156:159], v2 offset:17408
    v_exp_f32 v68, v68
    v_exp_f32 v69, v69
    v_exp_f32 v70, v70
    v_cvt_pk_bf16_f32 v137, v66, v67
    v_cvt_pk_bf16_f32 v138, v68, v69
    v_mfma_f32_32x32x16_bf16 v[112:127], v[160:163], v[144:147], v[112:127]
    s_mov_b32 m0, s25
    v_exp_f32 v71, v71
    v_exp_f32 v72, v72
    v_exp_f32 v73, v73
    v_cvt_pk_bf16_f32 v139, v70, v71
    v_cvt_pk_bf16_f32 v140, v72, v73
    v_mfma_f32_32x32x16_bf16 v[112:127], v[164:167], v[148:151], v[112:127]
    s_waitcnt lgkmcnt(1)
    v_exp_f32 v74, v74
    v_exp_f32 v75, v75
    v_exp_f32 v76, v76
    v_cvt_pk_bf16_f32 v141, v74, v75
    v_smfmac_f32_16x16x64_bf16 v[132:135], v[24:27], v[144:151], v28
    ds_read_b128 v[160:163], v2 offset:18432
    v_exp_f32 v77, v77
    v_exp_f32 v78, v78
    v_exp_f32 v79, v79
    v_cvt_pk_bf16_f32 v142, v76, v77
    v_cvt_pk_bf16_f32 v143, v78, v79
    v_mfma_f32_32x32x16_bf16 v[64:79], v[152:155], v[8:11], v[32:47]
    s_waitcnt lgkmcnt(1)
    v_exp_f32 v80, v80
    v_exp_f32 v81, v81
    v_exp_f32 v82, v82
    v_exp_f32 v83, v83
    v_cvt_pk_bf16_f32 v144, v80, v81
    v_mfma_f32_32x32x16_bf16 v[64:79], v[156:159], v[12:15], v[64:79]
    buffer_load_dwordx4 v194, s[20:23], s24 offen lds
    v_exp_f32 v84, v84
    v_exp_f32 v85, v85
    v_exp_f32 v86, v86
    v_cvt_pk_bf16_f32 v145, v82, v83
    v_cvt_pk_bf16_f32 v146, v84, v85
    v_mfma_f32_32x32x16_bf16 v[96:111], v[168:171], v[136:139], v[96:111]
    s_add_u32 s24, s24, 0x4000
    v_exp_f32 v87, v87
    v_exp_f32 v88, v88
    v_exp_f32 v89, v89
    v_cvt_pk_bf16_f32 v147, v86, v87
    v_cvt_pk_bf16_f32 v148, v88, v89
    v_mfma_f32_32x32x16_bf16 v[96:111], v[172:175], v[140:143], v[96:111]
    s_add_u32 s25, s25, 1024
    v_exp_f32 v90, v90
    v_exp_f32 v91, v91
    v_exp_f32 v92, v92
    v_cvt_pk_bf16_f32 v149, v90, v91
    v_smfmac_f32_16x16x64_bf16 v[128:131], v[24:27], v[136:143], v28
    ds_read_b128 v[164:167], v2 offset:19456
    v_exp_f32 v93, v93
    v_exp_f32 v94, v94
    v_exp_f32 v95, v95
    v_cvt_pk_bf16_f32 v150, v92, v93
    v_cvt_pk_bf16_f32 v151, v94, v95
    v_mfma_f32_32x32x16_bf16 v[80:95], v[152:155], v[16:19], v[48:63]
    ds_read_b128 v[152:155], v2 offset:20480
    v_exp_f32 v64, v64
    v_exp_f32 v65, v65
    v_exp_f32 v66, v66
    v_exp_f32 v67, v67
    v_cvt_pk_bf16_f32 v136, v64, v65
    v_mfma_f32_32x32x16_bf16 v[80:95], v[156:159], v[20:23], v[80:95]
    ds_read_b128 v[156:159], v2 offset:21504
    v_exp_f32 v68, v68
    v_exp_f32 v69, v69
    v_exp_f32 v70, v70
    v_cvt_pk_bf16_f32 v137, v66, v67
    v_cvt_pk_bf16_f32 v138, v68, v69
    v_mfma_f32_32x32x16_bf16 v[112:127], v[168:171], v[144:147], v[112:127]
    s_add_u32 m0, s51, 0
    v_exp_f32 v71, v71
    v_exp_f32 v72, v72
    v_exp_f32 v73, v73
    v_cvt_pk_bf16_f32 v139, v70, v71
    v_cvt_pk_bf16_f32 v140, v72, v73
    v_mfma_f32_32x32x16_bf16 v[112:127], v[172:175], v[148:151], v[112:127]
    s_waitcnt lgkmcnt(1)
    v_exp_f32 v74, v74
    v_exp_f32 v75, v75
    v_exp_f32 v76, v76
    v_cvt_pk_bf16_f32 v141, v74, v75
    v_smfmac_f32_16x16x64_bf16 v[132:135], v[24:27], v[144:151], v28
    ds_read_b128 v[168:171], v2 offset:22528
    v_exp_f32 v77, v77
    v_exp_f32 v78, v78
    v_exp_f32 v79, v79
    v_cvt_pk_bf16_f32 v142, v76, v77
    v_cvt_pk_bf16_f32 v143, v78, v79
    v_mfma_f32_32x32x16_bf16 v[64:79], v[152:155], v[8:11], v[32:47]
    s_waitcnt lgkmcnt(1)
    v_exp_f32 v80, v80
    v_exp_f32 v81, v81
    v_exp_f32 v82, v82
    v_exp_f32 v83, v83
    v_cvt_pk_bf16_f32 v144, v80, v81
    v_mfma_f32_32x32x16_bf16 v[64:79], v[156:159], v[12:15], v[64:79]
    s_add_u32 s52, s52, 16384
    v_exp_f32 v84, v84
    v_exp_f32 v85, v85
    v_exp_f32 v86, v86
    v_cvt_pk_bf16_f32 v145, v82, v83
    v_cvt_pk_bf16_f32 v146, v84, v85
    v_mfma_f32_32x32x16_bf16 v[96:111], v[160:163], v[136:139], v[96:111]
    s_waitcnt vmcnt(7)
    v_exp_f32 v87, v87
    v_exp_f32 v88, v88
    v_exp_f32 v89, v89
    v_cvt_pk_bf16_f32 v147, v86, v87
    v_cvt_pk_bf16_f32 v148, v88, v89
    v_mfma_f32_32x32x16_bf16 v[96:111], v[164:167], v[140:143], v[96:111]
    s_barrier
    v_exp_f32 v90, v90
    v_exp_f32 v91, v91
    v_exp_f32 v92, v92
    v_cvt_pk_bf16_f32 v149, v90, v91
    v_smfmac_f32_16x16x64_bf16 v[128:131], v[24:27], v[136:143], v28
    ds_read_b128 v[172:175], v2 offset:23552
    v_exp_f32 v93, v93
    v_exp_f32 v94, v94
    v_exp_f32 v95, v95
    v_cvt_pk_bf16_f32 v150, v92, v93
    v_cvt_pk_bf16_f32 v151, v94, v95
    v_mfma_f32_32x32x16_bf16 v[80:95], v[152:155], v[16:19], v[48:63]
    ds_read_b128 v[152:155], v2 offset:24576
    v_exp_f32 v64, v64
    v_exp_f32 v65, v65
    v_exp_f32 v66, v66
    v_exp_f32 v67, v67
    v_cvt_pk_bf16_f32 v136, v64, v65
    v_mfma_f32_32x32x16_bf16 v[80:95], v[156:159], v[20:23], v[80:95]
    ds_read_b128 v[156:159], v2 offset:25600
    v_exp_f32 v68, v68
    v_exp_f32 v69, v69
    v_exp_f32 v70, v70
    v_cvt_pk_bf16_f32 v137, v66, v67
    v_cvt_pk_bf16_f32 v138, v68, v69
    v_mfma_f32_32x32x16_bf16 v[112:127], v[160:163], v[144:147], v[112:127]
    buffer_load_dwordx4 v2, s[28:31], s52 offen offset:0 sc1 lds
    v_exp_f32 v71, v71
    v_exp_f32 v72, v72
    v_exp_f32 v73, v73
    v_cvt_pk_bf16_f32 v139, v70, v71
    v_cvt_pk_bf16_f32 v140, v72, v73
    v_mfma_f32_32x32x16_bf16 v[112:127], v[164:167], v[148:151], v[112:127]
    s_waitcnt lgkmcnt(1)
    s_add_u32 s43, s43, s47
    v_exp_f32 v74, v74
    v_exp_f32 v75, v75
    v_exp_f32 v76, v76
    v_cvt_pk_bf16_f32 v141, v74, v75
    v_smfmac_f32_16x16x64_bf16 v[132:135], v[24:27], v[144:151], v28
    ds_read_b128 v[160:163], v2 offset:26624
    v_exp_f32 v77, v77
    v_exp_f32 v78, v78
    v_exp_f32 v79, v79
    v_cvt_pk_bf16_f32 v142, v76, v77
    v_cvt_pk_bf16_f32 v143, v78, v79
    v_mfma_f32_32x32x16_bf16 v[64:79], v[152:155], v[8:11], v[32:47]
    s_waitcnt lgkmcnt(1)
    v_exp_f32 v80, v80
    v_exp_f32 v81, v81
    v_exp_f32 v82, v82
    v_exp_f32 v83, v83
    v_cvt_pk_bf16_f32 v144, v80, v81
    v_mfma_f32_32x32x16_bf16 v[64:79], v[156:159], v[12:15], v[64:79]
    buffer_load_dwordx4 v2, s[28:31], s52 offen offset:1024 sc1 lds
    v_exp_f32 v84, v84
    v_exp_f32 v85, v85
    v_exp_f32 v86, v86
    v_cvt_pk_bf16_f32 v145, v82, v83
    v_cvt_pk_bf16_f32 v146, v84, v85
    v_mfma_f32_32x32x16_bf16 v[96:111], v[168:171], v[136:139], v[96:111]
    s_add_u32 s44, s44, 8192
    v_exp_f32 v87, v87
    v_exp_f32 v88, v88
    v_exp_f32 v89, v89
    v_cvt_pk_bf16_f32 v147, v86, v87
    v_cvt_pk_bf16_f32 v148, v88, v89
    v_mfma_f32_32x32x16_bf16 v[96:111], v[172:175], v[140:143], v[96:111]
    buffer_load_dwordx4 v2, s[28:31], s52 offen offset:2048 sc1 lds
    v_exp_f32 v90, v90
    v_exp_f32 v91, v91
    v_exp_f32 v92, v92
    v_cvt_pk_bf16_f32 v149, v90, v91
    v_smfmac_f32_16x16x64_bf16 v[128:131], v[24:27], v[136:143], v28
    ds_read_b128 v[164:167], v2 offset:27648
    v_exp_f32 v93, v93
    v_exp_f32 v94, v94
    v_exp_f32 v95, v95
    v_cvt_pk_bf16_f32 v150, v92, v93
    v_cvt_pk_bf16_f32 v151, v94, v95
    v_mfma_f32_32x32x16_bf16 v[80:95], v[152:155], v[16:19], v[48:63]
    ds_read_b128 v[152:155], v2 offset:28672
    v_exp_f32 v64, v64
    v_exp_f32 v65, v65
    v_exp_f32 v66, v66
    v_exp_f32 v67, v67
    v_cvt_pk_bf16_f32 v136, v64, v65
    v_mfma_f32_32x32x16_bf16 v[80:95], v[156:159], v[20:23], v[80:95]
    ds_read_b128 v[156:159], v2 offset:29696
    v_exp_f32 v68, v68
    v_exp_f32 v69, v69
    v_exp_f32 v70, v70
    v_cvt_pk_bf16_f32 v137, v66, v67
    v_cvt_pk_bf16_f32 v138, v68, v69
    v_mfma_f32_32x32x16_bf16 v[112:127], v[168:171], v[144:147], v[112:127]
    buffer_load_dwordx4 v2, s[28:31], s52 offen offset:3072 sc1 lds
    v_exp_f32 v71, v71
    v_exp_f32 v72, v72
    v_exp_f32 v73, v73
    v_cvt_pk_bf16_f32 v139, v70, v71
    v_cvt_pk_bf16_f32 v140, v72, v73
    v_mfma_f32_32x32x16_bf16 v[112:127], v[172:175], v[148:151], v[112:127]
    s_waitcnt lgkmcnt(1)
    s_add_u32 m0, s44, 0
    v_exp_f32 v74, v74
    v_exp_f32 v75, v75
    v_exp_f32 v76, v76
    v_cvt_pk_bf16_f32 v141, v74, v75
    v_smfmac_f32_16x16x64_bf16 v[132:135], v[24:27], v[144:151], v28
    ds_read_b128 v[168:171], v2 offset:30720
    v_exp_f32 v77, v77
    v_exp_f32 v78, v78
    v_exp_f32 v79, v79
    v_cvt_pk_bf16_f32 v142, v76, v77
    v_cvt_pk_bf16_f32 v143, v78, v79
    v_mfma_f32_32x32x16_bf16 v[64:79], v[152:155], v[8:11], v[32:47]
    s_waitcnt lgkmcnt(1)
    v_exp_f32 v80, v80
    v_exp_f32 v81, v81
    v_exp_f32 v82, v82
    v_exp_f32 v83, v83
    v_cvt_pk_bf16_f32 v144, v80, v81
    v_mfma_f32_32x32x16_bf16 v[64:79], v[156:159], v[12:15], v[64:79]
    buffer_load_dwordx4 v192, s[8:11], s43 offen lds
    v_exp_f32 v84, v84
    v_exp_f32 v85, v85
    v_exp_f32 v86, v86
    v_cvt_pk_bf16_f32 v145, v82, v83
    v_cvt_pk_bf16_f32 v146, v84, v85
    v_mfma_f32_32x32x16_bf16 v[96:111], v[160:163], v[136:139], v[96:111]
    v_exp_f32 v87, v87
    v_exp_f32 v88, v88
    v_exp_f32 v89, v89
    v_cvt_pk_bf16_f32 v147, v86, v87
    v_cvt_pk_bf16_f32 v148, v88, v89
    v_mfma_f32_32x32x16_bf16 v[96:111], v[164:167], v[140:143], v[96:111]
    buffer_load_dwordx4 v195, s[8:11], s43 offen offset:1024 lds
    v_exp_f32 v90, v90
    v_exp_f32 v91, v91
    v_exp_f32 v92, v92
    v_cvt_pk_bf16_f32 v149, v90, v91
    v_smfmac_f32_16x16x64_bf16 v[128:131], v[24:27], v[136:143], v28
    ds_read_b128 v[172:175], v2 offset:31744
    v_exp_f32 v93, v93
    v_exp_f32 v94, v94
    v_exp_f32 v95, v95
    v_cvt_pk_bf16_f32 v150, v92, v93
    v_cvt_pk_bf16_f32 v151, v94, v95
    v_mfma_f32_32x32x16_bf16 v[80:95], v[152:155], v[16:19], v[48:63]
    ds_read_b128 v[152:155], v2 offset:32768
    v_exp_f32 v64, v64
    v_exp_f32 v65, v65
    v_exp_f32 v66, v66
    v_exp_f32 v67, v67
    v_cvt_pk_bf16_f32 v136, v64, v65
    v_mfma_f32_32x32x16_bf16 v[80:95], v[156:159], v[20:23], v[80:95]
    ds_read_b128 v[156:159], v2 offset:33792
    v_exp_f32 v68, v68
    v_exp_f32 v69, v69
    v_exp_f32 v70, v70
    v_cvt_pk_bf16_f32 v137, v66, v67
    v_cvt_pk_bf16_f32 v138, v68, v69
    v_mfma_f32_32x32x16_bf16 v[112:127], v[160:163], v[144:147], v[112:127]
    v_exp_f32 v71, v71
    v_exp_f32 v72, v72
    v_exp_f32 v73, v73
    v_cvt_pk_bf16_f32 v139, v70, v71
    v_cvt_pk_bf16_f32 v140, v72, v73
    v_mfma_f32_32x32x16_bf16 v[112:127], v[164:167], v[148:151], v[112:127]
    s_waitcnt lgkmcnt(1)
    v_exp_f32 v74, v74
    v_exp_f32 v75, v75
    v_exp_f32 v76, v76
    v_cvt_pk_bf16_f32 v141, v74, v75
    v_smfmac_f32_16x16x64_bf16 v[132:135], v[24:27], v[144:151], v28
    ds_read_b128 v[160:163], v2 offset:34816
    v_exp_f32 v77, v77
    v_exp_f32 v78, v78
    v_exp_f32 v79, v79
    v_cvt_pk_bf16_f32 v142, v76, v77
    v_cvt_pk_bf16_f32 v143, v78, v79
    v_mfma_f32_32x32x16_bf16 v[64:79], v[152:155], v[8:11], v[32:47]
    s_waitcnt lgkmcnt(1)
    v_exp_f32 v80, v80
    v_exp_f32 v81, v81
    v_exp_f32 v82, v82
    v_exp_f32 v83, v83
    v_cvt_pk_bf16_f32 v144, v80, v81
    v_mfma_f32_32x32x16_bf16 v[64:79], v[156:159], v[12:15], v[64:79]
    buffer_load_dword v181, v182, s[12:15], s3 offen
    v_exp_f32 v84, v84
    v_exp_f32 v85, v85
    v_exp_f32 v86, v86
    v_cvt_pk_bf16_f32 v145, v82, v83
    v_cvt_pk_bf16_f32 v146, v84, v85
    v_mfma_f32_32x32x16_bf16 v[96:111], v[168:171], v[136:139], v[96:111]
    s_add_u32 s3, s3, 1835008
    v_exp_f32 v87, v87
    v_exp_f32 v88, v88
    v_exp_f32 v89, v89
    v_cvt_pk_bf16_f32 v147, v86, v87
    v_cvt_pk_bf16_f32 v148, v88, v89
    v_mfma_f32_32x32x16_bf16 v[96:111], v[172:175], v[140:143], v[96:111]
    buffer_load_dword v181, v180, s[68:71], 0 offen
    v_exp_f32 v90, v90
    v_exp_f32 v91, v91
    v_exp_f32 v92, v92
    v_cvt_pk_bf16_f32 v149, v90, v91
    v_smfmac_f32_16x16x64_bf16 v[128:131], v[24:27], v[136:143], v28
    ds_read_b128 v[164:167], v2 offset:35840
    v_exp_f32 v93, v93
    v_exp_f32 v94, v94
    v_exp_f32 v95, v95
    v_cvt_pk_bf16_f32 v150, v92, v93
    v_cvt_pk_bf16_f32 v151, v94, v95
    v_mfma_f32_32x32x16_bf16 v[80:95], v[152:155], v[16:19], v[48:63]
    ds_read_b128 v[152:155], v2 offset:36864
    v_exp_f32 v64, v64
    v_exp_f32 v65, v65
    v_exp_f32 v66, v66
    v_exp_f32 v67, v67
    v_cvt_pk_bf16_f32 v136, v64, v65
    v_mfma_f32_32x32x16_bf16 v[80:95], v[156:159], v[20:23], v[80:95]
    ds_read_b128 v[156:159], v2 offset:37888
    v_exp_f32 v68, v68
    v_exp_f32 v69, v69
    v_exp_f32 v70, v70
    v_cvt_pk_bf16_f32 v137, v66, v67
    v_cvt_pk_bf16_f32 v138, v68, v69
    v_mfma_f32_32x32x16_bf16 v[112:127], v[168:171], v[144:147], v[112:127]
    s_add_u32 m0, s51, 16384
    v_exp_f32 v71, v71
    v_exp_f32 v72, v72
    v_exp_f32 v73, v73
    v_cvt_pk_bf16_f32 v139, v70, v71
    v_cvt_pk_bf16_f32 v140, v72, v73
    v_mfma_f32_32x32x16_bf16 v[112:127], v[172:175], v[148:151], v[112:127]
    s_waitcnt lgkmcnt(1)
    v_exp_f32 v74, v74
    v_exp_f32 v75, v75
    v_exp_f32 v76, v76
    v_cvt_pk_bf16_f32 v141, v74, v75
    v_smfmac_f32_16x16x64_bf16 v[132:135], v[24:27], v[144:151], v28
    ds_read_b128 v[168:171], v2 offset:38912
    v_exp_f32 v77, v77
    v_exp_f32 v78, v78
    v_exp_f32 v79, v79
    v_cvt_pk_bf16_f32 v142, v76, v77
    v_cvt_pk_bf16_f32 v143, v78, v79
    v_mfma_f32_32x32x16_bf16 v[64:79], v[152:155], v[8:11], v[32:47]
    s_waitcnt lgkmcnt(1)
    v_exp_f32 v80, v80
    v_exp_f32 v81, v81
    v_exp_f32 v82, v82
    v_exp_f32 v83, v83
    v_cvt_pk_bf16_f32 v144, v80, v81
    v_mfma_f32_32x32x16_bf16 v[64:79], v[156:159], v[12:15], v[64:79]
    s_add_u32 s52, s52, 16384
    v_exp_f32 v84, v84
    v_exp_f32 v85, v85
    v_exp_f32 v86, v86
    v_cvt_pk_bf16_f32 v145, v82, v83
    v_cvt_pk_bf16_f32 v146, v84, v85
    v_mfma_f32_32x32x16_bf16 v[96:111], v[160:163], v[136:139], v[96:111]
    s_waitcnt vmcnt(11)
    v_exp_f32 v87, v87
    v_exp_f32 v88, v88
    v_exp_f32 v89, v89
    v_cvt_pk_bf16_f32 v147, v86, v87
    v_cvt_pk_bf16_f32 v148, v88, v89
    v_mfma_f32_32x32x16_bf16 v[96:111], v[164:167], v[140:143], v[96:111]
    s_barrier
    v_exp_f32 v90, v90
    v_exp_f32 v91, v91
    v_exp_f32 v92, v92
    v_cvt_pk_bf16_f32 v149, v90, v91
    v_smfmac_f32_16x16x64_bf16 v[128:131], v[24:27], v[136:143], v28
    ds_read_b128 v[172:175], v2 offset:39936
    v_exp_f32 v93, v93
    v_exp_f32 v94, v94
    v_exp_f32 v95, v95
    v_cvt_pk_bf16_f32 v150, v92, v93
    v_cvt_pk_bf16_f32 v151, v94, v95
    v_mfma_f32_32x32x16_bf16 v[80:95], v[152:155], v[16:19], v[48:63]
    ds_read_b128 v[152:155], v2 offset:40960
    v_exp_f32 v64, v64
    v_exp_f32 v65, v65
    v_exp_f32 v66, v66
    v_exp_f32 v67, v67
    v_cvt_pk_bf16_f32 v136, v64, v65
    v_mfma_f32_32x32x16_bf16 v[80:95], v[156:159], v[20:23], v[80:95]
    ds_read_b128 v[156:159], v2 offset:41984
    v_exp_f32 v68, v68
    v_exp_f32 v69, v69
    v_exp_f32 v70, v70
    v_cvt_pk_bf16_f32 v137, v66, v67
    v_cvt_pk_bf16_f32 v138, v68, v69
    v_mfma_f32_32x32x16_bf16 v[112:127], v[160:163], v[144:147], v[112:127]
    buffer_load_dwordx4 v2, s[28:31], s52 offen offset:0 sc1 lds
    v_exp_f32 v71, v71
    v_exp_f32 v72, v72
    v_exp_f32 v73, v73
    v_cvt_pk_bf16_f32 v139, v70, v71
    v_cvt_pk_bf16_f32 v140, v72, v73
    v_mfma_f32_32x32x16_bf16 v[112:127], v[164:167], v[148:151], v[112:127]
    s_waitcnt lgkmcnt(1)
    s_add_u32 s43, s43, s47
    v_exp_f32 v74, v74
    v_exp_f32 v75, v75
    v_exp_f32 v76, v76
    v_cvt_pk_bf16_f32 v141, v74, v75
    v_smfmac_f32_16x16x64_bf16 v[132:135], v[24:27], v[144:151], v28
    ds_read_b128 v[160:163], v2 offset:43008
    v_exp_f32 v77, v77
    v_exp_f32 v78, v78
    v_exp_f32 v79, v79
    v_cvt_pk_bf16_f32 v142, v76, v77
    v_cvt_pk_bf16_f32 v143, v78, v79
    v_mfma_f32_32x32x16_bf16 v[64:79], v[152:155], v[8:11], v[32:47]
    s_waitcnt lgkmcnt(1)
    v_exp_f32 v80, v80
    v_exp_f32 v81, v81
    v_exp_f32 v82, v82
    v_exp_f32 v83, v83
    v_cvt_pk_bf16_f32 v144, v80, v81
    v_mfma_f32_32x32x16_bf16 v[64:79], v[156:159], v[12:15], v[64:79]
    buffer_load_dwordx4 v2, s[28:31], s52 offen offset:1024 sc1 lds
    v_exp_f32 v84, v84
    v_exp_f32 v85, v85
    v_exp_f32 v86, v86
    v_cvt_pk_bf16_f32 v145, v82, v83
    v_cvt_pk_bf16_f32 v146, v84, v85
    v_mfma_f32_32x32x16_bf16 v[96:111], v[168:171], v[136:139], v[96:111]
    s_add_u32 s44, s44, 8192
    v_exp_f32 v87, v87
    v_exp_f32 v88, v88
    v_exp_f32 v89, v89
    v_cvt_pk_bf16_f32 v147, v86, v87
    v_cvt_pk_bf16_f32 v148, v88, v89
    v_mfma_f32_32x32x16_bf16 v[96:111], v[172:175], v[140:143], v[96:111]
    buffer_load_dwordx4 v2, s[28:31], s52 offen offset:2048 sc1 lds
    v_exp_f32 v90, v90
    v_exp_f32 v91, v91
    v_exp_f32 v92, v92
    v_cvt_pk_bf16_f32 v149, v90, v91
    v_smfmac_f32_16x16x64_bf16 v[128:131], v[24:27], v[136:143], v28
    ds_read_b128 v[164:167], v2 offset:44032
    v_exp_f32 v93, v93
    v_exp_f32 v94, v94
    v_exp_f32 v95, v95
    v_cvt_pk_bf16_f32 v150, v92, v93
    v_cvt_pk_bf16_f32 v151, v94, v95
    v_mfma_f32_32x32x16_bf16 v[80:95], v[152:155], v[16:19], v[48:63]
    ds_read_b128 v[152:155], v2 offset:45056
    v_exp_f32 v64, v64
    v_exp_f32 v65, v65
    v_exp_f32 v66, v66
    v_exp_f32 v67, v67
    v_cvt_pk_bf16_f32 v136, v64, v65
    v_mfma_f32_32x32x16_bf16 v[80:95], v[156:159], v[20:23], v[80:95]
    ds_read_b128 v[156:159], v2 offset:46080
    v_exp_f32 v68, v68
    v_exp_f32 v69, v69
    v_exp_f32 v70, v70
    v_cvt_pk_bf16_f32 v137, v66, v67
    v_cvt_pk_bf16_f32 v138, v68, v69
    v_mfma_f32_32x32x16_bf16 v[112:127], v[168:171], v[144:147], v[112:127]
    buffer_load_dwordx4 v2, s[28:31], s52 offen offset:3072 sc1 lds
    v_exp_f32 v71, v71
    v_exp_f32 v72, v72
    v_exp_f32 v73, v73
    v_cvt_pk_bf16_f32 v139, v70, v71
    v_cvt_pk_bf16_f32 v140, v72, v73
    v_mfma_f32_32x32x16_bf16 v[112:127], v[172:175], v[148:151], v[112:127]
    s_waitcnt lgkmcnt(1)
    s_add_u32 m0, s44, 0
    v_exp_f32 v74, v74
    v_exp_f32 v75, v75
    v_exp_f32 v76, v76
    v_cvt_pk_bf16_f32 v141, v74, v75
    v_smfmac_f32_16x16x64_bf16 v[132:135], v[24:27], v[144:151], v28
    ds_read_b128 v[168:171], v2 offset:47104
    v_exp_f32 v77, v77
    v_exp_f32 v78, v78
    v_exp_f32 v79, v79
    v_cvt_pk_bf16_f32 v142, v76, v77
    v_cvt_pk_bf16_f32 v143, v78, v79
    v_mfma_f32_32x32x16_bf16 v[64:79], v[152:155], v[8:11], v[32:47]
    s_waitcnt lgkmcnt(1)
    v_exp_f32 v80, v80
    v_exp_f32 v81, v81
    v_exp_f32 v82, v82
    v_exp_f32 v83, v83
    v_cvt_pk_bf16_f32 v144, v80, v81
    v_mfma_f32_32x32x16_bf16 v[64:79], v[156:159], v[12:15], v[64:79]
    buffer_load_dwordx4 v192, s[8:11], s43 offen lds
    v_exp_f32 v84, v84
    v_exp_f32 v85, v85
    v_exp_f32 v86, v86
    v_cvt_pk_bf16_f32 v145, v82, v83
    v_cvt_pk_bf16_f32 v146, v84, v85
    v_mfma_f32_32x32x16_bf16 v[96:111], v[160:163], v[136:139], v[96:111]
    v_exp_f32 v87, v87
    v_exp_f32 v88, v88
    v_exp_f32 v89, v89
    v_cvt_pk_bf16_f32 v147, v86, v87
    v_cvt_pk_bf16_f32 v148, v88, v89
    v_mfma_f32_32x32x16_bf16 v[96:111], v[164:167], v[140:143], v[96:111]
    buffer_load_dwordx4 v195, s[8:11], s43 offen offset:1024 lds
    v_exp_f32 v90, v90
    v_exp_f32 v91, v91
    v_exp_f32 v92, v92
    v_cvt_pk_bf16_f32 v149, v90, v91
    v_smfmac_f32_16x16x64_bf16 v[128:131], v[24:27], v[136:143], v28
    ds_read_b128 v[172:175], v2 offset:48128
    v_exp_f32 v93, v93
    v_exp_f32 v94, v94
    v_exp_f32 v95, v95
    v_cvt_pk_bf16_f32 v150, v92, v93
    v_cvt_pk_bf16_f32 v151, v94, v95
    v_mfma_f32_32x32x16_bf16 v[80:95], v[152:155], v[16:19], v[48:63]
    ds_read_b128 v[152:155], v2 offset:49152
    v_exp_f32 v64, v64
    v_exp_f32 v65, v65
    v_exp_f32 v66, v66
    v_exp_f32 v67, v67
    v_cvt_pk_bf16_f32 v136, v64, v65
    v_mfma_f32_32x32x16_bf16 v[80:95], v[156:159], v[20:23], v[80:95]
    ds_read_b128 v[156:159], v2 offset:50176
    v_exp_f32 v68, v68
    v_exp_f32 v69, v69
    v_exp_f32 v70, v70
    v_cvt_pk_bf16_f32 v137, v66, v67
    v_cvt_pk_bf16_f32 v138, v68, v69
    v_mfma_f32_32x32x16_bf16 v[112:127], v[160:163], v[144:147], v[112:127]
    s_mov_b32 m0, s25
    v_exp_f32 v71, v71
    v_exp_f32 v72, v72
    v_exp_f32 v73, v73
    v_cvt_pk_bf16_f32 v139, v70, v71
    v_cvt_pk_bf16_f32 v140, v72, v73
    v_mfma_f32_32x32x16_bf16 v[112:127], v[164:167], v[148:151], v[112:127]
    s_waitcnt lgkmcnt(1)
    v_exp_f32 v74, v74
    v_exp_f32 v75, v75
    v_exp_f32 v76, v76
    v_cvt_pk_bf16_f32 v141, v74, v75
    v_smfmac_f32_16x16x64_bf16 v[132:135], v[24:27], v[144:151], v28
    ds_read_b128 v[160:163], v2 offset:51200
    v_exp_f32 v77, v77
    v_exp_f32 v78, v78
    v_exp_f32 v79, v79
    v_cvt_pk_bf16_f32 v142, v76, v77
    v_cvt_pk_bf16_f32 v143, v78, v79
    v_mfma_f32_32x32x16_bf16 v[64:79], v[152:155], v[8:11], v[32:47]
    s_waitcnt lgkmcnt(1)
    v_exp_f32 v80, v80
    v_exp_f32 v81, v81
    v_exp_f32 v82, v82
    v_exp_f32 v83, v83
    v_cvt_pk_bf16_f32 v144, v80, v81
    v_mfma_f32_32x32x16_bf16 v[64:79], v[156:159], v[12:15], v[64:79]
    buffer_load_dwordx4 v194, s[20:23], s24 offen lds
    v_exp_f32 v84, v84
    v_exp_f32 v85, v85
    v_exp_f32 v86, v86
    v_cvt_pk_bf16_f32 v145, v82, v83
    v_cvt_pk_bf16_f32 v146, v84, v85
    v_mfma_f32_32x32x16_bf16 v[96:111], v[168:171], v[136:139], v[96:111]
    s_add_u32 s24, s24, 0x4000
    v_exp_f32 v87, v87
    v_exp_f32 v88, v88
    v_exp_f32 v89, v89
    v_cvt_pk_bf16_f32 v147, v86, v87
    v_cvt_pk_bf16_f32 v148, v88, v89
    v_mfma_f32_32x32x16_bf16 v[96:111], v[172:175], v[140:143], v[96:111]
    s_add_u32 s25, s25, 1024
    v_exp_f32 v90, v90
    v_exp_f32 v91, v91
    v_exp_f32 v92, v92
    v_cvt_pk_bf16_f32 v149, v90, v91
    v_smfmac_f32_16x16x64_bf16 v[128:131], v[24:27], v[136:143], v28
    ds_read_b128 v[164:167], v2 offset:52224
    v_exp_f32 v93, v93
    v_exp_f32 v94, v94
    v_exp_f32 v95, v95
    v_cvt_pk_bf16_f32 v150, v92, v93
    v_cvt_pk_bf16_f32 v151, v94, v95
    v_mfma_f32_32x32x16_bf16 v[80:95], v[152:155], v[16:19], v[48:63]
    ds_read_b128 v[152:155], v2 offset:53248
    v_exp_f32 v64, v64
    v_exp_f32 v65, v65
    v_exp_f32 v66, v66
    v_exp_f32 v67, v67
    v_cvt_pk_bf16_f32 v136, v64, v65
    v_mfma_f32_32x32x16_bf16 v[80:95], v[156:159], v[20:23], v[80:95]
    ds_read_b128 v[156:159], v2 offset:54272
    v_exp_f32 v68, v68
    v_exp_f32 v69, v69
    v_exp_f32 v70, v70
    v_cvt_pk_bf16_f32 v137, v66, v67
    v_cvt_pk_bf16_f32 v138, v68, v69
    v_mfma_f32_32x32x16_bf16 v[112:127], v[168:171], v[144:147], v[112:127]
    s_add_u32 m0, s51, 32768
    v_exp_f32 v71, v71
    v_exp_f32 v72, v72
    v_exp_f32 v73, v73
    v_cvt_pk_bf16_f32 v139, v70, v71
    v_cvt_pk_bf16_f32 v140, v72, v73
    v_mfma_f32_32x32x16_bf16 v[112:127], v[172:175], v[148:151], v[112:127]
    s_waitcnt lgkmcnt(1)
    v_exp_f32 v74, v74
    v_exp_f32 v75, v75
    v_exp_f32 v76, v76
    v_cvt_pk_bf16_f32 v141, v74, v75
    v_smfmac_f32_16x16x64_bf16 v[132:135], v[24:27], v[144:151], v28
    ds_read_b128 v[168:171], v2 offset:55296
    v_exp_f32 v77, v77
    v_exp_f32 v78, v78
    v_exp_f32 v79, v79
    v_cvt_pk_bf16_f32 v142, v76, v77
    v_cvt_pk_bf16_f32 v143, v78, v79
    v_mfma_f32_32x32x16_bf16 v[64:79], v[152:155], v[8:11], v[32:47]
    s_waitcnt lgkmcnt(1)
    v_exp_f32 v80, v80
    v_exp_f32 v81, v81
    v_exp_f32 v82, v82
    v_exp_f32 v83, v83
    v_cvt_pk_bf16_f32 v144, v80, v81
    v_mfma_f32_32x32x16_bf16 v[64:79], v[156:159], v[12:15], v[64:79]
    s_add_u32 s52, s52, 16384
    v_exp_f32 v84, v84
    v_exp_f32 v85, v85
    v_exp_f32 v86, v86
    v_cvt_pk_bf16_f32 v145, v82, v83
    v_cvt_pk_bf16_f32 v146, v84, v85
    v_mfma_f32_32x32x16_bf16 v[96:111], v[160:163], v[136:139], v[96:111]
    s_waitcnt vmcnt(11)
    v_exp_f32 v87, v87
    v_exp_f32 v88, v88
    v_exp_f32 v89, v89
    v_cvt_pk_bf16_f32 v147, v86, v87
    v_cvt_pk_bf16_f32 v148, v88, v89
    v_mfma_f32_32x32x16_bf16 v[96:111], v[164:167], v[140:143], v[96:111]
    s_barrier
    v_exp_f32 v90, v90
    v_exp_f32 v91, v91
    v_exp_f32 v92, v92
    v_cvt_pk_bf16_f32 v149, v90, v91
    v_smfmac_f32_16x16x64_bf16 v[128:131], v[24:27], v[136:143], v28
    ds_read_b128 v[172:175], v2 offset:56320
    v_exp_f32 v93, v93
    v_exp_f32 v94, v94
    v_exp_f32 v95, v95
    v_cvt_pk_bf16_f32 v150, v92, v93
    v_cvt_pk_bf16_f32 v151, v94, v95
    v_mfma_f32_32x32x16_bf16 v[80:95], v[152:155], v[16:19], v[48:63]
    ds_read_b128 v[152:155], v2 offset:57344
    v_exp_f32 v64, v64
    v_exp_f32 v65, v65
    v_exp_f32 v66, v66
    v_exp_f32 v67, v67
    v_cvt_pk_bf16_f32 v136, v64, v65
    v_mfma_f32_32x32x16_bf16 v[80:95], v[156:159], v[20:23], v[80:95]
    ds_read_b128 v[156:159], v2 offset:58368
    v_exp_f32 v68, v68
    v_exp_f32 v69, v69
    v_exp_f32 v70, v70
    v_cvt_pk_bf16_f32 v137, v66, v67
    v_cvt_pk_bf16_f32 v138, v68, v69
    v_mfma_f32_32x32x16_bf16 v[112:127], v[160:163], v[144:147], v[112:127]
    buffer_load_dwordx4 v2, s[28:31], s52 offen offset:0 sc1 lds
    v_exp_f32 v71, v71
    v_exp_f32 v72, v72
    v_exp_f32 v73, v73
    v_cvt_pk_bf16_f32 v139, v70, v71
    v_cvt_pk_bf16_f32 v140, v72, v73
    v_mfma_f32_32x32x16_bf16 v[112:127], v[164:167], v[148:151], v[112:127]
    s_waitcnt lgkmcnt(1)
    v_exp_f32 v74, v74
    v_exp_f32 v75, v75
    v_exp_f32 v76, v76
    v_cvt_pk_bf16_f32 v141, v74, v75
    v_smfmac_f32_16x16x64_bf16 v[132:135], v[24:27], v[144:151], v28
    ds_read_b128 v[160:163], v2 offset:59392
    v_exp_f32 v77, v77
    v_exp_f32 v78, v78
    v_exp_f32 v79, v79
    v_cvt_pk_bf16_f32 v142, v76, v77
    v_cvt_pk_bf16_f32 v143, v78, v79
    v_mfma_f32_32x32x16_bf16 v[64:79], v[152:155], v[8:11], v[32:47]
    s_waitcnt lgkmcnt(1)
    v_exp_f32 v80, v80
    v_exp_f32 v81, v81
    v_exp_f32 v82, v82
    v_exp_f32 v83, v83
    v_cvt_pk_bf16_f32 v144, v80, v81
    v_mfma_f32_32x32x16_bf16 v[64:79], v[156:159], v[12:15], v[64:79]
    buffer_load_dwordx4 v2, s[28:31], s52 offen offset:1024 sc1 lds
    v_exp_f32 v84, v84
    v_exp_f32 v85, v85
    v_exp_f32 v86, v86
    v_cvt_pk_bf16_f32 v145, v82, v83
    v_cvt_pk_bf16_f32 v146, v84, v85
    v_mfma_f32_32x32x16_bf16 v[96:111], v[168:171], v[136:139], v[96:111]
    v_exp_f32 v87, v87
    v_exp_f32 v88, v88
    v_exp_f32 v89, v89
    v_cvt_pk_bf16_f32 v147, v86, v87
    v_cvt_pk_bf16_f32 v148, v88, v89
    v_mfma_f32_32x32x16_bf16 v[96:111], v[172:175], v[140:143], v[96:111]
    buffer_load_dwordx4 v2, s[28:31], s52 offen offset:2048 sc1 lds
    v_exp_f32 v90, v90
    v_exp_f32 v91, v91
    v_exp_f32 v92, v92
    v_cvt_pk_bf16_f32 v149, v90, v91
    v_smfmac_f32_16x16x64_bf16 v[128:131], v[24:27], v[136:143], v28
    ds_read_b128 v[164:167], v2 offset:60416
    v_exp_f32 v93, v93
    v_exp_f32 v94, v94
    v_exp_f32 v95, v95
    v_cvt_pk_bf16_f32 v150, v92, v93
    v_cvt_pk_bf16_f32 v151, v94, v95
    v_mfma_f32_32x32x16_bf16 v[80:95], v[152:155], v[16:19], v[48:63]
    ds_read_b128 v[152:155], v2 offset:61440
    v_exp_f32 v64, v64
    v_exp_f32 v65, v65
    v_exp_f32 v66, v66
    v_exp_f32 v67, v67
    v_cvt_pk_bf16_f32 v136, v64, v65
    v_mfma_f32_32x32x16_bf16 v[80:95], v[156:159], v[20:23], v[80:95]
    ds_read_b128 v[156:159], v2 offset:62464
    v_exp_f32 v68, v68
    v_exp_f32 v69, v69
    v_exp_f32 v70, v70
    v_cvt_pk_bf16_f32 v137, v66, v67
    v_cvt_pk_bf16_f32 v138, v68, v69
    v_mfma_f32_32x32x16_bf16 v[112:127], v[168:171], v[144:147], v[112:127]
    buffer_load_dwordx4 v2, s[28:31], s52 offen offset:3072 sc1 lds
    v_exp_f32 v71, v71
    v_exp_f32 v72, v72
    v_exp_f32 v73, v73
    v_cvt_pk_bf16_f32 v139, v70, v71
    v_cvt_pk_bf16_f32 v140, v72, v73
    v_mfma_f32_32x32x16_bf16 v[112:127], v[172:175], v[148:151], v[112:127]
    s_waitcnt lgkmcnt(1)
    v_exp_f32 v74, v74
    v_exp_f32 v75, v75
    v_exp_f32 v76, v76
    v_cvt_pk_bf16_f32 v141, v74, v75
    v_smfmac_f32_16x16x64_bf16 v[132:135], v[24:27], v[144:151], v28
    ds_read_b128 v[168:171], v2 offset:63488
    v_exp_f32 v77, v77
    v_exp_f32 v78, v78
    v_exp_f32 v79, v79
    v_cvt_pk_bf16_f32 v142, v76, v77
    v_cvt_pk_bf16_f32 v143, v78, v79
    v_mfma_f32_32x32x16_bf16 v[64:79], v[152:155], v[8:11], v[32:47]
    s_waitcnt lgkmcnt(1)
    v_exp_f32 v80, v80
    v_exp_f32 v81, v81
    v_exp_f32 v82, v82
    v_exp_f32 v83, v83
    v_cvt_pk_bf16_f32 v144, v80, v81
    v_mfma_f32_32x32x16_bf16 v[64:79], v[156:159], v[12:15], v[64:79]
    v_exp_f32 v84, v84
    v_exp_f32 v85, v85
    v_exp_f32 v86, v86
    v_cvt_pk_bf16_f32 v145, v82, v83
    v_cvt_pk_bf16_f32 v146, v84, v85
    v_mfma_f32_32x32x16_bf16 v[96:111], v[160:163], v[136:139], v[96:111]
    v_exp_f32 v87, v87
    v_exp_f32 v88, v88
    v_exp_f32 v89, v89
    v_cvt_pk_bf16_f32 v147, v86, v87
    v_cvt_pk_bf16_f32 v148, v88, v89
    v_mfma_f32_32x32x16_bf16 v[96:111], v[164:167], v[140:143], v[96:111]
    v_exp_f32 v90, v90
    v_exp_f32 v91, v91
    v_exp_f32 v92, v92
    v_cvt_pk_bf16_f32 v149, v90, v91
    v_smfmac_f32_16x16x64_bf16 v[128:131], v[24:27], v[136:143], v28
    ds_read_b128 v[172:175], v2 offset:64512
    v_exp_f32 v93, v93
    v_exp_f32 v94, v94
    v_exp_f32 v95, v95
    v_cvt_pk_bf16_f32 v150, v92, v93
    v_cvt_pk_bf16_f32 v151, v94, v95
    v_mfma_f32_32x32x16_bf16 v[80:95], v[152:155], v[16:19], v[48:63]
    ds_read_b128 v[152:155], v2 offset:0
    v_exp_f32 v64, v64
    v_exp_f32 v65, v65
    v_exp_f32 v66, v66
    v_exp_f32 v67, v67
    v_cvt_pk_bf16_f32 v136, v64, v65
    v_mfma_f32_32x32x16_bf16 v[80:95], v[156:159], v[20:23], v[80:95]
    ds_read_b128 v[156:159], v2 offset:1024
    v_exp_f32 v68, v68
    v_exp_f32 v69, v69
    v_exp_f32 v70, v70
    v_cvt_pk_bf16_f32 v137, v66, v67
    v_cvt_pk_bf16_f32 v138, v68, v69
    v_mfma_f32_32x32x16_bf16 v[112:127], v[160:163], v[144:147], v[112:127]
    v_exp_f32 v71, v71
    v_exp_f32 v72, v72
    v_exp_f32 v73, v73
    v_cvt_pk_bf16_f32 v139, v70, v71
    v_cvt_pk_bf16_f32 v140, v72, v73
    v_mfma_f32_32x32x16_bf16 v[112:127], v[164:167], v[148:151], v[112:127]
    s_waitcnt lgkmcnt(1)
    v_exp_f32 v74, v74
    v_exp_f32 v75, v75
    v_exp_f32 v76, v76
    v_cvt_pk_bf16_f32 v141, v74, v75
    v_smfmac_f32_16x16x64_bf16 v[132:135], v[24:27], v[144:151], v28
    ds_read_b128 v[160:163], v2 offset:2048
    v_exp_f32 v77, v77
    v_exp_f32 v78, v78
    v_exp_f32 v79, v79
    v_cvt_pk_bf16_f32 v142, v76, v77
    v_cvt_pk_bf16_f32 v143, v78, v79
    v_mfma_f32_32x32x16_bf16 v[64:79], v[152:155], v[8:11], v[32:47]
    s_waitcnt lgkmcnt(1)
    v_exp_f32 v80, v80
    v_exp_f32 v81, v81
    v_exp_f32 v82, v82
    v_exp_f32 v83, v83
    v_cvt_pk_bf16_f32 v144, v80, v81
    v_mfma_f32_32x32x16_bf16 v[64:79], v[156:159], v[12:15], v[64:79]
    v_exp_f32 v84, v84
    v_exp_f32 v85, v85
    v_exp_f32 v86, v86
    v_cvt_pk_bf16_f32 v145, v82, v83
    v_cvt_pk_bf16_f32 v146, v84, v85
    v_mfma_f32_32x32x16_bf16 v[96:111], v[168:171], v[136:139], v[96:111]
    v_exp_f32 v87, v87
    v_exp_f32 v88, v88
    v_exp_f32 v89, v89
    v_cvt_pk_bf16_f32 v147, v86, v87
    v_cvt_pk_bf16_f32 v148, v88, v89
    v_mfma_f32_32x32x16_bf16 v[96:111], v[172:175], v[140:143], v[96:111]
    v_exp_f32 v90, v90
    v_exp_f32 v91, v91
    v_exp_f32 v92, v92
    v_cvt_pk_bf16_f32 v149, v90, v91
    v_smfmac_f32_16x16x64_bf16 v[128:131], v[24:27], v[136:143], v28
    ds_read_b128 v[164:167], v2 offset:3072
    v_exp_f32 v93, v93
    v_exp_f32 v94, v94
    v_exp_f32 v95, v95
    v_cvt_pk_bf16_f32 v150, v92, v93
    v_cvt_pk_bf16_f32 v151, v94, v95
    s_sub_u32 s36, s36, 1
    s_cmp_lg_u32 s36, 0
    s_cbranch_scc1 attn_loop1
attn_epi:
    s_add_u32 s43, s43, s47
    s_mov_b32 s44, s45
    v_mfma_f32_32x32x16_bf16 v[112:127], v[168:171], v[144:147], v[112:127]
    v_mfma_f32_32x32x16_bf16 v[112:127], v[172:175], v[148:151], v[112:127]
    v_smfmac_f32_16x16x64_bf16 v[132:135], v[24:27], v[144:151], v28
    s_add_u32 s4, s38, 60817408
    s_addc_u32 s5, s39, 0
    s_mov_b32 s6, 3670016
    s_mov_b32 s7, 0x20000
    buffer_store_dwordx4 v[212:215], v208, s[4:7], 0 offen sc1
    s_add_u32 s4, s38, 60817408
    s_addc_u32 s5, s39, 0
    s_mov_b32 s6, 3670016
    s_mov_b32 s7, 0x20000
    buffer_store_dwordx4 v[220:223], v216, s[4:7], 0 offen sc1
    s_add_u32 s16, s38, 23068672
    s_addc_u32 s17, s39, 0
    s_mov_b32 s18, 4849664
    s_mov_b32 s19, 0x20000
    v_mov_b32 v176, 0
    v_mov_b32 v177, 0
    v_fmac_f32 v176, 0, v96
    v_fmac_f32 v177, 0, v97
    v_fmac_f32 v176, 0, v98
    v_fmac_f32 v177, 0, v99
    v_fmac_f32 v176, 0, v100
    v_fmac_f32 v177, 0, v101
    v_fmac_f32 v176, 0, v102
    v_fmac_f32 v177, 0, v103
    v_fmac_f32 v176, 0, v104
    v_fmac_f32 v177, 0, v105
    v_fmac_f32 v176, 0, v106
    v_fmac_f32 v177, 0, v107
    v_fmac_f32 v176, 0, v108
    v_fmac_f32 v177, 0, v109
    v_fmac_f32 v176, 0, v110
    v_fmac_f32 v177, 0, v111
    v_fmac_f32 v176, 0, v112
    v_fmac_f32 v177, 0, v113
    v_fmac_f32 v176, 0, v114
    v_fmac_f32 v177, 0, v115
    v_fmac_f32 v176, 0, v116
    v_fmac_f32 v177, 0, v117
    v_fmac_f32 v176, 0, v118
    v_fmac_f32 v177, 0, v119
    v_fmac_f32 v176, 0, v120
    v_fmac_f32 v177, 0, v121
    v_fmac_f32 v176, 0, v122
    v_fmac_f32 v177, 0, v123
    v_fmac_f32 v176, 0, v124
    v_fmac_f32 v177, 0, v125
    v_fmac_f32 v176, 0, v126
    v_fmac_f32 v177, 0, v127
    v_add_f32 v128, v128, v129
    v_add_f32 v132, v132, v133
    v_add_f32 v176, v176, v177
    v_add_f32 v176, v176, v128
    v_add_f32 v176, v176, v132
    v_cmp_ngt_f32 vcc, 0x53800000, v176
    s_cbranch_vccnz attn_slow
attn_fin:
    v_rcp_f32 v176, v128
    s_nop 0
    v_rcp_f32 v177, v132
    s_mul_i32 s32, s48, 151552
    s_add_u32 s33, s32, 75776
    v_mul_f32 v96, v96, v176
    v_mul_f32 v97, v97, v176
    v_mul_f32 v98, v98, v176
    v_mul_f32 v99, v99, v176
    v_mul_f32 v100, v100, v176
    v_mul_f32 v101, v101, v176
    v_mul_f32 v102, v102, v176
    v_mul_f32 v103, v103, v176
    v_mul_f32 v104, v104, v176
    v_mul_f32 v105, v105, v176
    v_mul_f32 v106, v106, v176
    v_mul_f32 v107, v107, v176
    v_mul_f32 v108, v108, v176
    v_mul_f32 v109, v109, v176
    v_mul_f32 v110, v110, v176
    v_mul_f32 v111, v111, v176
    v_cvt_pk_bf16_f32 v96, v96, v97
    v_cvt_pk_bf16_f32 v97, v98, v99
    v_cvt_pk_bf16_f32 v98, v100, v101
    v_cvt_pk_bf16_f32 v99, v102, v103
    v_cvt_pk_bf16_f32 v100, v104, v105
    v_cvt_pk_bf16_f32 v101, v106, v107
    v_cvt_pk_bf16_f32 v102, v108, v109
    v_cvt_pk_bf16_f32 v103, v110, v111
    buffer_store_dwordx4 v[96:99], v3, s[16:19], s32 offen sc1
    buffer_store_dwordx4 v[100:103], v3, s[16:19], s33 offen sc1
    v_mul_f32 v112, v112, v177
    v_mul_f32 v113, v113, v177
    v_mul_f32 v114, v114, v177
    v_mul_f32 v115, v115, v177
    v_mul_f32 v116, v116, v177
    v_mul_f32 v117, v117, v177
    v_mul_f32 v118, v118, v177
    v_mul_f32 v119, v119, v177
    v_mul_f32 v120, v120, v177
    v_mul_f32 v121, v121, v177
    v_mul_f32 v122, v122, v177
    v_mul_f32 v123, v123, v177
    v_mul_f32 v124, v124, v177
    v_mul_f32 v125, v125, v177
    v_mul_f32 v126, v126, v177
    v_mul_f32 v127, v127, v177
    v_cvt_pk_bf16_f32 v112, v112, v113
    v_cvt_pk_bf16_f32 v113, v114, v115
    v_cvt_pk_bf16_f32 v114, v116, v117
    v_cvt_pk_bf16_f32 v115, v118, v119
    v_cvt_pk_bf16_f32 v116, v120, v121
    v_cvt_pk_bf16_f32 v117, v122, v123
    v_cvt_pk_bf16_f32 v118, v124, v125
    v_cvt_pk_bf16_f32 v119, v126, v127
    buffer_store_dwordx4 v[112:115], v4, s[16:19], s32 offen sc1
    buffer_store_dwordx4 v[116:119], v4, s[16:19], s33 offen sc1
    s_add_u32 s56, s55, 1536
    s_lshr_b32 s57, s40, 1
    s_lshl_b32 s57, s57, 5
    s_add_u32 s57, s57, 1536
    s_lshl_b32 s58, s41, 1
    s_add_u32 s58, s58, 1760
    s_waitcnt lgkmcnt(0)
    v_bfe_u32 v18, v1, 4, 1
    v_bfe_u32 v19, v1, 3, 1
    v_lshl_add_u32 v18, v18, 2, v19
    s_lshl_b32 s32, s42, 3
    v_add_u32 v18, s32, v18
    v_lshrrev_b32 v19, 5, v1
    v_mul_u32_u24 v19, 75776, v19
    v_and_b32 v16, 7, v1
    v_lshl_add_u32 v19, v16, 4, v19
    v_add_u32 v16, 0, v18
    v_mul_u32_u24 v17, 9363, v16
    v_lshrrev_b32 v17, 16, v17
    v_add_u32 v10, v16, v17
    v_mul_u32_u24 v17, 7, v17
    v_sub_u32 v17, v16, v17
    v_add_u32 v17, 5, v17
    v_lshrrev_b32 v17, 3, v17
    v_add_lshl_u32 v10, v10, v17, 7
    v_add_u32 v10, v10, v19
    v_add_u32 v16, 2, v18
    v_mul_u32_u24 v17, 9363, v16
    v_lshrrev_b32 v17, 16, v17
    v_add_u32 v11, v16, v17
    v_mul_u32_u24 v17, 7, v17
    v_sub_u32 v17, v16, v17
    v_add_u32 v17, 5, v17
    v_lshrrev_b32 v17, 3, v17
    v_add_lshl_u32 v11, v11, v17, 7
    v_add_u32 v11, v11, v19
    s_mov_b32 s27, 0
    s_add_u32 s4, s38, 23068672
    s_addc_u32 s5, s39, 0
    s_mov_b32 s6, 4849664
    s_mov_b32 s7, 0x20000
    s_add_u32 s12, s38, 720896
    s_addc_u32 s13, s39, 0
    s_mov_b32 s14, 294912
    s_mov_b32 s15, 0x20000
    s_lshl_b32 s32, s56, 7
    s_lshl_b32 s59, s57, 7
    v_mov_b32 v30, 1
    v_mov_b32 v31, s32
    s_waitcnt vmcnt(0)
    s_barrier
    s_cmp_lg_u32 s26, 0
    s_cbranch_scc1 h0_nf
    s_mov_b64 exec, 1
    buffer_store_dword v30, v31, s[12:15], 0 offen sc1
    s_mov_b64 exec, -1
h0_nf:
    s_add_u32 m0, s44, 0
    s_nop 0
    buffer_load_dwordx4 v192, s[8:11], s43 offen lds
    s_add_u32 m0, s44, 1024
    s_nop 0
    buffer_load_dwordx4 v193, s[8:11], s43 offen lds
    s_add_u32 s43, s43, s47
    s_add_u32 s44, s44, 8192
    s_cmp_eq_u32 s44, s46
    s_cselect_b32 s44, s45, s44
    s_add_u32 m0, s44, 0
    s_nop 0
    buffer_load_dwordx4 v192, s[8:11], s43 offen lds
    s_add_u32 m0, s44, 1024
    s_nop 0
    buffer_load_dwordx4 v193, s[8:11], s43 offen lds
    s_add_u32 s43, s43, s47
    s_add_u32 s44, s44, 8192
    s_cmp_eq_u32 s44, s46
    s_cselect_b32 s44, s45, s44
    s_add_u32 m0, s44, 0
    s_nop 0
    buffer_load_dwordx4 v192, s[8:11], s43 offen lds
    s_add_u32 m0, s44, 1024
    s_nop 0
    buffer_load_dwordx4 v193, s[8:11], s43 offen lds
    s_add_u32 s43, s43, s47
    s_add_u32 s44, s44, 8192
    s_cmp_eq_u32 s44, s46
    s_cselect_b32 s44, s45, s44
    s_add_u32 m0, s44, 0
    s_nop 0
    buffer_load_dwordx4 v192, s[8:11], s43 offen lds
    s_add_u32 m0, s44, 1024
    s_nop 0
    buffer_load_dwordx4 v193, s[8:11], s43 offen lds
    s_add_u32 s43, s43, s47
    s_add_u32 s44, s44, 8192
    s_cmp_eq_u32 s44, s46
    s_cselect_b32 s44, s45, s44
    s_add_u32 m0, s44, 0
    s_nop 0
    buffer_load_dwordx4 v192, s[8:11], s43 offen lds
    s_add_u32 m0, s44, 1024
    s_nop 0
    buffer_load_dwordx4 v193, s[8:11], s43 offen lds
    s_add_u32 s43, s43, s47
    s_add_u32 s44, s44, 8192
    s_cmp_eq_u32 s44, s46
    s_cselect_b32 s44, s45, s44
    s_add_u32 m0, s44, 0
    s_nop 0
    buffer_load_dwordx4 v192, s[8:11], s43 offen lds
    s_add_u32 m0, s44, 1024
    s_nop 0
    buffer_load_dwordx4 v193, s[8:11], s43 offen lds
    s_add_u32 s43, s43, s47
    s_add_u32 s44, s44, 8192
    s_cmp_eq_u32 s44, s46
    s_cselect_b32 s44, s45, s44
    s_add_u32 m0, s44, 0
    s_nop 0
    buffer_load_dwordx4 v192, s[8:11], s43 offen lds
    s_add_u32 m0, s44, 1024
    s_nop 0
    buffer_load_dwordx4 v193, s[8:11], s43 offen lds
    s_add_u32 s43, s43, s47
    s_add_u32 s44, s44, 8192
    s_cmp_eq_u32 s44, s46
    s_cselect_b32 s44, s45, s44
    s_add_u32 m0, s44, 0
    s_nop 0
    buffer_load_dwordx4 v192, s[8:11], s43 offen lds
    s_add_u32 m0, s44, 1024
    s_nop 0
    buffer_load_dwordx4 v193, s[8:11], s43 offen lds
    s_add_u32 s43, s43, s47
    s_add_u32 s44, s44, 8192
    s_cmp_eq_u32 s44, s46
    s_cselect_b32 s44, s45, s44
    s_lshl_b32 s57, s26, 12
    s_add_u32 s57, s57, 139264
    s_mov_b32 s20, s38
    s_mov_b32 s21, s39
    s_mov_b32 s22, 49152
    s_mov_b32 s23, 0x20000
    v_lshrrev_b32 v16, 5, v1
    v_bfe_u32 v17, v1, 2, 3
    v_lshl_add_u32 v16, v16, 4, v17
    v_and_b32 v18, 3, v1
    v_lshlrev_b32 v16, 7, v16
    v_lshl_add_u32 v16, v18, 3, v16
    v_lshrrev_b32 v17, 1, v17
    v_lshl_add_u32 v5, v17, 5, v16
    s_mov_b32 s37, 65536
    s_getpc_b64 s[68:69]
mlp_kernel_pc3:
    s_add_u32 s68, s68, out_epi-mlp_kernel_pc3
    s_addc_u32 s69, s69, 0
    s_mov_b32 s70, mlp_kernel_end-out_epi+4
    s_cmp_lt_u32 s2, 256
    s_cselect_b32 s70, s70, 0
    s_mov_b32 s71, 0x20000
    s_lshr_b32 s32, s2, 3
    s_lshl_b32 s32, s32, 2
    s_add_u32 s32, s32, s26
    s_lshl_b32 s32, s32, 9
    v_lshrrev_b32 v2, 2, v1
    v_lshlrev_b32 v2, 20, v2
    v_lshl_add_u32 v2, v1, 7, v2
    v_add_u32 v2, s32, v2
    s_add_u32 s37, s37, 8192
    s_cmp_eq_u32 s37, 139264
    s_cselect_b32 s37, 0, s37
    v_add_u32 v6, s37, v5
    v_xor_b32 v7, 32, v6
    v_xor_b32 v8, 64, v6
    v_xor_b32 v9, 96, v6
    s_add_u32 s37, s37, 8192
    s_cmp_eq_u32 s37, 139264
    s_cselect_b32 s37, 0, s37
    ds_read_b64_tr_b16 a[0:1], v6 offset:0
    ds_read_b64_tr_b16 a[2:3], v6 offset:1024
    ds_read_b64_tr_b16 a[4:5], v7 offset:0
    ds_read_b64_tr_b16 a[6:7], v7 offset:1024
    ds_read_b64_tr_b16 a[8:9], v8 offset:0
    ds_read_b64_tr_b16 a[10:11], v8 offset:1024
    ds_read_b64_tr_b16 a[12:13], v9 offset:0
    ds_read_b64_tr_b16 a[14:15], v9 offset:1024
    ds_read_b64_tr_b16 a[16:17], v6 offset:4096
    ds_read_b64_tr_b16 a[18:19], v6 offset:5120
    ds_read_b64_tr_b16 a[20:21], v7 offset:4096
    ds_read_b64_tr_b16 a[22:23], v7 offset:5120
    ds_read_b64_tr_b16 a[24:25], v8 offset:4096
    ds_read_b64_tr_b16 a[26:27], v8 offset:5120
    ds_read_b64_tr_b16 a[28:29], v9 offset:4096
    ds_read_b64_tr_b16 a[30:31], v9 offset:5120
    s_cmp_lg_u32 s26, 0
    s_cbranch_scc1 h0_go
    v_and_b32 v30, 31, v1
    v_lshlrev_b32 v30, 7, v30
    v_add_u32 v30, s59, v30
    v_and_b32 v31, 1, v1
    v_add_lshl_u32 v31, v31, s58, 7
    v_cmp_lt_u32 vcc, 31, v1
    s_nop 1
    v_cndmask_b32 v30, v30, v31, vcc
h0_poll:
    buffer_load_dword v31, v30, s[12:15], 0 offen sc1
    s_waitcnt vmcnt(0)
    v_cmp_eq_u32 vcc, 1, v31
    s_cmp_eq_u64 vcc, -1
    s_cbranch_scc0 h0_poll
h0_go:
    s_waitcnt vmcnt(0)
    s_barrier
    buffer_load_dwordx4 a[32:35], v10, s[4:7], s27 offen sc1
    buffer_load_dwordx4 a[36:39], v11, s[4:7], s27 offen sc1
    s_add_u32 s27, s27, 151552
    buffer_load_dwordx4 a[40:43], v10, s[4:7], s27 offen sc1
    buffer_load_dwordx4 a[44:47], v11, s[4:7], s27 offen sc1
    s_add_u32 s27, s27, 151552
    buffer_load_dwordx4 a[48:51], v10, s[4:7], s27 offen sc1
    buffer_load_dwordx4 a[52:55], v11, s[4:7], s27 offen sc1
    s_add_u32 s27, s27, 151552
    buffer_load_dwordx4 a[56:59], v10, s[4:7], s27 offen sc1
    buffer_load_dwordx4 a[60:63], v11, s[4:7], s27 offen sc1
    s_add_u32 s27, s27, 151552
    buffer_load_dwordx4 a[64:67], v10, s[4:7], s27 offen sc1
    buffer_load_dwordx4 a[68:71], v11, s[4:7], s27 offen sc1
    s_add_u32 s27, s27, 151552
    s_lshl_b32 s32, s41, 8
    v_lshl_add_u32 v22, v1, 2, s32
    s_mov_b32 s32, 8192
    buffer_load_dword v24, v22, s[20:23], s32 offen sc1
    s_mov_b32 s32, 32768
    buffer_load_dword v25, v22, s[20:23], s32 offen sc1
    s_mov_b32 s32, 16384
    buffer_load_dword v26, v22, s[20:23], s32 offen sc1
    s_mov_b32 s32, 40960
    buffer_load_dword v27, v22, s[20:23], s32 offen sc1
    s_waitcnt vmcnt(12) lgkmcnt(12)
    v_mfma_f32_16x16x32_bf16 v[32:35], a[0:3], a[32:35], 0
    v_mfma_f32_16x16x32_bf16 v[36:39], a[0:3], a[36:39], 0
    v_add_u32 v6, s37, v5
    v_xor_b32 v7, 32, v6
    v_xor_b32 v8, 64, v6
    v_xor_b32 v9, 96, v6
    v_mfma_f32_16x16x32_bf16 v[40:43], a[4:7], a[32:35], 0
    ds_read_b64_tr_b16 a[0:1], v6 offset:0
    v_mfma_f32_16x16x32_bf16 v[44:47], a[4:7], a[36:39], 0
    s_waitcnt lgkmcnt(9)
    ds_read_b64_tr_b16 a[2:3], v6 offset:1024
    buffer_load_dwordx4 a[72:75], v10, s[4:7], s27 offen sc1
    buffer_load_dwordx4 a[76:79], v11, s[4:7], s27 offen sc1
    v_mfma_f32_16x16x32_bf16 v[48:51], a[8:11], a[32:35], 0
    ds_read_b64_tr_b16 a[4:5], v7 offset:0
    s_add_u32 s27, s27, 151552
    buffer_load_dwordx4 a[80:83], v10, s[4:7], s27 offen sc1
    v_mfma_f32_16x16x32_bf16 v[52:55], a[8:11], a[36:39], 0
    ds_read_b64_tr_b16 a[6:7], v7 offset:1024
    buffer_load_dwordx4 a[84:87], v11, s[4:7], s27 offen sc1
    s_add_u32 s27, s27, 151552
    v_mfma_f32_16x16x32_bf16 v[56:59], a[12:15], a[32:35], 0
    ds_read_b64_tr_b16 a[8:9], v8 offset:0
    buffer_load_dwordx4 a[88:91], v10, s[4:7], s27 offen sc1
    buffer_load_dwordx4 a[92:95], v11, s[4:7], s27 offen sc1
    v_mfma_f32_16x16x32_bf16 v[60:63], a[12:15], a[36:39], 0
    s_waitcnt vmcnt(16) lgkmcnt(9)
    ds_read_b64_tr_b16 a[10:11], v8 offset:1024
    s_add_u32 s27, s27, 151552
    v_mfma_f32_16x16x32_bf16 v[32:35], a[16:19], a[40:43], v[32:35]
    ds_read_b64_tr_b16 a[12:13], v9 offset:0
    buffer_load_dwordx4 a[32:35], v10, s[4:7], s27 offen sc1
    v_mfma_f32_16x16x32_bf16 v[36:39], a[16:19], a[44:47], v[36:39]
    ds_read_b64_tr_b16 a[14:15], v9 offset:1024
    buffer_load_dwordx4 a[36:39], v11, s[4:7], s27 offen sc1
    v_mfma_f32_16x16x32_bf16 v[40:43], a[20:23], a[40:43], v[40:43]
    ds_read_b64_tr_b16 a[16:17], v6 offset:4096
    v_mfma_f32_16x16x32_bf16 v[44:47], a[20:23], a[44:47], v[44:47]
    s_waitcnt lgkmcnt(9)
    ds_read_b64_tr_b16 a[18:19], v6 offset:5120
    s_add_u32 s27, s27, 151552
    v_mfma_f32_16x16x32_bf16 v[48:51], a[24:27], a[40:43], v[48:51]
    ds_read_b64_tr_b16 a[20:21], v7 offset:4096
    s_add_u32 s37, s37, 8192
    v_mfma_f32_16x16x32_bf16 v[52:55], a[24:27], a[44:47], v[52:55]
    ds_read_b64_tr_b16 a[22:23], v7 offset:5120
    v_mfma_f32_16x16x32_bf16 v[56:59], a[28:31], a[40:43], v[56:59]
    ds_read_b64_tr_b16 a[24:25], v8 offset:4096
    s_cmp_eq_u32 s37, 139264
    s_cselect_b32 s37, 0, s37
    v_mfma_f32_16x16x32_bf16 v[60:63], a[28:31], a[44:47], v[60:63]
    s_waitcnt vmcnt(16) lgkmcnt(9)
    ds_read_b64_tr_b16 a[26:27], v8 offset:5120
    v_mfma_f32_16x16x32_bf16 v[32:35], a[0:3], a[48:51], v[32:35]
    ds_read_b64_tr_b16 a[28:29], v9 offset:4096
    v_mfma_f32_16x16x32_bf16 v[36:39], a[0:3], a[52:55], v[36:39]
    ds_read_b64_tr_b16 a[30:31], v9 offset:5120
    v_add_u32 v6, s37, v5
    v_xor_b32 v7, 32, v6
    v_xor_b32 v8, 64, v6
    v_xor_b32 v9, 96, v6
    v_mfma_f32_16x16x32_bf16 v[40:43], a[4:7], a[48:51], v[40:43]
    ds_read_b64_tr_b16 a[0:1], v6 offset:0
    v_mfma_f32_16x16x32_bf16 v[44:47], a[4:7], a[52:55], v[44:47]
    s_waitcnt lgkmcnt(9)
    ds_read_b64_tr_b16 a[2:3], v6 offset:1024
    buffer_load_dwordx4 a[40:43], v10, s[4:7], s27 offen sc1
    v_mfma_f32_16x16x32_bf16 v[48:51], a[8:11], a[48:51], v[48:51]
    ds_read_b64_tr_b16 a[4:5], v7 offset:0
    buffer_load_dwordx4 a[44:47], v11, s[4:7], s27 offen sc1
    v_mfma_f32_16x16x32_bf16 v[52:55], a[8:11], a[52:55], v[52:55]
    ds_read_b64_tr_b16 a[6:7], v7 offset:1024
    v_mfma_f32_16x16x32_bf16 v[56:59], a[12:15], a[48:51], v[56:59]
    ds_read_b64_tr_b16 a[8:9], v8 offset:0
    s_add_u32 s27, s27, 151552
    v_mfma_f32_16x16x32_bf16 v[60:63], a[12:15], a[52:55], v[60:63]
    s_waitcnt vmcnt(16) lgkmcnt(9)
    ds_read_b64_tr_b16 a[10:11], v8 offset:1024
    v_mfma_f32_16x16x32_bf16 v[32:35], a[16:19], a[56:59], v[32:35]
    ds_read_b64_tr_b16 a[12:13], v9 offset:0
    buffer_load_dwordx4 a[48:51], v10, s[4:7], s27 offen sc1
    v_mfma_f32_16x16x32_bf16 v[36:39], a[16:19], a[60:63], v[36:39]
    ds_read_b64_tr_b16 a[14:15], v9 offset:1024
    buffer_load_dwordx4 a[52:55], v11, s[4:7], s27 offen sc1
    v_mfma_f32_16x16x32_bf16 v[40:43], a[20:23], a[56:59], v[40:43]
    ds_read_b64_tr_b16 a[16:17], v6 offset:4096
    v_mfma_f32_16x16x32_bf16 v[44:47], a[20:23], a[60:63], v[44:47]
    s_waitcnt lgkmcnt(9)
    ds_read_b64_tr_b16 a[18:19], v6 offset:5120
    s_add_u32 s27, s27, 151552
    v_mfma_f32_16x16x32_bf16 v[48:51], a[24:27], a[56:59], v[48:51]
    ds_read_b64_tr_b16 a[20:21], v7 offset:4096
    s_add_u32 s37, s37, 8192
    v_mfma_f32_16x16x32_bf16 v[52:55], a[24:27], a[60:63], v[52:55]
    ds_read_b64_tr_b16 a[22:23], v7 offset:5120
    v_mfma_f32_16x16x32_bf16 v[56:59], a[28:31], a[56:59], v[56:59]
    ds_read_b64_tr_b16 a[24:25], v8 offset:4096
    s_cmp_eq_u32 s37, 139264
    s_cselect_b32 s37, 0, s37
    v_mfma_f32_16x16x32_bf16 v[60:63], a[28:31], a[60:63], v[60:63]
    s_waitcnt vmcnt(16) lgkmcnt(9)
    ds_read_b64_tr_b16 a[26:27], v8 offset:5120
    v_mfma_f32_16x16x32_bf16 v[32:35], a[0:3], a[64:67], v[32:35]
    ds_read_b64_tr_b16 a[28:29], v9 offset:4096
    v_mfma_f32_16x16x32_bf16 v[36:39], a[0:3], a[68:71], v[36:39]
    ds_read_b64_tr_b16 a[30:31], v9 offset:5120
    v_add_u32 v6, s37, v5
    v_xor_b32 v7, 32, v6
    v_xor_b32 v8, 64, v6
    v_xor_b32 v9, 96, v6
    v_mfma_f32_16x16x32_bf16 v[40:43], a[4:7], a[64:67], v[40:43]
    ds_read_b64_tr_b16 a[0:1], v6 offset:0
    v_mfma_f32_16x16x32_bf16 v[44:47], a[4:7], a[68:71], v[44:47]
    s_waitcnt lgkmcnt(9)
    ds_read_b64_tr_b16 a[2:3], v6 offset:1024
    buffer_load_dwordx4 a[56:59], v10, s[4:7], s27 offen sc1
    v_mfma_f32_16x16x32_bf16 v[48:51], a[8:11], a[64:67], v[48:51]
    ds_read_b64_tr_b16 a[4:5], v7 offset:0
    buffer_load_dwordx4 a[60:63], v11, s[4:7], s27 offen sc1
    v_mfma_f32_16x16x32_bf16 v[52:55], a[8:11], a[68:71], v[52:55]
    ds_read_b64_tr_b16 a[6:7], v7 offset:1024
    v_mfma_f32_16x16x32_bf16 v[56:59], a[12:15], a[64:67], v[56:59]
    ds_read_b64_tr_b16 a[8:9], v8 offset:0
    s_add_u32 s27, s27, 151552
    v_mfma_f32_16x16x32_bf16 v[60:63], a[12:15], a[68:71], v[60:63]
    s_waitcnt vmcnt(12) lgkmcnt(9)
    ds_read_b64_tr_b16 a[10:11], v8 offset:1024
    v_mfma_f32_16x16x32_bf16 v[32:35], a[16:19], a[72:75], v[32:35]
    ds_read_b64_tr_b16 a[12:13], v9 offset:0
    buffer_load_dwordx4 a[64:67], v10, s[4:7], s27 offen sc1
    v_mfma_f32_16x16x32_bf16 v[36:39], a[16:19], a[76:79], v[36:39]
    ds_read_b64_tr_b16 a[14:15], v9 offset:1024
    buffer_load_dwordx4 a[68:71], v11, s[4:7], s27 offen sc1
    v_mfma_f32_16x16x32_bf16 v[40:43], a[20:23], a[72:75], v[40:43]
    ds_read_b64_tr_b16 a[16:17], v6 offset:4096
    v_mfma_f32_16x16x32_bf16 v[44:47], a[20:23], a[76:79], v[44:47]
    s_waitcnt lgkmcnt(9)
    ds_read_b64_tr_b16 a[18:19], v6 offset:5120
    s_add_u32 s27, s27, 151552
    v_mfma_f32_16x16x32_bf16 v[48:51], a[24:27], a[72:75], v[48:51]
    ds_read_b64_tr_b16 a[20:21], v7 offset:4096
    s_add_u32 s37, s37, 8192
    v_mfma_f32_16x16x32_bf16 v[52:55], a[24:27], a[76:79], v[52:55]
    ds_read_b64_tr_b16 a[22:23], v7 offset:5120
    v_mfma_f32_16x16x32_bf16 v[56:59], a[28:31], a[72:75], v[56:59]
    ds_read_b64_tr_b16 a[24:25], v8 offset:4096
    s_cmp_eq_u32 s37, 139264
    s_cselect_b32 s37, 0, s37
    v_mfma_f32_16x16x32_bf16 v[60:63], a[28:31], a[76:79], v[60:63]
    s_waitcnt vmcnt(12) lgkmcnt(9)
    ds_read_b64_tr_b16 a[26:27], v8 offset:5120
    v_mfma_f32_16x16x32_bf16 v[32:35], a[0:3], a[80:83], v[32:35]
    ds_read_b64_tr_b16 a[28:29], v9 offset:4096
    v_mfma_f32_16x16x32_bf16 v[36:39], a[0:3], a[84:87], v[36:39]
    ds_read_b64_tr_b16 a[30:31], v9 offset:5120
    v_add_u32 v6, s37, v5
    v_xor_b32 v7, 32, v6
    v_xor_b32 v8, 64, v6
    v_xor_b32 v9, 96, v6
    v_mfma_f32_16x16x32_bf16 v[40:43], a[4:7], a[80:83], v[40:43]
    ds_read_b64_tr_b16 a[0:1], v6 offset:0
    v_mfma_f32_16x16x32_bf16 v[44:47], a[4:7], a[84:87], v[44:47]
    s_waitcnt lgkmcnt(9)
    ds_read_b64_tr_b16 a[2:3], v6 offset:1024
    buffer_load_dwordx4 a[72:75], v10, s[4:7], s27 offen sc1
    v_mfma_f32_16x16x32_bf16 v[48:51], a[8:11], a[80:83], v[48:51]
    ds_read_b64_tr_b16 a[4:5], v7 offset:0
    buffer_load_dwordx4 a[76:79], v11, s[4:7], s27 offen sc1
    v_mfma_f32_16x16x32_bf16 v[52:55], a[8:11], a[84:87], v[52:55]
    ds_read_b64_tr_b16 a[6:7], v7 offset:1024
    v_mfma_f32_16x16x32_bf16 v[56:59], a[12:15], a[80:83], v[56:59]
    ds_read_b64_tr_b16 a[8:9], v8 offset:0
    s_add_u32 s27, s27, 151552
    v_mfma_f32_16x16x32_bf16 v[60:63], a[12:15], a[84:87], v[60:63]
    s_waitcnt vmcnt(12) lgkmcnt(9)
    ds_read_b64_tr_b16 a[10:11], v8 offset:1024
    v_mfma_f32_16x16x32_bf16 v[32:35], a[16:19], a[88:91], v[32:35]
    ds_read_b64_tr_b16 a[12:13], v9 offset:0
    buffer_load_dwordx4 a[80:83], v10, s[4:7], s27 offen sc1
    v_mfma_f32_16x16x32_bf16 v[36:39], a[16:19], a[92:95], v[36:39]
    ds_read_b64_tr_b16 a[14:15], v9 offset:1024
    buffer_load_dwordx4 a[84:87], v11, s[4:7], s27 offen sc1
    v_mfma_f32_16x16x32_bf16 v[40:43], a[20:23], a[88:91], v[40:43]
    ds_read_b64_tr_b16 a[16:17], v6 offset:4096
    v_mfma_f32_16x16x32_bf16 v[44:47], a[20:23], a[92:95], v[44:47]
    s_waitcnt lgkmcnt(9)
    ds_read_b64_tr_b16 a[18:19], v6 offset:5120
    s_add_u32 s27, s27, 151552
    v_mfma_f32_16x16x32_bf16 v[48:51], a[24:27], a[88:91], v[48:51]
    ds_read_b64_tr_b16 a[20:21], v7 offset:4096
    s_add_u32 s37, s37, 8192
    v_mfma_f32_16x16x32_bf16 v[52:55], a[24:27], a[92:95], v[52:55]
    ds_read_b64_tr_b16 a[22:23], v7 offset:5120
    v_mfma_f32_16x16x32_bf16 v[56:59], a[28:31], a[88:91], v[56:59]
    ds_read_b64_tr_b16 a[24:25], v8 offset:4096
    s_cmp_eq_u32 s37, 139264
    s_cselect_b32 s37, 0, s37
    v_mfma_f32_16x16x32_bf16 v[60:63], a[28:31], a[92:95], v[60:63]
    s_waitcnt vmcnt(12) lgkmcnt(9)
    ds_read_b64_tr_b16 a[26:27], v8 offset:5120
    ds_read_b64_tr_b16 a[28:29], v9 offset:4096
    ds_read_b64_tr_b16 a[30:31], v9 offset:5120
    s_mov_b32 s36, 3
.p2align 6
out_loop:
    v_mfma_f32_16x16x32_bf16 v[32:35], a[0:3], a[32:35], v[32:35]
    v_mfma_f32_16x16x32_bf16 v[36:39], a[0:3], a[36:39], v[36:39]
    s_barrier
    v_add_u32 v6, s37, v5
    v_xor_b32 v7, 32, v6
    v_xor_b32 v8, 64, v6
    v_xor_b32 v9, 96, v6
    v_mfma_f32_16x16x32_bf16 v[40:43], a[4:7], a[32:35], v[40:43]
    ds_read_b64_tr_b16 a[0:1], v6 offset:0
    v_mfma_f32_16x16x32_bf16 v[44:47], a[4:7], a[36:39], v[44:47]
    s_waitcnt lgkmcnt(9)
    ds_read_b64_tr_b16 a[2:3], v6 offset:1024
    buffer_load_dwordx4 a[88:91], v10, s[4:7], s27 offen sc1
    v_mfma_f32_16x16x32_bf16 v[48:51], a[8:11], a[32:35], v[48:51]
    ds_read_b64_tr_b16 a[4:5], v7 offset:0
    buffer_load_dwordx4 a[92:95], v11, s[4:7], s27 offen sc1
    v_mfma_f32_16x16x32_bf16 v[52:55], a[8:11], a[36:39], v[52:55]
    ds_read_b64_tr_b16 a[6:7], v7 offset:1024
    v_mfma_f32_16x16x32_bf16 v[56:59], a[12:15], a[32:35], v[56:59]
    ds_read_b64_tr_b16 a[8:9], v8 offset:0
    s_add_u32 s27, s27, 151552
    v_mfma_f32_16x16x32_bf16 v[60:63], a[12:15], a[36:39], v[60:63]
    s_waitcnt vmcnt(12) lgkmcnt(9)
    ds_read_b64_tr_b16 a[10:11], v8 offset:1024
    v_mfma_f32_16x16x32_bf16 v[32:35], a[16:19], a[40:43], v[32:35]
    ds_read_b64_tr_b16 a[12:13], v9 offset:0
    buffer_load_dwordx4 a[32:35], v10, s[4:7], s27 offen sc1
    v_mfma_f32_16x16x32_bf16 v[36:39], a[16:19], a[44:47], v[36:39]
    ds_read_b64_tr_b16 a[14:15], v9 offset:1024
    buffer_load_dwordx4 a[36:39], v11, s[4:7], s27 offen sc1
    v_mfma_f32_16x16x32_bf16 v[40:43], a[20:23], a[40:43], v[40:43]
    ds_read_b64_tr_b16 a[16:17], v6 offset:4096
    s_add_u32 s27, s27, 151552
    v_mfma_f32_16x16x32_bf16 v[44:47], a[20:23], a[44:47], v[44:47]
    s_waitcnt lgkmcnt(9)
    ds_read_b64_tr_b16 a[18:19], v6 offset:5120
    v_mfma_f32_16x16x32_bf16 v[48:51], a[24:27], a[40:43], v[48:51]
    ds_read_b64_tr_b16 a[20:21], v7 offset:4096
    buffer_load_dword v31, v2, s[68:71], 0 offen
    v_mfma_f32_16x16x32_bf16 v[52:55], a[24:27], a[44:47], v[52:55]
    ds_read_b64_tr_b16 a[22:23], v7 offset:5120
    s_add_u32 s37, s37, 8192
    v_mfma_f32_16x16x32_bf16 v[56:59], a[28:31], a[40:43], v[56:59]
    ds_read_b64_tr_b16 a[24:25], v8 offset:4096
    s_cmp_eq_u32 s37, 139264
    s_cselect_b32 s37, 0, s37
    v_mfma_f32_16x16x32_bf16 v[60:63], a[28:31], a[44:47], v[60:63]
    s_waitcnt vmcnt(13) lgkmcnt(9)
    ds_read_b64_tr_b16 a[26:27], v8 offset:5120
    v_mfma_f32_16x16x32_bf16 v[32:35], a[0:3], a[48:51], v[32:35]
    ds_read_b64_tr_b16 a[28:29], v9 offset:4096
    v_mfma_f32_16x16x32_bf16 v[36:39], a[0:3], a[52:55], v[36:39]
    ds_read_b64_tr_b16 a[30:31], v9 offset:5120
    v_add_u32 v6, s37, v5
    v_xor_b32 v7, 32, v6
    v_xor_b32 v8, 64, v6
    v_xor_b32 v9, 96, v6
    v_mfma_f32_16x16x32_bf16 v[40:43], a[4:7], a[48:51], v[40:43]
    ds_read_b64_tr_b16 a[0:1], v6 offset:0
    v_mfma_f32_16x16x32_bf16 v[44:47], a[4:7], a[52:55], v[44:47]
    s_waitcnt lgkmcnt(9)
    ds_read_b64_tr_b16 a[2:3], v6 offset:1024
    buffer_load_dwordx4 a[40:43], v10, s[4:7], s27 offen sc1
    v_mfma_f32_16x16x32_bf16 v[48:51], a[8:11], a[48:51], v[48:51]
    ds_read_b64_tr_b16 a[4:5], v7 offset:0
    buffer_load_dwordx4 a[44:47], v11, s[4:7], s27 offen sc1
    v_mfma_f32_16x16x32_bf16 v[52:55], a[8:11], a[52:55], v[52:55]
    ds_read_b64_tr_b16 a[6:7], v7 offset:1024
    v_mfma_f32_16x16x32_bf16 v[56:59], a[12:15], a[48:51], v[56:59]
    ds_read_b64_tr_b16 a[8:9], v8 offset:0
    s_add_u32 s27, s27, 151552
    v_mfma_f32_16x16x32_bf16 v[60:63], a[12:15], a[52:55], v[60:63]
    s_waitcnt vmcnt(13) lgkmcnt(9)
    ds_read_b64_tr_b16 a[10:11], v8 offset:1024
    v_mfma_f32_16x16x32_bf16 v[32:35], a[16:19], a[56:59], v[32:35]
    ds_read_b64_tr_b16 a[12:13], v9 offset:0
    buffer_load_dwordx4 a[48:51], v10, s[4:7], s27 offen sc1
    v_mfma_f32_16x16x32_bf16 v[36:39], a[16:19], a[60:63], v[36:39]
    ds_read_b64_tr_b16 a[14:15], v9 offset:1024
    buffer_load_dwordx4 a[52:55], v11, s[4:7], s27 offen sc1
    v_mfma_f32_16x16x32_bf16 v[40:43], a[20:23], a[56:59], v[40:43]
    ds_read_b64_tr_b16 a[16:17], v6 offset:4096
    v_mfma_f32_16x16x32_bf16 v[44:47], a[20:23], a[60:63], v[44:47]
    s_waitcnt lgkmcnt(9)
    ds_read_b64_tr_b16 a[18:19], v6 offset:5120
    s_add_u32 s27, s27, 151552
    v_mfma_f32_16x16x32_bf16 v[48:51], a[24:27], a[56:59], v[48:51]
    ds_read_b64_tr_b16 a[20:21], v7 offset:4096
    s_add_u32 s37, s37, 8192
    v_mfma_f32_16x16x32_bf16 v[52:55], a[24:27], a[60:63], v[52:55]
    ds_read_b64_tr_b16 a[22:23], v7 offset:5120
    v_mfma_f32_16x16x32_bf16 v[56:59], a[28:31], a[56:59], v[56:59]
    ds_read_b64_tr_b16 a[24:25], v8 offset:4096
    s_cmp_eq_u32 s37, 139264
    s_cselect_b32 s37, 0, s37
    v_mfma_f32_16x16x32_bf16 v[60:63], a[28:31], a[60:63], v[60:63]
    s_waitcnt vmcnt(13) lgkmcnt(9)
    ds_read_b64_tr_b16 a[26:27], v8 offset:5120
    v_mfma_f32_16x16x32_bf16 v[32:35], a[0:3], a[64:67], v[32:35]
    ds_read_b64_tr_b16 a[28:29], v9 offset:4096
    v_mfma_f32_16x16x32_bf16 v[36:39], a[0:3], a[68:71], v[36:39]
    ds_read_b64_tr_b16 a[30:31], v9 offset:5120
    v_add_u32 v6, s37, v5
    v_xor_b32 v7, 32, v6
    v_xor_b32 v8, 64, v6
    v_xor_b32 v9, 96, v6
    v_mfma_f32_16x16x32_bf16 v[40:43], a[4:7], a[64:67], v[40:43]
    ds_read_b64_tr_b16 a[0:1], v6 offset:0
    v_mfma_f32_16x16x32_bf16 v[44:47], a[4:7], a[68:71], v[44:47]
    s_waitcnt lgkmcnt(9)
    ds_read_b64_tr_b16 a[2:3], v6 offset:1024
    buffer_load_dwordx4 a[56:59], v10, s[4:7], s27 offen sc1
    v_mfma_f32_16x16x32_bf16 v[48:51], a[8:11], a[64:67], v[48:51]
    ds_read_b64_tr_b16 a[4:5], v7 offset:0
    buffer_load_dwordx4 a[60:63], v11, s[4:7], s27 offen sc1
    v_mfma_f32_16x16x32_bf16 v[52:55], a[8:11], a[68:71], v[52:55]
    ds_read_b64_tr_b16 a[6:7], v7 offset:1024
    v_mfma_f32_16x16x32_bf16 v[56:59], a[12:15], a[64:67], v[56:59]
    ds_read_b64_tr_b16 a[8:9], v8 offset:0
    s_add_u32 s27, s27, 151552
    v_mfma_f32_16x16x32_bf16 v[60:63], a[12:15], a[68:71], v[60:63]
    s_waitcnt vmcnt(13) lgkmcnt(9)
    ds_read_b64_tr_b16 a[10:11], v8 offset:1024
    v_mfma_f32_16x16x32_bf16 v[32:35], a[16:19], a[72:75], v[32:35]
    ds_read_b64_tr_b16 a[12:13], v9 offset:0
    buffer_load_dwordx4 a[64:67], v10, s[4:7], s27 offen sc1
    v_mfma_f32_16x16x32_bf16 v[36:39], a[16:19], a[76:79], v[36:39]
    ds_read_b64_tr_b16 a[14:15], v9 offset:1024
    buffer_load_dwordx4 a[68:71], v11, s[4:7], s27 offen sc1
    v_mfma_f32_16x16x32_bf16 v[40:43], a[20:23], a[72:75], v[40:43]
    ds_read_b64_tr_b16 a[16:17], v6 offset:4096
    v_mfma_f32_16x16x32_bf16 v[44:47], a[20:23], a[76:79], v[44:47]
    s_waitcnt lgkmcnt(9)
    ds_read_b64_tr_b16 a[18:19], v6 offset:5120
    s_add_u32 s27, s27, 151552
    v_mfma_f32_16x16x32_bf16 v[48:51], a[24:27], a[72:75], v[48:51]
    ds_read_b64_tr_b16 a[20:21], v7 offset:4096
    s_add_u32 s37, s37, 8192
    v_mfma_f32_16x16x32_bf16 v[52:55], a[24:27], a[76:79], v[52:55]
    ds_read_b64_tr_b16 a[22:23], v7 offset:5120
    v_mfma_f32_16x16x32_bf16 v[56:59], a[28:31], a[72:75], v[56:59]
    ds_read_b64_tr_b16 a[24:25], v8 offset:4096
    s_cmp_eq_u32 s37, 139264
    s_cselect_b32 s37, 0, s37
    v_mfma_f32_16x16x32_bf16 v[60:63], a[28:31], a[76:79], v[60:63]
    s_waitcnt vmcnt(13) lgkmcnt(9)
    ds_read_b64_tr_b16 a[26:27], v8 offset:5120
    v_mfma_f32_16x16x32_bf16 v[32:35], a[0:3], a[80:83], v[32:35]
    ds_read_b64_tr_b16 a[28:29], v9 offset:4096
    v_mfma_f32_16x16x32_bf16 v[36:39], a[0:3], a[84:87], v[36:39]
    ds_read_b64_tr_b16 a[30:31], v9 offset:5120
    v_add_u32 v6, s37, v5
    v_xor_b32 v7, 32, v6
    v_xor_b32 v8, 64, v6
    v_xor_b32 v9, 96, v6
    v_mfma_f32_16x16x32_bf16 v[40:43], a[4:7], a[80:83], v[40:43]
    ds_read_b64_tr_b16 a[0:1], v6 offset:0
    v_mfma_f32_16x16x32_bf16 v[44:47], a[4:7], a[84:87], v[44:47]
    s_waitcnt lgkmcnt(9)
    ds_read_b64_tr_b16 a[2:3], v6 offset:1024
    buffer_load_dwordx4 a[72:75], v10, s[4:7], s27 offen sc1
    v_mfma_f32_16x16x32_bf16 v[48:51], a[8:11], a[80:83], v[48:51]
    ds_read_b64_tr_b16 a[4:5], v7 offset:0
    buffer_load_dwordx4 a[76:79], v11, s[4:7], s27 offen sc1
    v_mfma_f32_16x16x32_bf16 v[52:55], a[8:11], a[84:87], v[52:55]
    ds_read_b64_tr_b16 a[6:7], v7 offset:1024
    v_mfma_f32_16x16x32_bf16 v[56:59], a[12:15], a[80:83], v[56:59]
    ds_read_b64_tr_b16 a[8:9], v8 offset:0
    s_add_u32 s27, s27, 151552
    v_mfma_f32_16x16x32_bf16 v[60:63], a[12:15], a[84:87], v[60:63]
    s_waitcnt vmcnt(13) lgkmcnt(9)
    ds_read_b64_tr_b16 a[10:11], v8 offset:1024
    v_mfma_f32_16x16x32_bf16 v[32:35], a[16:19], a[88:91], v[32:35]
    ds_read_b64_tr_b16 a[12:13], v9 offset:0
    buffer_load_dwordx4 a[80:83], v10, s[4:7], s27 offen sc1
    v_mfma_f32_16x16x32_bf16 v[36:39], a[16:19], a[92:95], v[36:39]
    ds_read_b64_tr_b16 a[14:15], v9 offset:1024
    buffer_load_dwordx4 a[84:87], v11, s[4:7], s27 offen sc1
    v_mfma_f32_16x16x32_bf16 v[40:43], a[20:23], a[88:91], v[40:43]
    ds_read_b64_tr_b16 a[16:17], v6 offset:4096
    s_add_u32 s27, s27, 151552
    v_mfma_f32_16x16x32_bf16 v[44:47], a[20:23], a[92:95], v[44:47]
    s_waitcnt lgkmcnt(9)
    ds_read_b64_tr_b16 a[18:19], v6 offset:5120
    v_mfma_f32_16x16x32_bf16 v[48:51], a[24:27], a[88:91], v[48:51]
    ds_read_b64_tr_b16 a[20:21], v7 offset:4096
    s_add_u32 s37, s37, 8192
    v_mfma_f32_16x16x32_bf16 v[52:55], a[24:27], a[92:95], v[52:55]
    ds_read_b64_tr_b16 a[22:23], v7 offset:5120
    s_cmp_eq_u32 s37, 139264
    s_cselect_b32 s37, 0, s37
    v_mfma_f32_16x16x32_bf16 v[56:59], a[28:31], a[88:91], v[56:59]
    ds_read_b64_tr_b16 a[24:25], v8 offset:4096
    s_sub_u32 s36, s36, 1
    s_cmp_lg_u32 s36, 0
    v_mfma_f32_16x16x32_bf16 v[60:63], a[28:31], a[92:95], v[60:63]
    s_waitcnt vmcnt(13) lgkmcnt(9)
    ds_read_b64_tr_b16 a[26:27], v8 offset:5120
    ds_read_b64_tr_b16 a[28:29], v9 offset:4096
    ds_read_b64_tr_b16 a[30:31], v9 offset:5120
    s_cbranch_scc1 out_loop
out_epi:
    s_and_b32 s32, s2, 7
    s_lshr_b32 s33, s2, 3
    s_lshr_b32 s34, s32, 2
    s_and_b32 s35, s32, 3
    s_and_b32 s48, s33, 3
    s_lshr_b32 s49, s33, 2
    s_mul_i32 s34, s34, 4
    s_add_u32 s48, s48, s34
    s_mul_i32 s35, s35, 8
    s_add_u32 s49, s49, s35
    s_lshl_b32 s50, s48, 2
    s_add_u32 s50, s50, s26
    s_mul_i32 s50, s50, 2
    s_and_b32 s32, s26, 1
    s_mul_i32 s33, s32, 229376
    s_mul_i32 s34, s49, 224
    s_add_u32 s33, s33, s34
    s_mov_b32 s55, 458752
    v_add_u32 v12, 0, v1
    v_mul_u32_u24 v13, 4682, v12
    v_lshrrev_b32 v13, 16, v13
    v_lshl_add_u32 v12, v12, 4, s33
    v_mul_u32_u24 v13, 6944, v13
    v_add_u32 v3, v12, v13
    v_add_u32 v12, 64, v1
    v_mul_u32_u24 v13, 4682, v12
    v_lshrrev_b32 v13, 16, v13
    v_lshl_add_u32 v12, v12, 4, s33
    v_mul_u32_u24 v13, 6944, v13
    v_add_u32 v4, v12, v13
    v_add_u32 v12, 128, v1
    v_mul_u32_u24 v13, 4682, v12
    v_lshrrev_b32 v13, 16, v13
    v_lshl_add_u32 v12, v12, 4, s33
    v_mul_u32_u24 v13, 6944, v13
    v_add_u32 v5, v12, v13
    v_add_u32 v12, 192, v1
    v_mul_u32_u24 v13, 4682, v12
    v_lshrrev_b32 v13, 16, v13
    v_lshl_add_u32 v12, v12, 4, s33
    v_mul_u32_u24 v13, 6944, v13
    v_add_u32 v6, v12, v13
    v_add_u32 v12, 256, v1
    v_mul_u32_u24 v13, 4682, v12
    v_lshrrev_b32 v13, 16, v13
    v_lshl_add_u32 v12, v12, 4, s33
    v_mul_u32_u24 v13, 6944, v13
    v_add_u32 v7, v12, v13
    v_add_u32 v12, 320, v1
    v_mul_u32_u24 v13, 4682, v12
    v_lshrrev_b32 v13, 16, v13
    v_lshl_add_u32 v12, v12, 4, s33
    v_mul_u32_u24 v13, 6944, v13
    v_add_u32 v8, v12, v13
    v_add_u32 v12, 384, v1
    v_mul_u32_u24 v13, 4682, v12
    v_lshrrev_b32 v13, 16, v13
    v_lshl_add_u32 v12, v12, 4, s33
    v_mul_u32_u24 v13, 6944, v13
    v_add_u32 v9, v12, v13
    s_mul_i32 s53, s26, 7168
    s_add_u32 s53, s53, 24576
    s_mov_b32 s51, 0
    s_add_u32 s52, s53, 57344
    s_add_u32 s54, s53, 114688
    s_cmp_ge_u32 s26, 2
    s_cselect_b32 s28, s66, s64
    s_cselect_b32 s29, s67, s65
    s_mov_b32 s30, 7340032
    s_mov_b32 s31, 0x20000
    s_add_u32 m0, s52, 0
    s_nop 0
    buffer_load_dwordx4 v3, s[28:31], s51 offen lds
    s_add_u32 m0, s52, 1024
    s_nop 0
    buffer_load_dwordx4 v4, s[28:31], s51 offen lds
    s_add_u32 m0, s52, 2048
    s_nop 0
    buffer_load_dwordx4 v5, s[28:31], s51 offen lds
    s_add_u32 m0, s52, 3072
    s_nop 0
    buffer_load_dwordx4 v6, s[28:31], s51 offen lds
    s_add_u32 s12, s38, 28311552
    s_addc_u32 s13, s39, 0
    s_mov_b32 s14, 4194304
    s_mov_b32 s15, 0x20000
    s_add_u32 s16, s38, 33554432
    s_addc_u32 s17, s39, 0
    s_mov_b32 s18, 4849664
    s_mov_b32 s19, 0x20000
    s_add_u32 s20, s38, 262144
    s_addc_u32 s21, s39, 0
    s_mov_b32 s22, 262144
    s_mov_b32 s23, 0x20000
    v_add_f32 v24, v24, v25
    v_add_f32 v26, v26, v27
    v_cvt_pk_bf16_f32 v24, v24, v24
    v_and_b32 v24, 0xffff0000, v24
    v_cvt_pk_bf16_f32 v26, v26, v26
    v_and_b32 v26, 0xffff0000, v26
    v_add_f32 v26, 1.0, v26
    v_cvt_pk_bf16_f32 v26, v26, v26
    v_and_b32 v26, 0xffff0000, v26
    s_lshl_b32 s33, s26, 9
    s_add_u32 s33, s33, 155648
    v_lshl_add_u32 v16, v1, 2, s33
    ds_write_b32 v16, v24
    ds_write_b32 v16, v26 offset:256
    s_add_u32 m0, s52, 4096
    s_nop 0
    buffer_load_dwordx4 v7, s[28:31], s51 offen lds
    s_add_u32 m0, s52, 5120
    s_nop 0
    buffer_load_dwordx4 v8, s[28:31], s51 offen lds
    s_add_u32 m0, s52, 6144
    s_nop 0
    buffer_load_dwordx4 v9, s[28:31], s51 offen lds
    s_add_u32 s51, s51, s55
    s_add_u32 s52, s52, 28672
    s_cmp_eq_u32 s52, s54
    s_cselect_b32 s52, s53, s52
    v_and_b32 v19, 15, v1
    v_lshlrev_b32 v19, 7, v19
    v_lshrrev_b32 v17, 5, v1
    v_and_b32 v18, 7, v1
    v_xor_b32 v17, v17, v18
    v_lshl_add_u32 v19, v17, 4, v19
    v_bfe_u32 v17, v1, 4, 1
    v_lshl_add_u32 v19, v17, 3, v19
    v_add_u32 v19, s57, v19
    v_lshrrev_b32 v16, 4, v1
    v_lshl_add_u32 v16, v16, 4, s33
    v_xor_b32 v20, 32, v19
    v_xor_b32 v21, 64, v19
    v_xor_b32 v22, 96, v19
    ds_read_b64 v[128:129], v19 offset:0
    ds_read_b64 v[130:131], v19 offset:2048
    ds_read_b64 v[132:133], v20 offset:0
    ds_read_b64 v[134:135], v20 offset:2048
    ds_read_b64 v[136:137], v21 offset:0
    ds_read_b64 v[138:139], v21 offset:2048
    ds_read_b64 v[140:141], v22 offset:0
    ds_read_b64 v[142:143], v22 offset:2048
    s_waitcnt lgkmcnt(8)
    ds_read_b128 v[64:67], v16 offset:0
    ds_read_b128 v[68:71], v16 offset:64
    ds_read_b128 v[72:75], v16 offset:128
    ds_read_b128 v[76:79], v16 offset:192
    ds_read_b128 v[80:83], v16 offset:256
    ds_read_b128 v[84:87], v16 offset:320
    ds_read_b128 v[88:91], v16 offset:384
    ds_read_b128 v[92:95], v16 offset:448
    v_bfe_u32 v24, v1, 4, 1
    v_lshrrev_b32 v25, 5, v1
    v_lshl_add_u32 v24, v24, 1, v25
    v_bfe_u32 v25, v1, 3, 1
    v_lshl_add_u32 v24, v24, 1, v25
    s_lshl_b32 s32, s42, 3
    s_add_u32 s32, s32, 0
    v_add_u32 v24, s32, v24
    v_mul_u32_u24 v25, 9363, v24
    v_lshrrev_b32 v25, 16, v25
    v_add_u32 v18, v24, v25
    v_mul_u32_u24 v25, 7, v25
    v_sub_u32 v25, v24, v25
    v_add_u32 v25, 5, v25
    v_lshrrev_b32 v25, 3, v25
    v_add_lshl_u32 v18, v18, v25, 7
    v_and_b32 v24, 7, v1
    v_lshl_add_u32 v18, v24, 4, v18
    v_lshlrev_b32 v17, 4, v1
    s_lshl_b32 s34, s42, 4
    s_add_u32 s34, s34, s41
    s_lshl_b32 s34, s34, 12
    s_mul_i32 s35, s41, 303104
    s_waitcnt lgkmcnt(8)
    v_lshlrev_b32 v96, 16, v128
    v_and_b32 v97, 0xffff0000, v128
    v_lshlrev_b32 v98, 16, v129
    v_and_b32 v99, 0xffff0000, v129
    v_lshlrev_b32 v100, 16, v130
    v_and_b32 v101, 0xffff0000, v130
    v_lshlrev_b32 v102, 16, v131
    v_and_b32 v103, 0xffff0000, v131
    v_lshlrev_b32 v104, 16, v132
    v_and_b32 v105, 0xffff0000, v132
    v_lshlrev_b32 v106, 16, v133
    v_and_b32 v107, 0xffff0000, v133
    v_lshlrev_b32 v108, 16, v134
    v_and_b32 v109, 0xffff0000, v134
    v_lshlrev_b32 v110, 16, v135
    v_and_b32 v111, 0xffff0000, v135
    v_lshlrev_b32 v112, 16, v136
    v_and_b32 v113, 0xffff0000, v136
    v_lshlrev_b32 v114, 16, v137
    v_and_b32 v115, 0xffff0000, v137
    v_lshlrev_b32 v116, 16, v138
    v_and_b32 v117, 0xffff0000, v138
    v_lshlrev_b32 v118, 16, v139
    v_and_b32 v119, 0xffff0000, v139
    v_lshlrev_b32 v120, 16, v140
    v_and_b32 v121, 0xffff0000, v140
    v_lshlrev_b32 v122, 16, v141
    v_and_b32 v123, 0xffff0000, v141
    v_lshlrev_b32 v124, 16, v142
    v_and_b32 v125, 0xffff0000, v142
    v_lshlrev_b32 v126, 16, v143
    v_and_b32 v127, 0xffff0000, v143
    s_waitcnt lgkmcnt(4)
    v_fmac_f32 v96, v64, v32
    v_fmac_f32 v97, v65, v33
    v_fmac_f32 v98, v66, v34
    v_fmac_f32 v99, v67, v35
    v_fmac_f32 v100, v64, v36
    v_fmac_f32 v101, v65, v37
    v_fmac_f32 v102, v66, v38
    v_fmac_f32 v103, v67, v39
    v_cvt_pk_bf16_f32 v128, v96, v97
    v_cvt_pk_bf16_f32 v129, v98, v99
    v_cvt_pk_bf16_f32 v130, v100, v101
    v_cvt_pk_bf16_f32 v131, v102, v103
    v_fmac_f32 v104, v68, v40
    v_fmac_f32 v105, v69, v41
    v_fmac_f32 v106, v70, v42
    v_fmac_f32 v107, v71, v43
    v_fmac_f32 v108, v68, v44
    v_fmac_f32 v109, v69, v45
    v_fmac_f32 v110, v70, v46
    v_fmac_f32 v111, v71, v47
    v_cvt_pk_bf16_f32 v132, v104, v105
    v_cvt_pk_bf16_f32 v133, v106, v107
    v_cvt_pk_bf16_f32 v134, v108, v109
    v_cvt_pk_bf16_f32 v135, v110, v111
    v_fmac_f32 v112, v72, v48
    v_fmac_f32 v113, v73, v49
    v_fmac_f32 v114, v74, v50
    v_fmac_f32 v115, v75, v51
    v_fmac_f32 v116, v72, v52
    v_fmac_f32 v117, v73, v53
    v_fmac_f32 v118, v74, v54
    v_fmac_f32 v119, v75, v55
    v_cvt_pk_bf16_f32 v136, v112, v113
    v_cvt_pk_bf16_f32 v137, v114, v115
    v_cvt_pk_bf16_f32 v138, v116, v117
    v_cvt_pk_bf16_f32 v139, v118, v119
    v_fmac_f32 v120, v76, v56
    v_fmac_f32 v121, v77, v57
    v_fmac_f32 v122, v78, v58
    v_fmac_f32 v123, v79, v59
    v_fmac_f32 v124, v76, v60
    v_fmac_f32 v125, v77, v61
    v_fmac_f32 v126, v78, v62
    v_fmac_f32 v127, v79, v63
    v_cvt_pk_bf16_f32 v140, v120, v121
    v_cvt_pk_bf16_f32 v141, v122, v123
    v_cvt_pk_bf16_f32 v142, v124, v125
    v_cvt_pk_bf16_f32 v143, v126, v127
    v_lshlrev_b32 v96, 16, v128
    v_and_b32 v97, 0xffff0000, v128
    v_lshlrev_b32 v98, 16, v129
    v_and_b32 v99, 0xffff0000, v129
    v_lshlrev_b32 v100, 16, v130
    v_and_b32 v101, 0xffff0000, v130
    v_lshlrev_b32 v102, 16, v131
    v_and_b32 v103, 0xffff0000, v131
    v_lshlrev_b32 v104, 16, v132
    v_and_b32 v105, 0xffff0000, v132
    v_lshlrev_b32 v106, 16, v133
    v_and_b32 v107, 0xffff0000, v133
    v_lshlrev_b32 v108, 16, v134
    v_and_b32 v109, 0xffff0000, v134
    v_lshlrev_b32 v110, 16, v135
    v_and_b32 v111, 0xffff0000, v135
    v_lshlrev_b32 v112, 16, v136
    v_and_b32 v113, 0xffff0000, v136
    v_lshlrev_b32 v114, 16, v137
    v_and_b32 v115, 0xffff0000, v137
    v_lshlrev_b32 v116, 16, v138
    v_and_b32 v117, 0xffff0000, v138
    v_lshlrev_b32 v118, 16, v139
    v_and_b32 v119, 0xffff0000, v139
    v_lshlrev_b32 v120, 16, v140
    v_and_b32 v121, 0xffff0000, v140
    v_lshlrev_b32 v122, 16, v141
    v_and_b32 v123, 0xffff0000, v141
    v_lshlrev_b32 v124, 16, v142
    v_and_b32 v125, 0xffff0000, v142
    v_lshlrev_b32 v126, 16, v143
    v_and_b32 v127, 0xffff0000, v143
    s_waitcnt lgkmcnt(0)
    v_mul_f32 v32, v80, v96
    v_mul_f32 v33, v81, v97
    v_mul_f32 v34, v82, v98
    v_mul_f32 v35, v83, v99
    v_mul_f32 v36, v80, v100
    v_mul_f32 v37, v81, v101
    v_mul_f32 v38, v82, v102
    v_mul_f32 v39, v83, v103
    v_cvt_pk_bf16_f32 v144, v32, v33
    v_cvt_pk_bf16_f32 v145, v34, v35
    v_cvt_pk_bf16_f32 v146, v36, v37
    v_cvt_pk_bf16_f32 v147, v38, v39
    v_mul_f32 v40, v84, v104
    v_mul_f32 v41, v85, v105
    v_mul_f32 v42, v86, v106
    v_mul_f32 v43, v87, v107
    v_mul_f32 v44, v84, v108
    v_mul_f32 v45, v85, v109
    v_mul_f32 v46, v86, v110
    v_mul_f32 v47, v87, v111
    v_cvt_pk_bf16_f32 v148, v40, v41
    v_cvt_pk_bf16_f32 v149, v42, v43
    v_cvt_pk_bf16_f32 v150, v44, v45
    v_cvt_pk_bf16_f32 v151, v46, v47
    v_permlane32_swap_b32 v144, v146
    v_permlane32_swap_b32 v145, v147
    buffer_store_dwordx4 v[144:147], v18, s[16:19], s35 offen sc1
    s_add_u32 s35, s35, 75776
    v_mul_f32 v48, v88, v112
    v_mul_f32 v49, v89, v113
    v_mul_f32 v50, v90, v114
    v_mul_f32 v51, v91, v115
    v_mul_f32 v52, v88, v116
    v_mul_f32 v53, v89, v117
    v_mul_f32 v54, v90, v118
    v_mul_f32 v55, v91, v119
    v_cvt_pk_bf16_f32 v152, v48, v49
    v_cvt_pk_bf16_f32 v153, v50, v51
    v_cvt_pk_bf16_f32 v154, v52, v53
    v_cvt_pk_bf16_f32 v155, v54, v55
    v_permlane32_swap_b32 v148, v150
    v_permlane32_swap_b32 v149, v151
    buffer_store_dwordx4 v[148:151], v18, s[16:19], s35 offen sc1
    s_add_u32 s35, s35, 75776
    v_mul_f32 v56, v92, v120
    v_mul_f32 v57, v93, v121
    v_mul_f32 v58, v94, v122
    v_mul_f32 v59, v95, v123
    v_mul_f32 v60, v92, v124
    v_mul_f32 v61, v93, v125
    v_mul_f32 v62, v94, v126
    v_mul_f32 v63, v95, v127
    v_cvt_pk_bf16_f32 v156, v56, v57
    v_cvt_pk_bf16_f32 v157, v58, v59
    v_cvt_pk_bf16_f32 v158, v60, v61
    v_cvt_pk_bf16_f32 v159, v62, v63
    v_permlane32_swap_b32 v152, v154
    v_permlane32_swap_b32 v153, v155
    buffer_store_dwordx4 v[152:155], v18, s[16:19], s35 offen sc1
    s_add_u32 s35, s35, 75776
    v_permlane32_swap_b32 v156, v158
    v_permlane32_swap_b32 v157, v159
    buffer_store_dwordx4 v[156:159], v18, s[16:19], s35 offen sc1
    s_add_u32 s35, s35, 75776
    v_add_f32 v24, v96, v97
    v_add_f32 v24, v24, v98
    v_add_f32 v24, v24, v99
    v_add_f32 v24, v24, v104
    v_add_f32 v24, v24, v105
    v_add_f32 v24, v24, v106
    v_add_f32 v24, v24, v107
    v_add_f32 v24, v24, v112
    v_add_f32 v24, v24, v113
    v_add_f32 v24, v24, v114
    v_add_f32 v24, v24, v115
    v_add_f32 v24, v24, v120
    v_add_f32 v24, v24, v121
    v_add_f32 v24, v24, v122
    v_add_f32 v24, v24, v123
    v_add_f32 v26, v100, v101
    v_add_f32 v26, v26, v102
    v_add_f32 v26, v26, v103
    v_add_f32 v26, v26, v108
    v_add_f32 v26, v26, v109
    v_add_f32 v26, v26, v110
    v_add_f32 v26, v26, v111
    v_add_f32 v26, v26, v116
    v_add_f32 v26, v26, v117
    v_add_f32 v26, v26, v118
    v_add_f32 v26, v26, v119
    v_add_f32 v26, v26, v124
    v_add_f32 v26, v26, v125
    v_add_f32 v26, v26, v126
    v_add_f32 v26, v26, v127
    v_mov_b32 v28, v24
    v_mov_b32 v29, v26
    s_nop 0
    v_permlane16_swap_b32 v24, v28
    v_permlane16_swap_b32 v26, v29
    v_add_f32 v24, v24, v28
    v_add_f32 v26, v26, v29
    v_mov_b32 v28, v24
    v_mov_b32 v29, v26
    s_nop 0
    v_permlane32_swap_b32 v24, v28
    v_permlane32_swap_b32 v26, v29
    v_add_f32 v24, v24, v28
    v_add_f32 v26, v26, v29
    v_mul_f32 v28, 0x3c800000, v24
    v_mul_f32 v29, 0x3c800000, v26
    v_sub_f32 v96, v96, v28
    v_sub_f32 v97, v97, v28
    v_sub_f32 v98, v98, v28
    v_sub_f32 v99, v99, v28
    v_sub_f32 v104, v104, v28
    v_sub_f32 v105, v105, v28
    v_sub_f32 v106, v106, v28
    v_sub_f32 v107, v107, v28
    v_sub_f32 v112, v112, v28
    v_sub_f32 v113, v113, v28
    v_sub_f32 v114, v114, v28
    v_sub_f32 v115, v115, v28
    v_sub_f32 v120, v120, v28
    v_sub_f32 v121, v121, v28
    v_sub_f32 v122, v122, v28
    v_sub_f32 v123, v123, v28
    v_mul_f32 v25, v96, v96
    v_fmac_f32 v25, v97, v97
    v_fmac_f32 v25, v98, v98
    v_fmac_f32 v25, v99, v99
    v_fmac_f32 v25, v104, v104
    v_fmac_f32 v25, v105, v105
    v_fmac_f32 v25, v106, v106
    v_fmac_f32 v25, v107, v107
    v_fmac_f32 v25, v112, v112
    v_fmac_f32 v25, v113, v113
    v_fmac_f32 v25, v114, v114
    v_fmac_f32 v25, v115, v115
    v_fmac_f32 v25, v120, v120
    v_fmac_f32 v25, v121, v121
    v_fmac_f32 v25, v122, v122
    v_fmac_f32 v25, v123, v123
    v_sub_f32 v100, v100, v29
    v_sub_f32 v101, v101, v29
    v_sub_f32 v102, v102, v29
    v_sub_f32 v103, v103, v29
    v_sub_f32 v108, v108, v29
    v_sub_f32 v109, v109, v29
    v_sub_f32 v110, v110, v29
    v_sub_f32 v111, v111, v29
    v_sub_f32 v116, v116, v29
    v_sub_f32 v117, v117, v29
    v_sub_f32 v118, v118, v29
    v_sub_f32 v119, v119, v29
    v_sub_f32 v124, v124, v29
    v_sub_f32 v125, v125, v29
    v_sub_f32 v126, v126, v29
    v_sub_f32 v127, v127, v29
    v_mul_f32 v27, v100, v100
    v_fmac_f32 v27, v101, v101
    v_fmac_f32 v27, v102, v102
    v_fmac_f32 v27, v103, v103
    v_fmac_f32 v27, v108, v108
    v_fmac_f32 v27, v109, v109
    v_fmac_f32 v27, v110, v110
    v_fmac_f32 v27, v111, v111
    v_fmac_f32 v27, v116, v116
    v_fmac_f32 v27, v117, v117
    v_fmac_f32 v27, v118, v118
    v_fmac_f32 v27, v119, v119
    v_fmac_f32 v27, v124, v124
    v_fmac_f32 v27, v125, v125
    v_fmac_f32 v27, v126, v126
    v_fmac_f32 v27, v127, v127
    v_mov_b32 v28, v25
    v_mov_b32 v29, v27
    s_nop 0
    v_permlane16_swap_b32 v25, v28
    v_permlane16_swap_b32 v27, v29
    v_add_f32 v25, v25, v28
    v_add_f32 v27, v27, v29
    v_mov_b32 v28, v25
    v_mov_b32 v29, v27
    s_nop 0
    v_permlane32_swap_b32 v25, v28
    v_permlane32_swap_b32 v27, v29
    v_add_f32 v25, v25, v28
    v_add_f32 v27, v27, v29
    v_cmp_lt_u32 vcc, 15, v1
    v_lshlrev_b32 v17, 3, v1
    s_lshl_b32 s32, s41, 14
    s_lshl_b32 s33, s42, 8
    s_add_u32 s32, s32, s33
    v_cndmask_b32 v24, v24, v26, vcc
    v_cndmask_b32 v25, v25, v27, vcc
    s_mov_b32 exec_hi, 0
    buffer_store_dwordx2 v[24:25], v17, s[20:23], s32 offen sc1
    s_mov_b32 exec_hi, -1
    v_accvgpr_write_b32 a158, v128
    v_accvgpr_write_b32 a159, v129
    v_accvgpr_write_b32 a160, v130
    v_accvgpr_write_b32 a161, v131
    v_accvgpr_write_b32 a162, v132
    v_accvgpr_write_b32 a163, v133
    v_accvgpr_write_b32 a164, v134
    v_accvgpr_write_b32 a165, v135
    v_accvgpr_write_b32 a166, v136
    v_accvgpr_write_b32 a167, v137
    v_accvgpr_write_b32 a168, v138
    v_accvgpr_write_b32 a169, v139
    v_accvgpr_write_b32 a170, v140
    v_accvgpr_write_b32 a171, v141
    v_accvgpr_write_b32 a172, v142
    v_accvgpr_write_b32 a173, v143
    s_lshl_b32 s56, s40, 4
    s_add_u32 s56, s56, s41
    s_lshl_b32 s57, s48, 5
    s_load_dwordx2 s[60:61], s[0:1], 48
    s_load_dwordx2 s[62:63], s[0:1], 72
    s_add_u32 s12, s38, 720896
    s_addc_u32 s13, s39, 0
    s_mov_b32 s14, 294912
    s_mov_b32 s15, 0x20000
    v_lshlrev_b32 v30, 7, v1
    s_lshl_b32 s32, s26, 13
    s_add_u32 s32, s32, 196608
h1_all:
    buffer_load_dword v31, v30, s[12:15], s32 offen sc1
    s_waitcnt vmcnt(0)
    v_cmp_eq_u32 vcc, 1, v31
    s_cmp_eq_u64 vcc, -1
    s_cbranch_scc0 h1_all
    s_lshl_b32 s32, s56, 7
    s_lshl_b32 s59, s57, 7
    v_mov_b32 v30, 1
    v_mov_b32 v31, s32
    s_waitcnt vmcnt(0)
    s_barrier
    s_cmp_lg_u32 s26, 0
    s_cbranch_scc1 h1_nf
    s_mov_b64 exec, 1
    buffer_store_dword v30, v31, s[12:15], 0 offen sc1
    s_mov_b64 exec, -1
h1_nf:
    s_add_u32 m0, s52, 0
    s_nop 0
    buffer_load_dwordx4 v3, s[28:31], s51 offen lds
    s_add_u32 m0, s52, 1024
    s_nop 0
    buffer_load_dwordx4 v4, s[28:31], s51 offen lds
    s_add_u32 m0, s52, 2048
    s_nop 0
    buffer_load_dwordx4 v5, s[28:31], s51 offen lds
    s_add_u32 m0, s52, 3072
    s_nop 0
    buffer_load_dwordx4 v6, s[28:31], s51 offen lds
    s_add_u32 m0, s52, 4096
    s_nop 0
    buffer_load_dwordx4 v7, s[28:31], s51 offen lds
    s_add_u32 m0, s52, 5120
    s_nop 0
    buffer_load_dwordx4 v8, s[28:31], s51 offen lds
    s_add_u32 m0, s52, 6144
    s_nop 0
    buffer_load_dwordx4 v9, s[28:31], s51 offen lds
    s_add_u32 s51, s51, s55
    s_add_u32 s52, s52, 28672
    s_cmp_eq_u32 s52, s54
    s_cselect_b32 s52, s53, s52
    v_bfe_u32 v18, v1, 4, 1
    v_bfe_u32 v19, v1, 3, 1
    v_lshl_add_u32 v18, v18, 2, v19
    s_lshl_b32 s32, s50, 3
    v_add_u32 v18, s32, v18
    v_lshrrev_b32 v19, 5, v1
    v_mul_u32_u24 v19, 75776, v19
    v_and_b32 v16, 7, v1
    v_lshl_add_u32 v19, v16, 4, v19
    v_add_u32 v16, 0, v18
    v_mul_u32_u24 v17, 9363, v16
    v_lshrrev_b32 v17, 16, v17
    v_add_u32 v12, v16, v17
    v_mul_u32_u24 v17, 7, v17
    v_sub_u32 v17, v16, v17
    v_add_u32 v17, 5, v17
    v_lshrrev_b32 v17, 3, v17
    v_add_lshl_u32 v12, v12, v17, 7
    v_add_u32 v12, v12, v19
    v_add_u32 v16, 2, v18
    v_mul_u32_u24 v17, 9363, v16
    v_lshrrev_b32 v17, 16, v17
    v_add_u32 v13, v16, v17
    v_mul_u32_u24 v17, 7, v17
    v_sub_u32 v17, v16, v17
    v_add_u32 v17, 5, v17
    v_lshrrev_b32 v17, 3, v17
    v_add_lshl_u32 v13, v13, v17, 7
    v_add_u32 v13, v13, v19
    v_add_u32 v16, 8, v18
    v_mul_u32_u24 v17, 9363, v16
    v_lshrrev_b32 v17, 16, v17
    v_add_u32 v14, v16, v17
    v_mul_u32_u24 v17, 7, v17
    v_sub_u32 v17, v16, v17
    v_add_u32 v17, 5, v17
    v_lshrrev_b32 v17, 3, v17
    v_add_lshl_u32 v14, v14, v17, 7
    v_add_u32 v14, v14, v19
    v_add_u32 v16, 10, v18
    v_mul_u32_u24 v17, 9363, v16
    v_lshrrev_b32 v17, 16, v17
    v_add_u32 v15, v16, v17
    v_mul_u32_u24 v17, 7, v17
    v_sub_u32 v17, v16, v17
    v_add_u32 v17, 5, v17
    v_lshrrev_b32 v17, 3, v17
    v_add_lshl_u32 v15, v15, v17, 7
    v_add_u32 v15, v15, v19
    s_mov_b32 s27, 0
    s_add_u32 s4, s38, 33554432
    s_addc_u32 s5, s39, 0
    s_mov_b32 s6, 4849664
    s_mov_b32 s7, 0x20000
    s_waitcnt lgkmcnt(0)
    s_and_b32 s32, s2, 7
    s_lshr_b32 s33, s2, 3
    s_lshr_b32 s34, s32, 1
    s_and_b32 s35, s32, 1
    s_and_b32 s40, s33, 3
    s_lshr_b32 s41, s33, 2
    s_mul_i32 s34, s34, 4
    s_add_u32 s40, s40, s34
    s_mul_i32 s35, s35, 8
    s_add_u32 s41, s41, s35
    s_lshl_b32 s42, s40, 2
    s_add_u32 s42, s42, s26
    s_mul_i32 s42, s42, 1
    s_and_b32 s32, s41, 6
    s_lshr_b32 s33, s41, 3
    s_lshl_b32 s33, s33, 1
    s_and_b32 s34, s41, 1
    s_add_u32 s33, s33, s34
    s_lshl_b32 s33, s33, 8
    s_lshl_b32 s34, s34, 1
    s_sub_u32 s43, 1, s34
    s_lshl_b32 s34, s41, 7
    s_mov_b32 s35, 2048
    s_cmp_eq_u32 s32, 2
    s_cselect_b32 s33, s33, s34
    s_cselect_b32 s35, 1024, s35
    s_cselect_b32 s34, 8, 7
    s_lshl_b32 s43, s43, s34
    s_lshl_b32 s47, s35, 6
    s_lshl_b32 s34, s35, 3
    s_lshl_b32 s32, s26, 4
    v_lshrrev_b32 v16, 3, v1
    v_and_b32 v17, 7, v1
    v_and_b32 v18, 6, v16
    v_xor_b32 v17, v17, v18
    v_add_u32 v16, s32, v16
    v_mul_lo_u32 v16, v16, s35
    v_lshl_add_u32 v16, v17, 4, v16
    v_add_u32 v26, s33, v16
    v_add_u32 v27, s34, v26
    v_add_u32 v28, s43, v26
    v_add_u32 v29, s43, v27
    s_lshl_b32 s45, s26, 11
    s_add_u32 s45, s45, 8192
    s_mov_b32 s43, 0
    s_add_u32 s44, s45, 81920
    s_add_u32 s46, s45, 131072
    s_add_u32 s32, s38, 60817408
    s_addc_u32 s33, s39, 0
    s_cmp_eq_u32 s47, 65536
    s_cselect_b32 s8, s32, s60
    s_cselect_b32 s9, s33, s61
    s_mul_i32 s10, s47, 28
    s_mov_b32 s11, 0x20000
    s_and_b32 s32, s41, 1
    s_mul_i32 s32, s32, s10
    s_add_u32 s8, s8, s32
    s_addc_u32 s9, s9, 0
    v_accvgpr_write_b32 a174, v26
    v_accvgpr_write_b32 a175, v27
    v_accvgpr_write_b32 a176, v28
    v_accvgpr_write_b32 a177, v29
    s_add_u32 s16, s38, 262144
    s_addc_u32 s17, s39, 0
    s_mov_b32 s18, 262144
    s_mov_b32 s19, 0x20000
    s_add_u32 s20, s38, 65536
    s_addc_u32 s21, s39, 0
    s_mov_b32 s22, 114688
    s_mov_b32 s23, 0x20000
    v_lshrrev_b32 v16, 5, v1
    v_bfe_u32 v17, v1, 2, 3
    v_lshl_add_u32 v16, v16, 4, v17
    v_and_b32 v18, 3, v1
    v_mul_u32_u24 v16, 224, v16
    v_lshl_add_u32 v10, v18, 3, v16
    s_mov_b32 s37, 53248
    s_getpc_b64 s[68:69]
mlp_kernel_pc4:
    s_add_u32 s68, s68, gu_top-mlp_kernel_pc4
    s_addc_u32 s69, s69, 0
    s_mov_b32 s70, mlp_kernel_end-gu_top+4
    s_cmp_lt_u32 s2, 256
    s_cselect_b32 s70, s70, 0
    s_mov_b32 s71, 0x20000
    s_lshr_b32 s32, s2, 3
    s_lshl_b32 s32, s32, 2
    s_add_u32 s32, s32, s26
    s_lshl_b32 s32, s32, 9
    v_lshrrev_b32 v2, 2, v1
    v_lshlrev_b32 v2, 20, v2
    v_lshl_add_u32 v2, v1, 7, v2
    v_add_u32 v2, s32, v2
gu_top:
    s_add_u32 s37, s37, 28672
    s_cmp_eq_u32 s37, 139264
    s_cselect_b32 s37, 24576, s37
    v_add_u32 v11, s37, v10
    ds_read_b64_tr_b16 a[0:1], v11 offset:0
    ds_read_b64_tr_b16 a[2:3], v11 offset:1792
    ds_read_b64_tr_b16 a[4:5], v11 offset:14336
    ds_read_b64_tr_b16 a[6:7], v11 offset:16128
    ds_read_b64_tr_b16 a[8:9], v11 offset:32
    ds_read_b64_tr_b16 a[10:11], v11 offset:1824
    ds_read_b64_tr_b16 a[12:13], v11 offset:14368
    ds_read_b64_tr_b16 a[14:15], v11 offset:16160
    ds_read_b64_tr_b16 a[16:17], v11 offset:64
    ds_read_b64_tr_b16 a[18:19], v11 offset:1856
    ds_read_b64_tr_b16 a[20:21], v11 offset:14400
    ds_read_b64_tr_b16 a[22:23], v11 offset:16192
    ds_read_b64_tr_b16 a[24:25], v11 offset:96
    ds_read_b64_tr_b16 a[26:27], v11 offset:1888
    ds_read_b64_tr_b16 a[28:29], v11 offset:14432
    ds_read_b64_tr_b16 a[30:31], v11 offset:16224
    ds_read_b64_tr_b16 a[32:33], v11 offset:128
    ds_read_b64_tr_b16 a[34:35], v11 offset:1920
    ds_read_b64_tr_b16 a[36:37], v11 offset:14464
    ds_read_b64_tr_b16 a[38:39], v11 offset:16256
    ds_read_b64_tr_b16 a[40:41], v11 offset:160
    ds_read_b64_tr_b16 a[42:43], v11 offset:1952
    ds_read_b64_tr_b16 a[44:45], v11 offset:14496
    ds_read_b64_tr_b16 a[46:47], v11 offset:16288
    ds_read_b64_tr_b16 a[48:49], v11 offset:192
    ds_read_b64_tr_b16 a[50:51], v11 offset:1984
    ds_read_b64_tr_b16 a[52:53], v11 offset:14528
    ds_read_b64_tr_b16 a[54:55], v11 offset:16320
    s_cmp_lg_u32 s26, 0
    s_cbranch_scc1 h1_go
    v_and_b32 v30, 31, v1
    v_lshlrev_b32 v30, 7, v30
    v_add_u32 v30, s59, v30
h1_poll:
    buffer_load_dword v31, v30, s[12:15], 0 offen sc1
    s_waitcnt vmcnt(0)
    v_cmp_eq_u32 vcc, 1, v31
    s_cmp_eq_u64 vcc, -1
    s_cbranch_scc0 h1_poll
h1_go:
    s_waitcnt vmcnt(0)
    s_barrier
    buffer_load_dwordx4 a[56:59], v12, s[4:7], s27 offen sc1
    buffer_load_dwordx4 a[60:63], v13, s[4:7], s27 offen sc1
    buffer_load_dwordx4 a[64:67], v14, s[4:7], s27 offen sc1
    buffer_load_dwordx4 a[68:71], v15, s[4:7], s27 offen sc1
    s_add_u32 s27, s27, 151552
    buffer_load_dwordx4 a[72:75], v12, s[4:7], s27 offen sc1
    buffer_load_dwordx4 a[76:79], v13, s[4:7], s27 offen sc1
    buffer_load_dwordx4 a[80:83], v14, s[4:7], s27 offen sc1
    buffer_load_dwordx4 a[84:87], v15, s[4:7], s27 offen sc1
    s_add_u32 s27, s27, 151552
    v_and_b32 v22, 15, v1
    v_lshlrev_b32 v22, 3, v22
    v_lshrrev_b32 v23, 4, v1
    v_lshl_add_u32 v22, v23, 16, v22
    s_lshl_b32 s56, s50, 8
    buffer_load_dwordx2 a[120:121], v22, s[16:19], s56 offen offset:0 sc1
    buffer_load_dwordx2 a[128:129], v22, s[16:19], s56 offen offset:128 sc1
    buffer_load_dwordx2 a[136:137], v22, s[16:19], s56 offen offset:256 sc1
    buffer_load_dwordx2 a[144:145], v22, s[16:19], s56 offen offset:384 sc1
    s_add_u32 s56, s56, 0x4000
    s_waitcnt vmcnt(8) lgkmcnt(14)
    v_mfma_f32_16x16x32_bf16 v[32:35], a[0:3], a[56:59], 0
    buffer_load_dwordx4 a[88:91], v12, s[4:7], s27 offen sc1
    v_mfma_f32_16x16x32_bf16 v[36:39], a[0:3], a[60:63], 0
    v_mfma_f32_16x16x32_bf16 v[40:43], a[0:3], a[64:67], 0
    buffer_load_dwordx4 a[92:95], v13, s[4:7], s27 offen sc1
    v_mfma_f32_16x16x32_bf16 v[44:47], a[0:3], a[68:71], 0
    v_mfma_f32_16x16x32_bf16 v[48:51], a[4:7], a[56:59], 0
    ds_read_b64_tr_b16 a[0:1], v11 offset:7168
    v_mfma_f32_16x16x32_bf16 v[52:55], a[4:7], a[60:63], 0
    ds_read_b64_tr_b16 a[2:3], v11 offset:8960
    v_mfma_f32_16x16x32_bf16 v[56:59], a[4:7], a[64:67], 0
    buffer_load_dwordx4 a[96:99], v14, s[4:7], s27 offen sc1
    v_mfma_f32_16x16x32_bf16 v[60:63], a[4:7], a[68:71], 0
    v_mfma_f32_16x16x32_bf16 v[64:67], a[8:11], a[56:59], 0
    ds_read_b64_tr_b16 a[4:5], v11 offset:21504
    v_mfma_f32_16x16x32_bf16 v[68:71], a[8:11], a[60:63], 0
    ds_read_b64_tr_b16 a[6:7], v11 offset:23296
    v_mfma_f32_16x16x32_bf16 v[72:75], a[8:11], a[64:67], 0
    buffer_load_dwordx4 a[100:103], v15, s[4:7], s27 offen sc1
    v_mfma_f32_16x16x32_bf16 v[76:79], a[8:11], a[68:71], 0
    s_add_u32 s27, s27, 151552
    v_mfma_f32_16x16x32_bf16 v[80:83], a[12:15], a[56:59], 0
    ds_read_b64_tr_b16 a[8:9], v11 offset:7200
    v_mfma_f32_16x16x32_bf16 v[84:87], a[12:15], a[60:63], 0
    ds_read_b64_tr_b16 a[10:11], v11 offset:8992
    v_mfma_f32_16x16x32_bf16 v[88:91], a[12:15], a[64:67], 0
    s_add_u32 m0, s52, 0
    v_mfma_f32_16x16x32_bf16 v[92:95], a[12:15], a[68:71], 0
    v_mfma_f32_16x16x32_bf16 v[96:99], a[16:19], a[56:59], 0
    ds_read_b64_tr_b16 a[12:13], v11 offset:21536
    v_mfma_f32_16x16x32_bf16 v[100:103], a[16:19], a[60:63], 0
    ds_read_b64_tr_b16 a[14:15], v11 offset:23328
    v_mfma_f32_16x16x32_bf16 v[104:107], a[16:19], a[64:67], 0
    buffer_load_dwordx4 v3, s[28:31], s51 offen lds
    v_mfma_f32_16x16x32_bf16 v[108:111], a[16:19], a[68:71], 0
    v_mfma_f32_16x16x32_bf16 v[112:115], a[20:23], a[56:59], 0
    ds_read_b64_tr_b16 a[16:17], v11 offset:7232
    v_mfma_f32_16x16x32_bf16 v[116:119], a[20:23], a[60:63], 0
    ds_read_b64_tr_b16 a[18:19], v11 offset:9024
    v_mfma_f32_16x16x32_bf16 v[120:123], a[20:23], a[64:67], 0
    s_add_u32 m0, s52, 1024
    v_mfma_f32_16x16x32_bf16 v[124:127], a[20:23], a[68:71], 0
    buffer_load_dwordx4 v4, s[28:31], s51 offen lds
    v_mfma_f32_16x16x32_bf16 v[128:131], a[24:27], a[56:59], 0
    ds_read_b64_tr_b16 a[20:21], v11 offset:21568
    v_mfma_f32_16x16x32_bf16 v[132:135], a[24:27], a[60:63], 0
    ds_read_b64_tr_b16 a[22:23], v11 offset:23360
    v_mfma_f32_16x16x32_bf16 v[136:139], a[24:27], a[64:67], 0
    s_add_u32 m0, s52, 2048
    v_mfma_f32_16x16x32_bf16 v[140:143], a[24:27], a[68:71], 0
    s_waitcnt lgkmcnt(12)
    v_mfma_f32_16x16x32_bf16 v[144:147], a[28:31], a[56:59], 0
    ds_read_b64_tr_b16 a[24:25], v11 offset:7264
    v_mfma_f32_16x16x32_bf16 v[148:151], a[28:31], a[60:63], 0
    ds_read_b64_tr_b16 a[26:27], v11 offset:9056
    v_mfma_f32_16x16x32_bf16 v[152:155], a[28:31], a[64:67], 0
    buffer_load_dwordx4 v5, s[28:31], s51 offen lds
    v_mfma_f32_16x16x32_bf16 v[156:159], a[28:31], a[68:71], 0
    v_mfma_f32_16x16x32_bf16 v[160:163], a[32:35], a[56:59], 0
    ds_read_b64_tr_b16 a[28:29], v11 offset:21600
    v_mfma_f32_16x16x32_bf16 v[164:167], a[32:35], a[60:63], 0
    ds_read_b64_tr_b16 a[30:31], v11 offset:23392
    v_mfma_f32_16x16x32_bf16 v[168:171], a[32:35], a[64:67], 0
    s_add_u32 m0, s52, 3072
    v_mfma_f32_16x16x32_bf16 v[172:175], a[32:35], a[68:71], 0
    buffer_load_dwordx4 v6, s[28:31], s51 offen lds
    v_mfma_f32_16x16x32_bf16 v[176:179], a[36:39], a[56:59], 0
    ds_read_b64_tr_b16 a[32:33], v11 offset:7296
    v_mfma_f32_16x16x32_bf16 v[180:183], a[36:39], a[60:63], 0
    ds_read_b64_tr_b16 a[34:35], v11 offset:9088
    v_mfma_f32_16x16x32_bf16 v[184:187], a[36:39], a[64:67], 0
    s_add_u32 m0, s52, 4096
    v_mfma_f32_16x16x32_bf16 v[188:191], a[36:39], a[68:71], 0
    v_mfma_f32_16x16x32_bf16 v[192:195], a[40:43], a[56:59], 0
    ds_read_b64_tr_b16 a[36:37], v11 offset:21632
    v_mfma_f32_16x16x32_bf16 v[196:199], a[40:43], a[60:63], 0
    ds_read_b64_tr_b16 a[38:39], v11 offset:23424
    v_mfma_f32_16x16x32_bf16 v[200:203], a[40:43], a[64:67], 0
    buffer_load_dwordx4 v7, s[28:31], s51 offen lds
    v_mfma_f32_16x16x32_bf16 v[204:207], a[40:43], a[68:71], 0
    v_mfma_f32_16x16x32_bf16 v[208:211], a[44:47], a[56:59], 0
    ds_read_b64_tr_b16 a[40:41], v11 offset:7328
    v_mfma_f32_16x16x32_bf16 v[212:215], a[44:47], a[60:63], 0
    ds_read_b64_tr_b16 a[42:43], v11 offset:9120
    v_mfma_f32_16x16x32_bf16 v[216:219], a[44:47], a[64:67], 0
    s_add_u32 m0, s52, 5120
    v_mfma_f32_16x16x32_bf16 v[220:223], a[44:47], a[68:71], 0
    buffer_load_dwordx4 v8, s[28:31], s51 offen lds
    v_mfma_f32_16x16x32_bf16 v[224:227], a[48:51], a[56:59], 0
    ds_read_b64_tr_b16 a[44:45], v11 offset:21664
    v_mfma_f32_16x16x32_bf16 v[228:231], a[48:51], a[60:63], 0
    ds_read_b64_tr_b16 a[46:47], v11 offset:23456
    v_mfma_f32_16x16x32_bf16 v[232:235], a[48:51], a[64:67], 0
    s_add_u32 s37, s37, 28672
    v_mfma_f32_16x16x32_bf16 v[236:239], a[48:51], a[68:71], 0
    v_mfma_f32_16x16x32_bf16 v[240:243], a[52:55], a[56:59], 0
    ds_read_b64_tr_b16 a[48:49], v11 offset:7360
    v_mfma_f32_16x16x32_bf16 v[244:247], a[52:55], a[60:63], 0
    ds_read_b64_tr_b16 a[50:51], v11 offset:9152
    v_mfma_f32_16x16x32_bf16 v[248:251], a[52:55], a[64:67], 0
    s_cmp_eq_u32 s37, 139264
    s_cselect_b32 s37, 24576, s37
    v_mfma_f32_16x16x32_bf16 v[252:255], a[52:55], a[68:71], 0
    s_waitcnt vmcnt(14) lgkmcnt(12)
    v_mfma_f32_16x16x32_bf16 v[32:35], a[0:3], a[72:75], v[32:35]
    ds_read_b64_tr_b16 a[52:53], v11 offset:21696
    v_mfma_f32_16x16x32_bf16 v[36:39], a[0:3], a[76:79], v[36:39]
    ds_read_b64_tr_b16 a[54:55], v11 offset:23488
    v_mfma_f32_16x16x32_bf16 v[40:43], a[0:3], a[80:83], v[40:43]
    v_mfma_f32_16x16x32_bf16 v[44:47], a[0:3], a[84:87], v[44:47]
    s_barrier
    v_add_u32 v11, s37, v10
    v_mfma_f32_16x16x32_bf16 v[48:51], a[4:7], a[72:75], v[48:51]
    ds_read_b64_tr_b16 a[0:1], v11 offset:0
    v_mfma_f32_16x16x32_bf16 v[52:55], a[4:7], a[76:79], v[52:55]
    ds_read_b64_tr_b16 a[2:3], v11 offset:1792
    v_mfma_f32_16x16x32_bf16 v[56:59], a[4:7], a[80:83], v[56:59]
    s_add_u32 m0, s52, 6144
    v_mfma_f32_16x16x32_bf16 v[60:63], a[4:7], a[84:87], v[60:63]
    buffer_load_dwordx4 v9, s[28:31], s51 offen lds
    v_mfma_f32_16x16x32_bf16 v[64:67], a[8:11], a[72:75], v[64:67]
    ds_read_b64_tr_b16 a[4:5], v11 offset:14336
    v_mfma_f32_16x16x32_bf16 v[68:71], a[8:11], a[76:79], v[68:71]
    ds_read_b64_tr_b16 a[6:7], v11 offset:16128
    v_mfma_f32_16x16x32_bf16 v[72:75], a[8:11], a[80:83], v[72:75]
    s_add_u32 s51, s51, s55
    v_mfma_f32_16x16x32_bf16 v[76:79], a[8:11], a[84:87], v[76:79]
    v_mfma_f32_16x16x32_bf16 v[80:83], a[12:15], a[72:75], v[80:83]
    ds_read_b64_tr_b16 a[8:9], v11 offset:32
    v_mfma_f32_16x16x32_bf16 v[84:87], a[12:15], a[76:79], v[84:87]
    ds_read_b64_tr_b16 a[10:11], v11 offset:1824
    v_mfma_f32_16x16x32_bf16 v[88:91], a[12:15], a[80:83], v[88:91]
    s_add_u32 s52, s52, 28672
    v_mfma_f32_16x16x32_bf16 v[92:95], a[12:15], a[84:87], v[92:95]
    v_mfma_f32_16x16x32_bf16 v[96:99], a[16:19], a[72:75], v[96:99]
    ds_read_b64_tr_b16 a[12:13], v11 offset:14368
    v_mfma_f32_16x16x32_bf16 v[100:103], a[16:19], a[76:79], v[100:103]
    ds_read_b64_tr_b16 a[14:15], v11 offset:16160
    v_mfma_f32_16x16x32_bf16 v[104:107], a[16:19], a[80:83], v[104:107]
    s_cmp_eq_u32 s52, s54
    s_cselect_b32 s52, s53, s52
    v_mfma_f32_16x16x32_bf16 v[108:111], a[16:19], a[84:87], v[108:111]
    buffer_load_dwordx4 a[104:107], v12, s[4:7], s27 offen sc1
    v_mfma_f32_16x16x32_bf16 v[112:115], a[20:23], a[72:75], v[112:115]
    ds_read_b64_tr_b16 a[16:17], v11 offset:64
    v_mfma_f32_16x16x32_bf16 v[116:119], a[20:23], a[76:79], v[116:119]
    ds_read_b64_tr_b16 a[18:19], v11 offset:1856
    v_mfma_f32_16x16x32_bf16 v[120:123], a[20:23], a[80:83], v[120:123]
    buffer_load_dwordx4 a[108:111], v13, s[4:7], s27 offen sc1
    v_mfma_f32_16x16x32_bf16 v[124:127], a[20:23], a[84:87], v[124:127]
    v_mfma_f32_16x16x32_bf16 v[128:131], a[24:27], a[72:75], v[128:131]
    ds_read_b64_tr_b16 a[20:21], v11 offset:14400
    v_mfma_f32_16x16x32_bf16 v[132:135], a[24:27], a[76:79], v[132:135]
    ds_read_b64_tr_b16 a[22:23], v11 offset:16192
    v_mfma_f32_16x16x32_bf16 v[136:139], a[24:27], a[80:83], v[136:139]
    buffer_load_dwordx4 a[112:115], v14, s[4:7], s27 offen sc1
    v_mfma_f32_16x16x32_bf16 v[140:143], a[24:27], a[84:87], v[140:143]
    s_waitcnt lgkmcnt(12)
    buffer_load_dwordx4 a[116:119], v15, s[4:7], s27 offen sc1
    v_mfma_f32_16x16x32_bf16 v[144:147], a[28:31], a[72:75], v[144:147]
    ds_read_b64_tr_b16 a[24:25], v11 offset:96
    v_mfma_f32_16x16x32_bf16 v[148:151], a[28:31], a[76:79], v[148:151]
    ds_read_b64_tr_b16 a[26:27], v11 offset:1888
    v_mfma_f32_16x16x32_bf16 v[152:155], a[28:31], a[80:83], v[152:155]
    s_add_u32 s27, s27, 151552
    v_mfma_f32_16x16x32_bf16 v[156:159], a[28:31], a[84:87], v[156:159]
    v_mfma_f32_16x16x32_bf16 v[160:163], a[32:35], a[72:75], v[160:163]
    ds_read_b64_tr_b16 a[28:29], v11 offset:14432
    v_mfma_f32_16x16x32_bf16 v[164:167], a[32:35], a[76:79], v[164:167]
    ds_read_b64_tr_b16 a[30:31], v11 offset:16224
    v_mfma_f32_16x16x32_bf16 v[168:171], a[32:35], a[80:83], v[168:171]
    buffer_load_dwordx4 a[56:59], v12, s[4:7], s27 offen sc1
    v_mfma_f32_16x16x32_bf16 v[172:175], a[32:35], a[84:87], v[172:175]
    v_mfma_f32_16x16x32_bf16 v[176:179], a[36:39], a[72:75], v[176:179]
    ds_read_b64_tr_b16 a[32:33], v11 offset:128
    v_mfma_f32_16x16x32_bf16 v[180:183], a[36:39], a[76:79], v[180:183]
    ds_read_b64_tr_b16 a[34:35], v11 offset:1920
    v_mfma_f32_16x16x32_bf16 v[184:187], a[36:39], a[80:83], v[184:187]
    buffer_load_dwordx4 a[60:63], v13, s[4:7], s27 offen sc1
    v_mfma_f32_16x16x32_bf16 v[188:191], a[36:39], a[84:87], v[188:191]
    buffer_load_dwordx4 a[64:67], v14, s[4:7], s27 offen sc1
    v_mfma_f32_16x16x32_bf16 v[192:195], a[40:43], a[72:75], v[192:195]
    ds_read_b64_tr_b16 a[36:37], v11 offset:14464
    v_mfma_f32_16x16x32_bf16 v[196:199], a[40:43], a[76:79], v[196:199]
    ds_read_b64_tr_b16 a[38:39], v11 offset:16256
    v_mfma_f32_16x16x32_bf16 v[200:203], a[40:43], a[80:83], v[200:203]
    buffer_load_dwordx4 a[68:71], v15, s[4:7], s27 offen sc1
    v_mfma_f32_16x16x32_bf16 v[204:207], a[40:43], a[84:87], v[204:207]
    v_mfma_f32_16x16x32_bf16 v[208:211], a[44:47], a[72:75], v[208:211]
    ds_read_b64_tr_b16 a[40:41], v11 offset:160
    v_mfma_f32_16x16x32_bf16 v[212:215], a[44:47], a[76:79], v[212:215]
    ds_read_b64_tr_b16 a[42:43], v11 offset:1952
    v_mfma_f32_16x16x32_bf16 v[216:219], a[44:47], a[80:83], v[216:219]
    s_add_u32 s27, s27, 151552
    v_mfma_f32_16x16x32_bf16 v[220:223], a[44:47], a[84:87], v[220:223]
    s_add_u32 m0, s52, 0
    v_mfma_f32_16x16x32_bf16 v[224:227], a[48:51], a[72:75], v[224:227]
    ds_read_b64_tr_b16 a[44:45], v11 offset:14496
    v_mfma_f32_16x16x32_bf16 v[228:231], a[48:51], a[76:79], v[228:231]
    ds_read_b64_tr_b16 a[46:47], v11 offset:16288
    v_mfma_f32_16x16x32_bf16 v[232:235], a[48:51], a[80:83], v[232:235]
    buffer_load_dwordx4 v3, s[28:31], s51 offen lds
    v_mfma_f32_16x16x32_bf16 v[236:239], a[48:51], a[84:87], v[236:239]
    v_mfma_f32_16x16x32_bf16 v[240:243], a[52:55], a[72:75], v[240:243]
    ds_read_b64_tr_b16 a[48:49], v11 offset:192
    v_mfma_f32_16x16x32_bf16 v[244:247], a[52:55], a[76:79], v[244:247]
    ds_read_b64_tr_b16 a[50:51], v11 offset:1984
    v_mfma_f32_16x16x32_bf16 v[248:251], a[52:55], a[80:83], v[248:251]
    buffer_load_dword a156, v2, s[68:71], 0 offen
    v_mfma_f32_16x16x32_bf16 v[252:255], a[52:55], a[84:87], v[252:255]
    s_waitcnt vmcnt(17) lgkmcnt(12)
    v_mfma_f32_16x16x32_bf16 v[32:35], a[0:3], a[88:91], v[32:35]
    ds_read_b64_tr_b16 a[52:53], v11 offset:14528
    v_mfma_f32_16x16x32_bf16 v[36:39], a[0:3], a[92:95], v[36:39]
    ds_read_b64_tr_b16 a[54:55], v11 offset:16320
    v_mfma_f32_16x16x32_bf16 v[40:43], a[0:3], a[96:99], v[40:43]
    s_add_u32 m0, s52, 1024
    s_nop 0
    buffer_load_dwordx4 v4, s[28:31], s51 offen lds
    v_mfma_f32_16x16x32_bf16 v[44:47], a[0:3], a[100:103], v[44:47]
    v_mfma_f32_16x16x32_bf16 v[48:51], a[4:7], a[88:91], v[48:51]
    ds_read_b64_tr_b16 a[0:1], v11 offset:7168
    v_mfma_f32_16x16x32_bf16 v[52:55], a[4:7], a[92:95], v[52:55]
    ds_read_b64_tr_b16 a[2:3], v11 offset:8960
    v_mfma_f32_16x16x32_bf16 v[56:59], a[4:7], a[96:99], v[56:59]
    s_add_u32 m0, s52, 2048
    v_mfma_f32_16x16x32_bf16 v[60:63], a[4:7], a[100:103], v[60:63]
    buffer_load_dwordx4 v5, s[28:31], s51 offen lds
    v_mfma_f32_16x16x32_bf16 v[64:67], a[8:11], a[88:91], v[64:67]
    ds_read_b64_tr_b16 a[4:5], v11 offset:21504
    v_mfma_f32_16x16x32_bf16 v[68:71], a[8:11], a[92:95], v[68:71]
    ds_read_b64_tr_b16 a[6:7], v11 offset:23296
    v_mfma_f32_16x16x32_bf16 v[72:75], a[8:11], a[96:99], v[72:75]
    s_add_u32 m0, s52, 3072
    v_mfma_f32_16x16x32_bf16 v[76:79], a[8:11], a[100:103], v[76:79]
    v_mfma_f32_16x16x32_bf16 v[80:83], a[12:15], a[88:91], v[80:83]
    ds_read_b64_tr_b16 a[8:9], v11 offset:7200
    v_mfma_f32_16x16x32_bf16 v[84:87], a[12:15], a[92:95], v[84:87]
    ds_read_b64_tr_b16 a[10:11], v11 offset:8992
    v_mfma_f32_16x16x32_bf16 v[88:91], a[12:15], a[96:99], v[88:91]
    buffer_load_dwordx4 v6, s[28:31], s51 offen lds
    v_mfma_f32_16x16x32_bf16 v[92:95], a[12:15], a[100:103], v[92:95]
    s_add_u32 m0, s52, 4096
    v_mfma_f32_16x16x32_bf16 v[96:99], a[16:19], a[88:91], v[96:99]
    ds_read_b64_tr_b16 a[12:13], v11 offset:21536
    v_mfma_f32_16x16x32_bf16 v[100:103], a[16:19], a[92:95], v[100:103]
    ds_read_b64_tr_b16 a[14:15], v11 offset:23328
    v_mfma_f32_16x16x32_bf16 v[104:107], a[16:19], a[96:99], v[104:107]
    buffer_load_dwordx4 v7, s[28:31], s51 offen lds
    v_mfma_f32_16x16x32_bf16 v[108:111], a[16:19], a[100:103], v[108:111]
    v_mfma_f32_16x16x32_bf16 v[112:115], a[20:23], a[88:91], v[112:115]
    ds_read_b64_tr_b16 a[16:17], v11 offset:7232
    v_mfma_f32_16x16x32_bf16 v[116:119], a[20:23], a[92:95], v[116:119]
    ds_read_b64_tr_b16 a[18:19], v11 offset:9024
    v_mfma_f32_16x16x32_bf16 v[120:123], a[20:23], a[96:99], v[120:123]
    s_add_u32 m0, s52, 5120
    s_nop 0
    buffer_load_dwordx4 v8, s[28:31], s51 offen lds
    v_mfma_f32_16x16x32_bf16 v[124:127], a[20:23], a[100:103], v[124:127]
    v_mfma_f32_16x16x32_bf16 v[128:131], a[24:27], a[88:91], v[128:131]
    ds_read_b64_tr_b16 a[20:21], v11 offset:21568
    v_mfma_f32_16x16x32_bf16 v[132:135], a[24:27], a[92:95], v[132:135]
    ds_read_b64_tr_b16 a[22:23], v11 offset:23360
    v_mfma_f32_16x16x32_bf16 v[136:139], a[24:27], a[96:99], v[136:139]
    s_add_u32 m0, s52, 6144
    v_mfma_f32_16x16x32_bf16 v[140:143], a[24:27], a[100:103], v[140:143]
    s_waitcnt lgkmcnt(12)
    v_mfma_f32_16x16x32_bf16 v[144:147], a[28:31], a[88:91], v[144:147]
    ds_read_b64_tr_b16 a[24:25], v11 offset:7264
    v_mfma_f32_16x16x32_bf16 v[148:151], a[28:31], a[92:95], v[148:151]
    ds_read_b64_tr_b16 a[26:27], v11 offset:9056
    v_mfma_f32_16x16x32_bf16 v[152:155], a[28:31], a[96:99], v[152:155]
    buffer_load_dwordx4 v9, s[28:31], s51 offen lds
    s_add_u32 s51, s51, s55
    v_mfma_f32_16x16x32_bf16 v[156:159], a[28:31], a[100:103], v[156:159]
    v_mfma_f32_16x16x32_bf16 v[160:163], a[32:35], a[88:91], v[160:163]
    ds_read_b64_tr_b16 a[28:29], v11 offset:21600
    v_mfma_f32_16x16x32_bf16 v[164:167], a[32:35], a[92:95], v[164:167]
    ds_read_b64_tr_b16 a[30:31], v11 offset:23392
    v_mfma_f32_16x16x32_bf16 v[168:171], a[32:35], a[96:99], v[168:171]
    s_add_u32 s52, s52, 28672
    v_mfma_f32_16x16x32_bf16 v[172:175], a[32:35], a[100:103], v[172:175]
    s_cmp_eq_u32 s52, s54
    s_cselect_b32 s52, s53, s52
    v_mfma_f32_16x16x32_bf16 v[176:179], a[36:39], a[88:91], v[176:179]
    ds_read_b64_tr_b16 a[32:33], v11 offset:7296
    v_mfma_f32_16x16x32_bf16 v[180:183], a[36:39], a[92:95], v[180:183]
    ds_read_b64_tr_b16 a[34:35], v11 offset:9088
    v_mfma_f32_16x16x32_bf16 v[184:187], a[36:39], a[96:99], v[184:187]
    buffer_load_dwordx4 a[72:75], v12, s[4:7], s27 offen sc1
    v_mfma_f32_16x16x32_bf16 v[188:191], a[36:39], a[100:103], v[188:191]
    v_mfma_f32_16x16x32_bf16 v[192:195], a[40:43], a[88:91], v[192:195]
    ds_read_b64_tr_b16 a[36:37], v11 offset:21632
    v_mfma_f32_16x16x32_bf16 v[196:199], a[40:43], a[92:95], v[196:199]
    ds_read_b64_tr_b16 a[38:39], v11 offset:23424
    v_mfma_f32_16x16x32_bf16 v[200:203], a[40:43], a[96:99], v[200:203]
    buffer_load_dwordx4 a[76:79], v13, s[4:7], s27 offen sc1
    v_mfma_f32_16x16x32_bf16 v[204:207], a[40:43], a[100:103], v[204:207]
    buffer_load_dwordx4 a[80:83], v14, s[4:7], s27 offen sc1
    v_mfma_f32_16x16x32_bf16 v[208:211], a[44:47], a[88:91], v[208:211]
    ds_read_b64_tr_b16 a[40:41], v11 offset:7328
    v_mfma_f32_16x16x32_bf16 v[212:215], a[44:47], a[92:95], v[212:215]
    ds_read_b64_tr_b16 a[42:43], v11 offset:9120
    v_mfma_f32_16x16x32_bf16 v[216:219], a[44:47], a[96:99], v[216:219]
    buffer_load_dwordx4 a[84:87], v15, s[4:7], s27 offen sc1
    v_mfma_f32_16x16x32_bf16 v[220:223], a[44:47], a[100:103], v[220:223]
    v_mfma_f32_16x16x32_bf16 v[224:227], a[48:51], a[88:91], v[224:227]
    ds_read_b64_tr_b16 a[44:45], v11 offset:21664
    v_mfma_f32_16x16x32_bf16 v[228:231], a[48:51], a[92:95], v[228:231]
    ds_read_b64_tr_b16 a[46:47], v11 offset:23456
    v_mfma_f32_16x16x32_bf16 v[232:235], a[48:51], a[96:99], v[232:235]
    s_add_u32 s27, s27, 151552
    s_add_u32 s37, s37, 28672
    v_mfma_f32_16x16x32_bf16 v[236:239], a[48:51], a[100:103], v[236:239]
    v_mfma_f32_16x16x32_bf16 v[240:243], a[52:55], a[88:91], v[240:243]
    ds_read_b64_tr_b16 a[48:49], v11 offset:7360
    v_mfma_f32_16x16x32_bf16 v[244:247], a[52:55], a[92:95], v[244:247]
    ds_read_b64_tr_b16 a[50:51], v11 offset:9152
    v_mfma_f32_16x16x32_bf16 v[248:251], a[52:55], a[96:99], v[248:251]
    s_cmp_eq_u32 s37, 139264
    s_cselect_b32 s37, 24576, s37
    v_mfma_f32_16x16x32_bf16 v[252:255], a[52:55], a[100:103], v[252:255]
    s_waitcnt vmcnt(16) lgkmcnt(12)
    v_mfma_f32_16x16x32_bf16 v[32:35], a[0:3], a[104:107], v[32:35]
    ds_read_b64_tr_b16 a[52:53], v11 offset:21696
    v_mfma_f32_16x16x32_bf16 v[36:39], a[0:3], a[108:111], v[36:39]
    ds_read_b64_tr_b16 a[54:55], v11 offset:23488
    v_mfma_f32_16x16x32_bf16 v[40:43], a[0:3], a[112:115], v[40:43]
    v_mfma_f32_16x16x32_bf16 v[44:47], a[0:3], a[116:119], v[44:47]
    s_barrier
    v_add_u32 v11, s37, v10
    v_mfma_f32_16x16x32_bf16 v[48:51], a[4:7], a[104:107], v[48:51]
    ds_read_b64_tr_b16 a[0:1], v11 offset:0
    v_mfma_f32_16x16x32_bf16 v[52:55], a[4:7], a[108:111], v[52:55]
    ds_read_b64_tr_b16 a[2:3], v11 offset:1792
    v_mfma_f32_16x16x32_bf16 v[56:59], a[4:7], a[112:115], v[56:59]
    buffer_load_dwordx4 a[88:91], v12, s[4:7], s27 offen sc1
    v_mfma_f32_16x16x32_bf16 v[60:63], a[4:7], a[116:119], v[60:63]
    v_mfma_f32_16x16x32_bf16 v[64:67], a[8:11], a[104:107], v[64:67]
    ds_read_b64_tr_b16 a[4:5], v11 offset:14336
    v_mfma_f32_16x16x32_bf16 v[68:71], a[8:11], a[108:111], v[68:71]
    ds_read_b64_tr_b16 a[6:7], v11 offset:16128
    v_mfma_f32_16x16x32_bf16 v[72:75], a[8:11], a[112:115], v[72:75]
    buffer_load_dwordx4 a[92:95], v13, s[4:7], s27 offen sc1
    v_mfma_f32_16x16x32_bf16 v[76:79], a[8:11], a[116:119], v[76:79]
    buffer_load_dwordx4 a[96:99], v14, s[4:7], s27 offen sc1
    v_mfma_f32_16x16x32_bf16 v[80:83], a[12:15], a[104:107], v[80:83]
    ds_read_b64_tr_b16 a[8:9], v11 offset:32
    v_mfma_f32_16x16x32_bf16 v[84:87], a[12:15], a[108:111], v[84:87]
    ds_read_b64_tr_b16 a[10:11], v11 offset:1824
    v_mfma_f32_16x16x32_bf16 v[88:91], a[12:15], a[112:115], v[88:91]
    v_mfma_f32_16x16x32_bf16 v[92:95], a[12:15], a[116:119], v[92:95]
    buffer_load_dwordx4 a[100:103], v15, s[4:7], s27 offen sc1
    v_mfma_f32_16x16x32_bf16 v[96:99], a[16:19], a[104:107], v[96:99]
    ds_read_b64_tr_b16 a[12:13], v11 offset:14368
    v_mfma_f32_16x16x32_bf16 v[100:103], a[16:19], a[108:111], v[100:103]
    ds_read_b64_tr_b16 a[14:15], v11 offset:16160
    v_mfma_f32_16x16x32_bf16 v[104:107], a[16:19], a[112:115], v[104:107]
    s_add_u32 s27, s27, 151552
    v_mfma_f32_16x16x32_bf16 v[108:111], a[16:19], a[116:119], v[108:111]
    v_mfma_f32_16x16x32_bf16 v[112:115], a[20:23], a[104:107], v[112:115]
    ds_read_b64_tr_b16 a[16:17], v11 offset:64
    v_mfma_f32_16x16x32_bf16 v[116:119], a[20:23], a[108:111], v[116:119]
    ds_read_b64_tr_b16 a[18:19], v11 offset:1856
    v_mfma_f32_16x16x32_bf16 v[120:123], a[20:23], a[112:115], v[120:123]
    s_add_u32 m0, s52, 0
    v_mfma_f32_16x16x32_bf16 v[124:127], a[20:23], a[116:119], v[124:127]
    v_mfma_f32_16x16x32_bf16 v[128:131], a[24:27], a[104:107], v[128:131]
    ds_read_b64_tr_b16 a[20:21], v11 offset:14400
    v_mfma_f32_16x16x32_bf16 v[132:135], a[24:27], a[108:111], v[132:135]
    ds_read_b64_tr_b16 a[22:23], v11 offset:16192
    v_mfma_f32_16x16x32_bf16 v[136:139], a[24:27], a[112:115], v[136:139]
    buffer_load_dwordx4 v3, s[28:31], s51 offen lds
    v_mfma_f32_16x16x32_bf16 v[140:143], a[24:27], a[116:119], v[140:143]
    s_waitcnt lgkmcnt(12)
    v_mfma_f32_16x16x32_bf16 v[144:147], a[28:31], a[104:107], v[144:147]
    ds_read_b64_tr_b16 a[24:25], v11 offset:96
    v_mfma_f32_16x16x32_bf16 v[148:151], a[28:31], a[108:111], v[148:151]
    ds_read_b64_tr_b16 a[26:27], v11 offset:1888
    v_mfma_f32_16x16x32_bf16 v[152:155], a[28:31], a[112:115], v[152:155]
    s_add_u32 m0, s52, 1024
    v_mfma_f32_16x16x32_bf16 v[156:159], a[28:31], a[116:119], v[156:159]
    v_mfma_f32_16x16x32_bf16 v[160:163], a[32:35], a[104:107], v[160:163]
    ds_read_b64_tr_b16 a[28:29], v11 offset:14432
    v_mfma_f32_16x16x32_bf16 v[164:167], a[32:35], a[108:111], v[164:167]
    ds_read_b64_tr_b16 a[30:31], v11 offset:16224
    v_mfma_f32_16x16x32_bf16 v[168:171], a[32:35], a[112:115], v[168:171]
    buffer_load_dwordx4 v4, s[28:31], s51 offen lds
    v_mfma_f32_16x16x32_bf16 v[172:175], a[32:35], a[116:119], v[172:175]
    s_add_u32 m0, s52, 2048
    v_mfma_f32_16x16x32_bf16 v[176:179], a[36:39], a[104:107], v[176:179]
    ds_read_b64_tr_b16 a[32:33], v11 offset:128
    v_mfma_f32_16x16x32_bf16 v[180:183], a[36:39], a[108:111], v[180:183]
    ds_read_b64_tr_b16 a[34:35], v11 offset:1920
    v_mfma_f32_16x16x32_bf16 v[184:187], a[36:39], a[112:115], v[184:187]
    v_mfma_f32_16x16x32_bf16 v[188:191], a[36:39], a[116:119], v[188:191]
    buffer_load_dwordx4 v5, s[28:31], s51 offen lds
    v_mfma_f32_16x16x32_bf16 v[192:195], a[40:43], a[104:107], v[192:195]
    ds_read_b64_tr_b16 a[36:37], v11 offset:14464
    v_mfma_f32_16x16x32_bf16 v[196:199], a[40:43], a[108:111], v[196:199]
    ds_read_b64_tr_b16 a[38:39], v11 offset:16256
    v_mfma_f32_16x16x32_bf16 v[200:203], a[40:43], a[112:115], v[200:203]
    s_add_u32 m0, s52, 3072
    v_mfma_f32_16x16x32_bf16 v[204:207], a[40:43], a[116:119], v[204:207]
    v_mfma_f32_16x16x32_bf16 v[208:211], a[44:47], a[104:107], v[208:211]
    ds_read_b64_tr_b16 a[40:41], v11 offset:160
    v_mfma_f32_16x16x32_bf16 v[212:215], a[44:47], a[108:111], v[212:215]
    ds_read_b64_tr_b16 a[42:43], v11 offset:1952
    v_mfma_f32_16x16x32_bf16 v[216:219], a[44:47], a[112:115], v[216:219]
    buffer_load_dwordx4 v6, s[28:31], s51 offen lds
    v_mfma_f32_16x16x32_bf16 v[220:223], a[44:47], a[116:119], v[220:223]
    v_mfma_f32_16x16x32_bf16 v[224:227], a[48:51], a[104:107], v[224:227]
    ds_read_b64_tr_b16 a[44:45], v11 offset:14496
    v_mfma_f32_16x16x32_bf16 v[228:231], a[48:51], a[108:111], v[228:231]
    ds_read_b64_tr_b16 a[46:47], v11 offset:16288
    v_mfma_f32_16x16x32_bf16 v[232:235], a[48:51], a[112:115], v[232:235]
    buffer_load_dwordx2 a[122:123], v22, s[16:19], s56 offen offset:0 sc1
    v_mfma_f32_16x16x32_bf16 v[236:239], a[48:51], a[116:119], v[236:239]
    v_mfma_f32_16x16x32_bf16 v[240:243], a[52:55], a[104:107], v[240:243]
    ds_read_b64_tr_b16 a[48:49], v11 offset:192
    v_mfma_f32_16x16x32_bf16 v[244:247], a[52:55], a[108:111], v[244:247]
    ds_read_b64_tr_b16 a[50:51], v11 offset:1984
    v_mfma_f32_16x16x32_bf16 v[248:251], a[52:55], a[112:115], v[248:251]
    buffer_load_dwordx2 a[130:131], v22, s[16:19], s56 offen offset:128 sc1
    v_mfma_f32_16x16x32_bf16 v[252:255], a[52:55], a[116:119], v[252:255]
    s_waitcnt vmcnt(22) lgkmcnt(12)
    v_mfma_f32_16x16x32_bf16 v[32:35], a[0:3], a[56:59], v[32:35]
    ds_read_b64_tr_b16 a[52:53], v11 offset:14528
    v_mfma_f32_16x16x32_bf16 v[36:39], a[0:3], a[60:63], v[36:39]
    ds_read_b64_tr_b16 a[54:55], v11 offset:16320
    v_mfma_f32_16x16x32_bf16 v[40:43], a[0:3], a[64:67], v[40:43]
    s_add_u32 m0, s52, 4096
    s_nop 0
    buffer_load_dwordx4 v7, s[28:31], s51 offen lds
    v_mfma_f32_16x16x32_bf16 v[44:47], a[0:3], a[68:71], v[44:47]
    v_mfma_f32_16x16x32_bf16 v[48:51], a[4:7], a[56:59], v[48:51]
    ds_read_b64_tr_b16 a[0:1], v11 offset:7168
    v_mfma_f32_16x16x32_bf16 v[52:55], a[4:7], a[60:63], v[52:55]
    ds_read_b64_tr_b16 a[2:3], v11 offset:8960
    v_mfma_f32_16x16x32_bf16 v[56:59], a[4:7], a[64:67], v[56:59]
    s_add_u32 m0, s52, 5120
    v_mfma_f32_16x16x32_bf16 v[60:63], a[4:7], a[68:71], v[60:63]
    v_mfma_f32_16x16x32_bf16 v[64:67], a[8:11], a[56:59], v[64:67]
    ds_read_b64_tr_b16 a[4:5], v11 offset:21504
    v_mfma_f32_16x16x32_bf16 v[68:71], a[8:11], a[60:63], v[68:71]
    ds_read_b64_tr_b16 a[6:7], v11 offset:23296
    v_mfma_f32_16x16x32_bf16 v[72:75], a[8:11], a[64:67], v[72:75]
    buffer_load_dwordx4 v8, s[28:31], s51 offen lds
    v_mfma_f32_16x16x32_bf16 v[76:79], a[8:11], a[68:71], v[76:79]
    s_add_u32 m0, s52, 6144
    v_mfma_f32_16x16x32_bf16 v[80:83], a[12:15], a[56:59], v[80:83]
    ds_read_b64_tr_b16 a[8:9], v11 offset:7200
    v_mfma_f32_16x16x32_bf16 v[84:87], a[12:15], a[60:63], v[84:87]
    ds_read_b64_tr_b16 a[10:11], v11 offset:8992
    v_mfma_f32_16x16x32_bf16 v[88:91], a[12:15], a[64:67], v[88:91]
    buffer_load_dwordx4 v9, s[28:31], s51 offen lds
    v_mfma_f32_16x16x32_bf16 v[92:95], a[12:15], a[68:71], v[92:95]
    v_mfma_f32_16x16x32_bf16 v[96:99], a[16:19], a[56:59], v[96:99]
    ds_read_b64_tr_b16 a[12:13], v11 offset:21536
    v_mfma_f32_16x16x32_bf16 v[100:103], a[16:19], a[60:63], v[100:103]
    ds_read_b64_tr_b16 a[14:15], v11 offset:23328
    v_mfma_f32_16x16x32_bf16 v[104:107], a[16:19], a[64:67], v[104:107]
    s_add_u32 s51, s51, s55
    v_mfma_f32_16x16x32_bf16 v[108:111], a[16:19], a[68:71], v[108:111]
    s_add_u32 s52, s52, 28672
    v_mfma_f32_16x16x32_bf16 v[112:115], a[20:23], a[56:59], v[112:115]
    ds_read_b64_tr_b16 a[16:17], v11 offset:7232
    v_mfma_f32_16x16x32_bf16 v[116:119], a[20:23], a[60:63], v[116:119]
    ds_read_b64_tr_b16 a[18:19], v11 offset:9024
    v_mfma_f32_16x16x32_bf16 v[120:123], a[20:23], a[64:67], v[120:123]
    s_cmp_eq_u32 s52, s54
    s_cselect_b32 s52, s53, s52
    v_mfma_f32_16x16x32_bf16 v[124:127], a[20:23], a[68:71], v[124:127]
    v_mfma_f32_16x16x32_bf16 v[128:131], a[24:27], a[56:59], v[128:131]
    ds_read_b64_tr_b16 a[20:21], v11 offset:21568
    v_mfma_f32_16x16x32_bf16 v[132:135], a[24:27], a[60:63], v[132:135]
    ds_read_b64_tr_b16 a[22:23], v11 offset:23360
    v_mfma_f32_16x16x32_bf16 v[136:139], a[24:27], a[64:67], v[136:139]
    buffer_load_dwordx4 a[104:107], v12, s[4:7], s27 offen sc1
    v_mfma_f32_16x16x32_bf16 v[140:143], a[24:27], a[68:71], v[140:143]
    s_waitcnt lgkmcnt(12)
    v_mfma_f32_16x16x32_bf16 v[144:147], a[28:31], a[56:59], v[144:147]
    ds_read_b64_tr_b16 a[24:25], v11 offset:7264
    v_mfma_f32_16x16x32_bf16 v[148:151], a[28:31], a[60:63], v[148:151]
    ds_read_b64_tr_b16 a[26:27], v11 offset:9056
    v_mfma_f32_16x16x32_bf16 v[152:155], a[28:31], a[64:67], v[152:155]
    buffer_load_dwordx4 a[108:111], v13, s[4:7], s27 offen sc1
    buffer_load_dwordx4 a[112:115], v14, s[4:7], s27 offen sc1
    v_mfma_f32_16x16x32_bf16 v[156:159], a[28:31], a[68:71], v[156:159]
    v_mfma_f32_16x16x32_bf16 v[160:163], a[32:35], a[56:59], v[160:163]
    ds_read_b64_tr_b16 a[28:29], v11 offset:21600
    v_mfma_f32_16x16x32_bf16 v[164:167], a[32:35], a[60:63], v[164:167]
    ds_read_b64_tr_b16 a[30:31], v11 offset:23392
    v_mfma_f32_16x16x32_bf16 v[168:171], a[32:35], a[64:67], v[168:171]
    buffer_load_dwordx4 a[116:119], v15, s[4:7], s27 offen sc1
    v_mfma_f32_16x16x32_bf16 v[172:175], a[32:35], a[68:71], v[172:175]
    v_mfma_f32_16x16x32_bf16 v[176:179], a[36:39], a[56:59], v[176:179]
    ds_read_b64_tr_b16 a[32:33], v11 offset:7296
    v_mfma_f32_16x16x32_bf16 v[180:183], a[36:39], a[60:63], v[180:183]
    ds_read_b64_tr_b16 a[34:35], v11 offset:9088
    v_mfma_f32_16x16x32_bf16 v[184:187], a[36:39], a[64:67], v[184:187]
    s_add_u32 s27, s27, 151552
    v_mfma_f32_16x16x32_bf16 v[188:191], a[36:39], a[68:71], v[188:191]
    buffer_load_dwordx2 a[138:139], v22, s[16:19], s56 offen offset:256 sc1
    v_mfma_f32_16x16x32_bf16 v[192:195], a[40:43], a[56:59], v[192:195]
    ds_read_b64_tr_b16 a[36:37], v11 offset:21632
    v_mfma_f32_16x16x32_bf16 v[196:199], a[40:43], a[60:63], v[196:199]
    ds_read_b64_tr_b16 a[38:39], v11 offset:23424
    v_mfma_f32_16x16x32_bf16 v[200:203], a[40:43], a[64:67], v[200:203]
    buffer_load_dwordx2 a[146:147], v22, s[16:19], s56 offen offset:384 sc1
    v_mfma_f32_16x16x32_bf16 v[204:207], a[40:43], a[68:71], v[204:207]
    v_mfma_f32_16x16x32_bf16 v[208:211], a[44:47], a[56:59], v[208:211]
    ds_read_b64_tr_b16 a[40:41], v11 offset:7328
    v_mfma_f32_16x16x32_bf16 v[212:215], a[44:47], a[60:63], v[212:215]
    ds_read_b64_tr_b16 a[42:43], v11 offset:9120
    v_mfma_f32_16x16x32_bf16 v[216:219], a[44:47], a[64:67], v[216:219]
    s_add_u32 s56, s56, 0x4000
    v_mfma_f32_16x16x32_bf16 v[220:223], a[44:47], a[68:71], v[220:223]
    buffer_load_dwordx2 a[124:125], v22, s[16:19], s56 offen offset:0 sc1
    v_mfma_f32_16x16x32_bf16 v[224:227], a[48:51], a[56:59], v[224:227]
    ds_read_b64_tr_b16 a[44:45], v11 offset:21664
    v_mfma_f32_16x16x32_bf16 v[228:231], a[48:51], a[60:63], v[228:231]
    ds_read_b64_tr_b16 a[46:47], v11 offset:23456
    v_mfma_f32_16x16x32_bf16 v[232:235], a[48:51], a[64:67], v[232:235]
    s_add_u32 s37, s37, 28672
    v_mfma_f32_16x16x32_bf16 v[236:239], a[48:51], a[68:71], v[236:239]
    v_mfma_f32_16x16x32_bf16 v[240:243], a[52:55], a[56:59], v[240:243]
    ds_read_b64_tr_b16 a[48:49], v11 offset:7360
    v_mfma_f32_16x16x32_bf16 v[244:247], a[52:55], a[60:63], v[244:247]
    ds_read_b64_tr_b16 a[50:51], v11 offset:9152
    v_mfma_f32_16x16x32_bf16 v[248:251], a[52:55], a[64:67], v[248:251]
    s_cmp_eq_u32 s37, 139264
    s_cselect_b32 s37, 24576, s37
    v_mfma_f32_16x16x32_bf16 v[252:255], a[52:55], a[68:71], v[252:255]
    s_waitcnt vmcnt(20) lgkmcnt(12)
    v_mfma_f32_16x16x32_bf16 v[32:35], a[0:3], a[72:75], v[32:35]
    ds_read_b64_tr_b16 a[52:53], v11 offset:21696
    v_mfma_f32_16x16x32_bf16 v[36:39], a[0:3], a[76:79], v[36:39]
    ds_read_b64_tr_b16 a[54:55], v11 offset:23488
    v_mfma_f32_16x16x32_bf16 v[40:43], a[0:3], a[80:83], v[40:43]
    v_mfma_f32_16x16x32_bf16 v[44:47], a[0:3], a[84:87], v[44:47]
    s_barrier
    v_add_u32 v11, s37, v10
    v_mfma_f32_16x16x32_bf16 v[48:51], a[4:7], a[72:75], v[48:51]
    ds_read_b64_tr_b16 a[0:1], v11 offset:0
    v_mfma_f32_16x16x32_bf16 v[52:55], a[4:7], a[76:79], v[52:55]
    ds_read_b64_tr_b16 a[2:3], v11 offset:1792
    v_mfma_f32_16x16x32_bf16 v[56:59], a[4:7], a[80:83], v[56:59]
    buffer_load_dwordx2 a[132:133], v22, s[16:19], s56 offen offset:128 sc1
    v_mfma_f32_16x16x32_bf16 v[60:63], a[4:7], a[84:87], v[60:63]
    v_mfma_f32_16x16x32_bf16 v[64:67], a[8:11], a[72:75], v[64:67]
    ds_read_b64_tr_b16 a[4:5], v11 offset:14336
    v_mfma_f32_16x16x32_bf16 v[68:71], a[8:11], a[76:79], v[68:71]
    ds_read_b64_tr_b16 a[6:7], v11 offset:16128
    v_mfma_f32_16x16x32_bf16 v[72:75], a[8:11], a[80:83], v[72:75]
    buffer_load_dwordx2 a[140:141], v22, s[16:19], s56 offen offset:256 sc1
    v_mfma_f32_16x16x32_bf16 v[76:79], a[8:11], a[84:87], v[76:79]
    buffer_load_dwordx2 a[148:149], v22, s[16:19], s56 offen offset:384 sc1
    v_mfma_f32_16x16x32_bf16 v[80:83], a[12:15], a[72:75], v[80:83]
    ds_read_b64_tr_b16 a[8:9], v11 offset:32
    v_mfma_f32_16x16x32_bf16 v[84:87], a[12:15], a[76:79], v[84:87]
    ds_read_b64_tr_b16 a[10:11], v11 offset:1824
    v_mfma_f32_16x16x32_bf16 v[88:91], a[12:15], a[80:83], v[88:91]
    s_add_u32 s56, s56, 0x4000
    v_mfma_f32_16x16x32_bf16 v[92:95], a[12:15], a[84:87], v[92:95]
    v_mfma_f32_16x16x32_bf16 v[96:99], a[16:19], a[72:75], v[96:99]
    ds_read_b64_tr_b16 a[12:13], v11 offset:14368
    v_mfma_f32_16x16x32_bf16 v[100:103], a[16:19], a[76:79], v[100:103]
    ds_read_b64_tr_b16 a[14:15], v11 offset:16160
    v_mfma_f32_16x16x32_bf16 v[104:107], a[16:19], a[80:83], v[104:107]
    buffer_load_dwordx2 a[126:127], v22, s[16:19], s56 offen offset:0 sc1
    v_mfma_f32_16x16x32_bf16 v[108:111], a[16:19], a[84:87], v[108:111]
    v_mfma_f32_16x16x32_bf16 v[112:115], a[20:23], a[72:75], v[112:115]
    ds_read_b64_tr_b16 a[16:17], v11 offset:64
    v_mfma_f32_16x16x32_bf16 v[116:119], a[20:23], a[76:79], v[116:119]
    ds_read_b64_tr_b16 a[18:19], v11 offset:1856
    v_mfma_f32_16x16x32_bf16 v[120:123], a[20:23], a[80:83], v[120:123]
    buffer_load_dwordx2 a[134:135], v22, s[16:19], s56 offen offset:128 sc1
    v_mfma_f32_16x16x32_bf16 v[124:127], a[20:23], a[84:87], v[124:127]
    buffer_load_dwordx2 a[142:143], v22, s[16:19], s56 offen offset:256 sc1
    v_mfma_f32_16x16x32_bf16 v[128:131], a[24:27], a[72:75], v[128:131]
    ds_read_b64_tr_b16 a[20:21], v11 offset:14400
    v_mfma_f32_16x16x32_bf16 v[132:135], a[24:27], a[76:79], v[132:135]
    ds_read_b64_tr_b16 a[22:23], v11 offset:16192
    v_mfma_f32_16x16x32_bf16 v[136:139], a[24:27], a[80:83], v[136:139]
    buffer_load_dwordx2 a[150:151], v22, s[16:19], s56 offen offset:384 sc1
    v_mfma_f32_16x16x32_bf16 v[140:143], a[24:27], a[84:87], v[140:143]
    s_waitcnt lgkmcnt(12)
    v_mfma_f32_16x16x32_bf16 v[144:147], a[28:31], a[72:75], v[144:147]
    ds_read_b64_tr_b16 a[24:25], v11 offset:96
    v_mfma_f32_16x16x32_bf16 v[148:151], a[28:31], a[76:79], v[148:151]
    ds_read_b64_tr_b16 a[26:27], v11 offset:1888
    v_mfma_f32_16x16x32_bf16 v[152:155], a[28:31], a[80:83], v[152:155]
    s_add_u32 s56, s56, 0x4000
    v_mfma_f32_16x16x32_bf16 v[156:159], a[28:31], a[84:87], v[156:159]
    v_mfma_f32_16x16x32_bf16 v[160:163], a[32:35], a[72:75], v[160:163]
    ds_read_b64_tr_b16 a[28:29], v11 offset:14432
    v_mfma_f32_16x16x32_bf16 v[164:167], a[32:35], a[76:79], v[164:167]
    ds_read_b64_tr_b16 a[30:31], v11 offset:16224
    v_mfma_f32_16x16x32_bf16 v[168:171], a[32:35], a[80:83], v[168:171]
    v_cmp_lt_u32 vcc, 111, v0
    v_mov_b32 v23, 13888
    s_nop 0
    v_cndmask_b32 v23, 0, v23, vcc
    v_lshl_add_u32 v23, v0, 2, v23
    s_mul_i32 s57, s49, 448
    v_mfma_f32_16x16x32_bf16 v[172:175], a[32:35], a[84:87], v[172:175]
    buffer_load_dword a152, v23, s[20:23], s57 offen sc1
    v_mfma_f32_16x16x32_bf16 v[176:179], a[36:39], a[72:75], v[176:179]
    ds_read_b64_tr_b16 a[32:33], v11 offset:128
    v_mfma_f32_16x16x32_bf16 v[180:183], a[36:39], a[76:79], v[180:183]
    ds_read_b64_tr_b16 a[34:35], v11 offset:1920
    v_mfma_f32_16x16x32_bf16 v[184:187], a[36:39], a[80:83], v[184:187]
    s_add_u32 s57, s57, 28672
    v_mfma_f32_16x16x32_bf16 v[188:191], a[36:39], a[84:87], v[188:191]
    v_mfma_f32_16x16x32_bf16 v[192:195], a[40:43], a[72:75], v[192:195]
    ds_read_b64_tr_b16 a[36:37], v11 offset:14464
    v_mfma_f32_16x16x32_bf16 v[196:199], a[40:43], a[76:79], v[196:199]
    ds_read_b64_tr_b16 a[38:39], v11 offset:16256
    v_mfma_f32_16x16x32_bf16 v[200:203], a[40:43], a[80:83], v[200:203]
    buffer_load_dword a153, v23, s[20:23], s57 offen sc1
    v_mfma_f32_16x16x32_bf16 v[204:207], a[40:43], a[84:87], v[204:207]
    v_mfma_f32_16x16x32_bf16 v[208:211], a[44:47], a[72:75], v[208:211]
    ds_read_b64_tr_b16 a[40:41], v11 offset:160
    v_mfma_f32_16x16x32_bf16 v[212:215], a[44:47], a[76:79], v[212:215]
    ds_read_b64_tr_b16 a[42:43], v11 offset:1952
    v_mfma_f32_16x16x32_bf16 v[216:219], a[44:47], a[80:83], v[216:219]
    s_add_u32 s57, s57, 28672
    v_mfma_f32_16x16x32_bf16 v[220:223], a[44:47], a[84:87], v[220:223]
    buffer_load_dword a154, v23, s[20:23], s57 offen sc1
    v_mfma_f32_16x16x32_bf16 v[224:227], a[48:51], a[72:75], v[224:227]
    ds_read_b64_tr_b16 a[44:45], v11 offset:14496
    v_mfma_f32_16x16x32_bf16 v[228:231], a[48:51], a[76:79], v[228:231]
    ds_read_b64_tr_b16 a[46:47], v11 offset:16288
    v_mfma_f32_16x16x32_bf16 v[232:235], a[48:51], a[80:83], v[232:235]
    s_add_u32 s57, s57, 28672
    v_mfma_f32_16x16x32_bf16 v[236:239], a[48:51], a[84:87], v[236:239]
    v_mfma_f32_16x16x32_bf16 v[240:243], a[52:55], a[72:75], v[240:243]
    ds_read_b64_tr_b16 a[48:49], v11 offset:192
    v_mfma_f32_16x16x32_bf16 v[244:247], a[52:55], a[76:79], v[244:247]
    ds_read_b64_tr_b16 a[50:51], v11 offset:1984
    v_mfma_f32_16x16x32_bf16 v[248:251], a[52:55], a[80:83], v[248:251]
    buffer_load_dword a156, v2, s[68:71], 0 offen
    v_mfma_f32_16x16x32_bf16 v[252:255], a[52:55], a[84:87], v[252:255]
    s_waitcnt vmcnt(27) lgkmcnt(12)
    v_mfma_f32_16x16x32_bf16 v[32:35], a[0:3], a[88:91], v[32:35]
    ds_read_b64_tr_b16 a[52:53], v11 offset:14528
    v_mfma_f32_16x16x32_bf16 v[36:39], a[0:3], a[92:95], v[36:39]
    ds_read_b64_tr_b16 a[54:55], v11 offset:16320
    v_mfma_f32_16x16x32_bf16 v[40:43], a[0:3], a[96:99], v[40:43]
    buffer_load_dword a155, v23, s[20:23], s57 offen sc1
    s_add_u32 s57, s57, 28672
    v_mfma_f32_16x16x32_bf16 v[44:47], a[0:3], a[100:103], v[44:47]
    v_mfma_f32_16x16x32_bf16 v[48:51], a[4:7], a[88:91], v[48:51]
    ds_read_b64_tr_b16 a[0:1], v11 offset:7168
    v_mfma_f32_16x16x32_bf16 v[52:55], a[4:7], a[92:95], v[52:55]
    ds_read_b64_tr_b16 a[2:3], v11 offset:8960
    v_mfma_f32_16x16x32_bf16 v[56:59], a[4:7], a[96:99], v[56:59]
    buffer_load_dwordx4 a[56:59], v12, s[4:7], s27 offen sc1
    v_mfma_f32_16x16x32_bf16 v[60:63], a[4:7], a[100:103], v[60:63]
    v_mfma_f32_16x16x32_bf16 v[64:67], a[8:11], a[88:91], v[64:67]
    ds_read_b64_tr_b16 a[4:5], v11 offset:21504
    v_mfma_f32_16x16x32_bf16 v[68:71], a[8:11], a[92:95], v[68:71]
    ds_read_b64_tr_b16 a[6:7], v11 offset:23296
    v_mfma_f32_16x16x32_bf16 v[72:75], a[8:11], a[96:99], v[72:75]
    buffer_load_dwordx4 a[60:63], v13, s[4:7], s27 offen sc1
    v_mfma_f32_16x16x32_bf16 v[76:79], a[8:11], a[100:103], v[76:79]
    buffer_load_dwordx4 a[64:67], v14, s[4:7], s27 offen sc1
    v_mfma_f32_16x16x32_bf16 v[80:83], a[12:15], a[88:91], v[80:83]
    ds_read_b64_tr_b16 a[8:9], v11 offset:7200
    v_mfma_f32_16x16x32_bf16 v[84:87], a[12:15], a[92:95], v[84:87]
    ds_read_b64_tr_b16 a[10:11], v11 offset:8992
    v_mfma_f32_16x16x32_bf16 v[88:91], a[12:15], a[96:99], v[88:91]
    buffer_load_dwordx4 a[68:71], v15, s[4:7], s27 offen sc1
    v_mfma_f32_16x16x32_bf16 v[92:95], a[12:15], a[100:103], v[92:95]
    v_mfma_f32_16x16x32_bf16 v[96:99], a[16:19], a[88:91], v[96:99]
    ds_read_b64_tr_b16 a[12:13], v11 offset:21536
    v_mfma_f32_16x16x32_bf16 v[100:103], a[16:19], a[92:95], v[100:103]
    ds_read_b64_tr_b16 a[14:15], v11 offset:23328
    v_mfma_f32_16x16x32_bf16 v[104:107], a[16:19], a[96:99], v[104:107]
    s_add_u32 s27, s27, 151552
    v_mfma_f32_16x16x32_bf16 v[108:111], a[16:19], a[100:103], v[108:111]
    v_mfma_f32_16x16x32_bf16 v[112:115], a[20:23], a[88:91], v[112:115]
    ds_read_b64_tr_b16 a[16:17], v11 offset:7232
    v_mfma_f32_16x16x32_bf16 v[116:119], a[20:23], a[92:95], v[116:119]
    ds_read_b64_tr_b16 a[18:19], v11 offset:9024
    v_mfma_f32_16x16x32_bf16 v[120:123], a[20:23], a[96:99], v[120:123]
    s_add_u32 m0, s52, 0
    v_mfma_f32_16x16x32_bf16 v[124:127], a[20:23], a[100:103], v[124:127]
    buffer_load_dwordx4 v3, s[28:31], s51 offen lds
    v_mfma_f32_16x16x32_bf16 v[128:131], a[24:27], a[88:91], v[128:131]
    ds_read_b64_tr_b16 a[20:21], v11 offset:21568
    v_mfma_f32_16x16x32_bf16 v[132:135], a[24:27], a[92:95], v[132:135]
    ds_read_b64_tr_b16 a[22:23], v11 offset:23360
    v_mfma_f32_16x16x32_bf16 v[136:139], a[24:27], a[96:99], v[136:139]
    s_add_u32 m0, s52, 1024
    v_mfma_f32_16x16x32_bf16 v[140:143], a[24:27], a[100:103], v[140:143]
    s_waitcnt lgkmcnt(12)
    v_mfma_f32_16x16x32_bf16 v[144:147], a[28:31], a[88:91], v[144:147]
    ds_read_b64_tr_b16 a[24:25], v11 offset:7264
    v_mfma_f32_16x16x32_bf16 v[148:151], a[28:31], a[92:95], v[148:151]
    ds_read_b64_tr_b16 a[26:27], v11 offset:9056
    v_mfma_f32_16x16x32_bf16 v[152:155], a[28:31], a[96:99], v[152:155]
    buffer_load_dwordx4 v4, s[28:31], s51 offen lds
    v_mfma_f32_16x16x32_bf16 v[156:159], a[28:31], a[100:103], v[156:159]
    v_mfma_f32_16x16x32_bf16 v[160:163], a[32:35], a[88:91], v[160:163]
    ds_read_b64_tr_b16 a[28:29], v11 offset:21600
    v_mfma_f32_16x16x32_bf16 v[164:167], a[32:35], a[92:95], v[164:167]
    ds_read_b64_tr_b16 a[30:31], v11 offset:23392
    v_mfma_f32_16x16x32_bf16 v[168:171], a[32:35], a[96:99], v[168:171]
    s_add_u32 m0, s52, 2048
    v_mfma_f32_16x16x32_bf16 v[172:175], a[32:35], a[100:103], v[172:175]
    buffer_load_dwordx4 v5, s[28:31], s51 offen lds
    v_mfma_f32_16x16x32_bf16 v[176:179], a[36:39], a[88:91], v[176:179]
    ds_read_b64_tr_b16 a[32:33], v11 offset:7296
    v_mfma_f32_16x16x32_bf16 v[180:183], a[36:39], a[92:95], v[180:183]
    ds_read_b64_tr_b16 a[34:35], v11 offset:9088
    v_mfma_f32_16x16x32_bf16 v[184:187], a[36:39], a[96:99], v[184:187]
    s_add_u32 m0, s52, 3072
    v_mfma_f32_16x16x32_bf16 v[188:191], a[36:39], a[100:103], v[188:191]
    v_mfma_f32_16x16x32_bf16 v[192:195], a[40:43], a[88:91], v[192:195]
    ds_read_b64_tr_b16 a[36:37], v11 offset:21632
    v_mfma_f32_16x16x32_bf16 v[196:199], a[40:43], a[92:95], v[196:199]
    ds_read_b64_tr_b16 a[38:39], v11 offset:23424
    v_mfma_f32_16x16x32_bf16 v[200:203], a[40:43], a[96:99], v[200:203]
    buffer_load_dwordx4 v6, s[28:31], s51 offen lds
    v_mfma_f32_16x16x32_bf16 v[204:207], a[40:43], a[100:103], v[204:207]
    v_mfma_f32_16x16x32_bf16 v[208:211], a[44:47], a[88:91], v[208:211]
    ds_read_b64_tr_b16 a[40:41], v11 offset:7328
    v_mfma_f32_16x16x32_bf16 v[212:215], a[44:47], a[92:95], v[212:215]
    ds_read_b64_tr_b16 a[42:43], v11 offset:9120
    v_mfma_f32_16x16x32_bf16 v[216:219], a[44:47], a[96:99], v[216:219]
    s_add_u32 m0, s52, 4096
    v_mfma_f32_16x16x32_bf16 v[220:223], a[44:47], a[100:103], v[220:223]
    buffer_load_dwordx4 v7, s[28:31], s51 offen lds
    v_mfma_f32_16x16x32_bf16 v[224:227], a[48:51], a[88:91], v[224:227]
    ds_read_b64_tr_b16 a[44:45], v11 offset:21664
    v_mfma_f32_16x16x32_bf16 v[228:231], a[48:51], a[92:95], v[228:231]
    ds_read_b64_tr_b16 a[46:47], v11 offset:23456
    v_mfma_f32_16x16x32_bf16 v[232:235], a[48:51], a[96:99], v[232:235]
    s_add_u32 s37, s37, 28672
    v_mfma_f32_16x16x32_bf16 v[236:239], a[48:51], a[100:103], v[236:239]
    v_mfma_f32_16x16x32_bf16 v[240:243], a[52:55], a[88:91], v[240:243]
    ds_read_b64_tr_b16 a[48:49], v11 offset:7360
    v_mfma_f32_16x16x32_bf16 v[244:247], a[52:55], a[92:95], v[244:247]
    ds_read_b64_tr_b16 a[50:51], v11 offset:9152
    v_mfma_f32_16x16x32_bf16 v[248:251], a[52:55], a[96:99], v[248:251]
    s_cmp_eq_u32 s37, 139264
    s_cselect_b32 s37, 24576, s37
    v_mfma_f32_16x16x32_bf16 v[252:255], a[52:55], a[100:103], v[252:255]
    s_waitcnt vmcnt(24) lgkmcnt(12)
    v_mfma_f32_16x16x32_bf16 v[32:35], a[0:3], a[104:107], v[32:35]
    ds_read_b64_tr_b16 a[52:53], v11 offset:21696
    v_mfma_f32_16x16x32_bf16 v[36:39], a[0:3], a[108:111], v[36:39]
    ds_read_b64_tr_b16 a[54:55], v11 offset:23488
    v_mfma_f32_16x16x32_bf16 v[40:43], a[0:3], a[112:115], v[40:43]
    v_mfma_f32_16x16x32_bf16 v[44:47], a[0:3], a[116:119], v[44:47]
    s_barrier
    v_add_u32 v11, s37, v10
    v_mfma_f32_16x16x32_bf16 v[48:51], a[4:7], a[104:107], v[48:51]
    ds_read_b64_tr_b16 a[0:1], v11 offset:0
    v_mfma_f32_16x16x32_bf16 v[52:55], a[4:7], a[108:111], v[52:55]
    ds_read_b64_tr_b16 a[2:3], v11 offset:1792
    v_mfma_f32_16x16x32_bf16 v[56:59], a[4:7], a[112:115], v[56:59]
    s_add_u32 m0, s52, 5120
    v_mfma_f32_16x16x32_bf16 v[60:63], a[4:7], a[116:119], v[60:63]
    v_mfma_f32_16x16x32_bf16 v[64:67], a[8:11], a[104:107], v[64:67]
    ds_read_b64_tr_b16 a[4:5], v11 offset:14336
    v_mfma_f32_16x16x32_bf16 v[68:71], a[8:11], a[108:111], v[68:71]
    ds_read_b64_tr_b16 a[6:7], v11 offset:16128
    v_mfma_f32_16x16x32_bf16 v[72:75], a[8:11], a[112:115], v[72:75]
    buffer_load_dwordx4 v8, s[28:31], s51 offen lds
    v_mfma_f32_16x16x32_bf16 v[76:79], a[8:11], a[116:119], v[76:79]
    s_add_u32 m0, s52, 6144
    v_mfma_f32_16x16x32_bf16 v[80:83], a[12:15], a[104:107], v[80:83]
    ds_read_b64_tr_b16 a[8:9], v11 offset:32
    v_mfma_f32_16x16x32_bf16 v[84:87], a[12:15], a[108:111], v[84:87]
    ds_read_b64_tr_b16 a[10:11], v11 offset:1824
    v_mfma_f32_16x16x32_bf16 v[88:91], a[12:15], a[112:115], v[88:91]
    buffer_load_dwordx4 v9, s[28:31], s51 offen lds
    v_mfma_f32_16x16x32_bf16 v[92:95], a[12:15], a[116:119], v[92:95]
    v_mfma_f32_16x16x32_bf16 v[96:99], a[16:19], a[104:107], v[96:99]
    ds_read_b64_tr_b16 a[12:13], v11 offset:14368
    v_mfma_f32_16x16x32_bf16 v[100:103], a[16:19], a[108:111], v[100:103]
    ds_read_b64_tr_b16 a[14:15], v11 offset:16160
    v_mfma_f32_16x16x32_bf16 v[104:107], a[16:19], a[112:115], v[104:107]
    s_add_u32 s51, s51, s55
    v_mfma_f32_16x16x32_bf16 v[108:111], a[16:19], a[116:119], v[108:111]
    v_mfma_f32_16x16x32_bf16 v[112:115], a[20:23], a[104:107], v[112:115]
    ds_read_b64_tr_b16 a[16:17], v11 offset:64
    v_mfma_f32_16x16x32_bf16 v[116:119], a[20:23], a[108:111], v[116:119]
    ds_read_b64_tr_b16 a[18:19], v11 offset:1856
    v_mfma_f32_16x16x32_bf16 v[120:123], a[20:23], a[112:115], v[120:123]
    s_add_u32 s52, s52, 28672
    v_mfma_f32_16x16x32_bf16 v[124:127], a[20:23], a[116:119], v[124:127]
    s_cmp_eq_u32 s52, s54
    s_cselect_b32 s52, s53, s52
    v_mfma_f32_16x16x32_bf16 v[128:131], a[24:27], a[104:107], v[128:131]
    ds_read_b64_tr_b16 a[20:21], v11 offset:14400
    v_mfma_f32_16x16x32_bf16 v[132:135], a[24:27], a[108:111], v[132:135]
    ds_read_b64_tr_b16 a[22:23], v11 offset:16192
    v_mfma_f32_16x16x32_bf16 v[136:139], a[24:27], a[112:115], v[136:139]
    buffer_load_dwordx4 a[72:75], v12, s[4:7], s27 offen sc1
    v_mfma_f32_16x16x32_bf16 v[140:143], a[24:27], a[116:119], v[140:143]
    s_waitcnt lgkmcnt(12)
    v_mfma_f32_16x16x32_bf16 v[144:147], a[28:31], a[104:107], v[144:147]
    ds_read_b64_tr_b16 a[24:25], v11 offset:96
    v_mfma_f32_16x16x32_bf16 v[148:151], a[28:31], a[108:111], v[148:151]
    ds_read_b64_tr_b16 a[26:27], v11 offset:1888
    v_mfma_f32_16x16x32_bf16 v[152:155], a[28:31], a[112:115], v[152:155]
    buffer_load_dwordx4 a[76:79], v13, s[4:7], s27 offen sc1
    v_mfma_f32_16x16x32_bf16 v[156:159], a[28:31], a[116:119], v[156:159]
    v_mfma_f32_16x16x32_bf16 v[160:163], a[32:35], a[104:107], v[160:163]
    ds_read_b64_tr_b16 a[28:29], v11 offset:14432
    v_mfma_f32_16x16x32_bf16 v[164:167], a[32:35], a[108:111], v[164:167]
    ds_read_b64_tr_b16 a[30:31], v11 offset:16224
    v_mfma_f32_16x16x32_bf16 v[168:171], a[32:35], a[112:115], v[168:171]
    buffer_load_dwordx4 a[80:83], v14, s[4:7], s27 offen sc1
    v_mfma_f32_16x16x32_bf16 v[172:175], a[32:35], a[116:119], v[172:175]
    buffer_load_dwordx4 a[84:87], v15, s[4:7], s27 offen sc1
    v_mfma_f32_16x16x32_bf16 v[176:179], a[36:39], a[104:107], v[176:179]
    ds_read_b64_tr_b16 a[32:33], v11 offset:128
    v_mfma_f32_16x16x32_bf16 v[180:183], a[36:39], a[108:111], v[180:183]
    ds_read_b64_tr_b16 a[34:35], v11 offset:1920
    v_mfma_f32_16x16x32_bf16 v[184:187], a[36:39], a[112:115], v[184:187]
    s_add_u32 s27, s27, 151552
    v_mfma_f32_16x16x32_bf16 v[188:191], a[36:39], a[116:119], v[188:191]
    v_mfma_f32_16x16x32_bf16 v[192:195], a[40:43], a[104:107], v[192:195]
    ds_read_b64_tr_b16 a[36:37], v11 offset:14464
    v_mfma_f32_16x16x32_bf16 v[196:199], a[40:43], a[108:111], v[196:199]
    ds_read_b64_tr_b16 a[38:39], v11 offset:16256
    v_mfma_f32_16x16x32_bf16 v[200:203], a[40:43], a[112:115], v[200:203]
    buffer_load_dwordx4 a[88:91], v12, s[4:7], s27 offen sc1
    v_mfma_f32_16x16x32_bf16 v[204:207], a[40:43], a[116:119], v[204:207]
    v_mfma_f32_16x16x32_bf16 v[208:211], a[44:47], a[104:107], v[208:211]
    ds_read_b64_tr_b16 a[40:41], v11 offset:160
    v_mfma_f32_16x16x32_bf16 v[212:215], a[44:47], a[108:111], v[212:215]
    ds_read_b64_tr_b16 a[42:43], v11 offset:1952
    v_mfma_f32_16x16x32_bf16 v[216:219], a[44:47], a[112:115], v[216:219]
    buffer_load_dwordx4 a[92:95], v13, s[4:7], s27 offen sc1
    v_mfma_f32_16x16x32_bf16 v[220:223], a[44:47], a[116:119], v[220:223]
    buffer_load_dwordx4 a[96:99], v14, s[4:7], s27 offen sc1
    v_mfma_f32_16x16x32_bf16 v[224:227], a[48:51], a[104:107], v[224:227]
    ds_read_b64_tr_b16 a[44:45], v11 offset:14496
    v_mfma_f32_16x16x32_bf16 v[228:231], a[48:51], a[108:111], v[228:231]
    ds_read_b64_tr_b16 a[46:47], v11 offset:16288
    v_mfma_f32_16x16x32_bf16 v[232:235], a[48:51], a[112:115], v[232:235]
    buffer_load_dwordx4 a[100:103], v15, s[4:7], s27 offen sc1
    v_mfma_f32_16x16x32_bf16 v[236:239], a[48:51], a[116:119], v[236:239]
    v_mfma_f32_16x16x32_bf16 v[240:243], a[52:55], a[104:107], v[240:243]
    ds_read_b64_tr_b16 a[48:49], v11 offset:192
    v_mfma_f32_16x16x32_bf16 v[244:247], a[52:55], a[108:111], v[244:247]
    ds_read_b64_tr_b16 a[50:51], v11 offset:1984
    v_mfma_f32_16x16x32_bf16 v[248:251], a[52:55], a[112:115], v[248:251]
    s_add_u32 s27, s27, 151552
    v_mfma_f32_16x16x32_bf16 v[252:255], a[52:55], a[116:119], v[252:255]
    s_waitcnt vmcnt(15) lgkmcnt(12)
    v_mfma_f32_16x16x32_bf16 v[32:35], a[0:3], a[56:59], v[32:35]
    ds_read_b64_tr_b16 a[52:53], v11 offset:14528
    v_mfma_f32_16x16x32_bf16 v[36:39], a[0:3], a[60:63], v[36:39]
    ds_read_b64_tr_b16 a[54:55], v11 offset:16320
    v_mfma_f32_16x16x32_bf16 v[40:43], a[0:3], a[64:67], v[40:43]
    s_add_u32 m0, s52, 0
    s_nop 0
    buffer_load_dwordx4 v3, s[28:31], s51 offen lds
    v_mfma_f32_16x16x32_bf16 v[44:47], a[0:3], a[68:71], v[44:47]
    v_accvgpr_read_b32 v16, a152
    v_mfma_f32_16x16x32_bf16 v[48:51], a[4:7], a[56:59], v[48:51]
    ds_read_b64_tr_b16 a[0:1], v11 offset:7168
    v_mfma_f32_16x16x32_bf16 v[52:55], a[4:7], a[60:63], v[52:55]
    ds_read_b64_tr_b16 a[2:3], v11 offset:8960
    v_mfma_f32_16x16x32_bf16 v[56:59], a[4:7], a[64:67], v[56:59]
    s_add_u32 m0, s52, 1024
    v_mfma_f32_16x16x32_bf16 v[60:63], a[4:7], a[68:71], v[60:63]
    buffer_load_dwordx4 v4, s[28:31], s51 offen lds
    v_mfma_f32_16x16x32_bf16 v[64:67], a[8:11], a[56:59], v[64:67]
    ds_read_b64_tr_b16 a[4:5], v11 offset:21504
    v_mfma_f32_16x16x32_bf16 v[68:71], a[8:11], a[60:63], v[68:71]
    ds_read_b64_tr_b16 a[6:7], v11 offset:23296
    v_mfma_f32_16x16x32_bf16 v[72:75], a[8:11], a[64:67], v[72:75]
    s_add_u32 m0, s52, 2048
    v_mfma_f32_16x16x32_bf16 v[76:79], a[8:11], a[68:71], v[76:79]
    v_accvgpr_read_b32 v17, a153
    v_mfma_f32_16x16x32_bf16 v[80:83], a[12:15], a[56:59], v[80:83]
    ds_read_b64_tr_b16 a[8:9], v11 offset:7200
    v_mfma_f32_16x16x32_bf16 v[84:87], a[12:15], a[60:63], v[84:87]
    ds_read_b64_tr_b16 a[10:11], v11 offset:8992
    v_mfma_f32_16x16x32_bf16 v[88:91], a[12:15], a[64:67], v[88:91]
    buffer_load_dwordx4 v5, s[28:31], s51 offen lds
    v_mfma_f32_16x16x32_bf16 v[92:95], a[12:15], a[68:71], v[92:95]
    s_add_u32 m0, s52, 3072
    v_mfma_f32_16x16x32_bf16 v[96:99], a[16:19], a[56:59], v[96:99]
    ds_read_b64_tr_b16 a[12:13], v11 offset:21536
    v_mfma_f32_16x16x32_bf16 v[100:103], a[16:19], a[60:63], v[100:103]
    ds_read_b64_tr_b16 a[14:15], v11 offset:23328
    v_mfma_f32_16x16x32_bf16 v[104:107], a[16:19], a[64:67], v[104:107]
    buffer_load_dwordx4 v6, s[28:31], s51 offen lds
    v_mfma_f32_16x16x32_bf16 v[108:111], a[16:19], a[68:71], v[108:111]
    v_accvgpr_read_b32 v18, a154
    v_mfma_f32_16x16x32_bf16 v[112:115], a[20:23], a[56:59], v[112:115]
    ds_read_b64_tr_b16 a[16:17], v11 offset:7232
    v_mfma_f32_16x16x32_bf16 v[116:119], a[20:23], a[60:63], v[116:119]
    ds_read_b64_tr_b16 a[18:19], v11 offset:9024
    v_mfma_f32_16x16x32_bf16 v[120:123], a[20:23], a[64:67], v[120:123]
    s_add_u32 m0, s52, 4096
    s_nop 0
    buffer_load_dwordx4 v7, s[28:31], s51 offen lds
    v_mfma_f32_16x16x32_bf16 v[124:127], a[20:23], a[68:71], v[124:127]
    v_accvgpr_read_b32 v19, a155
    v_mfma_f32_16x16x32_bf16 v[128:131], a[24:27], a[56:59], v[128:131]
    ds_read_b64_tr_b16 a[20:21], v11 offset:21568
    v_mfma_f32_16x16x32_bf16 v[132:135], a[24:27], a[60:63], v[132:135]
    ds_read_b64_tr_b16 a[22:23], v11 offset:23360
    v_mfma_f32_16x16x32_bf16 v[136:139], a[24:27], a[64:67], v[136:139]
    s_add_u32 m0, s52, 5120
    v_mfma_f32_16x16x32_bf16 v[140:143], a[24:27], a[68:71], v[140:143]
    s_waitcnt lgkmcnt(12)
    v_mfma_f32_16x16x32_bf16 v[144:147], a[28:31], a[56:59], v[144:147]
    ds_read_b64_tr_b16 a[24:25], v11 offset:7264
    v_mfma_f32_16x16x32_bf16 v[148:151], a[28:31], a[60:63], v[148:151]
    ds_read_b64_tr_b16 a[26:27], v11 offset:9056
    v_mfma_f32_16x16x32_bf16 v[152:155], a[28:31], a[64:67], v[152:155]
    buffer_load_dwordx4 v8, s[28:31], s51 offen lds
    s_add_u32 m0, s52, 6144
    v_mfma_f32_16x16x32_bf16 v[156:159], a[28:31], a[68:71], v[156:159]
    v_add_f32 v16, v16, v18
    v_mfma_f32_16x16x32_bf16 v[160:163], a[32:35], a[56:59], v[160:163]
    ds_read_b64_tr_b16 a[28:29], v11 offset:21600
    v_mfma_f32_16x16x32_bf16 v[164:167], a[32:35], a[60:63], v[164:167]
    ds_read_b64_tr_b16 a[30:31], v11 offset:23392
    v_mfma_f32_16x16x32_bf16 v[168:171], a[32:35], a[64:67], v[168:171]
    buffer_load_dwordx4 v9, s[28:31], s51 offen lds
    v_mfma_f32_16x16x32_bf16 v[172:175], a[32:35], a[68:71], v[172:175]
    s_add_u32 s51, s51, s55
    v_mfma_f32_16x16x32_bf16 v[176:179], a[36:39], a[56:59], v[176:179]
    ds_read_b64_tr_b16 a[32:33], v11 offset:7296
    v_mfma_f32_16x16x32_bf16 v[180:183], a[36:39], a[60:63], v[180:183]
    ds_read_b64_tr_b16 a[34:35], v11 offset:9088
    v_mfma_f32_16x16x32_bf16 v[184:187], a[36:39], a[64:67], v[184:187]
    s_add_u32 s52, s52, 28672
    v_mfma_f32_16x16x32_bf16 v[188:191], a[36:39], a[68:71], v[188:191]
    v_add_f32 v17, v17, v19
    v_mfma_f32_16x16x32_bf16 v[192:195], a[40:43], a[56:59], v[192:195]
    ds_read_b64_tr_b16 a[36:37], v11 offset:21632
    v_mfma_f32_16x16x32_bf16 v[196:199], a[40:43], a[60:63], v[196:199]
    ds_read_b64_tr_b16 a[38:39], v11 offset:23424
    v_mfma_f32_16x16x32_bf16 v[200:203], a[40:43], a[64:67], v[200:203]
    s_cmp_eq_u32 s52, s54
    s_cselect_b32 s52, s53, s52
    v_mfma_f32_16x16x32_bf16 v[204:207], a[40:43], a[68:71], v[204:207]
    buffer_load_dwordx4 a[104:107], v12, s[4:7], s27 offen sc1
    v_mfma_f32_16x16x32_bf16 v[208:211], a[44:47], a[56:59], v[208:211]
    ds_read_b64_tr_b16 a[40:41], v11 offset:7328
    v_mfma_f32_16x16x32_bf16 v[212:215], a[44:47], a[60:63], v[212:215]
    ds_read_b64_tr_b16 a[42:43], v11 offset:9120
    v_mfma_f32_16x16x32_bf16 v[216:219], a[44:47], a[64:67], v[216:219]
    buffer_load_dwordx4 a[108:111], v13, s[4:7], s27 offen sc1
    v_mfma_f32_16x16x32_bf16 v[220:223], a[44:47], a[68:71], v[220:223]
    v_lshlrev_b32 v18, 2, v0
    v_mfma_f32_16x16x32_bf16 v[224:227], a[48:51], a[56:59], v[224:227]
    ds_read_b64_tr_b16 a[44:45], v11 offset:21664
    v_mfma_f32_16x16x32_bf16 v[228:231], a[48:51], a[60:63], v[228:231]
    ds_read_b64_tr_b16 a[46:47], v11 offset:23456
    v_mfma_f32_16x16x32_bf16 v[232:235], a[48:51], a[64:67], v[232:235]
    buffer_load_dwordx4 a[112:115], v14, s[4:7], s27 offen sc1
    s_add_u32 s37, s37, 28672
    v_mfma_f32_16x16x32_bf16 v[236:239], a[48:51], a[68:71], v[236:239]
    v_add_u32 v18, 0, v18
    v_mfma_f32_16x16x32_bf16 v[240:243], a[52:55], a[56:59], v[240:243]
    ds_read_b64_tr_b16 a[48:49], v11 offset:7360
    v_mfma_f32_16x16x32_bf16 v[244:247], a[52:55], a[60:63], v[244:247]
    ds_read_b64_tr_b16 a[50:51], v11 offset:9152
    v_mfma_f32_16x16x32_bf16 v[248:251], a[52:55], a[64:67], v[248:251]
    s_cmp_eq_u32 s37, 139264
    s_cselect_b32 s37, 24576, s37
    v_mfma_f32_16x16x32_bf16 v[252:255], a[52:55], a[68:71], v[252:255]
    s_waitcnt vmcnt(14) lgkmcnt(12)
    v_mfma_f32_16x16x32_bf16 v[32:35], a[0:3], a[72:75], v[32:35]
    ds_read_b64_tr_b16 a[52:53], v11 offset:21696
    v_mfma_f32_16x16x32_bf16 v[36:39], a[0:3], a[76:79], v[36:39]
    ds_read_b64_tr_b16 a[54:55], v11 offset:23488
    v_mfma_f32_16x16x32_bf16 v[40:43], a[0:3], a[80:83], v[40:43]
    ds_write_b32 v18, v16
    v_mfma_f32_16x16x32_bf16 v[44:47], a[0:3], a[84:87], v[44:47]
    s_barrier
    v_add_u32 v11, s37, v10
    v_mfma_f32_16x16x32_bf16 v[48:51], a[4:7], a[72:75], v[48:51]
    ds_read_b64_tr_b16 a[0:1], v11 offset:0
    v_mfma_f32_16x16x32_bf16 v[52:55], a[4:7], a[76:79], v[52:55]
    ds_read_b64_tr_b16 a[2:3], v11 offset:1792
    v_mfma_f32_16x16x32_bf16 v[56:59], a[4:7], a[80:83], v[56:59]
    buffer_load_dwordx4 a[116:119], v15, s[4:7], s27 offen sc1
    v_mfma_f32_16x16x32_bf16 v[60:63], a[4:7], a[84:87], v[60:63]
    ds_write_b32 v18, v17 offset:1024
    v_mfma_f32_16x16x32_bf16 v[64:67], a[8:11], a[72:75], v[64:67]
    ds_read_b64_tr_b16 a[4:5], v11 offset:14336
    v_mfma_f32_16x16x32_bf16 v[68:71], a[8:11], a[76:79], v[68:71]
    ds_read_b64_tr_b16 a[6:7], v11 offset:16128
    v_mfma_f32_16x16x32_bf16 v[72:75], a[8:11], a[80:83], v[72:75]
    s_add_u32 s27, s27, 151552
    v_mfma_f32_16x16x32_bf16 v[76:79], a[8:11], a[84:87], v[76:79]
    buffer_load_dwordx4 a[56:59], v12, s[4:7], s27 offen sc1
    v_mfma_f32_16x16x32_bf16 v[80:83], a[12:15], a[72:75], v[80:83]
    ds_read_b64_tr_b16 a[8:9], v11 offset:32
    v_mfma_f32_16x16x32_bf16 v[84:87], a[12:15], a[76:79], v[84:87]
    ds_read_b64_tr_b16 a[10:11], v11 offset:1824
    v_mfma_f32_16x16x32_bf16 v[88:91], a[12:15], a[80:83], v[88:91]
    buffer_load_dwordx4 a[60:63], v13, s[4:7], s27 offen sc1
    v_mfma_f32_16x16x32_bf16 v[92:95], a[12:15], a[84:87], v[92:95]
    v_accvgpr_read_b32 v16, a120
    v_mfma_f32_16x16x32_bf16 v[96:99], a[16:19], a[72:75], v[96:99]
    ds_read_b64_tr_b16 a[12:13], v11 offset:14368
    v_mfma_f32_16x16x32_bf16 v[100:103], a[16:19], a[76:79], v[100:103]
    ds_read_b64_tr_b16 a[14:15], v11 offset:16160
    v_mfma_f32_16x16x32_bf16 v[104:107], a[16:19], a[80:83], v[104:107]
    buffer_load_dwordx4 a[64:67], v14, s[4:7], s27 offen sc1
    v_mfma_f32_16x16x32_bf16 v[108:111], a[16:19], a[84:87], v[108:111]
    v_accvgpr_read_b32 v17, a121
    v_mfma_f32_16x16x32_bf16 v[112:115], a[20:23], a[72:75], v[112:115]
    ds_read_b64_tr_b16 a[16:17], v11 offset:64
    v_mfma_f32_16x16x32_bf16 v[116:119], a[20:23], a[76:79], v[116:119]
    ds_read_b64_tr_b16 a[18:19], v11 offset:1856
    v_mfma_f32_16x16x32_bf16 v[120:123], a[20:23], a[80:83], v[120:123]
    buffer_load_dwordx4 a[68:71], v15, s[4:7], s27 offen sc1
    v_mfma_f32_16x16x32_bf16 v[124:127], a[20:23], a[84:87], v[124:127]
    v_accvgpr_read_b32 v18, a122
    v_mfma_f32_16x16x32_bf16 v[128:131], a[24:27], a[72:75], v[128:131]
    ds_read_b64_tr_b16 a[20:21], v11 offset:14400
    v_mfma_f32_16x16x32_bf16 v[132:135], a[24:27], a[76:79], v[132:135]
    ds_read_b64_tr_b16 a[22:23], v11 offset:16192
    v_mfma_f32_16x16x32_bf16 v[136:139], a[24:27], a[80:83], v[136:139]
    s_add_u32 s27, s27, 151552
    v_mfma_f32_16x16x32_bf16 v[140:143], a[24:27], a[84:87], v[140:143]
    s_waitcnt lgkmcnt(14)
    s_add_u32 m0, s52, 0
    v_mfma_f32_16x16x32_bf16 v[144:147], a[28:31], a[72:75], v[144:147]
    ds_read_b64_tr_b16 a[24:25], v11 offset:96
    v_mfma_f32_16x16x32_bf16 v[148:151], a[28:31], a[76:79], v[148:151]
    ds_read_b64_tr_b16 a[26:27], v11 offset:1888
    v_mfma_f32_16x16x32_bf16 v[152:155], a[28:31], a[80:83], v[152:155]
    buffer_load_dwordx4 v3, s[28:31], s51 offen lds
    v_mfma_f32_16x16x32_bf16 v[156:159], a[28:31], a[84:87], v[156:159]
    v_accvgpr_read_b32 v19, a123
    v_mfma_f32_16x16x32_bf16 v[160:163], a[32:35], a[72:75], v[160:163]
    ds_read_b64_tr_b16 a[28:29], v11 offset:14432
    v_mfma_f32_16x16x32_bf16 v[164:167], a[32:35], a[76:79], v[164:167]
    ds_read_b64_tr_b16 a[30:31], v11 offset:16224
    v_mfma_f32_16x16x32_bf16 v[168:171], a[32:35], a[80:83], v[168:171]
    s_add_u32 m0, s52, 1024
    v_mfma_f32_16x16x32_bf16 v[172:175], a[32:35], a[84:87], v[172:175]
    v_accvgpr_read_b32 v20, a124
    v_mfma_f32_16x16x32_bf16 v[176:179], a[36:39], a[72:75], v[176:179]
    ds_read_b64_tr_b16 a[32:33], v11 offset:128
    v_mfma_f32_16x16x32_bf16 v[180:183], a[36:39], a[76:79], v[180:183]
    ds_read_b64_tr_b16 a[34:35], v11 offset:1920
    v_mfma_f32_16x16x32_bf16 v[184:187], a[36:39], a[80:83], v[184:187]
    buffer_load_dwordx4 v4, s[28:31], s51 offen lds
    v_mfma_f32_16x16x32_bf16 v[188:191], a[36:39], a[84:87], v[188:191]
    v_accvgpr_read_b32 v21, a125
    v_mfma_f32_16x16x32_bf16 v[192:195], a[40:43], a[72:75], v[192:195]
    ds_read_b64_tr_b16 a[36:37], v11 offset:14464
    v_mfma_f32_16x16x32_bf16 v[196:199], a[40:43], a[76:79], v[196:199]
    ds_read_b64_tr_b16 a[38:39], v11 offset:16256
    v_mfma_f32_16x16x32_bf16 v[200:203], a[40:43], a[80:83], v[200:203]
    s_add_u32 m0, s52, 2048
    v_mfma_f32_16x16x32_bf16 v[204:207], a[40:43], a[84:87], v[204:207]
    buffer_load_dwordx4 v5, s[28:31], s51 offen lds
    v_mfma_f32_16x16x32_bf16 v[208:211], a[44:47], a[72:75], v[208:211]
    ds_read_b64_tr_b16 a[40:41], v11 offset:160
    v_mfma_f32_16x16x32_bf16 v[212:215], a[44:47], a[76:79], v[212:215]
    ds_read_b64_tr_b16 a[42:43], v11 offset:1952
    v_mfma_f32_16x16x32_bf16 v[216:219], a[44:47], a[80:83], v[216:219]
    s_add_u32 m0, s52, 3072
    v_mfma_f32_16x16x32_bf16 v[220:223], a[44:47], a[84:87], v[220:223]
    v_accvgpr_read_b32 v22, a126
    v_mfma_f32_16x16x32_bf16 v[224:227], a[48:51], a[72:75], v[224:227]
    ds_read_b64_tr_b16 a[44:45], v11 offset:14496
    v_mfma_f32_16x16x32_bf16 v[228:231], a[48:51], a[76:79], v[228:231]
    ds_read_b64_tr_b16 a[46:47], v11 offset:16288
    v_mfma_f32_16x16x32_bf16 v[232:235], a[48:51], a[80:83], v[232:235]
    buffer_load_dwordx4 v6, s[28:31], s51 offen lds
    v_mfma_f32_16x16x32_bf16 v[236:239], a[48:51], a[84:87], v[236:239]
    v_accvgpr_read_b32 v23, a127
    v_mfma_f32_16x16x32_bf16 v[240:243], a[52:55], a[72:75], v[240:243]
    ds_read_b64_tr_b16 a[48:49], v11 offset:192
    v_mfma_f32_16x16x32_bf16 v[244:247], a[52:55], a[76:79], v[244:247]
    ds_read_b64_tr_b16 a[50:51], v11 offset:1984
    v_mfma_f32_16x16x32_bf16 v[248:251], a[52:55], a[80:83], v[248:251]
    buffer_load_dword a156, v2, s[68:71], 0 offen
    v_mfma_f32_16x16x32_bf16 v[252:255], a[52:55], a[84:87], v[252:255]
    s_waitcnt vmcnt(20) lgkmcnt(12)
    v_mfma_f32_16x16x32_bf16 v[32:35], a[0:3], a[88:91], v[32:35]
    ds_read_b64_tr_b16 a[52:53], v11 offset:14528
    v_mfma_f32_16x16x32_bf16 v[36:39], a[0:3], a[92:95], v[36:39]
    ds_read_b64_tr_b16 a[54:55], v11 offset:16320
    v_mfma_f32_16x16x32_bf16 v[40:43], a[0:3], a[96:99], v[40:43]
    s_add_u32 m0, s52, 4096
    v_mfma_f32_16x16x32_bf16 v[44:47], a[0:3], a[100:103], v[44:47]
    buffer_load_dwordx4 v7, s[28:31], s51 offen lds
    v_mfma_f32_16x16x32_bf16 v[48:51], a[4:7], a[88:91], v[48:51]
    ds_read_b64_tr_b16 a[0:1], v11 offset:7168
    v_mfma_f32_16x16x32_bf16 v[52:55], a[4:7], a[92:95], v[52:55]
    ds_read_b64_tr_b16 a[2:3], v11 offset:8960
    v_mfma_f32_16x16x32_bf16 v[56:59], a[4:7], a[96:99], v[56:59]
    v_add_f32 v24, v16, v18
    v_mfma_f32_16x16x32_bf16 v[60:63], a[4:7], a[100:103], v[60:63]
    s_add_u32 m0, s52, 5120
    v_mfma_f32_16x16x32_bf16 v[64:67], a[8:11], a[88:91], v[64:67]
    ds_read_b64_tr_b16 a[4:5], v11 offset:21504
    v_mfma_f32_16x16x32_bf16 v[68:71], a[8:11], a[92:95], v[68:71]
    ds_read_b64_tr_b16 a[6:7], v11 offset:23296
    v_mfma_f32_16x16x32_bf16 v[72:75], a[8:11], a[96:99], v[72:75]
    buffer_load_dwordx4 v8, s[28:31], s51 offen lds
    v_mfma_f32_16x16x32_bf16 v[76:79], a[8:11], a[100:103], v[76:79]
    v_add_f32 v25, v17, v19
    v_mfma_f32_16x16x32_bf16 v[80:83], a[12:15], a[88:91], v[80:83]
    ds_read_b64_tr_b16 a[8:9], v11 offset:7200
    v_mfma_f32_16x16x32_bf16 v[84:87], a[12:15], a[92:95], v[84:87]
    ds_read_b64_tr_b16 a[10:11], v11 offset:8992
    v_mfma_f32_16x16x32_bf16 v[88:91], a[12:15], a[96:99], v[88:91]
    s_add_u32 m0, s52, 6144
    v_mfma_f32_16x16x32_bf16 v[92:95], a[12:15], a[100:103], v[92:95]
    v_add_f32 v24, v24, v20
    v_mfma_f32_16x16x32_bf16 v[96:99], a[16:19], a[88:91], v[96:99]
    ds_read_b64_tr_b16 a[12:13], v11 offset:21536
    v_mfma_f32_16x16x32_bf16 v[100:103], a[16:19], a[92:95], v[100:103]
    ds_read_b64_tr_b16 a[14:15], v11 offset:23328
    v_mfma_f32_16x16x32_bf16 v[104:107], a[16:19], a[96:99], v[104:107]
    buffer_load_dwordx4 v9, s[28:31], s51 offen lds
    v_mfma_f32_16x16x32_bf16 v[108:111], a[16:19], a[100:103], v[108:111]
    v_add_f32 v25, v25, v21
    v_mfma_f32_16x16x32_bf16 v[112:115], a[20:23], a[88:91], v[112:115]
    ds_read_b64_tr_b16 a[16:17], v11 offset:7232
    v_mfma_f32_16x16x32_bf16 v[116:119], a[20:23], a[92:95], v[116:119]
    ds_read_b64_tr_b16 a[18:19], v11 offset:9024
    v_mfma_f32_16x16x32_bf16 v[120:123], a[20:23], a[96:99], v[120:123]
    s_add_u32 s51, s51, s55
    v_mfma_f32_16x16x32_bf16 v[124:127], a[20:23], a[100:103], v[124:127]
    v_add_f32 v24, v24, v22
    v_mfma_f32_16x16x32_bf16 v[128:131], a[24:27], a[88:91], v[128:131]
    ds_read_b64_tr_b16 a[20:21], v11 offset:21568
    v_mfma_f32_16x16x32_bf16 v[132:135], a[24:27], a[92:95], v[132:135]
    ds_read_b64_tr_b16 a[22:23], v11 offset:23360
    v_mfma_f32_16x16x32_bf16 v[136:139], a[24:27], a[96:99], v[136:139]
    s_add_u32 s52, s52, 28672
    v_mfma_f32_16x16x32_bf16 v[140:143], a[24:27], a[100:103], v[140:143]
    s_waitcnt lgkmcnt(12)
    v_mfma_f32_16x16x32_bf16 v[144:147], a[28:31], a[88:91], v[144:147]
    ds_read_b64_tr_b16 a[24:25], v11 offset:7264
    v_mfma_f32_16x16x32_bf16 v[148:151], a[28:31], a[92:95], v[148:151]
    ds_read_b64_tr_b16 a[26:27], v11 offset:9056
    v_mfma_f32_16x16x32_bf16 v[152:155], a[28:31], a[96:99], v[152:155]
    s_cmp_eq_u32 s52, s54
    s_cselect_b32 s52, s53, s52
    v_mfma_f32_16x16x32_bf16 v[156:159], a[28:31], a[100:103], v[156:159]
    buffer_load_dwordx4 a[72:75], v12, s[4:7], s27 offen sc1
    v_mfma_f32_16x16x32_bf16 v[160:163], a[32:35], a[88:91], v[160:163]
    ds_read_b64_tr_b16 a[28:29], v11 offset:21600
    v_mfma_f32_16x16x32_bf16 v[164:167], a[32:35], a[92:95], v[164:167]
    ds_read_b64_tr_b16 a[30:31], v11 offset:23392
    v_mfma_f32_16x16x32_bf16 v[168:171], a[32:35], a[96:99], v[168:171]
    v_add_f32 v25, v25, v23
    v_mfma_f32_16x16x32_bf16 v[172:175], a[32:35], a[100:103], v[172:175]
    buffer_load_dwordx4 a[76:79], v13, s[4:7], s27 offen sc1
    v_mfma_f32_16x16x32_bf16 v[176:179], a[36:39], a[88:91], v[176:179]
    ds_read_b64_tr_b16 a[32:33], v11 offset:7296
    v_mfma_f32_16x16x32_bf16 v[180:183], a[36:39], a[92:95], v[180:183]
    ds_read_b64_tr_b16 a[34:35], v11 offset:9088
    v_mfma_f32_16x16x32_bf16 v[184:187], a[36:39], a[96:99], v[184:187]
    buffer_load_dwordx4 a[80:83], v14, s[4:7], s27 offen sc1
    v_mfma_f32_16x16x32_bf16 v[188:191], a[36:39], a[100:103], v[188:191]
    v_mov_b32 v17, v24
    v_mfma_f32_16x16x32_bf16 v[192:195], a[40:43], a[88:91], v[192:195]
    ds_read_b64_tr_b16 a[36:37], v11 offset:21632
    v_mfma_f32_16x16x32_bf16 v[196:199], a[40:43], a[92:95], v[196:199]
    ds_read_b64_tr_b16 a[38:39], v11 offset:23424
    v_mfma_f32_16x16x32_bf16 v[200:203], a[40:43], a[96:99], v[200:203]
    buffer_load_dwordx4 a[84:87], v15, s[4:7], s27 offen sc1
    v_mfma_f32_16x16x32_bf16 v[204:207], a[40:43], a[100:103], v[204:207]
    v_permlane16_swap_b32 v24, v17
    v_mfma_f32_16x16x32_bf16 v[208:211], a[44:47], a[88:91], v[208:211]
    ds_read_b64_tr_b16 a[40:41], v11 offset:7328
    v_mfma_f32_16x16x32_bf16 v[212:215], a[44:47], a[92:95], v[212:215]
    ds_read_b64_tr_b16 a[42:43], v11 offset:9120
    v_mfma_f32_16x16x32_bf16 v[216:219], a[44:47], a[96:99], v[216:219]
    s_add_u32 s27, s27, 151552
    v_mfma_f32_16x16x32_bf16 v[220:223], a[44:47], a[100:103], v[220:223]
    v_add_f32 v24, v24, v17
    v_mfma_f32_16x16x32_bf16 v[224:227], a[48:51], a[88:91], v[224:227]
    ds_read_b64_tr_b16 a[44:45], v11 offset:21664
    v_mfma_f32_16x16x32_bf16 v[228:231], a[48:51], a[92:95], v[228:231]
    ds_read_b64_tr_b16 a[46:47], v11 offset:23456
    v_mfma_f32_16x16x32_bf16 v[232:235], a[48:51], a[96:99], v[232:235]
    s_add_u32 s37, s37, 28672
    v_mfma_f32_16x16x32_bf16 v[236:239], a[48:51], a[100:103], v[236:239]
    v_mov_b32 v17, v24
    v_mfma_f32_16x16x32_bf16 v[240:243], a[52:55], a[88:91], v[240:243]
    ds_read_b64_tr_b16 a[48:49], v11 offset:7360
    v_mfma_f32_16x16x32_bf16 v[244:247], a[52:55], a[92:95], v[244:247]
    ds_read_b64_tr_b16 a[50:51], v11 offset:9152
    v_mfma_f32_16x16x32_bf16 v[248:251], a[52:55], a[96:99], v[248:251]
    s_cmp_eq_u32 s37, 139264
    s_cselect_b32 s37, 24576, s37
    v_mfma_f32_16x16x32_bf16 v[252:255], a[52:55], a[100:103], v[252:255]
    s_waitcnt vmcnt(16) lgkmcnt(12)
    v_mfma_f32_16x16x32_bf16 v[32:35], a[0:3], a[104:107], v[32:35]
    ds_read_b64_tr_b16 a[52:53], v11 offset:21696
    v_mfma_f32_16x16x32_bf16 v[36:39], a[0:3], a[108:111], v[36:39]
    ds_read_b64_tr_b16 a[54:55], v11 offset:23488
    v_mfma_f32_16x16x32_bf16 v[40:43], a[0:3], a[112:115], v[40:43]
    v_permlane32_swap_b32 v24, v17
    v_mfma_f32_16x16x32_bf16 v[44:47], a[0:3], a[116:119], v[44:47]
    s_barrier
    v_add_u32 v11, s37, v10
    v_mfma_f32_16x16x32_bf16 v[48:51], a[4:7], a[104:107], v[48:51]
    ds_read_b64_tr_b16 a[0:1], v11 offset:0
    v_mfma_f32_16x16x32_bf16 v[52:55], a[4:7], a[108:111], v[52:55]
    ds_read_b64_tr_b16 a[2:3], v11 offset:1792
    v_mfma_f32_16x16x32_bf16 v[56:59], a[4:7], a[112:115], v[56:59]
    buffer_load_dwordx4 a[88:91], v12, s[4:7], s27 offen sc1
    v_mfma_f32_16x16x32_bf16 v[60:63], a[4:7], a[116:119], v[60:63]
    v_add_f32 v24, v24, v17
    v_mfma_f32_16x16x32_bf16 v[64:67], a[8:11], a[104:107], v[64:67]
    ds_read_b64_tr_b16 a[4:5], v11 offset:14336
    v_mfma_f32_16x16x32_bf16 v[68:71], a[8:11], a[108:111], v[68:71]
    ds_read_b64_tr_b16 a[6:7], v11 offset:16128
    v_mfma_f32_16x16x32_bf16 v[72:75], a[8:11], a[112:115], v[72:75]
    buffer_load_dwordx4 a[92:95], v13, s[4:7], s27 offen sc1
    v_mfma_f32_16x16x32_bf16 v[76:79], a[8:11], a[116:119], v[76:79]
    v_mul_f32 v17, 0x3d800000, v24
    v_mfma_f32_16x16x32_bf16 v[80:83], a[12:15], a[104:107], v[80:83]
    ds_read_b64_tr_b16 a[8:9], v11 offset:32
    v_mfma_f32_16x16x32_bf16 v[84:87], a[12:15], a[108:111], v[84:87]
    ds_read_b64_tr_b16 a[10:11], v11 offset:1824
    v_mfma_f32_16x16x32_bf16 v[88:91], a[12:15], a[112:115], v[88:91]
    buffer_load_dwordx4 a[96:99], v14, s[4:7], s27 offen sc1
    v_mfma_f32_16x16x32_bf16 v[92:95], a[12:15], a[116:119], v[92:95]
    v_sub_f32 v16, v16, v17
    v_mfma_f32_16x16x32_bf16 v[96:99], a[16:19], a[104:107], v[96:99]
    ds_read_b64_tr_b16 a[12:13], v11 offset:14368
    v_mfma_f32_16x16x32_bf16 v[100:103], a[16:19], a[108:111], v[100:103]
    ds_read_b64_tr_b16 a[14:15], v11 offset:16160
    v_mfma_f32_16x16x32_bf16 v[104:107], a[16:19], a[112:115], v[104:107]
    buffer_load_dwordx4 a[100:103], v15, s[4:7], s27 offen sc1
    v_mfma_f32_16x16x32_bf16 v[108:111], a[16:19], a[116:119], v[108:111]
    v_sub_f32 v18, v18, v17
    v_mfma_f32_16x16x32_bf16 v[112:115], a[20:23], a[104:107], v[112:115]
    ds_read_b64_tr_b16 a[16:17], v11 offset:64
    v_mfma_f32_16x16x32_bf16 v[116:119], a[20:23], a[108:111], v[116:119]
    ds_read_b64_tr_b16 a[18:19], v11 offset:1856
    v_mfma_f32_16x16x32_bf16 v[120:123], a[20:23], a[112:115], v[120:123]
    s_add_u32 s27, s27, 151552
    v_mfma_f32_16x16x32_bf16 v[124:127], a[20:23], a[116:119], v[124:127]
    v_sub_f32 v20, v20, v17
    v_mfma_f32_16x16x32_bf16 v[128:131], a[24:27], a[104:107], v[128:131]
    ds_read_b64_tr_b16 a[20:21], v11 offset:14400
    v_mfma_f32_16x16x32_bf16 v[132:135], a[24:27], a[108:111], v[132:135]
    ds_read_b64_tr_b16 a[22:23], v11 offset:16192
    v_mfma_f32_16x16x32_bf16 v[136:139], a[24:27], a[112:115], v[136:139]
    s_add_u32 m0, s52, 0
    v_mfma_f32_16x16x32_bf16 v[140:143], a[24:27], a[116:119], v[140:143]
    s_waitcnt lgkmcnt(12)
    v_mfma_f32_16x16x32_bf16 v[144:147], a[28:31], a[104:107], v[144:147]
    ds_read_b64_tr_b16 a[24:25], v11 offset:96
    v_mfma_f32_16x16x32_bf16 v[148:151], a[28:31], a[108:111], v[148:151]
    ds_read_b64_tr_b16 a[26:27], v11 offset:1888
    v_mfma_f32_16x16x32_bf16 v[152:155], a[28:31], a[112:115], v[152:155]
    buffer_load_dwordx4 v3, s[28:31], s51 offen lds
    v_mfma_f32_16x16x32_bf16 v[156:159], a[28:31], a[116:119], v[156:159]
    v_sub_f32 v22, v22, v17
    v_mfma_f32_16x16x32_bf16 v[160:163], a[32:35], a[104:107], v[160:163]
    ds_read_b64_tr_b16 a[28:29], v11 offset:14432
    v_mfma_f32_16x16x32_bf16 v[164:167], a[32:35], a[108:111], v[164:167]
    ds_read_b64_tr_b16 a[30:31], v11 offset:16224
    v_mfma_f32_16x16x32_bf16 v[168:171], a[32:35], a[112:115], v[168:171]
    s_add_u32 m0, s52, 1024
    v_mfma_f32_16x16x32_bf16 v[172:175], a[32:35], a[116:119], v[172:175]
    v_mul_f32 v17, v16, v16
    v_mfma_f32_16x16x32_bf16 v[176:179], a[36:39], a[104:107], v[176:179]
    ds_read_b64_tr_b16 a[32:33], v11 offset:128
    v_fmac_f32 v17, v18, v18
    v_mfma_f32_16x16x32_bf16 v[180:183], a[36:39], a[108:111], v[180:183]
    ds_read_b64_tr_b16 a[34:35], v11 offset:1920
    v_fmac_f32 v17, v20, v20
    v_mfma_f32_16x16x32_bf16 v[184:187], a[36:39], a[112:115], v[184:187]
    buffer_load_dwordx4 v4, s[28:31], s51 offen lds
    v_mfma_f32_16x16x32_bf16 v[188:191], a[36:39], a[116:119], v[188:191]
    v_fmac_f32 v17, v22, v22
    v_mfma_f32_16x16x32_bf16 v[192:195], a[40:43], a[104:107], v[192:195]
    ds_read_b64_tr_b16 a[36:37], v11 offset:14464
    v_fmac_f32 v25, 0x3c800000, v17
    v_mfma_f32_16x16x32_bf16 v[196:199], a[40:43], a[108:111], v[196:199]
    ds_read_b64_tr_b16 a[38:39], v11 offset:16256
    v_mfma_f32_16x16x32_bf16 v[200:203], a[40:43], a[112:115], v[200:203]
    s_add_u32 m0, s52, 2048
    v_mfma_f32_16x16x32_bf16 v[204:207], a[40:43], a[116:119], v[204:207]
    v_mov_b32 v17, v25
    v_mfma_f32_16x16x32_bf16 v[208:211], a[44:47], a[104:107], v[208:211]
    ds_read_b64_tr_b16 a[40:41], v11 offset:160
    v_mfma_f32_16x16x32_bf16 v[212:215], a[44:47], a[108:111], v[212:215]
    ds_read_b64_tr_b16 a[42:43], v11 offset:1952
    v_mfma_f32_16x16x32_bf16 v[216:219], a[44:47], a[112:115], v[216:219]
    buffer_load_dwordx4 v5, s[28:31], s51 offen lds
    v_mfma_f32_16x16x32_bf16 v[220:223], a[44:47], a[116:119], v[220:223]
    v_permlane16_swap_b32 v25, v17
    v_mfma_f32_16x16x32_bf16 v[224:227], a[48:51], a[104:107], v[224:227]
    ds_read_b64_tr_b16 a[44:45], v11 offset:14496
    v_mfma_f32_16x16x32_bf16 v[228:231], a[48:51], a[108:111], v[228:231]
    ds_read_b64_tr_b16 a[46:47], v11 offset:16288
    v_mfma_f32_16x16x32_bf16 v[232:235], a[48:51], a[112:115], v[232:235]
    s_add_u32 m0, s52, 3072
    v_mfma_f32_16x16x32_bf16 v[236:239], a[48:51], a[116:119], v[236:239]
    v_add_f32 v25, v25, v17
    v_mfma_f32_16x16x32_bf16 v[240:243], a[52:55], a[104:107], v[240:243]
    ds_read_b64_tr_b16 a[48:49], v11 offset:192
    v_mfma_f32_16x16x32_bf16 v[244:247], a[52:55], a[108:111], v[244:247]
    ds_read_b64_tr_b16 a[50:51], v11 offset:1984
    v_mfma_f32_16x16x32_bf16 v[248:251], a[52:55], a[112:115], v[248:251]
    buffer_load_dwordx4 v6, s[28:31], s51 offen lds
    v_mfma_f32_16x16x32_bf16 v[252:255], a[52:55], a[116:119], v[252:255]
    s_waitcnt vmcnt(20) lgkmcnt(12)
    v_mfma_f32_16x16x32_bf16 v[32:35], a[0:3], a[56:59], v[32:35]
    ds_read_b64_tr_b16 a[52:53], v11 offset:14528
    v_mfma_f32_16x16x32_bf16 v[36:39], a[0:3], a[60:63], v[36:39]
    ds_read_b64_tr_b16 a[54:55], v11 offset:16320
    v_mfma_f32_16x16x32_bf16 v[40:43], a[0:3], a[64:67], v[40:43]
    s_add_u32 m0, s52, 4096
    v_mfma_f32_16x16x32_bf16 v[44:47], a[0:3], a[68:71], v[44:47]
    buffer_load_dwordx4 v7, s[28:31], s51 offen lds
    v_mfma_f32_16x16x32_bf16 v[48:51], a[4:7], a[56:59], v[48:51]
    ds_read_b64_tr_b16 a[0:1], v11 offset:7168
    v_mfma_f32_16x16x32_bf16 v[52:55], a[4:7], a[60:63], v[52:55]
    ds_read_b64_tr_b16 a[2:3], v11 offset:8960
    v_mfma_f32_16x16x32_bf16 v[56:59], a[4:7], a[64:67], v[56:59]
    v_mov_b32 v17, v25
    v_mfma_f32_16x16x32_bf16 v[60:63], a[4:7], a[68:71], v[60:63]
    s_add_u32 m0, s52, 5120
    v_mfma_f32_16x16x32_bf16 v[64:67], a[8:11], a[56:59], v[64:67]
    ds_read_b64_tr_b16 a[4:5], v11 offset:21504
    v_mfma_f32_16x16x32_bf16 v[68:71], a[8:11], a[60:63], v[68:71]
    ds_read_b64_tr_b16 a[6:7], v11 offset:23296
    v_mfma_f32_16x16x32_bf16 v[72:75], a[8:11], a[64:67], v[72:75]
    buffer_load_dwordx4 v8, s[28:31], s51 offen lds
    v_mfma_f32_16x16x32_bf16 v[76:79], a[8:11], a[68:71], v[76:79]
    v_permlane32_swap_b32 v25, v17
    v_mfma_f32_16x16x32_bf16 v[80:83], a[12:15], a[56:59], v[80:83]
    ds_read_b64_tr_b16 a[8:9], v11 offset:7200
    v_mfma_f32_16x16x32_bf16 v[84:87], a[12:15], a[60:63], v[84:87]
    ds_read_b64_tr_b16 a[10:11], v11 offset:8992
    v_mfma_f32_16x16x32_bf16 v[88:91], a[12:15], a[64:67], v[88:91]
    s_add_u32 m0, s52, 6144
    v_mfma_f32_16x16x32_bf16 v[92:95], a[12:15], a[68:71], v[92:95]
    v_add_f32 v25, v25, v17
    v_mfma_f32_16x16x32_bf16 v[96:99], a[16:19], a[56:59], v[96:99]
    ds_read_b64_tr_b16 a[12:13], v11 offset:21536
    v_mfma_f32_16x16x32_bf16 v[100:103], a[16:19], a[60:63], v[100:103]
    ds_read_b64_tr_b16 a[14:15], v11 offset:23328
    v_mfma_f32_16x16x32_bf16 v[104:107], a[16:19], a[64:67], v[104:107]
    buffer_load_dwordx4 v9, s[28:31], s51 offen lds
    v_mfma_f32_16x16x32_bf16 v[108:111], a[16:19], a[68:71], v[108:111]
    v_mov_b32 v17, 0x3727c5ac
    v_mfma_f32_16x16x32_bf16 v[112:115], a[20:23], a[56:59], v[112:115]
    ds_read_b64_tr_b16 a[16:17], v11 offset:7232
    v_fmac_f32 v17, 0x3a800000, v25
    v_mfma_f32_16x16x32_bf16 v[116:119], a[20:23], a[60:63], v[116:119]
    ds_read_b64_tr_b16 a[18:19], v11 offset:9024
    v_mfma_f32_16x16x32_bf16 v[120:123], a[20:23], a[64:67], v[120:123]
    s_add_u32 s51, s51, s55
    v_mfma_f32_16x16x32_bf16 v[124:127], a[20:23], a[68:71], v[124:127]
    v_mul_f32 v24, 0xba800000, v24
    v_mfma_f32_16x16x32_bf16 v[128:131], a[24:27], a[56:59], v[128:131]
    ds_read_b64_tr_b16 a[20:21], v11 offset:21568
    v_mfma_f32_16x16x32_bf16 v[132:135], a[24:27], a[60:63], v[132:135]
    ds_read_b64_tr_b16 a[22:23], v11 offset:23360
    v_mfma_f32_16x16x32_bf16 v[136:139], a[24:27], a[64:67], v[136:139]
    s_add_u32 s52, s52, 28672
    v_mfma_f32_16x16x32_bf16 v[140:143], a[24:27], a[68:71], v[140:143]
    s_waitcnt lgkmcnt(12)
    v_mfma_f32_16x16x32_bf16 v[144:147], a[28:31], a[56:59], v[144:147]
    ds_read_b64_tr_b16 a[24:25], v11 offset:7264
    v_mfma_f32_16x16x32_bf16 v[148:151], a[28:31], a[60:63], v[148:151]
    ds_read_b64_tr_b16 a[26:27], v11 offset:9056
    v_mfma_f32_16x16x32_bf16 v[152:155], a[28:31], a[64:67], v[152:155]
    s_cmp_eq_u32 s52, s54
    s_cselect_b32 s52, s53, s52
    v_mfma_f32_16x16x32_bf16 v[156:159], a[28:31], a[68:71], v[156:159]
    buffer_load_dwordx4 a[104:107], v12, s[4:7], s27 offen sc1
    v_mfma_f32_16x16x32_bf16 v[160:163], a[32:35], a[56:59], v[160:163]
    ds_read_b64_tr_b16 a[28:29], v11 offset:21600
    v_mfma_f32_16x16x32_bf16 v[164:167], a[32:35], a[60:63], v[164:167]
    ds_read_b64_tr_b16 a[30:31], v11 offset:23392
    v_mfma_f32_16x16x32_bf16 v[168:171], a[32:35], a[64:67], v[168:171]
    v_sqrt_f32 v25, v17
    v_mfma_f32_16x16x32_bf16 v[172:175], a[32:35], a[68:71], v[172:175]
    buffer_load_dwordx4 a[108:111], v13, s[4:7], s27 offen sc1
    v_mfma_f32_16x16x32_bf16 v[176:179], a[36:39], a[56:59], v[176:179]
    ds_read_b64_tr_b16 a[32:33], v11 offset:7296
    v_mfma_f32_16x16x32_bf16 v[180:183], a[36:39], a[60:63], v[180:183]
    ds_read_b64_tr_b16 a[34:35], v11 offset:9088
    v_mfma_f32_16x16x32_bf16 v[184:187], a[36:39], a[64:67], v[184:187]
    buffer_load_dwordx4 a[112:115], v14, s[4:7], s27 offen sc1
    v_mfma_f32_16x16x32_bf16 v[188:191], a[36:39], a[68:71], v[188:191]
    v_accvgpr_read_b32 v16, a128
    v_mfma_f32_16x16x32_bf16 v[192:195], a[40:43], a[56:59], v[192:195]
    ds_read_b64_tr_b16 a[36:37], v11 offset:21632
    v_mfma_f32_16x16x32_bf16 v[196:199], a[40:43], a[60:63], v[196:199]
    ds_read_b64_tr_b16 a[38:39], v11 offset:23424
    v_mfma_f32_16x16x32_bf16 v[200:203], a[40:43], a[64:67], v[200:203]
    buffer_load_dwordx4 a[116:119], v15, s[4:7], s27 offen sc1
    v_mfma_f32_16x16x32_bf16 v[204:207], a[40:43], a[68:71], v[204:207]
    v_accvgpr_read_b32 v17, a129
    v_mfma_f32_16x16x32_bf16 v[208:211], a[44:47], a[56:59], v[208:211]
    ds_read_b64_tr_b16 a[40:41], v11 offset:7328
    v_mfma_f32_16x16x32_bf16 v[212:215], a[44:47], a[60:63], v[212:215]
    ds_read_b64_tr_b16 a[42:43], v11 offset:9120
    v_mfma_f32_16x16x32_bf16 v[216:219], a[44:47], a[64:67], v[216:219]
    s_add_u32 s27, s27, 151552
    v_mfma_f32_16x16x32_bf16 v[220:223], a[44:47], a[68:71], v[220:223]
    v_accvgpr_read_b32 v18, a130
    v_mfma_f32_16x16x32_bf16 v[224:227], a[48:51], a[56:59], v[224:227]
    ds_read_b64_tr_b16 a[44:45], v11 offset:21664
    v_mfma_f32_16x16x32_bf16 v[228:231], a[48:51], a[60:63], v[228:231]
    ds_read_b64_tr_b16 a[46:47], v11 offset:23456
    v_mfma_f32_16x16x32_bf16 v[232:235], a[48:51], a[64:67], v[232:235]
    s_add_u32 s37, s37, 28672
    v_mfma_f32_16x16x32_bf16 v[236:239], a[48:51], a[68:71], v[236:239]
    v_accvgpr_read_b32 v19, a131
    v_mfma_f32_16x16x32_bf16 v[240:243], a[52:55], a[56:59], v[240:243]
    ds_read_b64_tr_b16 a[48:49], v11 offset:7360
    v_mfma_f32_16x16x32_bf16 v[244:247], a[52:55], a[60:63], v[244:247]
    ds_read_b64_tr_b16 a[50:51], v11 offset:9152
    v_mfma_f32_16x16x32_bf16 v[248:251], a[52:55], a[64:67], v[248:251]
    s_cmp_eq_u32 s37, 139264
    s_cselect_b32 s37, 24576, s37
    v_mfma_f32_16x16x32_bf16 v[252:255], a[52:55], a[68:71], v[252:255]
    s_waitcnt vmcnt(15) lgkmcnt(12)
    v_mfma_f32_16x16x32_bf16 v[32:35], a[0:3], a[72:75], v[32:35]
    ds_read_b64_tr_b16 a[52:53], v11 offset:21696
    v_mfma_f32_16x16x32_bf16 v[36:39], a[0:3], a[76:79], v[36:39]
    ds_read_b64_tr_b16 a[54:55], v11 offset:23488
    v_mfma_f32_16x16x32_bf16 v[40:43], a[0:3], a[80:83], v[40:43]
    v_accvgpr_read_b32 v20, a132
    v_mfma_f32_16x16x32_bf16 v[44:47], a[0:3], a[84:87], v[44:47]
    s_barrier
    v_add_u32 v11, s37, v10
    v_mfma_f32_16x16x32_bf16 v[48:51], a[4:7], a[72:75], v[48:51]
    ds_read_b64_tr_b16 a[0:1], v11 offset:0
    v_mfma_f32_16x16x32_bf16 v[52:55], a[4:7], a[76:79], v[52:55]
    ds_read_b64_tr_b16 a[2:3], v11 offset:1792
    v_mfma_f32_16x16x32_bf16 v[56:59], a[4:7], a[80:83], v[56:59]
    buffer_load_dwordx4 a[56:59], v12, s[4:7], s27 offen sc1
    v_mfma_f32_16x16x32_bf16 v[60:63], a[4:7], a[84:87], v[60:63]
    v_accvgpr_read_b32 v21, a133
    v_mfma_f32_16x16x32_bf16 v[64:67], a[8:11], a[72:75], v[64:67]
    ds_read_b64_tr_b16 a[4:5], v11 offset:14336
    v_mfma_f32_16x16x32_bf16 v[68:71], a[8:11], a[76:79], v[68:71]
    ds_read_b64_tr_b16 a[6:7], v11 offset:16128
    v_mfma_f32_16x16x32_bf16 v[72:75], a[8:11], a[80:83], v[72:75]
    buffer_load_dwordx4 a[60:63], v13, s[4:7], s27 offen sc1
    v_mfma_f32_16x16x32_bf16 v[76:79], a[8:11], a[84:87], v[76:79]
    v_accvgpr_read_b32 v22, a134
    v_mfma_f32_16x16x32_bf16 v[80:83], a[12:15], a[72:75], v[80:83]
    ds_read_b64_tr_b16 a[8:9], v11 offset:32
    v_mfma_f32_16x16x32_bf16 v[84:87], a[12:15], a[76:79], v[84:87]
    ds_read_b64_tr_b16 a[10:11], v11 offset:1824
    v_mfma_f32_16x16x32_bf16 v[88:91], a[12:15], a[80:83], v[88:91]
    buffer_load_dwordx4 a[64:67], v14, s[4:7], s27 offen sc1
    v_mfma_f32_16x16x32_bf16 v[92:95], a[12:15], a[84:87], v[92:95]
    buffer_load_dwordx4 a[68:71], v15, s[4:7], s27 offen sc1
    v_mfma_f32_16x16x32_bf16 v[96:99], a[16:19], a[72:75], v[96:99]
    ds_read_b64_tr_b16 a[12:13], v11 offset:14368
    v_mfma_f32_16x16x32_bf16 v[100:103], a[16:19], a[76:79], v[100:103]
    ds_read_b64_tr_b16 a[14:15], v11 offset:16160
    v_mfma_f32_16x16x32_bf16 v[104:107], a[16:19], a[80:83], v[104:107]
    v_accvgpr_read_b32 v23, a135
    v_mfma_f32_16x16x32_bf16 v[108:111], a[16:19], a[84:87], v[108:111]
    s_add_u32 s27, s27, 151552
    v_mfma_f32_16x16x32_bf16 v[112:115], a[20:23], a[72:75], v[112:115]
    ds_read_b64_tr_b16 a[16:17], v11 offset:64
    v_mfma_f32_16x16x32_bf16 v[116:119], a[20:23], a[76:79], v[116:119]
    ds_read_b64_tr_b16 a[18:19], v11 offset:1856
    v_mfma_f32_16x16x32_bf16 v[120:123], a[20:23], a[80:83], v[120:123]
    v_add_f32 v26, v16, v18
    v_mfma_f32_16x16x32_bf16 v[124:127], a[20:23], a[84:87], v[124:127]
    s_add_u32 m0, s52, 0
    v_mfma_f32_16x16x32_bf16 v[128:131], a[24:27], a[72:75], v[128:131]
    ds_read_b64_tr_b16 a[20:21], v11 offset:14400
    v_mfma_f32_16x16x32_bf16 v[132:135], a[24:27], a[76:79], v[132:135]
    ds_read_b64_tr_b16 a[22:23], v11 offset:16192
    v_mfma_f32_16x16x32_bf16 v[136:139], a[24:27], a[80:83], v[136:139]
    buffer_load_dwordx4 v3, s[28:31], s51 offen lds
    v_mfma_f32_16x16x32_bf16 v[140:143], a[24:27], a[84:87], v[140:143]
    s_waitcnt lgkmcnt(12)
    v_mfma_f32_16x16x32_bf16 v[144:147], a[28:31], a[72:75], v[144:147]
    ds_read_b64_tr_b16 a[24:25], v11 offset:96
    v_mfma_f32_16x16x32_bf16 v[148:151], a[28:31], a[76:79], v[148:151]
    ds_read_b64_tr_b16 a[26:27], v11 offset:1888
    v_mfma_f32_16x16x32_bf16 v[152:155], a[28:31], a[80:83], v[152:155]
    s_add_u32 m0, s52, 1024
    v_mfma_f32_16x16x32_bf16 v[156:159], a[28:31], a[84:87], v[156:159]
    v_add_f32 v27, v17, v19
    v_mfma_f32_16x16x32_bf16 v[160:163], a[32:35], a[72:75], v[160:163]
    ds_read_b64_tr_b16 a[28:29], v11 offset:14432
    v_mfma_f32_16x16x32_bf16 v[164:167], a[32:35], a[76:79], v[164:167]
    ds_read_b64_tr_b16 a[30:31], v11 offset:16224
    v_mfma_f32_16x16x32_bf16 v[168:171], a[32:35], a[80:83], v[168:171]
    buffer_load_dwordx4 v4, s[28:31], s51 offen lds
    v_mfma_f32_16x16x32_bf16 v[172:175], a[32:35], a[84:87], v[172:175]
    v_add_f32 v26, v26, v20
    v_mfma_f32_16x16x32_bf16 v[176:179], a[36:39], a[72:75], v[176:179]
    ds_read_b64_tr_b16 a[32:33], v11 offset:128
    v_mfma_f32_16x16x32_bf16 v[180:183], a[36:39], a[76:79], v[180:183]
    ds_read_b64_tr_b16 a[34:35], v11 offset:1920
    v_mfma_f32_16x16x32_bf16 v[184:187], a[36:39], a[80:83], v[184:187]
    s_add_u32 m0, s52, 2048
    v_mfma_f32_16x16x32_bf16 v[188:191], a[36:39], a[84:87], v[188:191]
    v_add_f32 v27, v27, v21
    v_mfma_f32_16x16x32_bf16 v[192:195], a[40:43], a[72:75], v[192:195]
    ds_read_b64_tr_b16 a[36:37], v11 offset:14464
    v_mfma_f32_16x16x32_bf16 v[196:199], a[40:43], a[76:79], v[196:199]
    ds_read_b64_tr_b16 a[38:39], v11 offset:16256
    v_mfma_f32_16x16x32_bf16 v[200:203], a[40:43], a[80:83], v[200:203]
    buffer_load_dwordx4 v5, s[28:31], s51 offen lds
    v_mfma_f32_16x16x32_bf16 v[204:207], a[40:43], a[84:87], v[204:207]
    v_add_f32 v26, v26, v22
    v_mfma_f32_16x16x32_bf16 v[208:211], a[44:47], a[72:75], v[208:211]
    ds_read_b64_tr_b16 a[40:41], v11 offset:160
    v_mfma_f32_16x16x32_bf16 v[212:215], a[44:47], a[76:79], v[212:215]
    ds_read_b64_tr_b16 a[42:43], v11 offset:1952
    v_mfma_f32_16x16x32_bf16 v[216:219], a[44:47], a[80:83], v[216:219]
    s_add_u32 m0, s52, 3072
    v_mfma_f32_16x16x32_bf16 v[220:223], a[44:47], a[84:87], v[220:223]
    v_add_f32 v27, v27, v23
    v_mfma_f32_16x16x32_bf16 v[224:227], a[48:51], a[72:75], v[224:227]
    ds_read_b64_tr_b16 a[44:45], v11 offset:14496
    v_mfma_f32_16x16x32_bf16 v[228:231], a[48:51], a[76:79], v[228:231]
    ds_read_b64_tr_b16 a[46:47], v11 offset:16288
    v_mfma_f32_16x16x32_bf16 v[232:235], a[48:51], a[80:83], v[232:235]
    buffer_load_dwordx4 v6, s[28:31], s51 offen lds
    v_mov_b32 v17, v26
    v_mfma_f32_16x16x32_bf16 v[236:239], a[48:51], a[84:87], v[236:239]
    s_nop 0
    v_permlane16_swap_b32 v26, v17
    v_mfma_f32_16x16x32_bf16 v[240:243], a[52:55], a[72:75], v[240:243]
    ds_read_b64_tr_b16 a[48:49], v11 offset:192
    v_add_f32 v26, v26, v17
    v_mfma_f32_16x16x32_bf16 v[244:247], a[52:55], a[76:79], v[244:247]
    ds_read_b64_tr_b16 a[50:51], v11 offset:1984
    v_mov_b32 v17, v26
    v_mfma_f32_16x16x32_bf16 v[248:251], a[52:55], a[80:83], v[248:251]
    buffer_load_dword a156, v2, s[68:71], 0 offen
    v_permlane32_swap_b32 v26, v17
    v_mfma_f32_16x16x32_bf16 v[252:255], a[52:55], a[84:87], v[252:255]
    s_waitcnt vmcnt(20) lgkmcnt(12)
    v_add_f32 v26, v26, v17
    v_mfma_f32_16x16x32_bf16 v[32:35], a[0:3], a[88:91], v[32:35]
    ds_read_b64_tr_b16 a[52:53], v11 offset:14528
    v_mul_f32 v17, 0x3d800000, v26
    v_mfma_f32_16x16x32_bf16 v[36:39], a[0:3], a[92:95], v[36:39]
    ds_read_b64_tr_b16 a[54:55], v11 offset:16320
    v_sub_f32 v16, v16, v17
    v_mfma_f32_16x16x32_bf16 v[40:43], a[0:3], a[96:99], v[40:43]
    s_add_u32 m0, s52, 4096
    v_sub_f32 v18, v18, v17
    v_mfma_f32_16x16x32_bf16 v[44:47], a[0:3], a[100:103], v[44:47]
    buffer_load_dwordx4 v7, s[28:31], s51 offen lds
    v_sub_f32 v20, v20, v17
    v_mfma_f32_16x16x32_bf16 v[48:51], a[4:7], a[88:91], v[48:51]
    ds_read_b64_tr_b16 a[0:1], v11 offset:7168
    v_sub_f32 v22, v22, v17
    v_mfma_f32_16x16x32_bf16 v[52:55], a[4:7], a[92:95], v[52:55]
    ds_read_b64_tr_b16 a[2:3], v11 offset:8960
    v_mul_f32 v17, v16, v16
    v_mfma_f32_16x16x32_bf16 v[56:59], a[4:7], a[96:99], v[56:59]
    v_fmac_f32 v17, v18, v18
    v_mfma_f32_16x16x32_bf16 v[60:63], a[4:7], a[100:103], v[60:63]
    s_add_u32 m0, s52, 5120
    v_fmac_f32 v17, v20, v20
    v_mfma_f32_16x16x32_bf16 v[64:67], a[8:11], a[88:91], v[64:67]
    ds_read_b64_tr_b16 a[4:5], v11 offset:21504
    v_fmac_f32 v17, v22, v22
    v_mfma_f32_16x16x32_bf16 v[68:71], a[8:11], a[92:95], v[68:71]
    ds_read_b64_tr_b16 a[6:7], v11 offset:23296
    v_fmac_f32 v27, 0x3c800000, v17
    v_mfma_f32_16x16x32_bf16 v[72:75], a[8:11], a[96:99], v[72:75]
    buffer_load_dwordx4 v8, s[28:31], s51 offen lds
    v_mov_b32 v17, v27
    v_mfma_f32_16x16x32_bf16 v[76:79], a[8:11], a[100:103], v[76:79]
    s_nop 0
    v_permlane16_swap_b32 v27, v17
    v_mfma_f32_16x16x32_bf16 v[80:83], a[12:15], a[88:91], v[80:83]
    ds_read_b64_tr_b16 a[8:9], v11 offset:7200
    v_add_f32 v27, v27, v17
    v_mfma_f32_16x16x32_bf16 v[84:87], a[12:15], a[92:95], v[84:87]
    ds_read_b64_tr_b16 a[10:11], v11 offset:8992
    v_mov_b32 v17, v27
    v_mfma_f32_16x16x32_bf16 v[88:91], a[12:15], a[96:99], v[88:91]
    s_add_u32 m0, s52, 6144
    v_permlane32_swap_b32 v27, v17
    v_mfma_f32_16x16x32_bf16 v[92:95], a[12:15], a[100:103], v[92:95]
    v_add_f32 v27, v27, v17
    v_mfma_f32_16x16x32_bf16 v[96:99], a[16:19], a[88:91], v[96:99]
    ds_read_b64_tr_b16 a[12:13], v11 offset:21536
    v_mov_b32 v17, 0x3727c5ac
    v_mfma_f32_16x16x32_bf16 v[100:103], a[16:19], a[92:95], v[100:103]
    ds_read_b64_tr_b16 a[14:15], v11 offset:23328
    v_fmac_f32 v17, 0x3a800000, v27
    v_mfma_f32_16x16x32_bf16 v[104:107], a[16:19], a[96:99], v[104:107]
    buffer_load_dwordx4 v9, s[28:31], s51 offen lds
    v_mul_f32 v26, 0xba800000, v26
    v_mfma_f32_16x16x32_bf16 v[108:111], a[16:19], a[100:103], v[108:111]
    v_sqrt_f32 v27, v17
    v_mfma_f32_16x16x32_bf16 v[112:115], a[20:23], a[88:91], v[112:115]
    ds_read_b64_tr_b16 a[16:17], v11 offset:7232
    v_accvgpr_read_b32 v16, a136
    v_mfma_f32_16x16x32_bf16 v[116:119], a[20:23], a[92:95], v[116:119]
    ds_read_b64_tr_b16 a[18:19], v11 offset:9024
    v_accvgpr_read_b32 v17, a137
    v_mfma_f32_16x16x32_bf16 v[120:123], a[20:23], a[96:99], v[120:123]
    s_add_u32 s51, s51, s55
    v_accvgpr_read_b32 v18, a138
    v_mfma_f32_16x16x32_bf16 v[124:127], a[20:23], a[100:103], v[124:127]
    v_accvgpr_read_b32 v19, a139
    v_mfma_f32_16x16x32_bf16 v[128:131], a[24:27], a[88:91], v[128:131]
    ds_read_b64_tr_b16 a[20:21], v11 offset:21568
    v_accvgpr_read_b32 v20, a140
    v_mfma_f32_16x16x32_bf16 v[132:135], a[24:27], a[92:95], v[132:135]
    ds_read_b64_tr_b16 a[22:23], v11 offset:23360
    v_accvgpr_read_b32 v21, a141
    v_mfma_f32_16x16x32_bf16 v[136:139], a[24:27], a[96:99], v[136:139]
    s_add_u32 s52, s52, 28672
    v_accvgpr_read_b32 v22, a142
    v_mfma_f32_16x16x32_bf16 v[140:143], a[24:27], a[100:103], v[140:143]
    s_waitcnt lgkmcnt(12)
    v_accvgpr_read_b32 v23, a143
    v_mfma_f32_16x16x32_bf16 v[144:147], a[28:31], a[88:91], v[144:147]
    ds_read_b64_tr_b16 a[24:25], v11 offset:7264
    v_add_f32 v28, v16, v18
    v_mfma_f32_16x16x32_bf16 v[148:151], a[28:31], a[92:95], v[148:151]
    ds_read_b64_tr_b16 a[26:27], v11 offset:9056
    v_add_f32 v29, v17, v19
    v_mfma_f32_16x16x32_bf16 v[152:155], a[28:31], a[96:99], v[152:155]
    s_cmp_eq_u32 s52, s54
    s_cselect_b32 s52, s53, s52
    v_add_f32 v28, v28, v20
    v_mfma_f32_16x16x32_bf16 v[156:159], a[28:31], a[100:103], v[156:159]
    buffer_load_dwordx4 a[72:75], v12, s[4:7], s27 offen sc1
    v_add_f32 v29, v29, v21
    v_mfma_f32_16x16x32_bf16 v[160:163], a[32:35], a[88:91], v[160:163]
    ds_read_b64_tr_b16 a[28:29], v11 offset:21600
    v_add_f32 v28, v28, v22
    v_mfma_f32_16x16x32_bf16 v[164:167], a[32:35], a[92:95], v[164:167]
    ds_read_b64_tr_b16 a[30:31], v11 offset:23392
    v_add_f32 v29, v29, v23
    v_mfma_f32_16x16x32_bf16 v[168:171], a[32:35], a[96:99], v[168:171]
    v_mov_b32 v17, v28
    v_mfma_f32_16x16x32_bf16 v[172:175], a[32:35], a[100:103], v[172:175]
    buffer_load_dwordx4 a[76:79], v13, s[4:7], s27 offen sc1
    v_permlane16_swap_b32 v28, v17
    v_mfma_f32_16x16x32_bf16 v[176:179], a[36:39], a[88:91], v[176:179]
    ds_read_b64_tr_b16 a[32:33], v11 offset:7296
    v_add_f32 v28, v28, v17
    v_mfma_f32_16x16x32_bf16 v[180:183], a[36:39], a[92:95], v[180:183]
    ds_read_b64_tr_b16 a[34:35], v11 offset:9088
    v_mov_b32 v17, v28
    v_mfma_f32_16x16x32_bf16 v[184:187], a[36:39], a[96:99], v[184:187]
    buffer_load_dwordx4 a[80:83], v14, s[4:7], s27 offen sc1
    v_permlane32_swap_b32 v28, v17
    v_mfma_f32_16x16x32_bf16 v[188:191], a[36:39], a[100:103], v[188:191]
    v_add_f32 v28, v28, v17
    v_mfma_f32_16x16x32_bf16 v[192:195], a[40:43], a[88:91], v[192:195]
    ds_read_b64_tr_b16 a[36:37], v11 offset:21632
    v_mul_f32 v17, 0x3d800000, v28
    v_mfma_f32_16x16x32_bf16 v[196:199], a[40:43], a[92:95], v[196:199]
    ds_read_b64_tr_b16 a[38:39], v11 offset:23424
    v_sub_f32 v16, v16, v17
    v_mfma_f32_16x16x32_bf16 v[200:203], a[40:43], a[96:99], v[200:203]
    buffer_load_dwordx4 a[84:87], v15, s[4:7], s27 offen sc1
    v_sub_f32 v18, v18, v17
    v_mfma_f32_16x16x32_bf16 v[204:207], a[40:43], a[100:103], v[204:207]
    v_sub_f32 v20, v20, v17
    v_mfma_f32_16x16x32_bf16 v[208:211], a[44:47], a[88:91], v[208:211]
    ds_read_b64_tr_b16 a[40:41], v11 offset:7328
    v_sub_f32 v22, v22, v17
    v_mfma_f32_16x16x32_bf16 v[212:215], a[44:47], a[92:95], v[212:215]
    ds_read_b64_tr_b16 a[42:43], v11 offset:9120
    v_mul_f32 v17, v16, v16
    v_mfma_f32_16x16x32_bf16 v[216:219], a[44:47], a[96:99], v[216:219]
    s_add_u32 s27, s27, 151552
    v_fmac_f32 v17, v18, v18
    v_mfma_f32_16x16x32_bf16 v[220:223], a[44:47], a[100:103], v[220:223]
    v_fmac_f32 v17, v20, v20
    v_mfma_f32_16x16x32_bf16 v[224:227], a[48:51], a[88:91], v[224:227]
    ds_read_b64_tr_b16 a[44:45], v11 offset:21664
    v_fmac_f32 v17, v22, v22
    v_mfma_f32_16x16x32_bf16 v[228:231], a[48:51], a[92:95], v[228:231]
    ds_read_b64_tr_b16 a[46:47], v11 offset:23456
    v_fmac_f32 v29, 0x3c800000, v17
    v_mfma_f32_16x16x32_bf16 v[232:235], a[48:51], a[96:99], v[232:235]
    s_add_u32 s37, s37, 28672
    v_mov_b32 v17, v29
    v_mfma_f32_16x16x32_bf16 v[236:239], a[48:51], a[100:103], v[236:239]
    s_nop 0
    v_permlane16_swap_b32 v29, v17
    v_mfma_f32_16x16x32_bf16 v[240:243], a[52:55], a[88:91], v[240:243]
    ds_read_b64_tr_b16 a[48:49], v11 offset:7360
    v_add_f32 v29, v29, v17
    v_mfma_f32_16x16x32_bf16 v[244:247], a[52:55], a[92:95], v[244:247]
    ds_read_b64_tr_b16 a[50:51], v11 offset:9152
    v_mov_b32 v17, v29
    v_mfma_f32_16x16x32_bf16 v[248:251], a[52:55], a[96:99], v[248:251]
    s_cmp_eq_u32 s37, 139264
    s_cselect_b32 s37, 24576, s37
    v_permlane32_swap_b32 v29, v17
    v_mfma_f32_16x16x32_bf16 v[252:255], a[52:55], a[100:103], v[252:255]
    s_waitcnt vmcnt(16) lgkmcnt(12)
    v_add_f32 v29, v29, v17
    v_mfma_f32_16x16x32_bf16 v[32:35], a[0:3], a[104:107], v[32:35]
    ds_read_b64_tr_b16 a[52:53], v11 offset:21696
    v_mov_b32 v17, 0x3727c5ac
    v_mfma_f32_16x16x32_bf16 v[36:39], a[0:3], a[108:111], v[36:39]
    ds_read_b64_tr_b16 a[54:55], v11 offset:23488
    v_fmac_f32 v17, 0x3a800000, v29
    v_mfma_f32_16x16x32_bf16 v[40:43], a[0:3], a[112:115], v[40:43]
    v_mul_f32 v28, 0xba800000, v28
    v_mfma_f32_16x16x32_bf16 v[44:47], a[0:3], a[116:119], v[44:47]
    s_barrier
    v_add_u32 v11, s37, v10
    v_sqrt_f32 v29, v17
    v_mfma_f32_16x16x32_bf16 v[48:51], a[4:7], a[104:107], v[48:51]
    ds_read_b64_tr_b16 a[0:1], v11 offset:0
    v_accvgpr_read_b32 v16, a144
    v_mfma_f32_16x16x32_bf16 v[52:55], a[4:7], a[108:111], v[52:55]
    ds_read_b64_tr_b16 a[2:3], v11 offset:1792
    v_accvgpr_read_b32 v17, a145
    v_mfma_f32_16x16x32_bf16 v[56:59], a[4:7], a[112:115], v[56:59]
    buffer_load_dwordx4 a[88:91], v12, s[4:7], s27 offen sc1
    v_accvgpr_read_b32 v18, a146
    v_mfma_f32_16x16x32_bf16 v[60:63], a[4:7], a[116:119], v[60:63]
    v_accvgpr_read_b32 v19, a147
    v_mfma_f32_16x16x32_bf16 v[64:67], a[8:11], a[104:107], v[64:67]
    ds_read_b64_tr_b16 a[4:5], v11 offset:14336
    v_accvgpr_read_b32 v20, a148
    v_mfma_f32_16x16x32_bf16 v[68:71], a[8:11], a[108:111], v[68:71]
    ds_read_b64_tr_b16 a[6:7], v11 offset:16128
    v_accvgpr_read_b32 v21, a149
    v_mfma_f32_16x16x32_bf16 v[72:75], a[8:11], a[112:115], v[72:75]
    buffer_load_dwordx4 a[92:95], v13, s[4:7], s27 offen sc1
    v_accvgpr_read_b32 v22, a150
    v_mfma_f32_16x16x32_bf16 v[76:79], a[8:11], a[116:119], v[76:79]
    v_accvgpr_read_b32 v23, a151
    v_mfma_f32_16x16x32_bf16 v[80:83], a[12:15], a[104:107], v[80:83]
    ds_read_b64_tr_b16 a[8:9], v11 offset:32
    v_add_f32 v30, v16, v18
    v_mfma_f32_16x16x32_bf16 v[84:87], a[12:15], a[108:111], v[84:87]
    ds_read_b64_tr_b16 a[10:11], v11 offset:1824
    v_add_f32 v31, v17, v19
    v_mfma_f32_16x16x32_bf16 v[88:91], a[12:15], a[112:115], v[88:91]
    buffer_load_dwordx4 a[96:99], v14, s[4:7], s27 offen sc1
    v_add_f32 v30, v30, v20
    v_mfma_f32_16x16x32_bf16 v[92:95], a[12:15], a[116:119], v[92:95]
    v_add_f32 v31, v31, v21
    v_mfma_f32_16x16x32_bf16 v[96:99], a[16:19], a[104:107], v[96:99]
    ds_read_b64_tr_b16 a[12:13], v11 offset:14368
    v_add_f32 v30, v30, v22
    v_mfma_f32_16x16x32_bf16 v[100:103], a[16:19], a[108:111], v[100:103]
    ds_read_b64_tr_b16 a[14:15], v11 offset:16160
    v_add_f32 v31, v31, v23
    v_mfma_f32_16x16x32_bf16 v[104:107], a[16:19], a[112:115], v[104:107]
    buffer_load_dwordx4 a[100:103], v15, s[4:7], s27 offen sc1
    v_mov_b32 v17, v30
    v_mfma_f32_16x16x32_bf16 v[108:111], a[16:19], a[116:119], v[108:111]
    s_nop 0
    v_permlane16_swap_b32 v30, v17
    v_mfma_f32_16x16x32_bf16 v[112:115], a[20:23], a[104:107], v[112:115]
    ds_read_b64_tr_b16 a[16:17], v11 offset:64
    v_add_f32 v30, v30, v17
    v_mfma_f32_16x16x32_bf16 v[116:119], a[20:23], a[108:111], v[116:119]
    ds_read_b64_tr_b16 a[18:19], v11 offset:1856
    v_mov_b32 v17, v30
    v_mfma_f32_16x16x32_bf16 v[120:123], a[20:23], a[112:115], v[120:123]
    s_add_u32 s27, s27, 151552
    v_permlane32_swap_b32 v30, v17
    v_mfma_f32_16x16x32_bf16 v[124:127], a[20:23], a[116:119], v[124:127]
    v_add_f32 v30, v30, v17
    v_mfma_f32_16x16x32_bf16 v[128:131], a[24:27], a[104:107], v[128:131]
    ds_read_b64_tr_b16 a[20:21], v11 offset:14400
    v_mul_f32 v17, 0x3d800000, v30
    v_mfma_f32_16x16x32_bf16 v[132:135], a[24:27], a[108:111], v[132:135]
    ds_read_b64_tr_b16 a[22:23], v11 offset:16192
    v_sub_f32 v16, v16, v17
    v_mfma_f32_16x16x32_bf16 v[136:139], a[24:27], a[112:115], v[136:139]
    s_add_u32 m0, s52, 0
    v_sub_f32 v18, v18, v17
    v_mfma_f32_16x16x32_bf16 v[140:143], a[24:27], a[116:119], v[140:143]
    s_waitcnt lgkmcnt(12)
    v_sub_f32 v20, v20, v17
    v_mfma_f32_16x16x32_bf16 v[144:147], a[28:31], a[104:107], v[144:147]
    ds_read_b64_tr_b16 a[24:25], v11 offset:96
    v_sub_f32 v22, v22, v17
    v_mfma_f32_16x16x32_bf16 v[148:151], a[28:31], a[108:111], v[148:151]
    ds_read_b64_tr_b16 a[26:27], v11 offset:1888
    v_mul_f32 v17, v16, v16
    v_mfma_f32_16x16x32_bf16 v[152:155], a[28:31], a[112:115], v[152:155]
    buffer_load_dwordx4 v3, s[28:31], s51 offen lds
    v_fmac_f32 v17, v18, v18
    v_mfma_f32_16x16x32_bf16 v[156:159], a[28:31], a[116:119], v[156:159]
    v_fmac_f32 v17, v20, v20
    v_mfma_f32_16x16x32_bf16 v[160:163], a[32:35], a[104:107], v[160:163]
    ds_read_b64_tr_b16 a[28:29], v11 offset:14432
    v_fmac_f32 v17, v22, v22
    v_mfma_f32_16x16x32_bf16 v[164:167], a[32:35], a[108:111], v[164:167]
    ds_read_b64_tr_b16 a[30:31], v11 offset:16224
    v_fmac_f32 v31, 0x3c800000, v17
    v_mfma_f32_16x16x32_bf16 v[168:171], a[32:35], a[112:115], v[168:171]
    s_add_u32 m0, s52, 1024
    v_mov_b32 v17, v31
    v_mfma_f32_16x16x32_bf16 v[172:175], a[32:35], a[116:119], v[172:175]
    s_nop 0
    v_permlane16_swap_b32 v31, v17
    v_mfma_f32_16x16x32_bf16 v[176:179], a[36:39], a[104:107], v[176:179]
    ds_read_b64_tr_b16 a[32:33], v11 offset:128
    v_add_f32 v31, v31, v17
    v_mfma_f32_16x16x32_bf16 v[180:183], a[36:39], a[108:111], v[180:183]
    ds_read_b64_tr_b16 a[34:35], v11 offset:1920
    v_mov_b32 v17, v31
    v_mfma_f32_16x16x32_bf16 v[184:187], a[36:39], a[112:115], v[184:187]
    buffer_load_dwordx4 v4, s[28:31], s51 offen lds
    v_permlane32_swap_b32 v31, v17
    v_mfma_f32_16x16x32_bf16 v[188:191], a[36:39], a[116:119], v[188:191]
    v_add_f32 v31, v31, v17
    v_mfma_f32_16x16x32_bf16 v[192:195], a[40:43], a[104:107], v[192:195]
    ds_read_b64_tr_b16 a[36:37], v11 offset:14464
    v_mov_b32 v17, 0x3727c5ac
    v_mfma_f32_16x16x32_bf16 v[196:199], a[40:43], a[108:111], v[196:199]
    ds_read_b64_tr_b16 a[38:39], v11 offset:16256
    v_fmac_f32 v17, 0x3a800000, v31
    v_mfma_f32_16x16x32_bf16 v[200:203], a[40:43], a[112:115], v[200:203]
    s_add_u32 m0, s52, 2048
    v_mul_f32 v30, 0xba800000, v30
    v_mfma_f32_16x16x32_bf16 v[204:207], a[40:43], a[116:119], v[204:207]
    v_sqrt_f32 v31, v17
    v_mfma_f32_16x16x32_bf16 v[208:211], a[44:47], a[104:107], v[208:211]
    ds_read_b64_tr_b16 a[40:41], v11 offset:160
    v_lshrrev_b32 v0, 4, v1
    v_mfma_f32_16x16x32_bf16 v[212:215], a[44:47], a[108:111], v[212:215]
    ds_read_b64_tr_b16 a[42:43], v11 offset:1952
    v_lshlrev_b32 v0, 4, v0
    v_mfma_f32_16x16x32_bf16 v[216:219], a[44:47], a[112:115], v[216:219]
    buffer_load_dwordx4 v5, s[28:31], s51 offen lds
    v_add_u32 v0, 0, v0
    v_mfma_f32_16x16x32_bf16 v[220:223], a[44:47], a[116:119], v[220:223]
    v_mfma_f32_16x16x32_bf16 v[224:227], a[48:51], a[104:107], v[224:227]
    ds_read_b64_tr_b16 a[44:45], v11 offset:14496
    v_mfma_f32_16x16x32_bf16 v[228:231], a[48:51], a[108:111], v[228:231]
    ds_read_b64_tr_b16 a[46:47], v11 offset:16288
    v_mfma_f32_16x16x32_bf16 v[232:235], a[48:51], a[112:115], v[232:235]
    s_add_u32 m0, s52, 3072
    v_mfma_f32_16x16x32_bf16 v[236:239], a[48:51], a[116:119], v[236:239]
    ds_read_b128 v[16:19], v0 offset:0
    v_mfma_f32_16x16x32_bf16 v[240:243], a[52:55], a[104:107], v[240:243]
    ds_read_b64_tr_b16 a[48:49], v11 offset:192
    v_mfma_f32_16x16x32_bf16 v[244:247], a[52:55], a[108:111], v[244:247]
    ds_read_b64_tr_b16 a[50:51], v11 offset:1984
    v_mfma_f32_16x16x32_bf16 v[248:251], a[52:55], a[112:115], v[248:251]
    buffer_load_dwordx4 v6, s[28:31], s51 offen lds
    v_mfma_f32_16x16x32_bf16 v[252:255], a[52:55], a[116:119], v[252:255]
    s_waitcnt vmcnt(20) lgkmcnt(13)
    v_mfma_f32_16x16x32_bf16 v[32:35], a[0:3], a[56:59], v[32:35]
    ds_read_b64_tr_b16 a[52:53], v11 offset:14528
    ds_read_b128 v[20:23], v0 offset:1024
    v_mfma_f32_16x16x32_bf16 v[36:39], a[0:3], a[60:63], v[36:39]
    ds_read_b64_tr_b16 a[54:55], v11 offset:16320
    v_mfma_f32_16x16x32_bf16 v[40:43], a[0:3], a[64:67], v[40:43]
    s_add_u32 m0, s52, 4096
    v_mfma_f32_16x16x32_bf16 v[44:47], a[0:3], a[68:71], v[44:47]
    buffer_load_dwordx4 v7, s[28:31], s51 offen lds
    v_mfma_f32_16x16x32_bf16 v[48:51], a[4:7], a[56:59], v[48:51]
    ds_read_b64_tr_b16 a[0:1], v11 offset:7168
    v_mfma_f32_16x16x32_bf16 v[52:55], a[4:7], a[60:63], v[52:55]
    ds_read_b64_tr_b16 a[2:3], v11 offset:8960
    v_mfma_f32_16x16x32_bf16 v[56:59], a[4:7], a[64:67], v[56:59]
    v_mfma_f32_16x16x32_bf16 v[60:63], a[4:7], a[68:71], v[60:63]
    s_add_u32 m0, s52, 5120
    v_mfma_f32_16x16x32_bf16 v[64:67], a[8:11], a[56:59], v[64:67]
    ds_read_b64_tr_b16 a[4:5], v11 offset:21504
    v_mfma_f32_16x16x32_bf16 v[68:71], a[8:11], a[60:63], v[68:71]
    ds_read_b64_tr_b16 a[6:7], v11 offset:23296
    v_mfma_f32_16x16x32_bf16 v[72:75], a[8:11], a[64:67], v[72:75]
    buffer_load_dwordx4 v8, s[28:31], s51 offen lds
    v_mfma_f32_16x16x32_bf16 v[76:79], a[8:11], a[68:71], v[76:79]
    v_mfma_f32_16x16x32_bf16 v[80:83], a[12:15], a[56:59], v[80:83]
    ds_read_b64_tr_b16 a[8:9], v11 offset:7200
    s_waitcnt lgkmcnt(6)
    v_mfma_f32_16x16x32_bf16 v[84:87], a[12:15], a[60:63], v[84:87]
    ds_read_b64_tr_b16 a[10:11], v11 offset:8992
    v_fmac_f32 v32, v24, v16
    v_mfma_f32_16x16x32_bf16 v[88:91], a[12:15], a[64:67], v[88:91]
    s_add_u32 m0, s52, 6144
    v_fmac_f32 v33, v24, v17
    v_mfma_f32_16x16x32_bf16 v[92:95], a[12:15], a[68:71], v[92:95]
    v_fmac_f32 v34, v24, v18
    v_mfma_f32_16x16x32_bf16 v[96:99], a[16:19], a[56:59], v[96:99]
    ds_read_b64_tr_b16 a[12:13], v11 offset:21536
    v_fmac_f32 v35, v24, v19
    v_mfma_f32_16x16x32_bf16 v[100:103], a[16:19], a[60:63], v[100:103]
    ds_read_b64_tr_b16 a[14:15], v11 offset:23328
    v_fmac_f32 v36, v26, v16
    v_mfma_f32_16x16x32_bf16 v[104:107], a[16:19], a[64:67], v[104:107]
    buffer_load_dwordx4 v9, s[28:31], s51 offen lds
    v_mfma_f32_16x16x32_bf16 v[108:111], a[16:19], a[68:71], v[108:111]
    v_fmac_f32 v37, v26, v17
    v_mfma_f32_16x16x32_bf16 v[112:115], a[20:23], a[56:59], v[112:115]
    ds_read_b64_tr_b16 a[16:17], v11 offset:7232
    v_fmac_f32 v38, v26, v18
    v_mfma_f32_16x16x32_bf16 v[116:119], a[20:23], a[60:63], v[116:119]
    ds_read_b64_tr_b16 a[18:19], v11 offset:9024
    v_fmac_f32 v39, v26, v19
    v_mfma_f32_16x16x32_bf16 v[120:123], a[20:23], a[64:67], v[120:123]
    s_add_u32 s51, s51, s55
    v_fmac_f32 v40, v28, v16
    v_mfma_f32_16x16x32_bf16 v[124:127], a[20:23], a[68:71], v[124:127]
    v_fmac_f32 v41, v28, v17
    v_mfma_f32_16x16x32_bf16 v[128:131], a[24:27], a[56:59], v[128:131]
    ds_read_b64_tr_b16 a[20:21], v11 offset:21568
    v_fmac_f32 v42, v28, v18
    v_mfma_f32_16x16x32_bf16 v[132:135], a[24:27], a[60:63], v[132:135]
    ds_read_b64_tr_b16 a[22:23], v11 offset:23360
    v_fmac_f32 v43, v28, v19
    v_mfma_f32_16x16x32_bf16 v[136:139], a[24:27], a[64:67], v[136:139]
    s_add_u32 s52, s52, 28672
    v_fmac_f32 v44, v30, v16
    v_mfma_f32_16x16x32_bf16 v[140:143], a[24:27], a[68:71], v[140:143]
    s_waitcnt lgkmcnt(12)
    v_fmac_f32 v45, v30, v17
    v_mfma_f32_16x16x32_bf16 v[144:147], a[28:31], a[56:59], v[144:147]
    ds_read_b64_tr_b16 a[24:25], v11 offset:7264
    v_fmac_f32 v46, v30, v18
    v_mfma_f32_16x16x32_bf16 v[148:151], a[28:31], a[60:63], v[148:151]
    ds_read_b64_tr_b16 a[26:27], v11 offset:9056
    v_fmac_f32 v47, v30, v19
    v_mfma_f32_16x16x32_bf16 v[152:155], a[28:31], a[64:67], v[152:155]
    s_cmp_eq_u32 s52, s54
    s_cselect_b32 s52, s53, s52
    v_mfma_f32_16x16x32_bf16 v[156:159], a[28:31], a[68:71], v[156:159]
    buffer_load_dwordx4 a[104:107], v12, s[4:7], s27 offen sc1
    v_mfma_f32_16x16x32_bf16 v[160:163], a[32:35], a[56:59], v[160:163]
    ds_read_b64_tr_b16 a[28:29], v11 offset:21600
    v_fmac_f32 v32, v25, v20
    v_mfma_f32_16x16x32_bf16 v[164:167], a[32:35], a[60:63], v[164:167]
    ds_read_b64_tr_b16 a[30:31], v11 offset:23392
    v_fmac_f32 v33, v25, v21
    v_mfma_f32_16x16x32_bf16 v[168:171], a[32:35], a[64:67], v[168:171]
    v_fmac_f32 v34, v25, v22
    v_mfma_f32_16x16x32_bf16 v[172:175], a[32:35], a[68:71], v[172:175]
    buffer_load_dwordx4 a[108:111], v13, s[4:7], s27 offen sc1
    v_mfma_f32_16x16x32_bf16 v[176:179], a[36:39], a[56:59], v[176:179]
    ds_read_b64_tr_b16 a[32:33], v11 offset:7296
    v_fmac_f32 v35, v25, v23
    v_mfma_f32_16x16x32_bf16 v[180:183], a[36:39], a[60:63], v[180:183]
    ds_read_b64_tr_b16 a[34:35], v11 offset:9088
    v_fmac_f32 v36, v27, v20
    v_mfma_f32_16x16x32_bf16 v[184:187], a[36:39], a[64:67], v[184:187]
    buffer_load_dwordx4 a[112:115], v14, s[4:7], s27 offen sc1
    v_mfma_f32_16x16x32_bf16 v[188:191], a[36:39], a[68:71], v[188:191]
    v_fmac_f32 v37, v27, v21
    v_mfma_f32_16x16x32_bf16 v[192:195], a[40:43], a[56:59], v[192:195]
    ds_read_b64_tr_b16 a[36:37], v11 offset:21632
    v_fmac_f32 v38, v27, v22
    v_mfma_f32_16x16x32_bf16 v[196:199], a[40:43], a[60:63], v[196:199]
    ds_read_b64_tr_b16 a[38:39], v11 offset:23424
    v_fmac_f32 v39, v27, v23
    v_mfma_f32_16x16x32_bf16 v[200:203], a[40:43], a[64:67], v[200:203]
    buffer_load_dwordx4 a[116:119], v15, s[4:7], s27 offen sc1
    v_mfma_f32_16x16x32_bf16 v[204:207], a[40:43], a[68:71], v[204:207]
    v_fmac_f32 v40, v29, v20
    v_mfma_f32_16x16x32_bf16 v[208:211], a[44:47], a[56:59], v[208:211]
    ds_read_b64_tr_b16 a[40:41], v11 offset:7328
    v_fmac_f32 v41, v29, v21
    v_mfma_f32_16x16x32_bf16 v[212:215], a[44:47], a[60:63], v[212:215]
    ds_read_b64_tr_b16 a[42:43], v11 offset:9120
    v_fmac_f32 v42, v29, v22
    v_mfma_f32_16x16x32_bf16 v[216:219], a[44:47], a[64:67], v[216:219]
    s_add_u32 s27, s27, 151552
    v_fmac_f32 v43, v29, v23
    v_mfma_f32_16x16x32_bf16 v[220:223], a[44:47], a[68:71], v[220:223]
    v_fmac_f32 v44, v31, v20
    v_mfma_f32_16x16x32_bf16 v[224:227], a[48:51], a[56:59], v[224:227]
    ds_read_b64_tr_b16 a[44:45], v11 offset:21664
    v_fmac_f32 v45, v31, v21
    v_mfma_f32_16x16x32_bf16 v[228:231], a[48:51], a[60:63], v[228:231]
    ds_read_b64_tr_b16 a[46:47], v11 offset:23456
    v_fmac_f32 v46, v31, v22
    v_mfma_f32_16x16x32_bf16 v[232:235], a[48:51], a[64:67], v[232:235]
    s_add_u32 s37, s37, 28672
    v_fmac_f32 v47, v31, v23
    v_mfma_f32_16x16x32_bf16 v[236:239], a[48:51], a[68:71], v[236:239]
    v_mfma_f32_16x16x32_bf16 v[240:243], a[52:55], a[56:59], v[240:243]
    ds_read_b64_tr_b16 a[48:49], v11 offset:7360
    v_mfma_f32_16x16x32_bf16 v[244:247], a[52:55], a[60:63], v[244:247]
    ds_read_b64_tr_b16 a[50:51], v11 offset:9152
    v_mfma_f32_16x16x32_bf16 v[248:251], a[52:55], a[64:67], v[248:251]
    s_cmp_eq_u32 s37, 139264
    s_cselect_b32 s37, 24576, s37
    v_mfma_f32_16x16x32_bf16 v[252:255], a[52:55], a[68:71], v[252:255]
    s_waitcnt vmcnt(15) lgkmcnt(12)
    v_mfma_f32_16x16x32_bf16 v[32:35], a[0:3], a[72:75], v[32:35]
    ds_read_b64_tr_b16 a[52:53], v11 offset:21696
    v_mfma_f32_16x16x32_bf16 v[36:39], a[0:3], a[76:79], v[36:39]
    ds_read_b64_tr_b16 a[54:55], v11 offset:23488
    v_mfma_f32_16x16x32_bf16 v[40:43], a[0:3], a[80:83], v[40:43]
    ds_read_b128 v[16:19], v0 offset:448
    v_mfma_f32_16x16x32_bf16 v[44:47], a[0:3], a[84:87], v[44:47]
    s_barrier
    v_add_u32 v11, s37, v10
    v_mfma_f32_16x16x32_bf16 v[48:51], a[4:7], a[72:75], v[48:51]
    ds_read_b64_tr_b16 a[0:1], v11 offset:0
    ds_read_b128 v[20:23], v0 offset:1472
    v_mfma_f32_16x16x32_bf16 v[52:55], a[4:7], a[76:79], v[52:55]
    ds_read_b64_tr_b16 a[2:3], v11 offset:1792
    v_mfma_f32_16x16x32_bf16 v[56:59], a[4:7], a[80:83], v[56:59]
    buffer_load_dwordx4 a[56:59], v12, s[4:7], s27 offen sc1
    v_mfma_f32_16x16x32_bf16 v[60:63], a[4:7], a[84:87], v[60:63]
    v_mfma_f32_16x16x32_bf16 v[64:67], a[8:11], a[72:75], v[64:67]
    ds_read_b64_tr_b16 a[4:5], v11 offset:14336
    v_mfma_f32_16x16x32_bf16 v[68:71], a[8:11], a[76:79], v[68:71]
    ds_read_b64_tr_b16 a[6:7], v11 offset:16128
    v_mfma_f32_16x16x32_bf16 v[72:75], a[8:11], a[80:83], v[72:75]
    buffer_load_dwordx4 a[60:63], v13, s[4:7], s27 offen sc1
    v_mfma_f32_16x16x32_bf16 v[76:79], a[8:11], a[84:87], v[76:79]
    v_mfma_f32_16x16x32_bf16 v[80:83], a[12:15], a[72:75], v[80:83]
    ds_read_b64_tr_b16 a[8:9], v11 offset:32
    v_mfma_f32_16x16x32_bf16 v[84:87], a[12:15], a[76:79], v[84:87]
    ds_read_b64_tr_b16 a[10:11], v11 offset:1824
    v_mfma_f32_16x16x32_bf16 v[88:91], a[12:15], a[80:83], v[88:91]
    buffer_load_dwordx4 a[64:67], v14, s[4:7], s27 offen sc1
    v_mfma_f32_16x16x32_bf16 v[92:95], a[12:15], a[84:87], v[92:95]
    buffer_load_dwordx4 a[68:71], v15, s[4:7], s27 offen sc1
    v_mfma_f32_16x16x32_bf16 v[96:99], a[16:19], a[72:75], v[96:99]
    ds_read_b64_tr_b16 a[12:13], v11 offset:14368
    s_waitcnt lgkmcnt(6)
    v_mfma_f32_16x16x32_bf16 v[100:103], a[16:19], a[76:79], v[100:103]
    ds_read_b64_tr_b16 a[14:15], v11 offset:16160
    v_fmac_f32 v48, v24, v16
    v_mfma_f32_16x16x32_bf16 v[104:107], a[16:19], a[80:83], v[104:107]
    v_fmac_f32 v49, v24, v17
    v_mfma_f32_16x16x32_bf16 v[108:111], a[16:19], a[84:87], v[108:111]
    s_add_u32 s27, s27, 151552
    v_fmac_f32 v50, v24, v18
    v_mfma_f32_16x16x32_bf16 v[112:115], a[20:23], a[72:75], v[112:115]
    ds_read_b64_tr_b16 a[16:17], v11 offset:64
    v_fmac_f32 v51, v24, v19
    v_mfma_f32_16x16x32_bf16 v[116:119], a[20:23], a[76:79], v[116:119]
    ds_read_b64_tr_b16 a[18:19], v11 offset:1856
    v_fmac_f32 v52, v26, v16
    v_mfma_f32_16x16x32_bf16 v[120:123], a[20:23], a[80:83], v[120:123]
    v_fmac_f32 v53, v26, v17
    v_mfma_f32_16x16x32_bf16 v[124:127], a[20:23], a[84:87], v[124:127]
    s_add_u32 m0, s52, 0
    v_fmac_f32 v54, v26, v18
    v_mfma_f32_16x16x32_bf16 v[128:131], a[24:27], a[72:75], v[128:131]
    ds_read_b64_tr_b16 a[20:21], v11 offset:14400
    v_fmac_f32 v55, v26, v19
    v_mfma_f32_16x16x32_bf16 v[132:135], a[24:27], a[76:79], v[132:135]
    ds_read_b64_tr_b16 a[22:23], v11 offset:16192
    v_fmac_f32 v56, v28, v16
    v_mfma_f32_16x16x32_bf16 v[136:139], a[24:27], a[80:83], v[136:139]
    buffer_load_dwordx4 v3, s[28:31], s51 offen lds
    v_mfma_f32_16x16x32_bf16 v[140:143], a[24:27], a[84:87], v[140:143]
    v_fmac_f32 v57, v28, v17
    v_mfma_f32_16x16x32_bf16 v[144:147], a[28:31], a[72:75], v[144:147]
    ds_read_b64_tr_b16 a[24:25], v11 offset:96
    v_fmac_f32 v58, v28, v18
    v_mfma_f32_16x16x32_bf16 v[148:151], a[28:31], a[76:79], v[148:151]
    ds_read_b64_tr_b16 a[26:27], v11 offset:1888
    v_fmac_f32 v59, v28, v19
    v_mfma_f32_16x16x32_bf16 v[152:155], a[28:31], a[80:83], v[152:155]
    s_add_u32 m0, s52, 1024
    v_fmac_f32 v60, v30, v16
    v_mfma_f32_16x16x32_bf16 v[156:159], a[28:31], a[84:87], v[156:159]
    v_fmac_f32 v61, v30, v17
    v_mfma_f32_16x16x32_bf16 v[160:163], a[32:35], a[72:75], v[160:163]
    ds_read_b64_tr_b16 a[28:29], v11 offset:14432
    v_fmac_f32 v62, v30, v18
    v_mfma_f32_16x16x32_bf16 v[164:167], a[32:35], a[76:79], v[164:167]
    ds_read_b64_tr_b16 a[30:31], v11 offset:16224
    v_fmac_f32 v63, v30, v19
    v_mfma_f32_16x16x32_bf16 v[168:171], a[32:35], a[80:83], v[168:171]
    buffer_load_dwordx4 v4, s[28:31], s51 offen lds
    v_mfma_f32_16x16x32_bf16 v[172:175], a[32:35], a[84:87], v[172:175]
    v_fmac_f32 v48, v25, v20
    v_mfma_f32_16x16x32_bf16 v[176:179], a[36:39], a[72:75], v[176:179]
    ds_read_b64_tr_b16 a[32:33], v11 offset:128
    v_fmac_f32 v49, v25, v21
    v_mfma_f32_16x16x32_bf16 v[180:183], a[36:39], a[76:79], v[180:183]
    ds_read_b64_tr_b16 a[34:35], v11 offset:1920
    v_fmac_f32 v50, v25, v22
    v_mfma_f32_16x16x32_bf16 v[184:187], a[36:39], a[80:83], v[184:187]
    s_add_u32 m0, s52, 2048
    v_fmac_f32 v51, v25, v23
    v_mfma_f32_16x16x32_bf16 v[188:191], a[36:39], a[84:87], v[188:191]
    v_fmac_f32 v52, v27, v20
    v_mfma_f32_16x16x32_bf16 v[192:195], a[40:43], a[72:75], v[192:195]
    ds_read_b64_tr_b16 a[36:37], v11 offset:14464
    v_fmac_f32 v53, v27, v21
    v_mfma_f32_16x16x32_bf16 v[196:199], a[40:43], a[76:79], v[196:199]
    ds_read_b64_tr_b16 a[38:39], v11 offset:16256
    v_fmac_f32 v54, v27, v22
    v_mfma_f32_16x16x32_bf16 v[200:203], a[40:43], a[80:83], v[200:203]
    buffer_load_dwordx4 v5, s[28:31], s51 offen lds
    v_mfma_f32_16x16x32_bf16 v[204:207], a[40:43], a[84:87], v[204:207]
    v_fmac_f32 v55, v27, v23
    v_mfma_f32_16x16x32_bf16 v[208:211], a[44:47], a[72:75], v[208:211]
    ds_read_b64_tr_b16 a[40:41], v11 offset:160
    v_fmac_f32 v56, v29, v20
    v_mfma_f32_16x16x32_bf16 v[212:215], a[44:47], a[76:79], v[212:215]
    ds_read_b64_tr_b16 a[42:43], v11 offset:1952
    v_fmac_f32 v57, v29, v21
    v_mfma_f32_16x16x32_bf16 v[216:219], a[44:47], a[80:83], v[216:219]
    s_add_u32 m0, s52, 3072
    v_fmac_f32 v58, v29, v22
    v_mfma_f32_16x16x32_bf16 v[220:223], a[44:47], a[84:87], v[220:223]
    v_fmac_f32 v59, v29, v23
    v_mfma_f32_16x16x32_bf16 v[224:227], a[48:51], a[72:75], v[224:227]
    ds_read_b64_tr_b16 a[44:45], v11 offset:14496
    v_fmac_f32 v60, v31, v20
    v_mfma_f32_16x16x32_bf16 v[228:231], a[48:51], a[76:79], v[228:231]
    ds_read_b64_tr_b16 a[46:47], v11 offset:16288
    v_fmac_f32 v61, v31, v21
    v_mfma_f32_16x16x32_bf16 v[232:235], a[48:51], a[80:83], v[232:235]
    buffer_load_dwordx4 v6, s[28:31], s51 offen lds
    v_mfma_f32_16x16x32_bf16 v[236:239], a[48:51], a[84:87], v[236:239]
    v_fmac_f32 v62, v31, v22
    v_mfma_f32_16x16x32_bf16 v[240:243], a[52:55], a[72:75], v[240:243]
    ds_read_b64_tr_b16 a[48:49], v11 offset:192
    v_fmac_f32 v63, v31, v23
    v_mfma_f32_16x16x32_bf16 v[244:247], a[52:55], a[76:79], v[244:247]
    ds_read_b64_tr_b16 a[50:51], v11 offset:1984
    v_mfma_f32_16x16x32_bf16 v[248:251], a[52:55], a[80:83], v[248:251]
    buffer_load_dword a156, v2, s[68:71], 0 offen
    v_mfma_f32_16x16x32_bf16 v[252:255], a[52:55], a[84:87], v[252:255]
    s_waitcnt vmcnt(20) lgkmcnt(12)
    v_mfma_f32_16x16x32_bf16 v[32:35], a[0:3], a[88:91], v[32:35]
    ds_read_b64_tr_b16 a[52:53], v11 offset:14528
    v_mfma_f32_16x16x32_bf16 v[36:39], a[0:3], a[92:95], v[36:39]
    ds_read_b64_tr_b16 a[54:55], v11 offset:16320
    v_mfma_f32_16x16x32_bf16 v[40:43], a[0:3], a[96:99], v[40:43]
    s_add_u32 m0, s52, 4096
    v_mfma_f32_16x16x32_bf16 v[44:47], a[0:3], a[100:103], v[44:47]
    buffer_load_dwordx4 v7, s[28:31], s51 offen lds
    v_mfma_f32_16x16x32_bf16 v[48:51], a[4:7], a[88:91], v[48:51]
    ds_read_b64_tr_b16 a[0:1], v11 offset:7168
    v_mfma_f32_16x16x32_bf16 v[52:55], a[4:7], a[92:95], v[52:55]
    ds_read_b64_tr_b16 a[2:3], v11 offset:8960
    v_mfma_f32_16x16x32_bf16 v[56:59], a[4:7], a[96:99], v[56:59]
    ds_read_b128 v[16:19], v0 offset:64
    v_mfma_f32_16x16x32_bf16 v[60:63], a[4:7], a[100:103], v[60:63]
    s_add_u32 m0, s52, 5120
    v_mfma_f32_16x16x32_bf16 v[64:67], a[8:11], a[88:91], v[64:67]
    ds_read_b64_tr_b16 a[4:5], v11 offset:21504
    ds_read_b128 v[20:23], v0 offset:1088
    v_mfma_f32_16x16x32_bf16 v[68:71], a[8:11], a[92:95], v[68:71]
    ds_read_b64_tr_b16 a[6:7], v11 offset:23296
    v_mfma_f32_16x16x32_bf16 v[72:75], a[8:11], a[96:99], v[72:75]
    buffer_load_dwordx4 v8, s[28:31], s51 offen lds
    v_mfma_f32_16x16x32_bf16 v[76:79], a[8:11], a[100:103], v[76:79]
    v_mfma_f32_16x16x32_bf16 v[80:83], a[12:15], a[88:91], v[80:83]
    ds_read_b64_tr_b16 a[8:9], v11 offset:7200
    v_mfma_f32_16x16x32_bf16 v[84:87], a[12:15], a[92:95], v[84:87]
    ds_read_b64_tr_b16 a[10:11], v11 offset:8992
    v_mfma_f32_16x16x32_bf16 v[88:91], a[12:15], a[96:99], v[88:91]
    s_add_u32 m0, s52, 6144
    v_mfma_f32_16x16x32_bf16 v[92:95], a[12:15], a[100:103], v[92:95]
    v_mfma_f32_16x16x32_bf16 v[96:99], a[16:19], a[88:91], v[96:99]
    ds_read_b64_tr_b16 a[12:13], v11 offset:21536
    v_mfma_f32_16x16x32_bf16 v[100:103], a[16:19], a[92:95], v[100:103]
    ds_read_b64_tr_b16 a[14:15], v11 offset:23328
    v_mfma_f32_16x16x32_bf16 v[104:107], a[16:19], a[96:99], v[104:107]
    buffer_load_dwordx4 v9, s[28:31], s51 offen lds
    v_mfma_f32_16x16x32_bf16 v[108:111], a[16:19], a[100:103], v[108:111]
    v_mfma_f32_16x16x32_bf16 v[112:115], a[20:23], a[88:91], v[112:115]
    ds_read_b64_tr_b16 a[16:17], v11 offset:7232
    s_waitcnt lgkmcnt(6)
    v_mfma_f32_16x16x32_bf16 v[116:119], a[20:23], a[92:95], v[116:119]
    ds_read_b64_tr_b16 a[18:19], v11 offset:9024
    v_fmac_f32 v64, v24, v16
    v_mfma_f32_16x16x32_bf16 v[120:123], a[20:23], a[96:99], v[120:123]
    s_add_u32 s51, s51, s55
    v_fmac_f32 v65, v24, v17
    v_mfma_f32_16x16x32_bf16 v[124:127], a[20:23], a[100:103], v[124:127]
    v_fmac_f32 v66, v24, v18
    v_mfma_f32_16x16x32_bf16 v[128:131], a[24:27], a[88:91], v[128:131]
    ds_read_b64_tr_b16 a[20:21], v11 offset:21568
    v_fmac_f32 v67, v24, v19
    v_mfma_f32_16x16x32_bf16 v[132:135], a[24:27], a[92:95], v[132:135]
    ds_read_b64_tr_b16 a[22:23], v11 offset:23360
    v_fmac_f32 v68, v26, v16
    v_mfma_f32_16x16x32_bf16 v[136:139], a[24:27], a[96:99], v[136:139]
    s_add_u32 s52, s52, 28672
    v_fmac_f32 v69, v26, v17
    v_mfma_f32_16x16x32_bf16 v[140:143], a[24:27], a[100:103], v[140:143]
    v_fmac_f32 v70, v26, v18
    v_mfma_f32_16x16x32_bf16 v[144:147], a[28:31], a[88:91], v[144:147]
    ds_read_b64_tr_b16 a[24:25], v11 offset:7264
    v_fmac_f32 v71, v26, v19
    v_mfma_f32_16x16x32_bf16 v[148:151], a[28:31], a[92:95], v[148:151]
    ds_read_b64_tr_b16 a[26:27], v11 offset:9056
    v_fmac_f32 v72, v28, v16
    v_mfma_f32_16x16x32_bf16 v[152:155], a[28:31], a[96:99], v[152:155]
    s_cmp_eq_u32 s52, s54
    s_cselect_b32 s52, s53, s52
    v_mfma_f32_16x16x32_bf16 v[156:159], a[28:31], a[100:103], v[156:159]
    buffer_load_dwordx4 a[72:75], v12, s[4:7], s27 offen sc1
    v_mfma_f32_16x16x32_bf16 v[160:163], a[32:35], a[88:91], v[160:163]
    ds_read_b64_tr_b16 a[28:29], v11 offset:21600
    v_fmac_f32 v73, v28, v17
    v_mfma_f32_16x16x32_bf16 v[164:167], a[32:35], a[92:95], v[164:167]
    ds_read_b64_tr_b16 a[30:31], v11 offset:23392
    v_fmac_f32 v74, v28, v18
    v_mfma_f32_16x16x32_bf16 v[168:171], a[32:35], a[96:99], v[168:171]
    v_fmac_f32 v75, v28, v19
    v_mfma_f32_16x16x32_bf16 v[172:175], a[32:35], a[100:103], v[172:175]
    buffer_load_dwordx4 a[76:79], v13, s[4:7], s27 offen sc1
    v_mfma_f32_16x16x32_bf16 v[176:179], a[36:39], a[88:91], v[176:179]
    ds_read_b64_tr_b16 a[32:33], v11 offset:7296
    v_fmac_f32 v76, v30, v16
    v_mfma_f32_16x16x32_bf16 v[180:183], a[36:39], a[92:95], v[180:183]
    ds_read_b64_tr_b16 a[34:35], v11 offset:9088
    v_fmac_f32 v77, v30, v17
    v_mfma_f32_16x16x32_bf16 v[184:187], a[36:39], a[96:99], v[184:187]
    buffer_load_dwordx4 a[80:83], v14, s[4:7], s27 offen sc1
    v_mfma_f32_16x16x32_bf16 v[188:191], a[36:39], a[100:103], v[188:191]
    v_fmac_f32 v78, v30, v18
    v_mfma_f32_16x16x32_bf16 v[192:195], a[40:43], a[88:91], v[192:195]
    ds_read_b64_tr_b16 a[36:37], v11 offset:21632
    v_fmac_f32 v79, v30, v19
    v_mfma_f32_16x16x32_bf16 v[196:199], a[40:43], a[92:95], v[196:199]
    ds_read_b64_tr_b16 a[38:39], v11 offset:23424
    v_fmac_f32 v64, v25, v20
    v_mfma_f32_16x16x32_bf16 v[200:203], a[40:43], a[96:99], v[200:203]
    buffer_load_dwordx4 a[84:87], v15, s[4:7], s27 offen sc1
    v_mfma_f32_16x16x32_bf16 v[204:207], a[40:43], a[100:103], v[204:207]
    v_fmac_f32 v65, v25, v21
    v_mfma_f32_16x16x32_bf16 v[208:211], a[44:47], a[88:91], v[208:211]
    ds_read_b64_tr_b16 a[40:41], v11 offset:7328
    v_fmac_f32 v66, v25, v22
    v_mfma_f32_16x16x32_bf16 v[212:215], a[44:47], a[92:95], v[212:215]
    ds_read_b64_tr_b16 a[42:43], v11 offset:9120
    v_fmac_f32 v67, v25, v23
    v_mfma_f32_16x16x32_bf16 v[216:219], a[44:47], a[96:99], v[216:219]
    s_add_u32 s27, s27, 151552
    v_fmac_f32 v68, v27, v20
    v_mfma_f32_16x16x32_bf16 v[220:223], a[44:47], a[100:103], v[220:223]
    v_fmac_f32 v69, v27, v21
    v_mfma_f32_16x16x32_bf16 v[224:227], a[48:51], a[88:91], v[224:227]
    ds_read_b64_tr_b16 a[44:45], v11 offset:21664
    v_fmac_f32 v70, v27, v22
    v_mfma_f32_16x16x32_bf16 v[228:231], a[48:51], a[92:95], v[228:231]
    ds_read_b64_tr_b16 a[46:47], v11 offset:23456
    v_fmac_f32 v71, v27, v23
    v_mfma_f32_16x16x32_bf16 v[232:235], a[48:51], a[96:99], v[232:235]
    s_add_u32 s37, s37, 28672
    v_fmac_f32 v72, v29, v20
    v_mfma_f32_16x16x32_bf16 v[236:239], a[48:51], a[100:103], v[236:239]
    v_fmac_f32 v73, v29, v21
    v_mfma_f32_16x16x32_bf16 v[240:243], a[52:55], a[88:91], v[240:243]
    ds_read_b64_tr_b16 a[48:49], v11 offset:7360
    v_fmac_f32 v74, v29, v22
    v_mfma_f32_16x16x32_bf16 v[244:247], a[52:55], a[92:95], v[244:247]
    ds_read_b64_tr_b16 a[50:51], v11 offset:9152
    v_fmac_f32 v75, v29, v23
    v_mfma_f32_16x16x32_bf16 v[248:251], a[52:55], a[96:99], v[248:251]
    s_cmp_eq_u32 s37, 139264
    s_cselect_b32 s37, 24576, s37
    v_mfma_f32_16x16x32_bf16 v[252:255], a[52:55], a[100:103], v[252:255]
    s_waitcnt vmcnt(16) lgkmcnt(12)
    v_fmac_f32 v76, v31, v20
    v_mfma_f32_16x16x32_bf16 v[32:35], a[0:3], a[104:107], v[32:35]
    ds_read_b64_tr_b16 a[52:53], v11 offset:21696
    v_fmac_f32 v77, v31, v21
    v_mfma_f32_16x16x32_bf16 v[36:39], a[0:3], a[108:111], v[36:39]
    ds_read_b64_tr_b16 a[54:55], v11 offset:23488
    v_fmac_f32 v78, v31, v22
    v_mfma_f32_16x16x32_bf16 v[40:43], a[0:3], a[112:115], v[40:43]
    v_fmac_f32 v79, v31, v23
    v_mfma_f32_16x16x32_bf16 v[44:47], a[0:3], a[116:119], v[44:47]
    s_barrier
    v_add_u32 v11, s37, v10
    v_mfma_f32_16x16x32_bf16 v[48:51], a[4:7], a[104:107], v[48:51]
    ds_read_b64_tr_b16 a[0:1], v11 offset:0
    v_mfma_f32_16x16x32_bf16 v[52:55], a[4:7], a[108:111], v[52:55]
    ds_read_b64_tr_b16 a[2:3], v11 offset:1792
    v_mfma_f32_16x16x32_bf16 v[56:59], a[4:7], a[112:115], v[56:59]
    buffer_load_dwordx4 a[88:91], v12, s[4:7], s27 offen sc1
    v_mfma_f32_16x16x32_bf16 v[60:63], a[4:7], a[116:119], v[60:63]
    ds_read_b128 v[16:19], v0 offset:512
    v_mfma_f32_16x16x32_bf16 v[64:67], a[8:11], a[104:107], v[64:67]
    ds_read_b64_tr_b16 a[4:5], v11 offset:14336
    v_mfma_f32_16x16x32_bf16 v[68:71], a[8:11], a[108:111], v[68:71]
    ds_read_b64_tr_b16 a[6:7], v11 offset:16128
    v_mfma_f32_16x16x32_bf16 v[72:75], a[8:11], a[112:115], v[72:75]
    buffer_load_dwordx4 a[92:95], v13, s[4:7], s27 offen sc1
    v_mfma_f32_16x16x32_bf16 v[76:79], a[8:11], a[116:119], v[76:79]
    ds_read_b128 v[20:23], v0 offset:1536
    v_mfma_f32_16x16x32_bf16 v[80:83], a[12:15], a[104:107], v[80:83]
    ds_read_b64_tr_b16 a[8:9], v11 offset:32
    v_mfma_f32_16x16x32_bf16 v[84:87], a[12:15], a[108:111], v[84:87]
    ds_read_b64_tr_b16 a[10:11], v11 offset:1824
    v_mfma_f32_16x16x32_bf16 v[88:91], a[12:15], a[112:115], v[88:91]
    buffer_load_dwordx4 a[96:99], v14, s[4:7], s27 offen sc1
    v_mfma_f32_16x16x32_bf16 v[92:95], a[12:15], a[116:119], v[92:95]
    v_mfma_f32_16x16x32_bf16 v[96:99], a[16:19], a[104:107], v[96:99]
    ds_read_b64_tr_b16 a[12:13], v11 offset:14368
    v_mfma_f32_16x16x32_bf16 v[100:103], a[16:19], a[108:111], v[100:103]
    ds_read_b64_tr_b16 a[14:15], v11 offset:16160
    v_mfma_f32_16x16x32_bf16 v[104:107], a[16:19], a[112:115], v[104:107]
    buffer_load_dwordx4 a[100:103], v15, s[4:7], s27 offen sc1
    v_mfma_f32_16x16x32_bf16 v[108:111], a[16:19], a[116:119], v[108:111]
    v_mfma_f32_16x16x32_bf16 v[112:115], a[20:23], a[104:107], v[112:115]
    ds_read_b64_tr_b16 a[16:17], v11 offset:64
    v_mfma_f32_16x16x32_bf16 v[116:119], a[20:23], a[108:111], v[116:119]
    ds_read_b64_tr_b16 a[18:19], v11 offset:1856
    v_mfma_f32_16x16x32_bf16 v[120:123], a[20:23], a[112:115], v[120:123]
    s_add_u32 s27, s27, 151552
    v_mfma_f32_16x16x32_bf16 v[124:127], a[20:23], a[116:119], v[124:127]
    v_mfma_f32_16x16x32_bf16 v[128:131], a[24:27], a[104:107], v[128:131]
    ds_read_b64_tr_b16 a[20:21], v11 offset:14400
    s_waitcnt lgkmcnt(7)
    v_mfma_f32_16x16x32_bf16 v[132:135], a[24:27], a[108:111], v[132:135]
    ds_read_b64_tr_b16 a[22:23], v11 offset:16192
    v_fmac_f32 v80, v24, v16
    v_mfma_f32_16x16x32_bf16 v[136:139], a[24:27], a[112:115], v[136:139]
    s_add_u32 m0, s52, 0
    v_fmac_f32 v81, v24, v17
    v_mfma_f32_16x16x32_bf16 v[140:143], a[24:27], a[116:119], v[140:143]
    v_fmac_f32 v82, v24, v18
    v_mfma_f32_16x16x32_bf16 v[144:147], a[28:31], a[104:107], v[144:147]
    ds_read_b64_tr_b16 a[24:25], v11 offset:96
    v_fmac_f32 v83, v24, v19
    v_mfma_f32_16x16x32_bf16 v[148:151], a[28:31], a[108:111], v[148:151]
    ds_read_b64_tr_b16 a[26:27], v11 offset:1888
    v_fmac_f32 v84, v26, v16
    v_mfma_f32_16x16x32_bf16 v[152:155], a[28:31], a[112:115], v[152:155]
    buffer_load_dwordx4 v3, s[28:31], s51 offen lds
    v_mfma_f32_16x16x32_bf16 v[156:159], a[28:31], a[116:119], v[156:159]
    v_fmac_f32 v85, v26, v17
    v_mfma_f32_16x16x32_bf16 v[160:163], a[32:35], a[104:107], v[160:163]
    ds_read_b64_tr_b16 a[28:29], v11 offset:14432
    v_fmac_f32 v86, v26, v18
    v_mfma_f32_16x16x32_bf16 v[164:167], a[32:35], a[108:111], v[164:167]
    ds_read_b64_tr_b16 a[30:31], v11 offset:16224
    v_fmac_f32 v87, v26, v19
    v_mfma_f32_16x16x32_bf16 v[168:171], a[32:35], a[112:115], v[168:171]
    s_add_u32 m0, s52, 1024
    v_fmac_f32 v88, v28, v16
    v_mfma_f32_16x16x32_bf16 v[172:175], a[32:35], a[116:119], v[172:175]
    v_fmac_f32 v89, v28, v17
    v_mfma_f32_16x16x32_bf16 v[176:179], a[36:39], a[104:107], v[176:179]
    ds_read_b64_tr_b16 a[32:33], v11 offset:128
    v_fmac_f32 v90, v28, v18
    v_mfma_f32_16x16x32_bf16 v[180:183], a[36:39], a[108:111], v[180:183]
    ds_read_b64_tr_b16 a[34:35], v11 offset:1920
    v_fmac_f32 v91, v28, v19
    v_mfma_f32_16x16x32_bf16 v[184:187], a[36:39], a[112:115], v[184:187]
    buffer_load_dwordx4 v4, s[28:31], s51 offen lds
    v_mfma_f32_16x16x32_bf16 v[188:191], a[36:39], a[116:119], v[188:191]
    v_fmac_f32 v92, v30, v16
    v_mfma_f32_16x16x32_bf16 v[192:195], a[40:43], a[104:107], v[192:195]
    ds_read_b64_tr_b16 a[36:37], v11 offset:14464
    v_fmac_f32 v93, v30, v17
    v_mfma_f32_16x16x32_bf16 v[196:199], a[40:43], a[108:111], v[196:199]
    ds_read_b64_tr_b16 a[38:39], v11 offset:16256
    v_fmac_f32 v94, v30, v18
    v_mfma_f32_16x16x32_bf16 v[200:203], a[40:43], a[112:115], v[200:203]
    s_add_u32 m0, s52, 2048
    v_fmac_f32 v95, v30, v19
    v_mfma_f32_16x16x32_bf16 v[204:207], a[40:43], a[116:119], v[204:207]
    v_fmac_f32 v80, v25, v20
    v_mfma_f32_16x16x32_bf16 v[208:211], a[44:47], a[104:107], v[208:211]
    ds_read_b64_tr_b16 a[40:41], v11 offset:160
    v_fmac_f32 v81, v25, v21
    v_mfma_f32_16x16x32_bf16 v[212:215], a[44:47], a[108:111], v[212:215]
    ds_read_b64_tr_b16 a[42:43], v11 offset:1952
    v_fmac_f32 v82, v25, v22
    v_mfma_f32_16x16x32_bf16 v[216:219], a[44:47], a[112:115], v[216:219]
    buffer_load_dwordx4 v5, s[28:31], s51 offen lds
    v_mfma_f32_16x16x32_bf16 v[220:223], a[44:47], a[116:119], v[220:223]
    v_fmac_f32 v83, v25, v23
    v_mfma_f32_16x16x32_bf16 v[224:227], a[48:51], a[104:107], v[224:227]
    ds_read_b64_tr_b16 a[44:45], v11 offset:14496
    v_fmac_f32 v84, v27, v20
    v_mfma_f32_16x16x32_bf16 v[228:231], a[48:51], a[108:111], v[228:231]
    ds_read_b64_tr_b16 a[46:47], v11 offset:16288
    v_fmac_f32 v85, v27, v21
    v_mfma_f32_16x16x32_bf16 v[232:235], a[48:51], a[112:115], v[232:235]
    s_add_u32 m0, s52, 3072
    v_fmac_f32 v86, v27, v22
    v_mfma_f32_16x16x32_bf16 v[236:239], a[48:51], a[116:119], v[236:239]
    v_fmac_f32 v87, v27, v23
    v_mfma_f32_16x16x32_bf16 v[240:243], a[52:55], a[104:107], v[240:243]
    ds_read_b64_tr_b16 a[48:49], v11 offset:192
    v_fmac_f32 v88, v29, v20
    v_mfma_f32_16x16x32_bf16 v[244:247], a[52:55], a[108:111], v[244:247]
    ds_read_b64_tr_b16 a[50:51], v11 offset:1984
    v_fmac_f32 v89, v29, v21
    v_mfma_f32_16x16x32_bf16 v[248:251], a[52:55], a[112:115], v[248:251]
    buffer_load_dwordx4 v6, s[28:31], s51 offen lds
    v_mfma_f32_16x16x32_bf16 v[252:255], a[52:55], a[116:119], v[252:255]
    s_waitcnt vmcnt(20) lgkmcnt(12)
    v_fmac_f32 v90, v29, v22
    v_mfma_f32_16x16x32_bf16 v[32:35], a[0:3], a[56:59], v[32:35]
    ds_read_b64_tr_b16 a[52:53], v11 offset:14528
    v_fmac_f32 v91, v29, v23
    v_mfma_f32_16x16x32_bf16 v[36:39], a[0:3], a[60:63], v[36:39]
    ds_read_b64_tr_b16 a[54:55], v11 offset:16320
    v_fmac_f32 v92, v31, v20
    v_mfma_f32_16x16x32_bf16 v[40:43], a[0:3], a[64:67], v[40:43]
    s_add_u32 m0, s52, 4096
    v_fmac_f32 v93, v31, v21
    v_mfma_f32_16x16x32_bf16 v[44:47], a[0:3], a[68:71], v[44:47]
    buffer_load_dwordx4 v7, s[28:31], s51 offen lds
    v_mfma_f32_16x16x32_bf16 v[48:51], a[4:7], a[56:59], v[48:51]
    ds_read_b64_tr_b16 a[0:1], v11 offset:7168
    v_fmac_f32 v94, v31, v22
    v_mfma_f32_16x16x32_bf16 v[52:55], a[4:7], a[60:63], v[52:55]
    ds_read_b64_tr_b16 a[2:3], v11 offset:8960
    v_fmac_f32 v95, v31, v23
    v_mfma_f32_16x16x32_bf16 v[56:59], a[4:7], a[64:67], v[56:59]
    v_mfma_f32_16x16x32_bf16 v[60:63], a[4:7], a[68:71], v[60:63]
    s_add_u32 m0, s52, 5120
    v_mfma_f32_16x16x32_bf16 v[64:67], a[8:11], a[56:59], v[64:67]
    ds_read_b64_tr_b16 a[4:5], v11 offset:21504
    v_mfma_f32_16x16x32_bf16 v[68:71], a[8:11], a[60:63], v[68:71]
    ds_read_b64_tr_b16 a[6:7], v11 offset:23296
    v_mfma_f32_16x16x32_bf16 v[72:75], a[8:11], a[64:67], v[72:75]
    buffer_load_dwordx4 v8, s[28:31], s51 offen lds
    v_mfma_f32_16x16x32_bf16 v[76:79], a[8:11], a[68:71], v[76:79]
    ds_read_b128 v[16:19], v0 offset:128
    v_mfma_f32_16x16x32_bf16 v[80:83], a[12:15], a[56:59], v[80:83]
    ds_read_b64_tr_b16 a[8:9], v11 offset:7200
    v_mfma_f32_16x16x32_bf16 v[84:87], a[12:15], a[60:63], v[84:87]
    ds_read_b64_tr_b16 a[10:11], v11 offset:8992
    v_mfma_f32_16x16x32_bf16 v[88:91], a[12:15], a[64:67], v[88:91]
    s_add_u32 m0, s52, 6144
    v_mfma_f32_16x16x32_bf16 v[92:95], a[12:15], a[68:71], v[92:95]
    ds_read_b128 v[20:23], v0 offset:1152
    v_mfma_f32_16x16x32_bf16 v[96:99], a[16:19], a[56:59], v[96:99]
    ds_read_b64_tr_b16 a[12:13], v11 offset:21536
    v_mfma_f32_16x16x32_bf16 v[100:103], a[16:19], a[60:63], v[100:103]
    ds_read_b64_tr_b16 a[14:15], v11 offset:23328
    v_mfma_f32_16x16x32_bf16 v[104:107], a[16:19], a[64:67], v[104:107]
    buffer_load_dwordx4 v9, s[28:31], s51 offen lds
    v_mfma_f32_16x16x32_bf16 v[108:111], a[16:19], a[68:71], v[108:111]
    v_mfma_f32_16x16x32_bf16 v[112:115], a[20:23], a[56:59], v[112:115]
    ds_read_b64_tr_b16 a[16:17], v11 offset:7232
    v_mfma_f32_16x16x32_bf16 v[116:119], a[20:23], a[60:63], v[116:119]
    ds_read_b64_tr_b16 a[18:19], v11 offset:9024
    v_mfma_f32_16x16x32_bf16 v[120:123], a[20:23], a[64:67], v[120:123]
    s_add_u32 s51, s51, s55
    v_mfma_f32_16x16x32_bf16 v[124:127], a[20:23], a[68:71], v[124:127]
    v_mfma_f32_16x16x32_bf16 v[128:131], a[24:27], a[56:59], v[128:131]
    ds_read_b64_tr_b16 a[20:21], v11 offset:21568
    v_mfma_f32_16x16x32_bf16 v[132:135], a[24:27], a[60:63], v[132:135]
    ds_read_b64_tr_b16 a[22:23], v11 offset:23360
    v_mfma_f32_16x16x32_bf16 v[136:139], a[24:27], a[64:67], v[136:139]
    s_add_u32 s52, s52, 28672
    v_mfma_f32_16x16x32_bf16 v[140:143], a[24:27], a[68:71], v[140:143]
    s_waitcnt lgkmcnt(14)
    v_mfma_f32_16x16x32_bf16 v[144:147], a[28:31], a[56:59], v[144:147]
    ds_read_b64_tr_b16 a[24:25], v11 offset:7264
    s_waitcnt lgkmcnt(7)
    v_mfma_f32_16x16x32_bf16 v[148:151], a[28:31], a[60:63], v[148:151]
    ds_read_b64_tr_b16 a[26:27], v11 offset:9056
    v_fmac_f32 v96, v24, v16
    v_mfma_f32_16x16x32_bf16 v[152:155], a[28:31], a[64:67], v[152:155]
    s_cmp_eq_u32 s52, s54
    s_cselect_b32 s52, s53, s52
    v_mfma_f32_16x16x32_bf16 v[156:159], a[28:31], a[68:71], v[156:159]
    buffer_load_dwordx4 a[104:107], v12, s[4:7], s27 offen sc1
    v_mfma_f32_16x16x32_bf16 v[160:163], a[32:35], a[56:59], v[160:163]
    ds_read_b64_tr_b16 a[28:29], v11 offset:21600
    v_fmac_f32 v97, v24, v17
    v_mfma_f32_16x16x32_bf16 v[164:167], a[32:35], a[60:63], v[164:167]
    ds_read_b64_tr_b16 a[30:31], v11 offset:23392
    v_fmac_f32 v98, v24, v18
    v_mfma_f32_16x16x32_bf16 v[168:171], a[32:35], a[64:67], v[168:171]
    v_fmac_f32 v99, v24, v19
    v_mfma_f32_16x16x32_bf16 v[172:175], a[32:35], a[68:71], v[172:175]
    buffer_load_dwordx4 a[108:111], v13, s[4:7], s27 offen sc1
    v_mfma_f32_16x16x32_bf16 v[176:179], a[36:39], a[56:59], v[176:179]
    ds_read_b64_tr_b16 a[32:33], v11 offset:7296
    v_fmac_f32 v100, v26, v16
    v_mfma_f32_16x16x32_bf16 v[180:183], a[36:39], a[60:63], v[180:183]
    ds_read_b64_tr_b16 a[34:35], v11 offset:9088
    v_fmac_f32 v101, v26, v17
    v_mfma_f32_16x16x32_bf16 v[184:187], a[36:39], a[64:67], v[184:187]
    buffer_load_dwordx4 a[112:115], v14, s[4:7], s27 offen sc1
    v_mfma_f32_16x16x32_bf16 v[188:191], a[36:39], a[68:71], v[188:191]
    v_fmac_f32 v102, v26, v18
    v_mfma_f32_16x16x32_bf16 v[192:195], a[40:43], a[56:59], v[192:195]
    ds_read_b64_tr_b16 a[36:37], v11 offset:21632
    v_fmac_f32 v103, v26, v19
    v_mfma_f32_16x16x32_bf16 v[196:199], a[40:43], a[60:63], v[196:199]
    ds_read_b64_tr_b16 a[38:39], v11 offset:23424
    v_fmac_f32 v104, v28, v16
    v_mfma_f32_16x16x32_bf16 v[200:203], a[40:43], a[64:67], v[200:203]
    buffer_load_dwordx4 a[116:119], v15, s[4:7], s27 offen sc1
    v_mfma_f32_16x16x32_bf16 v[204:207], a[40:43], a[68:71], v[204:207]
    v_fmac_f32 v105, v28, v17
    v_mfma_f32_16x16x32_bf16 v[208:211], a[44:47], a[56:59], v[208:211]
    ds_read_b64_tr_b16 a[40:41], v11 offset:7328
    v_fmac_f32 v106, v28, v18
    v_mfma_f32_16x16x32_bf16 v[212:215], a[44:47], a[60:63], v[212:215]
    ds_read_b64_tr_b16 a[42:43], v11 offset:9120
    v_fmac_f32 v107, v28, v19
    v_mfma_f32_16x16x32_bf16 v[216:219], a[44:47], a[64:67], v[216:219]
    s_add_u32 s27, s27, 151552
    v_fmac_f32 v108, v30, v16
    v_mfma_f32_16x16x32_bf16 v[220:223], a[44:47], a[68:71], v[220:223]
    v_fmac_f32 v109, v30, v17
    v_mfma_f32_16x16x32_bf16 v[224:227], a[48:51], a[56:59], v[224:227]
    ds_read_b64_tr_b16 a[44:45], v11 offset:21664
    v_fmac_f32 v110, v30, v18
    v_mfma_f32_16x16x32_bf16 v[228:231], a[48:51], a[60:63], v[228:231]
    ds_read_b64_tr_b16 a[46:47], v11 offset:23456
    v_fmac_f32 v111, v30, v19
    v_mfma_f32_16x16x32_bf16 v[232:235], a[48:51], a[64:67], v[232:235]
    s_add_u32 s37, s37, 28672
    v_fmac_f32 v96, v25, v20
    v_mfma_f32_16x16x32_bf16 v[236:239], a[48:51], a[68:71], v[236:239]
    v_fmac_f32 v97, v25, v21
    v_mfma_f32_16x16x32_bf16 v[240:243], a[52:55], a[56:59], v[240:243]
    ds_read_b64_tr_b16 a[48:49], v11 offset:7360
    v_fmac_f32 v98, v25, v22
    v_mfma_f32_16x16x32_bf16 v[244:247], a[52:55], a[60:63], v[244:247]
    ds_read_b64_tr_b16 a[50:51], v11 offset:9152
    v_fmac_f32 v99, v25, v23
    v_mfma_f32_16x16x32_bf16 v[248:251], a[52:55], a[64:67], v[248:251]
    s_cmp_eq_u32 s37, 139264
    s_cselect_b32 s37, 24576, s37
    v_mfma_f32_16x16x32_bf16 v[252:255], a[52:55], a[68:71], v[252:255]
    s_waitcnt vmcnt(15) lgkmcnt(12)
    v_fmac_f32 v100, v27, v20
    v_mfma_f32_16x16x32_bf16 v[32:35], a[0:3], a[72:75], v[32:35]
    ds_read_b64_tr_b16 a[52:53], v11 offset:21696
    v_fmac_f32 v101, v27, v21
    v_mfma_f32_16x16x32_bf16 v[36:39], a[0:3], a[76:79], v[36:39]
    ds_read_b64_tr_b16 a[54:55], v11 offset:23488
    v_fmac_f32 v102, v27, v22
    v_mfma_f32_16x16x32_bf16 v[40:43], a[0:3], a[80:83], v[40:43]
    v_fmac_f32 v103, v27, v23
    v_mfma_f32_16x16x32_bf16 v[44:47], a[0:3], a[84:87], v[44:47]
    s_barrier
    v_add_u32 v11, s37, v10
    v_mfma_f32_16x16x32_bf16 v[48:51], a[4:7], a[72:75], v[48:51]
    ds_read_b64_tr_b16 a[0:1], v11 offset:0
    v_fmac_f32 v104, v29, v20
    v_mfma_f32_16x16x32_bf16 v[52:55], a[4:7], a[76:79], v[52:55]
    ds_read_b64_tr_b16 a[2:3], v11 offset:1792
    v_fmac_f32 v105, v29, v21
    v_mfma_f32_16x16x32_bf16 v[56:59], a[4:7], a[80:83], v[56:59]
    buffer_load_dwordx4 a[56:59], v12, s[4:7], s27 offen sc1
    v_mfma_f32_16x16x32_bf16 v[60:63], a[4:7], a[84:87], v[60:63]
    v_fmac_f32 v106, v29, v22
    v_mfma_f32_16x16x32_bf16 v[64:67], a[8:11], a[72:75], v[64:67]
    ds_read_b64_tr_b16 a[4:5], v11 offset:14336
    v_fmac_f32 v107, v29, v23
    v_mfma_f32_16x16x32_bf16 v[68:71], a[8:11], a[76:79], v[68:71]
    ds_read_b64_tr_b16 a[6:7], v11 offset:16128
    v_fmac_f32 v108, v31, v20
    v_mfma_f32_16x16x32_bf16 v[72:75], a[8:11], a[80:83], v[72:75]
    buffer_load_dwordx4 a[60:63], v13, s[4:7], s27 offen sc1
    v_fmac_f32 v109, v31, v21
    v_mfma_f32_16x16x32_bf16 v[76:79], a[8:11], a[84:87], v[76:79]
    v_fmac_f32 v110, v31, v22
    v_mfma_f32_16x16x32_bf16 v[80:83], a[12:15], a[72:75], v[80:83]
    ds_read_b64_tr_b16 a[8:9], v11 offset:32
    v_fmac_f32 v111, v31, v23
    v_mfma_f32_16x16x32_bf16 v[84:87], a[12:15], a[76:79], v[84:87]
    ds_read_b64_tr_b16 a[10:11], v11 offset:1824
    v_mfma_f32_16x16x32_bf16 v[88:91], a[12:15], a[80:83], v[88:91]
    buffer_load_dwordx4 a[64:67], v14, s[4:7], s27 offen sc1
    v_mfma_f32_16x16x32_bf16 v[92:95], a[12:15], a[84:87], v[92:95]
    buffer_load_dwordx4 a[68:71], v15, s[4:7], s27 offen sc1
    v_mfma_f32_16x16x32_bf16 v[96:99], a[16:19], a[72:75], v[96:99]
    ds_read_b64_tr_b16 a[12:13], v11 offset:14368
    v_mfma_f32_16x16x32_bf16 v[100:103], a[16:19], a[76:79], v[100:103]
    ds_read_b64_tr_b16 a[14:15], v11 offset:16160
    v_mfma_f32_16x16x32_bf16 v[104:107], a[16:19], a[80:83], v[104:107]
    ds_read_b128 v[16:19], v0 offset:576
    v_mfma_f32_16x16x32_bf16 v[108:111], a[16:19], a[84:87], v[108:111]
    s_add_u32 s27, s27, 151552
    v_mfma_f32_16x16x32_bf16 v[112:115], a[20:23], a[72:75], v[112:115]
    ds_read_b64_tr_b16 a[16:17], v11 offset:64
    ds_read_b128 v[20:23], v0 offset:1600
    v_mfma_f32_16x16x32_bf16 v[116:119], a[20:23], a[76:79], v[116:119]
    ds_read_b64_tr_b16 a[18:19], v11 offset:1856
    v_mfma_f32_16x16x32_bf16 v[120:123], a[20:23], a[80:83], v[120:123]
    v_mfma_f32_16x16x32_bf16 v[124:127], a[20:23], a[84:87], v[124:127]
    s_add_u32 m0, s52, 0
    v_mfma_f32_16x16x32_bf16 v[128:131], a[24:27], a[72:75], v[128:131]
    ds_read_b64_tr_b16 a[20:21], v11 offset:14400
    v_mfma_f32_16x16x32_bf16 v[132:135], a[24:27], a[76:79], v[132:135]
    ds_read_b64_tr_b16 a[22:23], v11 offset:16192
    v_mfma_f32_16x16x32_bf16 v[136:139], a[24:27], a[80:83], v[136:139]
    buffer_load_dwordx4 v3, s[28:31], s51 offen lds
    v_mfma_f32_16x16x32_bf16 v[140:143], a[24:27], a[84:87], v[140:143]
    s_waitcnt lgkmcnt(14)
    v_mfma_f32_16x16x32_bf16 v[144:147], a[28:31], a[72:75], v[144:147]
    ds_read_b64_tr_b16 a[24:25], v11 offset:96
    v_mfma_f32_16x16x32_bf16 v[148:151], a[28:31], a[76:79], v[148:151]
    ds_read_b64_tr_b16 a[26:27], v11 offset:1888
    v_mfma_f32_16x16x32_bf16 v[152:155], a[28:31], a[80:83], v[152:155]
    s_add_u32 m0, s52, 1024
    v_mfma_f32_16x16x32_bf16 v[156:159], a[28:31], a[84:87], v[156:159]
    v_mfma_f32_16x16x32_bf16 v[160:163], a[32:35], a[72:75], v[160:163]
    ds_read_b64_tr_b16 a[28:29], v11 offset:14432
    s_waitcnt lgkmcnt(6)
    v_mfma_f32_16x16x32_bf16 v[164:167], a[32:35], a[76:79], v[164:167]
    ds_read_b64_tr_b16 a[30:31], v11 offset:16224
    v_fmac_f32 v112, v24, v16
    v_mfma_f32_16x16x32_bf16 v[168:171], a[32:35], a[80:83], v[168:171]
    buffer_load_dwordx4 v4, s[28:31], s51 offen lds
    v_mfma_f32_16x16x32_bf16 v[172:175], a[32:35], a[84:87], v[172:175]
    v_fmac_f32 v113, v24, v17
    v_mfma_f32_16x16x32_bf16 v[176:179], a[36:39], a[72:75], v[176:179]
    ds_read_b64_tr_b16 a[32:33], v11 offset:128
    v_fmac_f32 v114, v24, v18
    v_mfma_f32_16x16x32_bf16 v[180:183], a[36:39], a[76:79], v[180:183]
    ds_read_b64_tr_b16 a[34:35], v11 offset:1920
    v_fmac_f32 v115, v24, v19
    v_mfma_f32_16x16x32_bf16 v[184:187], a[36:39], a[80:83], v[184:187]
    s_add_u32 m0, s52, 2048
    v_fmac_f32 v116, v26, v16
    v_mfma_f32_16x16x32_bf16 v[188:191], a[36:39], a[84:87], v[188:191]
    v_fmac_f32 v117, v26, v17
    v_mfma_f32_16x16x32_bf16 v[192:195], a[40:43], a[72:75], v[192:195]
    ds_read_b64_tr_b16 a[36:37], v11 offset:14464
    v_fmac_f32 v118, v26, v18
    v_mfma_f32_16x16x32_bf16 v[196:199], a[40:43], a[76:79], v[196:199]
    ds_read_b64_tr_b16 a[38:39], v11 offset:16256
    v_fmac_f32 v119, v26, v19
    v_mfma_f32_16x16x32_bf16 v[200:203], a[40:43], a[80:83], v[200:203]
    buffer_load_dwordx4 v5, s[28:31], s51 offen lds
    v_mfma_f32_16x16x32_bf16 v[204:207], a[40:43], a[84:87], v[204:207]
    v_fmac_f32 v120, v28, v16
    v_mfma_f32_16x16x32_bf16 v[208:211], a[44:47], a[72:75], v[208:211]
    ds_read_b64_tr_b16 a[40:41], v11 offset:160
    v_fmac_f32 v121, v28, v17
    v_mfma_f32_16x16x32_bf16 v[212:215], a[44:47], a[76:79], v[212:215]
    ds_read_b64_tr_b16 a[42:43], v11 offset:1952
    v_fmac_f32 v122, v28, v18
    v_mfma_f32_16x16x32_bf16 v[216:219], a[44:47], a[80:83], v[216:219]
    s_add_u32 m0, s52, 3072
    v_fmac_f32 v123, v28, v19
    v_mfma_f32_16x16x32_bf16 v[220:223], a[44:47], a[84:87], v[220:223]
    v_fmac_f32 v124, v30, v16
    v_mfma_f32_16x16x32_bf16 v[224:227], a[48:51], a[72:75], v[224:227]
    ds_read_b64_tr_b16 a[44:45], v11 offset:14496
    v_fmac_f32 v125, v30, v17
    v_mfma_f32_16x16x32_bf16 v[228:231], a[48:51], a[76:79], v[228:231]
    ds_read_b64_tr_b16 a[46:47], v11 offset:16288
    v_fmac_f32 v126, v30, v18
    v_mfma_f32_16x16x32_bf16 v[232:235], a[48:51], a[80:83], v[232:235]
    buffer_load_dwordx4 v6, s[28:31], s51 offen lds
    v_mfma_f32_16x16x32_bf16 v[236:239], a[48:51], a[84:87], v[236:239]
    v_fmac_f32 v127, v30, v19
    v_mfma_f32_16x16x32_bf16 v[240:243], a[52:55], a[72:75], v[240:243]
    ds_read_b64_tr_b16 a[48:49], v11 offset:192
    v_fmac_f32 v112, v25, v20
    v_mfma_f32_16x16x32_bf16 v[244:247], a[52:55], a[76:79], v[244:247]
    ds_read_b64_tr_b16 a[50:51], v11 offset:1984
    v_fmac_f32 v113, v25, v21
    v_mfma_f32_16x16x32_bf16 v[248:251], a[52:55], a[80:83], v[248:251]
    buffer_load_dword a156, v2, s[68:71], 0 offen
    v_mfma_f32_16x16x32_bf16 v[252:255], a[52:55], a[84:87], v[252:255]
    s_waitcnt vmcnt(20) lgkmcnt(12)
    v_fmac_f32 v114, v25, v22
    v_mfma_f32_16x16x32_bf16 v[32:35], a[0:3], a[88:91], v[32:35]
    ds_read_b64_tr_b16 a[52:53], v11 offset:14528
    v_fmac_f32 v115, v25, v23
    v_mfma_f32_16x16x32_bf16 v[36:39], a[0:3], a[92:95], v[36:39]
    ds_read_b64_tr_b16 a[54:55], v11 offset:16320
    v_fmac_f32 v116, v27, v20
    v_mfma_f32_16x16x32_bf16 v[40:43], a[0:3], a[96:99], v[40:43]
    s_add_u32 m0, s52, 4096
    v_fmac_f32 v117, v27, v21
    v_mfma_f32_16x16x32_bf16 v[44:47], a[0:3], a[100:103], v[44:47]
    buffer_load_dwordx4 v7, s[28:31], s51 offen lds
    v_mfma_f32_16x16x32_bf16 v[48:51], a[4:7], a[88:91], v[48:51]
    ds_read_b64_tr_b16 a[0:1], v11 offset:7168
    v_fmac_f32 v118, v27, v22
    v_mfma_f32_16x16x32_bf16 v[52:55], a[4:7], a[92:95], v[52:55]
    ds_read_b64_tr_b16 a[2:3], v11 offset:8960
    v_fmac_f32 v119, v27, v23
    v_mfma_f32_16x16x32_bf16 v[56:59], a[4:7], a[96:99], v[56:59]
    v_fmac_f32 v120, v29, v20
    v_mfma_f32_16x16x32_bf16 v[60:63], a[4:7], a[100:103], v[60:63]
    s_add_u32 m0, s52, 5120
    v_fmac_f32 v121, v29, v21
    v_mfma_f32_16x16x32_bf16 v[64:67], a[8:11], a[88:91], v[64:67]
    ds_read_b64_tr_b16 a[4:5], v11 offset:21504
    v_fmac_f32 v122, v29, v22
    v_mfma_f32_16x16x32_bf16 v[68:71], a[8:11], a[92:95], v[68:71]
    ds_read_b64_tr_b16 a[6:7], v11 offset:23296
    v_fmac_f32 v123, v29, v23
    v_mfma_f32_16x16x32_bf16 v[72:75], a[8:11], a[96:99], v[72:75]
    buffer_load_dwordx4 v8, s[28:31], s51 offen lds
    v_mfma_f32_16x16x32_bf16 v[76:79], a[8:11], a[100:103], v[76:79]
    v_fmac_f32 v124, v31, v20
    v_mfma_f32_16x16x32_bf16 v[80:83], a[12:15], a[88:91], v[80:83]
    ds_read_b64_tr_b16 a[8:9], v11 offset:7200
    v_fmac_f32 v125, v31, v21
    v_mfma_f32_16x16x32_bf16 v[84:87], a[12:15], a[92:95], v[84:87]
    ds_read_b64_tr_b16 a[10:11], v11 offset:8992
    v_fmac_f32 v126, v31, v22
    v_mfma_f32_16x16x32_bf16 v[88:91], a[12:15], a[96:99], v[88:91]
    s_add_u32 m0, s52, 6144
    v_fmac_f32 v127, v31, v23
    v_mfma_f32_16x16x32_bf16 v[92:95], a[12:15], a[100:103], v[92:95]
    v_mfma_f32_16x16x32_bf16 v[96:99], a[16:19], a[88:91], v[96:99]
    ds_read_b64_tr_b16 a[12:13], v11 offset:21536
    v_mfma_f32_16x16x32_bf16 v[100:103], a[16:19], a[92:95], v[100:103]
    ds_read_b64_tr_b16 a[14:15], v11 offset:23328
    v_mfma_f32_16x16x32_bf16 v[104:107], a[16:19], a[96:99], v[104:107]
    buffer_load_dwordx4 v9, s[28:31], s51 offen lds
    v_mfma_f32_16x16x32_bf16 v[108:111], a[16:19], a[100:103], v[108:111]
    ds_read_b128 v[16:19], v0 offset:192
    v_mfma_f32_16x16x32_bf16 v[112:115], a[20:23], a[88:91], v[112:115]
    ds_read_b64_tr_b16 a[16:17], v11 offset:7232
    v_mfma_f32_16x16x32_bf16 v[116:119], a[20:23], a[92:95], v[116:119]
    ds_read_b64_tr_b16 a[18:19], v11 offset:9024
    v_mfma_f32_16x16x32_bf16 v[120:123], a[20:23], a[96:99], v[120:123]
    s_add_u32 s51, s51, s55
    v_mfma_f32_16x16x32_bf16 v[124:127], a[20:23], a[100:103], v[124:127]
    ds_read_b128 v[20:23], v0 offset:1216
    v_mfma_f32_16x16x32_bf16 v[128:131], a[24:27], a[88:91], v[128:131]
    ds_read_b64_tr_b16 a[20:21], v11 offset:21568
    v_mfma_f32_16x16x32_bf16 v[132:135], a[24:27], a[92:95], v[132:135]
    ds_read_b64_tr_b16 a[22:23], v11 offset:23360
    v_mfma_f32_16x16x32_bf16 v[136:139], a[24:27], a[96:99], v[136:139]
    s_add_u32 s52, s52, 28672
    v_mfma_f32_16x16x32_bf16 v[140:143], a[24:27], a[100:103], v[140:143]
    s_waitcnt lgkmcnt(14)
    v_mfma_f32_16x16x32_bf16 v[144:147], a[28:31], a[88:91], v[144:147]
    ds_read_b64_tr_b16 a[24:25], v11 offset:7264
    v_mfma_f32_16x16x32_bf16 v[148:151], a[28:31], a[92:95], v[148:151]
    ds_read_b64_tr_b16 a[26:27], v11 offset:9056
    v_mfma_f32_16x16x32_bf16 v[152:155], a[28:31], a[96:99], v[152:155]
    s_cmp_eq_u32 s52, s54
    s_cselect_b32 s52, s53, s52
    v_mfma_f32_16x16x32_bf16 v[156:159], a[28:31], a[100:103], v[156:159]
    buffer_load_dwordx4 a[72:75], v12, s[4:7], s27 offen sc1
    v_mfma_f32_16x16x32_bf16 v[160:163], a[32:35], a[88:91], v[160:163]
    ds_read_b64_tr_b16 a[28:29], v11 offset:21600
    v_mfma_f32_16x16x32_bf16 v[164:167], a[32:35], a[92:95], v[164:167]
    ds_read_b64_tr_b16 a[30:31], v11 offset:23392
    v_mfma_f32_16x16x32_bf16 v[168:171], a[32:35], a[96:99], v[168:171]
    v_mfma_f32_16x16x32_bf16 v[172:175], a[32:35], a[100:103], v[172:175]
    buffer_load_dwordx4 a[76:79], v13, s[4:7], s27 offen sc1
    v_mfma_f32_16x16x32_bf16 v[176:179], a[36:39], a[88:91], v[176:179]
    ds_read_b64_tr_b16 a[32:33], v11 offset:7296
    s_waitcnt lgkmcnt(7)
    v_mfma_f32_16x16x32_bf16 v[180:183], a[36:39], a[92:95], v[180:183]
    ds_read_b64_tr_b16 a[34:35], v11 offset:9088
    v_fmac_f32 v128, v24, v16
    v_mfma_f32_16x16x32_bf16 v[184:187], a[36:39], a[96:99], v[184:187]
    buffer_load_dwordx4 a[80:83], v14, s[4:7], s27 offen sc1
    v_mfma_f32_16x16x32_bf16 v[188:191], a[36:39], a[100:103], v[188:191]
    v_fmac_f32 v129, v24, v17
    v_mfma_f32_16x16x32_bf16 v[192:195], a[40:43], a[88:91], v[192:195]
    ds_read_b64_tr_b16 a[36:37], v11 offset:21632
    v_fmac_f32 v130, v24, v18
    v_mfma_f32_16x16x32_bf16 v[196:199], a[40:43], a[92:95], v[196:199]
    ds_read_b64_tr_b16 a[38:39], v11 offset:23424
    v_fmac_f32 v131, v24, v19
    v_mfma_f32_16x16x32_bf16 v[200:203], a[40:43], a[96:99], v[200:203]
    buffer_load_dwordx4 a[84:87], v15, s[4:7], s27 offen sc1
    v_mfma_f32_16x16x32_bf16 v[204:207], a[40:43], a[100:103], v[204:207]
    v_fmac_f32 v132, v26, v16
    v_mfma_f32_16x16x32_bf16 v[208:211], a[44:47], a[88:91], v[208:211]
    ds_read_b64_tr_b16 a[40:41], v11 offset:7328
    v_fmac_f32 v133, v26, v17
    v_mfma_f32_16x16x32_bf16 v[212:215], a[44:47], a[92:95], v[212:215]
    ds_read_b64_tr_b16 a[42:43], v11 offset:9120
    v_fmac_f32 v134, v26, v18
    v_mfma_f32_16x16x32_bf16 v[216:219], a[44:47], a[96:99], v[216:219]
    s_add_u32 s27, s27, 151552
    v_fmac_f32 v135, v26, v19
    v_mfma_f32_16x16x32_bf16 v[220:223], a[44:47], a[100:103], v[220:223]
    v_fmac_f32 v136, v28, v16
    v_mfma_f32_16x16x32_bf16 v[224:227], a[48:51], a[88:91], v[224:227]
    ds_read_b64_tr_b16 a[44:45], v11 offset:21664
    v_fmac_f32 v137, v28, v17
    v_mfma_f32_16x16x32_bf16 v[228:231], a[48:51], a[92:95], v[228:231]
    ds_read_b64_tr_b16 a[46:47], v11 offset:23456
    v_fmac_f32 v138, v28, v18
    v_mfma_f32_16x16x32_bf16 v[232:235], a[48:51], a[96:99], v[232:235]
    s_add_u32 s37, s37, 28672
    v_fmac_f32 v139, v28, v19
    v_mfma_f32_16x16x32_bf16 v[236:239], a[48:51], a[100:103], v[236:239]
    v_fmac_f32 v140, v30, v16
    v_mfma_f32_16x16x32_bf16 v[240:243], a[52:55], a[88:91], v[240:243]
    ds_read_b64_tr_b16 a[48:49], v11 offset:7360
    v_fmac_f32 v141, v30, v17
    v_mfma_f32_16x16x32_bf16 v[244:247], a[52:55], a[92:95], v[244:247]
    ds_read_b64_tr_b16 a[50:51], v11 offset:9152
    v_fmac_f32 v142, v30, v18
    v_mfma_f32_16x16x32_bf16 v[248:251], a[52:55], a[96:99], v[248:251]
    s_cmp_eq_u32 s37, 139264
    s_cselect_b32 s37, 24576, s37
    v_mfma_f32_16x16x32_bf16 v[252:255], a[52:55], a[100:103], v[252:255]
    s_waitcnt vmcnt(16) lgkmcnt(12)
    v_fmac_f32 v143, v30, v19
    v_mfma_f32_16x16x32_bf16 v[32:35], a[0:3], a[104:107], v[32:35]
    ds_read_b64_tr_b16 a[52:53], v11 offset:21696
    v_fmac_f32 v128, v25, v20
    v_mfma_f32_16x16x32_bf16 v[36:39], a[0:3], a[108:111], v[36:39]
    ds_read_b64_tr_b16 a[54:55], v11 offset:23488
    v_fmac_f32 v129, v25, v21
    v_mfma_f32_16x16x32_bf16 v[40:43], a[0:3], a[112:115], v[40:43]
    v_fmac_f32 v130, v25, v22
    v_mfma_f32_16x16x32_bf16 v[44:47], a[0:3], a[116:119], v[44:47]
    s_barrier
    v_add_u32 v11, s37, v10
    v_mfma_f32_16x16x32_bf16 v[48:51], a[4:7], a[104:107], v[48:51]
    ds_read_b64_tr_b16 a[0:1], v11 offset:0
    v_fmac_f32 v131, v25, v23
    v_mfma_f32_16x16x32_bf16 v[52:55], a[4:7], a[108:111], v[52:55]
    ds_read_b64_tr_b16 a[2:3], v11 offset:1792
    v_fmac_f32 v132, v27, v20
    v_mfma_f32_16x16x32_bf16 v[56:59], a[4:7], a[112:115], v[56:59]
    buffer_load_dwordx4 a[88:91], v12, s[4:7], s27 offen sc1
    v_mfma_f32_16x16x32_bf16 v[60:63], a[4:7], a[116:119], v[60:63]
    v_fmac_f32 v133, v27, v21
    v_mfma_f32_16x16x32_bf16 v[64:67], a[8:11], a[104:107], v[64:67]
    ds_read_b64_tr_b16 a[4:5], v11 offset:14336
    v_fmac_f32 v134, v27, v22
    v_mfma_f32_16x16x32_bf16 v[68:71], a[8:11], a[108:111], v[68:71]
    ds_read_b64_tr_b16 a[6:7], v11 offset:16128
    v_fmac_f32 v135, v27, v23
    v_mfma_f32_16x16x32_bf16 v[72:75], a[8:11], a[112:115], v[72:75]
    buffer_load_dwordx4 a[92:95], v13, s[4:7], s27 offen sc1
    v_mfma_f32_16x16x32_bf16 v[76:79], a[8:11], a[116:119], v[76:79]
    v_fmac_f32 v136, v29, v20
    v_mfma_f32_16x16x32_bf16 v[80:83], a[12:15], a[104:107], v[80:83]
    ds_read_b64_tr_b16 a[8:9], v11 offset:32
    v_fmac_f32 v137, v29, v21
    v_mfma_f32_16x16x32_bf16 v[84:87], a[12:15], a[108:111], v[84:87]
    ds_read_b64_tr_b16 a[10:11], v11 offset:1824
    v_fmac_f32 v138, v29, v22
    v_mfma_f32_16x16x32_bf16 v[88:91], a[12:15], a[112:115], v[88:91]
    buffer_load_dwordx4 a[96:99], v14, s[4:7], s27 offen sc1
    v_mfma_f32_16x16x32_bf16 v[92:95], a[12:15], a[116:119], v[92:95]
    v_fmac_f32 v139, v29, v23
    v_mfma_f32_16x16x32_bf16 v[96:99], a[16:19], a[104:107], v[96:99]
    ds_read_b64_tr_b16 a[12:13], v11 offset:14368
    v_fmac_f32 v140, v31, v20
    v_mfma_f32_16x16x32_bf16 v[100:103], a[16:19], a[108:111], v[100:103]
    ds_read_b64_tr_b16 a[14:15], v11 offset:16160
    v_fmac_f32 v141, v31, v21
    v_mfma_f32_16x16x32_bf16 v[104:107], a[16:19], a[112:115], v[104:107]
    buffer_load_dwordx4 a[100:103], v15, s[4:7], s27 offen sc1
    v_mfma_f32_16x16x32_bf16 v[108:111], a[16:19], a[116:119], v[108:111]
    v_fmac_f32 v142, v31, v22
    v_mfma_f32_16x16x32_bf16 v[112:115], a[20:23], a[104:107], v[112:115]
    ds_read_b64_tr_b16 a[16:17], v11 offset:64
    v_fmac_f32 v143, v31, v23
    v_mfma_f32_16x16x32_bf16 v[116:119], a[20:23], a[108:111], v[116:119]
    ds_read_b64_tr_b16 a[18:19], v11 offset:1856
    v_mfma_f32_16x16x32_bf16 v[120:123], a[20:23], a[112:115], v[120:123]
    s_add_u32 s27, s27, 151552
    v_mfma_f32_16x16x32_bf16 v[124:127], a[20:23], a[116:119], v[124:127]
    ds_read_b128 v[16:19], v0 offset:640
    v_mfma_f32_16x16x32_bf16 v[128:131], a[24:27], a[104:107], v[128:131]
    ds_read_b64_tr_b16 a[20:21], v11 offset:14400
    v_mfma_f32_16x16x32_bf16 v[132:135], a[24:27], a[108:111], v[132:135]
    ds_read_b64_tr_b16 a[22:23], v11 offset:16192
    v_mfma_f32_16x16x32_bf16 v[136:139], a[24:27], a[112:115], v[136:139]
    s_add_u32 m0, s52, 0
    v_mfma_f32_16x16x32_bf16 v[140:143], a[24:27], a[116:119], v[140:143]
    s_waitcnt lgkmcnt(13)
    v_mfma_f32_16x16x32_bf16 v[144:147], a[28:31], a[104:107], v[144:147]
    ds_read_b64_tr_b16 a[24:25], v11 offset:96
    ds_read_b128 v[20:23], v0 offset:1664
    v_mfma_f32_16x16x32_bf16 v[148:151], a[28:31], a[108:111], v[148:151]
    ds_read_b64_tr_b16 a[26:27], v11 offset:1888
    v_mfma_f32_16x16x32_bf16 v[152:155], a[28:31], a[112:115], v[152:155]
    buffer_load_dwordx4 v3, s[28:31], s51 offen lds
    v_mfma_f32_16x16x32_bf16 v[156:159], a[28:31], a[116:119], v[156:159]
    v_mfma_f32_16x16x32_bf16 v[160:163], a[32:35], a[104:107], v[160:163]
    ds_read_b64_tr_b16 a[28:29], v11 offset:14432
    v_mfma_f32_16x16x32_bf16 v[164:167], a[32:35], a[108:111], v[164:167]
    ds_read_b64_tr_b16 a[30:31], v11 offset:16224
    v_mfma_f32_16x16x32_bf16 v[168:171], a[32:35], a[112:115], v[168:171]
    s_add_u32 m0, s52, 1024
    v_mfma_f32_16x16x32_bf16 v[172:175], a[32:35], a[116:119], v[172:175]
    v_mfma_f32_16x16x32_bf16 v[176:179], a[36:39], a[104:107], v[176:179]
    ds_read_b64_tr_b16 a[32:33], v11 offset:128
    v_mfma_f32_16x16x32_bf16 v[180:183], a[36:39], a[108:111], v[180:183]
    ds_read_b64_tr_b16 a[34:35], v11 offset:1920
    v_mfma_f32_16x16x32_bf16 v[184:187], a[36:39], a[112:115], v[184:187]
    buffer_load_dwordx4 v4, s[28:31], s51 offen lds
    v_mfma_f32_16x16x32_bf16 v[188:191], a[36:39], a[116:119], v[188:191]
    v_mfma_f32_16x16x32_bf16 v[192:195], a[40:43], a[104:107], v[192:195]
    ds_read_b64_tr_b16 a[36:37], v11 offset:14464
    s_waitcnt lgkmcnt(6)
    v_mfma_f32_16x16x32_bf16 v[196:199], a[40:43], a[108:111], v[196:199]
    ds_read_b64_tr_b16 a[38:39], v11 offset:16256
    v_fmac_f32 v144, v24, v16
    v_mfma_f32_16x16x32_bf16 v[200:203], a[40:43], a[112:115], v[200:203]
    s_add_u32 m0, s52, 2048
    v_fmac_f32 v145, v24, v17
    v_mfma_f32_16x16x32_bf16 v[204:207], a[40:43], a[116:119], v[204:207]
    v_fmac_f32 v146, v24, v18
    v_mfma_f32_16x16x32_bf16 v[208:211], a[44:47], a[104:107], v[208:211]
    ds_read_b64_tr_b16 a[40:41], v11 offset:160
    v_fmac_f32 v147, v24, v19
    v_mfma_f32_16x16x32_bf16 v[212:215], a[44:47], a[108:111], v[212:215]
    ds_read_b64_tr_b16 a[42:43], v11 offset:1952
    v_fmac_f32 v148, v26, v16
    v_mfma_f32_16x16x32_bf16 v[216:219], a[44:47], a[112:115], v[216:219]
    buffer_load_dwordx4 v5, s[28:31], s51 offen lds
    v_mfma_f32_16x16x32_bf16 v[220:223], a[44:47], a[116:119], v[220:223]
    v_fmac_f32 v149, v26, v17
    v_mfma_f32_16x16x32_bf16 v[224:227], a[48:51], a[104:107], v[224:227]
    ds_read_b64_tr_b16 a[44:45], v11 offset:14496
    v_fmac_f32 v150, v26, v18
    v_mfma_f32_16x16x32_bf16 v[228:231], a[48:51], a[108:111], v[228:231]
    ds_read_b64_tr_b16 a[46:47], v11 offset:16288
    v_fmac_f32 v151, v26, v19
    v_mfma_f32_16x16x32_bf16 v[232:235], a[48:51], a[112:115], v[232:235]
    s_add_u32 m0, s52, 3072
    v_fmac_f32 v152, v28, v16
    v_mfma_f32_16x16x32_bf16 v[236:239], a[48:51], a[116:119], v[236:239]
    v_fmac_f32 v153, v28, v17
    v_mfma_f32_16x16x32_bf16 v[240:243], a[52:55], a[104:107], v[240:243]
    ds_read_b64_tr_b16 a[48:49], v11 offset:192
    v_fmac_f32 v154, v28, v18
    v_mfma_f32_16x16x32_bf16 v[244:247], a[52:55], a[108:111], v[244:247]
    ds_read_b64_tr_b16 a[50:51], v11 offset:1984
    v_fmac_f32 v155, v28, v19
    v_mfma_f32_16x16x32_bf16 v[248:251], a[52:55], a[112:115], v[248:251]
    buffer_load_dwordx4 v6, s[28:31], s51 offen lds
    v_mfma_f32_16x16x32_bf16 v[252:255], a[52:55], a[116:119], v[252:255]
    s_waitcnt vmcnt(20) lgkmcnt(12)
    v_fmac_f32 v156, v30, v16
    v_mfma_f32_16x16x32_bf16 v[32:35], a[0:3], a[56:59], v[32:35]
    ds_read_b64_tr_b16 a[52:53], v11 offset:14528
    v_fmac_f32 v157, v30, v17
    v_mfma_f32_16x16x32_bf16 v[36:39], a[0:3], a[60:63], v[36:39]
    ds_read_b64_tr_b16 a[54:55], v11 offset:16320
    v_fmac_f32 v158, v30, v18
    v_mfma_f32_16x16x32_bf16 v[40:43], a[0:3], a[64:67], v[40:43]
    s_add_u32 m0, s52, 4096
    v_fmac_f32 v159, v30, v19
    v_mfma_f32_16x16x32_bf16 v[44:47], a[0:3], a[68:71], v[44:47]
    buffer_load_dwordx4 v7, s[28:31], s51 offen lds
    v_mfma_f32_16x16x32_bf16 v[48:51], a[4:7], a[56:59], v[48:51]
    ds_read_b64_tr_b16 a[0:1], v11 offset:7168
    v_fmac_f32 v144, v25, v20
    v_mfma_f32_16x16x32_bf16 v[52:55], a[4:7], a[60:63], v[52:55]
    ds_read_b64_tr_b16 a[2:3], v11 offset:8960
    v_fmac_f32 v145, v25, v21
    v_mfma_f32_16x16x32_bf16 v[56:59], a[4:7], a[64:67], v[56:59]
    v_fmac_f32 v146, v25, v22
    v_mfma_f32_16x16x32_bf16 v[60:63], a[4:7], a[68:71], v[60:63]
    s_add_u32 m0, s52, 5120
    v_fmac_f32 v147, v25, v23
    v_mfma_f32_16x16x32_bf16 v[64:67], a[8:11], a[56:59], v[64:67]
    ds_read_b64_tr_b16 a[4:5], v11 offset:21504
    v_fmac_f32 v148, v27, v20
    v_mfma_f32_16x16x32_bf16 v[68:71], a[8:11], a[60:63], v[68:71]
    ds_read_b64_tr_b16 a[6:7], v11 offset:23296
    v_fmac_f32 v149, v27, v21
    v_mfma_f32_16x16x32_bf16 v[72:75], a[8:11], a[64:67], v[72:75]
    buffer_load_dwordx4 v8, s[28:31], s51 offen lds
    v_mfma_f32_16x16x32_bf16 v[76:79], a[8:11], a[68:71], v[76:79]
    v_fmac_f32 v150, v27, v22
    v_mfma_f32_16x16x32_bf16 v[80:83], a[12:15], a[56:59], v[80:83]
    ds_read_b64_tr_b16 a[8:9], v11 offset:7200
    v_fmac_f32 v151, v27, v23
    v_mfma_f32_16x16x32_bf16 v[84:87], a[12:15], a[60:63], v[84:87]
    ds_read_b64_tr_b16 a[10:11], v11 offset:8992
    v_fmac_f32 v152, v29, v20
    v_mfma_f32_16x16x32_bf16 v[88:91], a[12:15], a[64:67], v[88:91]
    s_add_u32 m0, s52, 6144
    v_fmac_f32 v153, v29, v21
    v_mfma_f32_16x16x32_bf16 v[92:95], a[12:15], a[68:71], v[92:95]
    v_fmac_f32 v154, v29, v22
    v_mfma_f32_16x16x32_bf16 v[96:99], a[16:19], a[56:59], v[96:99]
    ds_read_b64_tr_b16 a[12:13], v11 offset:21536
    v_fmac_f32 v155, v29, v23
    v_mfma_f32_16x16x32_bf16 v[100:103], a[16:19], a[60:63], v[100:103]
    ds_read_b64_tr_b16 a[14:15], v11 offset:23328
    v_fmac_f32 v156, v31, v20
    v_mfma_f32_16x16x32_bf16 v[104:107], a[16:19], a[64:67], v[104:107]
    buffer_load_dwordx4 v9, s[28:31], s51 offen lds
    v_mfma_f32_16x16x32_bf16 v[108:111], a[16:19], a[68:71], v[108:111]
    v_fmac_f32 v157, v31, v21
    v_mfma_f32_16x16x32_bf16 v[112:115], a[20:23], a[56:59], v[112:115]
    ds_read_b64_tr_b16 a[16:17], v11 offset:7232
    v_fmac_f32 v158, v31, v22
    v_mfma_f32_16x16x32_bf16 v[116:119], a[20:23], a[60:63], v[116:119]
    ds_read_b64_tr_b16 a[18:19], v11 offset:9024
    v_fmac_f32 v159, v31, v23
    v_mfma_f32_16x16x32_bf16 v[120:123], a[20:23], a[64:67], v[120:123]
    s_add_u32 s51, s51, s55
    v_mfma_f32_16x16x32_bf16 v[124:127], a[20:23], a[68:71], v[124:127]
    v_mfma_f32_16x16x32_bf16 v[128:131], a[24:27], a[56:59], v[128:131]
    ds_read_b64_tr_b16 a[20:21], v11 offset:21568
    v_mfma_f32_16x16x32_bf16 v[132:135], a[24:27], a[60:63], v[132:135]
    ds_read_b64_tr_b16 a[22:23], v11 offset:23360
    v_mfma_f32_16x16x32_bf16 v[136:139], a[24:27], a[64:67], v[136:139]
    s_add_u32 s52, s52, 28672
    v_mfma_f32_16x16x32_bf16 v[140:143], a[24:27], a[68:71], v[140:143]
    s_waitcnt lgkmcnt(12)
    v_mfma_f32_16x16x32_bf16 v[144:147], a[28:31], a[56:59], v[144:147]
    ds_read_b64_tr_b16 a[24:25], v11 offset:7264
    v_mfma_f32_16x16x32_bf16 v[148:151], a[28:31], a[60:63], v[148:151]
    ds_read_b64_tr_b16 a[26:27], v11 offset:9056
    v_mfma_f32_16x16x32_bf16 v[152:155], a[28:31], a[64:67], v[152:155]
    s_cmp_eq_u32 s52, s54
    s_cselect_b32 s52, s53, s52
    v_mfma_f32_16x16x32_bf16 v[156:159], a[28:31], a[68:71], v[156:159]
    buffer_load_dwordx4 a[104:107], v12, s[4:7], s27 offen sc1
    ds_read_b128 v[16:19], v0 offset:256
    v_mfma_f32_16x16x32_bf16 v[160:163], a[32:35], a[56:59], v[160:163]
    ds_read_b64_tr_b16 a[28:29], v11 offset:21600
    ds_read_b128 v[20:23], v0 offset:1280
    v_mfma_f32_16x16x32_bf16 v[164:167], a[32:35], a[60:63], v[164:167]
    ds_read_b64_tr_b16 a[30:31], v11 offset:23392
    v_mfma_f32_16x16x32_bf16 v[168:171], a[32:35], a[64:67], v[168:171]
    v_mfma_f32_16x16x32_bf16 v[172:175], a[32:35], a[68:71], v[172:175]
    buffer_load_dwordx4 a[108:111], v13, s[4:7], s27 offen sc1
    v_mfma_f32_16x16x32_bf16 v[176:179], a[36:39], a[56:59], v[176:179]
    ds_read_b64_tr_b16 a[32:33], v11 offset:7296
    v_mfma_f32_16x16x32_bf16 v[180:183], a[36:39], a[60:63], v[180:183]
    ds_read_b64_tr_b16 a[34:35], v11 offset:9088
    v_mfma_f32_16x16x32_bf16 v[184:187], a[36:39], a[64:67], v[184:187]
    buffer_load_dwordx4 a[112:115], v14, s[4:7], s27 offen sc1
    v_mfma_f32_16x16x32_bf16 v[188:191], a[36:39], a[68:71], v[188:191]
    v_mfma_f32_16x16x32_bf16 v[192:195], a[40:43], a[56:59], v[192:195]
    ds_read_b64_tr_b16 a[36:37], v11 offset:21632
    v_mfma_f32_16x16x32_bf16 v[196:199], a[40:43], a[60:63], v[196:199]
    ds_read_b64_tr_b16 a[38:39], v11 offset:23424
    v_mfma_f32_16x16x32_bf16 v[200:203], a[40:43], a[64:67], v[200:203]
    buffer_load_dwordx4 a[116:119], v15, s[4:7], s27 offen sc1
    v_mfma_f32_16x16x32_bf16 v[204:207], a[40:43], a[68:71], v[204:207]
    v_mfma_f32_16x16x32_bf16 v[208:211], a[44:47], a[56:59], v[208:211]
    ds_read_b64_tr_b16 a[40:41], v11 offset:7328
    s_waitcnt lgkmcnt(6)
    v_mfma_f32_16x16x32_bf16 v[212:215], a[44:47], a[60:63], v[212:215]
    ds_read_b64_tr_b16 a[42:43], v11 offset:9120
    v_fmac_f32 v160, v24, v16
    v_mfma_f32_16x16x32_bf16 v[216:219], a[44:47], a[64:67], v[216:219]
    s_add_u32 s27, s27, 151552
    v_fmac_f32 v161, v24, v17
    v_mfma_f32_16x16x32_bf16 v[220:223], a[44:47], a[68:71], v[220:223]
    v_fmac_f32 v162, v24, v18
    v_mfma_f32_16x16x32_bf16 v[224:227], a[48:51], a[56:59], v[224:227]
    ds_read_b64_tr_b16 a[44:45], v11 offset:21664
    v_fmac_f32 v163, v24, v19
    v_mfma_f32_16x16x32_bf16 v[228:231], a[48:51], a[60:63], v[228:231]
    ds_read_b64_tr_b16 a[46:47], v11 offset:23456
    v_fmac_f32 v164, v26, v16
    v_mfma_f32_16x16x32_bf16 v[232:235], a[48:51], a[64:67], v[232:235]
    s_add_u32 s37, s37, 28672
    v_fmac_f32 v165, v26, v17
    v_mfma_f32_16x16x32_bf16 v[236:239], a[48:51], a[68:71], v[236:239]
    v_fmac_f32 v166, v26, v18
    v_mfma_f32_16x16x32_bf16 v[240:243], a[52:55], a[56:59], v[240:243]
    ds_read_b64_tr_b16 a[48:49], v11 offset:7360
    v_fmac_f32 v167, v26, v19
    v_mfma_f32_16x16x32_bf16 v[244:247], a[52:55], a[60:63], v[244:247]
    ds_read_b64_tr_b16 a[50:51], v11 offset:9152
    v_fmac_f32 v168, v28, v16
    v_mfma_f32_16x16x32_bf16 v[248:251], a[52:55], a[64:67], v[248:251]
    s_cmp_eq_u32 s37, 139264
    s_cselect_b32 s37, 24576, s37
    v_mfma_f32_16x16x32_bf16 v[252:255], a[52:55], a[68:71], v[252:255]
    s_waitcnt vmcnt(15)
    v_fmac_f32 v169, v28, v17
    v_mfma_f32_16x16x32_bf16 v[32:35], a[0:3], a[72:75], v[32:35]
    ds_read_b64_tr_b16 a[52:53], v11 offset:21696
    v_fmac_f32 v170, v28, v18
    v_mfma_f32_16x16x32_bf16 v[36:39], a[0:3], a[76:79], v[36:39]
    ds_read_b64_tr_b16 a[54:55], v11 offset:23488
    v_fmac_f32 v171, v28, v19
    v_mfma_f32_16x16x32_bf16 v[40:43], a[0:3], a[80:83], v[40:43]
    v_fmac_f32 v172, v30, v16
    v_mfma_f32_16x16x32_bf16 v[44:47], a[0:3], a[84:87], v[44:47]
    s_barrier
    v_add_u32 v11, s37, v10
    v_mfma_f32_16x16x32_bf16 v[48:51], a[4:7], a[72:75], v[48:51]
    ds_read_b64_tr_b16 a[0:1], v11 offset:0
    v_fmac_f32 v173, v30, v17
    v_mfma_f32_16x16x32_bf16 v[52:55], a[4:7], a[76:79], v[52:55]
    ds_read_b64_tr_b16 a[2:3], v11 offset:1792
    v_fmac_f32 v174, v30, v18
    v_mfma_f32_16x16x32_bf16 v[56:59], a[4:7], a[80:83], v[56:59]
    buffer_load_dwordx4 a[56:59], v12, s[4:7], s27 offen sc1
    v_mfma_f32_16x16x32_bf16 v[60:63], a[4:7], a[84:87], v[60:63]
    v_fmac_f32 v175, v30, v19
    v_mfma_f32_16x16x32_bf16 v[64:67], a[8:11], a[72:75], v[64:67]
    ds_read_b64_tr_b16 a[4:5], v11 offset:14336
    v_fmac_f32 v160, v25, v20
    v_mfma_f32_16x16x32_bf16 v[68:71], a[8:11], a[76:79], v[68:71]
    ds_read_b64_tr_b16 a[6:7], v11 offset:16128
    v_fmac_f32 v161, v25, v21
    v_mfma_f32_16x16x32_bf16 v[72:75], a[8:11], a[80:83], v[72:75]
    buffer_load_dwordx4 a[60:63], v13, s[4:7], s27 offen sc1
    v_mfma_f32_16x16x32_bf16 v[76:79], a[8:11], a[84:87], v[76:79]
    v_fmac_f32 v162, v25, v22
    v_mfma_f32_16x16x32_bf16 v[80:83], a[12:15], a[72:75], v[80:83]
    ds_read_b64_tr_b16 a[8:9], v11 offset:32
    v_fmac_f32 v163, v25, v23
    v_mfma_f32_16x16x32_bf16 v[84:87], a[12:15], a[76:79], v[84:87]
    ds_read_b64_tr_b16 a[10:11], v11 offset:1824
    v_fmac_f32 v164, v27, v20
    v_mfma_f32_16x16x32_bf16 v[88:91], a[12:15], a[80:83], v[88:91]
    buffer_load_dwordx4 a[64:67], v14, s[4:7], s27 offen sc1
    v_mfma_f32_16x16x32_bf16 v[92:95], a[12:15], a[84:87], v[92:95]
    buffer_load_dwordx4 a[68:71], v15, s[4:7], s27 offen sc1
    v_mfma_f32_16x16x32_bf16 v[96:99], a[16:19], a[72:75], v[96:99]
    ds_read_b64_tr_b16 a[12:13], v11 offset:14368
    v_fmac_f32 v165, v27, v21
    v_mfma_f32_16x16x32_bf16 v[100:103], a[16:19], a[76:79], v[100:103]
    ds_read_b64_tr_b16 a[14:15], v11 offset:16160
    v_fmac_f32 v166, v27, v22
    v_mfma_f32_16x16x32_bf16 v[104:107], a[16:19], a[80:83], v[104:107]
    v_fmac_f32 v167, v27, v23
    v_mfma_f32_16x16x32_bf16 v[108:111], a[16:19], a[84:87], v[108:111]
    s_add_u32 s27, s27, 151552
    v_fmac_f32 v168, v29, v20
    v_mfma_f32_16x16x32_bf16 v[112:115], a[20:23], a[72:75], v[112:115]
    ds_read_b64_tr_b16 a[16:17], v11 offset:64
    v_fmac_f32 v169, v29, v21
    v_mfma_f32_16x16x32_bf16 v[116:119], a[20:23], a[76:79], v[116:119]
    ds_read_b64_tr_b16 a[18:19], v11 offset:1856
    v_fmac_f32 v170, v29, v22
    v_mfma_f32_16x16x32_bf16 v[120:123], a[20:23], a[80:83], v[120:123]
    v_fmac_f32 v171, v29, v23
    v_mfma_f32_16x16x32_bf16 v[124:127], a[20:23], a[84:87], v[124:127]
    s_add_u32 m0, s52, 0
    v_fmac_f32 v172, v31, v20
    v_mfma_f32_16x16x32_bf16 v[128:131], a[24:27], a[72:75], v[128:131]
    ds_read_b64_tr_b16 a[20:21], v11 offset:14400
    v_fmac_f32 v173, v31, v21
    v_mfma_f32_16x16x32_bf16 v[132:135], a[24:27], a[76:79], v[132:135]
    ds_read_b64_tr_b16 a[22:23], v11 offset:16192
    v_fmac_f32 v174, v31, v22
    v_mfma_f32_16x16x32_bf16 v[136:139], a[24:27], a[80:83], v[136:139]
    buffer_load_dwordx4 v3, s[28:31], s51 offen lds
    v_mfma_f32_16x16x32_bf16 v[140:143], a[24:27], a[84:87], v[140:143]
    s_waitcnt lgkmcnt(12)
    v_fmac_f32 v175, v31, v23
    v_mfma_f32_16x16x32_bf16 v[144:147], a[28:31], a[72:75], v[144:147]
    ds_read_b64_tr_b16 a[24:25], v11 offset:96
    v_mfma_f32_16x16x32_bf16 v[148:151], a[28:31], a[76:79], v[148:151]
    ds_read_b64_tr_b16 a[26:27], v11 offset:1888
    v_mfma_f32_16x16x32_bf16 v[152:155], a[28:31], a[80:83], v[152:155]
    s_add_u32 m0, s52, 1024
    v_mfma_f32_16x16x32_bf16 v[156:159], a[28:31], a[84:87], v[156:159]
    ds_read_b128 v[16:19], v0 offset:704
    v_mfma_f32_16x16x32_bf16 v[160:163], a[32:35], a[72:75], v[160:163]
    ds_read_b64_tr_b16 a[28:29], v11 offset:14432
    v_mfma_f32_16x16x32_bf16 v[164:167], a[32:35], a[76:79], v[164:167]
    ds_read_b64_tr_b16 a[30:31], v11 offset:16224
    v_mfma_f32_16x16x32_bf16 v[168:171], a[32:35], a[80:83], v[168:171]
    buffer_load_dwordx4 v4, s[28:31], s51 offen lds
    v_mfma_f32_16x16x32_bf16 v[172:175], a[32:35], a[84:87], v[172:175]
    ds_read_b128 v[20:23], v0 offset:1728
    v_mfma_f32_16x16x32_bf16 v[176:179], a[36:39], a[72:75], v[176:179]
    ds_read_b64_tr_b16 a[32:33], v11 offset:128
    v_mfma_f32_16x16x32_bf16 v[180:183], a[36:39], a[76:79], v[180:183]
    ds_read_b64_tr_b16 a[34:35], v11 offset:1920
    v_mfma_f32_16x16x32_bf16 v[184:187], a[36:39], a[80:83], v[184:187]
    s_add_u32 m0, s52, 2048
    v_mfma_f32_16x16x32_bf16 v[188:191], a[36:39], a[84:87], v[188:191]
    v_mfma_f32_16x16x32_bf16 v[192:195], a[40:43], a[72:75], v[192:195]
    ds_read_b64_tr_b16 a[36:37], v11 offset:14464
    v_mfma_f32_16x16x32_bf16 v[196:199], a[40:43], a[76:79], v[196:199]
    ds_read_b64_tr_b16 a[38:39], v11 offset:16256
    v_mfma_f32_16x16x32_bf16 v[200:203], a[40:43], a[80:83], v[200:203]
    buffer_load_dwordx4 v5, s[28:31], s51 offen lds
    v_mfma_f32_16x16x32_bf16 v[204:207], a[40:43], a[84:87], v[204:207]
    v_mfma_f32_16x16x32_bf16 v[208:211], a[44:47], a[72:75], v[208:211]
    ds_read_b64_tr_b16 a[40:41], v11 offset:160
    v_mfma_f32_16x16x32_bf16 v[212:215], a[44:47], a[76:79], v[212:215]
    ds_read_b64_tr_b16 a[42:43], v11 offset:1952
    v_mfma_f32_16x16x32_bf16 v[216:219], a[44:47], a[80:83], v[216:219]
    s_add_u32 m0, s52, 3072
    v_mfma_f32_16x16x32_bf16 v[220:223], a[44:47], a[84:87], v[220:223]
    v_mfma_f32_16x16x32_bf16 v[224:227], a[48:51], a[72:75], v[224:227]
    ds_read_b64_tr_b16 a[44:45], v11 offset:14496
    s_waitcnt lgkmcnt(7)
    v_mfma_f32_16x16x32_bf16 v[228:231], a[48:51], a[76:79], v[228:231]
    ds_read_b64_tr_b16 a[46:47], v11 offset:16288
    v_fmac_f32 v176, v24, v16
    v_mfma_f32_16x16x32_bf16 v[232:235], a[48:51], a[80:83], v[232:235]
    buffer_load_dwordx4 v6, s[28:31], s51 offen lds
    v_mfma_f32_16x16x32_bf16 v[236:239], a[48:51], a[84:87], v[236:239]
    v_fmac_f32 v177, v24, v17
    v_mfma_f32_16x16x32_bf16 v[240:243], a[52:55], a[72:75], v[240:243]
    ds_read_b64_tr_b16 a[48:49], v11 offset:192
    v_fmac_f32 v178, v24, v18
    v_mfma_f32_16x16x32_bf16 v[244:247], a[52:55], a[76:79], v[244:247]
    ds_read_b64_tr_b16 a[50:51], v11 offset:1984
    v_fmac_f32 v179, v24, v19
    v_mfma_f32_16x16x32_bf16 v[248:251], a[52:55], a[80:83], v[248:251]
    buffer_load_dword a156, v2, s[68:71], 0 offen
    v_mfma_f32_16x16x32_bf16 v[252:255], a[52:55], a[84:87], v[252:255]
    s_waitcnt vmcnt(20)
    v_fmac_f32 v180, v26, v16
    ds_read_b64_tr_b16 a[52:53], v11 offset:14528
    ds_read_b64_tr_b16 a[54:55], v11 offset:16320
    v_mfma_f32_16x16x32_bf16 v[32:35], a[0:3], a[88:91], v[32:35]
    s_add_u32 m0, s52, 4096
    v_fmac_f32 v181, v26, v17
    v_mfma_f32_16x16x32_bf16 v[36:39], a[0:3], a[92:95], v[36:39]
    v_fmac_f32 v182, v26, v18
    v_mfma_f32_16x16x32_bf16 v[40:43], a[0:3], a[96:99], v[40:43]
    v_fmac_f32 v183, v26, v19
    v_mfma_f32_16x16x32_bf16 v[44:47], a[0:3], a[100:103], v[44:47]
    buffer_load_dwordx4 v7, s[28:31], s51 offen lds
    v_mfma_f32_16x16x32_bf16 v[48:51], a[4:7], a[88:91], v[48:51]
    ds_read_b64_tr_b16 a[0:1], v11 offset:7168
    v_fmac_f32 v184, v28, v16
    v_mfma_f32_16x16x32_bf16 v[52:55], a[4:7], a[92:95], v[52:55]
    ds_read_b64_tr_b16 a[2:3], v11 offset:8960
    v_fmac_f32 v185, v28, v17
    v_mfma_f32_16x16x32_bf16 v[56:59], a[4:7], a[96:99], v[56:59]
    v_fmac_f32 v186, v28, v18
    v_mfma_f32_16x16x32_bf16 v[60:63], a[4:7], a[100:103], v[60:63]
    s_add_u32 m0, s52, 5120
    v_fmac_f32 v187, v28, v19
    v_mfma_f32_16x16x32_bf16 v[64:67], a[8:11], a[88:91], v[64:67]
    ds_read_b64_tr_b16 a[4:5], v11 offset:21504
    v_fmac_f32 v188, v30, v16
    v_mfma_f32_16x16x32_bf16 v[68:71], a[8:11], a[92:95], v[68:71]
    ds_read_b64_tr_b16 a[6:7], v11 offset:23296
    v_fmac_f32 v189, v30, v17
    v_mfma_f32_16x16x32_bf16 v[72:75], a[8:11], a[96:99], v[72:75]
    buffer_load_dwordx4 v8, s[28:31], s51 offen lds
    v_mfma_f32_16x16x32_bf16 v[76:79], a[8:11], a[100:103], v[76:79]
    v_fmac_f32 v190, v30, v18
    v_mfma_f32_16x16x32_bf16 v[80:83], a[12:15], a[88:91], v[80:83]
    ds_read_b64_tr_b16 a[8:9], v11 offset:7200
    v_fmac_f32 v191, v30, v19
    v_mfma_f32_16x16x32_bf16 v[84:87], a[12:15], a[92:95], v[84:87]
    ds_read_b64_tr_b16 a[10:11], v11 offset:8992
    v_fmac_f32 v176, v25, v20
    v_mfma_f32_16x16x32_bf16 v[88:91], a[12:15], a[96:99], v[88:91]
    s_add_u32 m0, s52, 6144
    v_fmac_f32 v177, v25, v21
    v_mfma_f32_16x16x32_bf16 v[92:95], a[12:15], a[100:103], v[92:95]
    v_fmac_f32 v178, v25, v22
    v_mfma_f32_16x16x32_bf16 v[96:99], a[16:19], a[88:91], v[96:99]
    ds_read_b64_tr_b16 a[12:13], v11 offset:21536
    v_fmac_f32 v179, v25, v23
    v_mfma_f32_16x16x32_bf16 v[100:103], a[16:19], a[92:95], v[100:103]
    ds_read_b64_tr_b16 a[14:15], v11 offset:23328
    v_fmac_f32 v180, v27, v20
    v_mfma_f32_16x16x32_bf16 v[104:107], a[16:19], a[96:99], v[104:107]
    buffer_load_dwordx4 v9, s[28:31], s51 offen lds
    v_mfma_f32_16x16x32_bf16 v[108:111], a[16:19], a[100:103], v[108:111]
    v_fmac_f32 v181, v27, v21
    v_mfma_f32_16x16x32_bf16 v[112:115], a[20:23], a[88:91], v[112:115]
    ds_read_b64_tr_b16 a[16:17], v11 offset:7232
    v_fmac_f32 v182, v27, v22
    v_mfma_f32_16x16x32_bf16 v[116:119], a[20:23], a[92:95], v[116:119]
    ds_read_b64_tr_b16 a[18:19], v11 offset:9024
    v_fmac_f32 v183, v27, v23
    v_mfma_f32_16x16x32_bf16 v[120:123], a[20:23], a[96:99], v[120:123]
    s_add_u32 s51, s51, s55
    v_fmac_f32 v184, v29, v20
    v_mfma_f32_16x16x32_bf16 v[124:127], a[20:23], a[100:103], v[124:127]
    v_fmac_f32 v185, v29, v21
    v_mfma_f32_16x16x32_bf16 v[128:131], a[24:27], a[88:91], v[128:131]
    ds_read_b64_tr_b16 a[20:21], v11 offset:21568
    v_fmac_f32 v186, v29, v22
    v_mfma_f32_16x16x32_bf16 v[132:135], a[24:27], a[92:95], v[132:135]
    ds_read_b64_tr_b16 a[22:23], v11 offset:23360
    v_fmac_f32 v187, v29, v23
    v_mfma_f32_16x16x32_bf16 v[136:139], a[24:27], a[96:99], v[136:139]
    s_add_u32 s52, s52, 28672
    v_fmac_f32 v188, v31, v20
    v_mfma_f32_16x16x32_bf16 v[140:143], a[24:27], a[100:103], v[140:143]
    s_waitcnt lgkmcnt(12)
    v_fmac_f32 v189, v31, v21
    v_mfma_f32_16x16x32_bf16 v[144:147], a[28:31], a[88:91], v[144:147]
    ds_read_b64_tr_b16 a[24:25], v11 offset:7264
    v_fmac_f32 v190, v31, v22
    v_mfma_f32_16x16x32_bf16 v[148:151], a[28:31], a[92:95], v[148:151]
    ds_read_b64_tr_b16 a[26:27], v11 offset:9056
    v_fmac_f32 v191, v31, v23
    v_mfma_f32_16x16x32_bf16 v[152:155], a[28:31], a[96:99], v[152:155]
    s_cmp_eq_u32 s52, s54
    s_cselect_b32 s52, s53, s52
    v_mfma_f32_16x16x32_bf16 v[156:159], a[28:31], a[100:103], v[156:159]
    buffer_load_dwordx4 a[72:75], v12, s[4:7], s27 offen sc1
    v_mfma_f32_16x16x32_bf16 v[160:163], a[32:35], a[88:91], v[160:163]
    ds_read_b64_tr_b16 a[28:29], v11 offset:21600
    v_mfma_f32_16x16x32_bf16 v[164:167], a[32:35], a[92:95], v[164:167]
    ds_read_b64_tr_b16 a[30:31], v11 offset:23392
    v_mfma_f32_16x16x32_bf16 v[168:171], a[32:35], a[96:99], v[168:171]
    ds_read_b128 v[16:19], v0 offset:320
    v_mfma_f32_16x16x32_bf16 v[172:175], a[32:35], a[100:103], v[172:175]
    buffer_load_dwordx4 a[76:79], v13, s[4:7], s27 offen sc1
    v_mfma_f32_16x16x32_bf16 v[176:179], a[36:39], a[88:91], v[176:179]
    ds_read_b64_tr_b16 a[32:33], v11 offset:7296
    v_mfma_f32_16x16x32_bf16 v[180:183], a[36:39], a[92:95], v[180:183]
    ds_read_b64_tr_b16 a[34:35], v11 offset:9088
    v_mfma_f32_16x16x32_bf16 v[184:187], a[36:39], a[96:99], v[184:187]
    buffer_load_dwordx4 a[80:83], v14, s[4:7], s27 offen sc1
    v_mfma_f32_16x16x32_bf16 v[188:191], a[36:39], a[100:103], v[188:191]
    ds_read_b128 v[20:23], v0 offset:1344
    v_mfma_f32_16x16x32_bf16 v[192:195], a[40:43], a[88:91], v[192:195]
    ds_read_b64_tr_b16 a[36:37], v11 offset:21632
    v_mfma_f32_16x16x32_bf16 v[196:199], a[40:43], a[92:95], v[196:199]
    ds_read_b64_tr_b16 a[38:39], v11 offset:23424
    v_mfma_f32_16x16x32_bf16 v[200:203], a[40:43], a[96:99], v[200:203]
    buffer_load_dwordx4 a[84:87], v15, s[4:7], s27 offen sc1
    v_mfma_f32_16x16x32_bf16 v[204:207], a[40:43], a[100:103], v[204:207]
    v_accvgpr_read_b32 v3, a174
    v_mfma_f32_16x16x32_bf16 v[208:211], a[44:47], a[88:91], v[208:211]
    ds_read_b64_tr_b16 a[40:41], v11 offset:7328
    v_mfma_f32_16x16x32_bf16 v[212:215], a[44:47], a[92:95], v[212:215]
    ds_read_b64_tr_b16 a[42:43], v11 offset:9120
    v_mfma_f32_16x16x32_bf16 v[216:219], a[44:47], a[96:99], v[216:219]
    s_add_u32 s27, s27, 151552
    v_mfma_f32_16x16x32_bf16 v[220:223], a[44:47], a[100:103], v[220:223]
    v_accvgpr_read_b32 v4, a175
    v_mfma_f32_16x16x32_bf16 v[224:227], a[48:51], a[88:91], v[224:227]
    ds_read_b64_tr_b16 a[44:45], v11 offset:21664
    v_mfma_f32_16x16x32_bf16 v[228:231], a[48:51], a[92:95], v[228:231]
    ds_read_b64_tr_b16 a[46:47], v11 offset:23456
    v_accvgpr_read_b32 v5, a176
    v_mfma_f32_16x16x32_bf16 v[232:235], a[48:51], a[96:99], v[232:235]
    s_add_u32 s37, s37, 28672
    v_accvgpr_read_b32 v6, a177
    v_mfma_f32_16x16x32_bf16 v[236:239], a[48:51], a[100:103], v[236:239]
    v_mfma_f32_16x16x32_bf16 v[240:243], a[52:55], a[88:91], v[240:243]
    ds_read_b64_tr_b16 a[48:49], v11 offset:7360
    s_waitcnt lgkmcnt(7)
    v_mfma_f32_16x16x32_bf16 v[244:247], a[52:55], a[92:95], v[244:247]
    ds_read_b64_tr_b16 a[50:51], v11 offset:9152
    v_fmac_f32 v192, v24, v16
    v_mfma_f32_16x16x32_bf16 v[248:251], a[52:55], a[96:99], v[248:251]
    s_cmp_eq_u32 s37, 139264
    s_cselect_b32 s37, 24576, s37
    v_mfma_f32_16x16x32_bf16 v[252:255], a[52:55], a[100:103], v[252:255]
    s_waitcnt vmcnt(16)
    v_fmac_f32 v193, v24, v17
    v_mfma_f32_16x16x32_bf16 v[32:35], a[0:3], a[104:107], v[32:35]
    ds_read_b64_tr_b16 a[52:53], v11 offset:21696
    v_fmac_f32 v194, v24, v18
    v_mfma_f32_16x16x32_bf16 v[36:39], a[0:3], a[108:111], v[36:39]
    ds_read_b64_tr_b16 a[54:55], v11 offset:23488
    v_fmac_f32 v195, v24, v19
    v_mfma_f32_16x16x32_bf16 v[40:43], a[0:3], a[112:115], v[40:43]
    v_fmac_f32 v196, v26, v16
    v_mfma_f32_16x16x32_bf16 v[44:47], a[0:3], a[116:119], v[44:47]
    s_barrier
    v_add_u32 v11, s37, v10
    v_mfma_f32_16x16x32_bf16 v[48:51], a[4:7], a[104:107], v[48:51]
    ds_read_b64_tr_b16 a[0:1], v11 offset:0
    v_fmac_f32 v197, v26, v17
    v_mfma_f32_16x16x32_bf16 v[52:55], a[4:7], a[108:111], v[52:55]
    ds_read_b64_tr_b16 a[2:3], v11 offset:1792
    v_fmac_f32 v198, v26, v18
    v_mfma_f32_16x16x32_bf16 v[56:59], a[4:7], a[112:115], v[56:59]
    buffer_load_dwordx4 a[88:91], v12, s[4:7], s27 offen sc1
    v_mfma_f32_16x16x32_bf16 v[60:63], a[4:7], a[116:119], v[60:63]
    v_fmac_f32 v199, v26, v19
    v_mfma_f32_16x16x32_bf16 v[64:67], a[8:11], a[104:107], v[64:67]
    ds_read_b64_tr_b16 a[4:5], v11 offset:14336
    v_fmac_f32 v200, v28, v16
    v_mfma_f32_16x16x32_bf16 v[68:71], a[8:11], a[108:111], v[68:71]
    ds_read_b64_tr_b16 a[6:7], v11 offset:16128
    v_fmac_f32 v201, v28, v17
    v_mfma_f32_16x16x32_bf16 v[72:75], a[8:11], a[112:115], v[72:75]
    buffer_load_dwordx4 a[92:95], v13, s[4:7], s27 offen sc1
    v_mfma_f32_16x16x32_bf16 v[76:79], a[8:11], a[116:119], v[76:79]
    v_fmac_f32 v202, v28, v18
    v_mfma_f32_16x16x32_bf16 v[80:83], a[12:15], a[104:107], v[80:83]
    ds_read_b64_tr_b16 a[8:9], v11 offset:32
    v_fmac_f32 v203, v28, v19
    v_mfma_f32_16x16x32_bf16 v[84:87], a[12:15], a[108:111], v[84:87]
    ds_read_b64_tr_b16 a[10:11], v11 offset:1824
    v_fmac_f32 v204, v30, v16
    v_mfma_f32_16x16x32_bf16 v[88:91], a[12:15], a[112:115], v[88:91]
    v_fmac_f32 v205, v30, v17
    v_mfma_f32_16x16x32_bf16 v[92:95], a[12:15], a[116:119], v[92:95]
    v_fmac_f32 v206, v30, v18
    v_mfma_f32_16x16x32_bf16 v[96:99], a[16:19], a[104:107], v[96:99]
    ds_read_b64_tr_b16 a[12:13], v11 offset:14368
    v_fmac_f32 v207, v30, v19
    v_mfma_f32_16x16x32_bf16 v[100:103], a[16:19], a[108:111], v[100:103]
    ds_read_b64_tr_b16 a[14:15], v11 offset:16160
    v_fmac_f32 v192, v25, v20
    v_mfma_f32_16x16x32_bf16 v[104:107], a[16:19], a[112:115], v[104:107]
    buffer_load_dwordx4 a[96:99], v14, s[4:7], s27 offen sc1
    v_mfma_f32_16x16x32_bf16 v[108:111], a[16:19], a[116:119], v[108:111]
    v_fmac_f32 v193, v25, v21
    v_mfma_f32_16x16x32_bf16 v[112:115], a[20:23], a[104:107], v[112:115]
    ds_read_b64_tr_b16 a[16:17], v11 offset:64
    v_fmac_f32 v194, v25, v22
    v_mfma_f32_16x16x32_bf16 v[116:119], a[20:23], a[108:111], v[116:119]
    ds_read_b64_tr_b16 a[18:19], v11 offset:1856
    v_fmac_f32 v195, v25, v23
    v_mfma_f32_16x16x32_bf16 v[120:123], a[20:23], a[112:115], v[120:123]
    buffer_load_dwordx4 a[100:103], v15, s[4:7], s27 offen sc1
    v_mfma_f32_16x16x32_bf16 v[124:127], a[20:23], a[116:119], v[124:127]
    v_fmac_f32 v196, v27, v20
    v_mfma_f32_16x16x32_bf16 v[128:131], a[24:27], a[104:107], v[128:131]
    ds_read_b64_tr_b16 a[20:21], v11 offset:14400
    v_fmac_f32 v197, v27, v21
    v_mfma_f32_16x16x32_bf16 v[132:135], a[24:27], a[108:111], v[132:135]
    ds_read_b64_tr_b16 a[22:23], v11 offset:16192
    v_fmac_f32 v198, v27, v22
    v_mfma_f32_16x16x32_bf16 v[136:139], a[24:27], a[112:115], v[136:139]
    v_fmac_f32 v199, v27, v23
    v_mfma_f32_16x16x32_bf16 v[140:143], a[24:27], a[116:119], v[140:143]
    s_waitcnt lgkmcnt(12)
    s_add_u32 s27, s27, 151552
    v_mfma_f32_16x16x32_bf16 v[144:147], a[28:31], a[104:107], v[144:147]
    ds_read_b64_tr_b16 a[24:25], v11 offset:96
    v_fmac_f32 v200, v29, v20
    v_mfma_f32_16x16x32_bf16 v[148:151], a[28:31], a[108:111], v[148:151]
    ds_read_b64_tr_b16 a[26:27], v11 offset:1888
    v_fmac_f32 v201, v29, v21
    v_mfma_f32_16x16x32_bf16 v[152:155], a[28:31], a[112:115], v[152:155]
    v_fmac_f32 v202, v29, v22
    v_mfma_f32_16x16x32_bf16 v[156:159], a[28:31], a[116:119], v[156:159]
    v_fmac_f32 v203, v29, v23
    v_mfma_f32_16x16x32_bf16 v[160:163], a[32:35], a[104:107], v[160:163]
    ds_read_b64_tr_b16 a[28:29], v11 offset:14432
    v_fmac_f32 v204, v31, v20
    v_mfma_f32_16x16x32_bf16 v[164:167], a[32:35], a[108:111], v[164:167]
    ds_read_b64_tr_b16 a[30:31], v11 offset:16224
    v_fmac_f32 v205, v31, v21
    v_mfma_f32_16x16x32_bf16 v[168:171], a[32:35], a[112:115], v[168:171]
    s_add_u32 m0, s44, 0
    v_fmac_f32 v206, v31, v22
    v_mfma_f32_16x16x32_bf16 v[172:175], a[32:35], a[116:119], v[172:175]
    v_fmac_f32 v207, v31, v23
    v_mfma_f32_16x16x32_bf16 v[176:179], a[36:39], a[104:107], v[176:179]
    ds_read_b64_tr_b16 a[32:33], v11 offset:128
    v_mfma_f32_16x16x32_bf16 v[180:183], a[36:39], a[108:111], v[180:183]
    ds_read_b64_tr_b16 a[34:35], v11 offset:1920
    v_mfma_f32_16x16x32_bf16 v[184:187], a[36:39], a[112:115], v[184:187]
    ds_read_b128 v[16:19], v0 offset:768
    v_mfma_f32_16x16x32_bf16 v[188:191], a[36:39], a[116:119], v[188:191]
    buffer_load_dwordx4 v3, s[8:11], s43 offen lds
    v_mfma_f32_16x16x32_bf16 v[192:195], a[40:43], a[104:107], v[192:195]
    ds_read_b64_tr_b16 a[36:37], v11 offset:14464
    v_mfma_f32_16x16x32_bf16 v[196:199], a[40:43], a[108:111], v[196:199]
    ds_read_b64_tr_b16 a[38:39], v11 offset:16256
    v_mfma_f32_16x16x32_bf16 v[200:203], a[40:43], a[112:115], v[200:203]
    ds_read_b128 v[20:23], v0 offset:1792
    v_mfma_f32_16x16x32_bf16 v[204:207], a[40:43], a[116:119], v[204:207]
    v_mfma_f32_16x16x32_bf16 v[208:211], a[44:47], a[104:107], v[208:211]
    ds_read_b64_tr_b16 a[40:41], v11 offset:160
    v_mfma_f32_16x16x32_bf16 v[212:215], a[44:47], a[108:111], v[212:215]
    ds_read_b64_tr_b16 a[42:43], v11 offset:1952
    v_mfma_f32_16x16x32_bf16 v[216:219], a[44:47], a[112:115], v[216:219]
    s_add_u32 m0, s44, 1024
    v_mfma_f32_16x16x32_bf16 v[220:223], a[44:47], a[116:119], v[220:223]
    v_mfma_f32_16x16x32_bf16 v[224:227], a[48:51], a[104:107], v[224:227]
    ds_read_b64_tr_b16 a[44:45], v11 offset:14496
    v_mfma_f32_16x16x32_bf16 v[228:231], a[48:51], a[108:111], v[228:231]
    ds_read_b64_tr_b16 a[46:47], v11 offset:16288
    v_mfma_f32_16x16x32_bf16 v[232:235], a[48:51], a[112:115], v[232:235]
    buffer_load_dwordx4 v4, s[8:11], s43 offen lds
    v_mfma_f32_16x16x32_bf16 v[236:239], a[48:51], a[116:119], v[236:239]
    v_mfma_f32_16x16x32_bf16 v[240:243], a[52:55], a[104:107], v[240:243]
    ds_read_b64_tr_b16 a[48:49], v11 offset:192
    v_mfma_f32_16x16x32_bf16 v[244:247], a[52:55], a[108:111], v[244:247]
    ds_read_b64_tr_b16 a[50:51], v11 offset:1984
    v_mfma_f32_16x16x32_bf16 v[248:251], a[52:55], a[112:115], v[248:251]
    v_mfma_f32_16x16x32_bf16 v[252:255], a[52:55], a[116:119], v[252:255]
    s_waitcnt vmcnt(18) lgkmcnt(14)
    v_mfma_f32_16x16x32_bf16 v[32:35], a[0:3], a[56:59], v[32:35]
    ds_read_b64_tr_b16 a[52:53], v11 offset:14528
    s_waitcnt lgkmcnt(7)
    v_mfma_f32_16x16x32_bf16 v[36:39], a[0:3], a[60:63], v[36:39]
    ds_read_b64_tr_b16 a[54:55], v11 offset:16320
    v_fmac_f32 v208, v24, v16
    v_mfma_f32_16x16x32_bf16 v[40:43], a[0:3], a[64:67], v[40:43]
    buffer_load_dwordx4 a[104:107], v12, s[4:7], s27 offen sc1
    v_mfma_f32_16x16x32_bf16 v[44:47], a[0:3], a[68:71], v[44:47]
    v_fmac_f32 v209, v24, v17
    v_mfma_f32_16x16x32_bf16 v[48:51], a[4:7], a[56:59], v[48:51]
    ds_read_b64_tr_b16 a[0:1], v11 offset:7168
    v_fmac_f32 v210, v24, v18
    v_mfma_f32_16x16x32_bf16 v[52:55], a[4:7], a[60:63], v[52:55]
    ds_read_b64_tr_b16 a[2:3], v11 offset:8960
    v_fmac_f32 v211, v24, v19
    v_mfma_f32_16x16x32_bf16 v[56:59], a[4:7], a[64:67], v[56:59]
    buffer_load_dwordx4 a[108:111], v13, s[4:7], s27 offen sc1
    v_mfma_f32_16x16x32_bf16 v[60:63], a[4:7], a[68:71], v[60:63]
    v_fmac_f32 v212, v26, v16
    v_mfma_f32_16x16x32_bf16 v[64:67], a[8:11], a[56:59], v[64:67]
    ds_read_b64_tr_b16 a[4:5], v11 offset:21504
    v_fmac_f32 v213, v26, v17
    v_mfma_f32_16x16x32_bf16 v[68:71], a[8:11], a[60:63], v[68:71]
    ds_read_b64_tr_b16 a[6:7], v11 offset:23296
    v_fmac_f32 v214, v26, v18
    v_mfma_f32_16x16x32_bf16 v[72:75], a[8:11], a[64:67], v[72:75]
    buffer_load_dwordx4 a[112:115], v14, s[4:7], s27 offen sc1
    v_mfma_f32_16x16x32_bf16 v[76:79], a[8:11], a[68:71], v[76:79]
    v_fmac_f32 v215, v26, v19
    v_mfma_f32_16x16x32_bf16 v[80:83], a[12:15], a[56:59], v[80:83]
    ds_read_b64_tr_b16 a[8:9], v11 offset:7200
    v_fmac_f32 v216, v28, v16
    v_mfma_f32_16x16x32_bf16 v[84:87], a[12:15], a[60:63], v[84:87]
    ds_read_b64_tr_b16 a[10:11], v11 offset:8992
    v_fmac_f32 v217, v28, v17
    v_mfma_f32_16x16x32_bf16 v[88:91], a[12:15], a[64:67], v[88:91]
    buffer_load_dwordx4 a[116:119], v15, s[4:7], s27 offen sc1
    v_mfma_f32_16x16x32_bf16 v[92:95], a[12:15], a[68:71], v[92:95]
    v_fmac_f32 v218, v28, v18
    v_mfma_f32_16x16x32_bf16 v[96:99], a[16:19], a[56:59], v[96:99]
    ds_read_b64_tr_b16 a[12:13], v11 offset:21536
    v_fmac_f32 v219, v28, v19
    v_mfma_f32_16x16x32_bf16 v[100:103], a[16:19], a[60:63], v[100:103]
    ds_read_b64_tr_b16 a[14:15], v11 offset:23328
    v_fmac_f32 v220, v30, v16
    v_mfma_f32_16x16x32_bf16 v[104:107], a[16:19], a[64:67], v[104:107]
    s_add_u32 s27, s27, 151552
    v_fmac_f32 v221, v30, v17
    v_mfma_f32_16x16x32_bf16 v[108:111], a[16:19], a[68:71], v[108:111]
    v_fmac_f32 v222, v30, v18
    v_mfma_f32_16x16x32_bf16 v[112:115], a[20:23], a[56:59], v[112:115]
    ds_read_b64_tr_b16 a[16:17], v11 offset:7232
    v_fmac_f32 v223, v30, v19
    v_mfma_f32_16x16x32_bf16 v[116:119], a[20:23], a[60:63], v[116:119]
    ds_read_b64_tr_b16 a[18:19], v11 offset:9024
    v_fmac_f32 v208, v25, v20
    v_mfma_f32_16x16x32_bf16 v[120:123], a[20:23], a[64:67], v[120:123]
    s_add_u32 m0, s44, 8192
    v_fmac_f32 v209, v25, v21
    v_mfma_f32_16x16x32_bf16 v[124:127], a[20:23], a[68:71], v[124:127]
    v_fmac_f32 v210, v25, v22
    v_mfma_f32_16x16x32_bf16 v[128:131], a[24:27], a[56:59], v[128:131]
    ds_read_b64_tr_b16 a[20:21], v11 offset:21568
    v_fmac_f32 v211, v25, v23
    v_mfma_f32_16x16x32_bf16 v[132:135], a[24:27], a[60:63], v[132:135]
    ds_read_b64_tr_b16 a[22:23], v11 offset:23360
    v_fmac_f32 v212, v27, v20
    v_mfma_f32_16x16x32_bf16 v[136:139], a[24:27], a[64:67], v[136:139]
    buffer_load_dwordx4 v5, s[8:11], s43 offen lds
    v_mfma_f32_16x16x32_bf16 v[140:143], a[24:27], a[68:71], v[140:143]
    s_waitcnt lgkmcnt(12)
    v_fmac_f32 v213, v27, v21
    v_mfma_f32_16x16x32_bf16 v[144:147], a[28:31], a[56:59], v[144:147]
    ds_read_b64_tr_b16 a[24:25], v11 offset:7264
    v_fmac_f32 v214, v27, v22
    v_mfma_f32_16x16x32_bf16 v[148:151], a[28:31], a[60:63], v[148:151]
    ds_read_b64_tr_b16 a[26:27], v11 offset:9056
    v_fmac_f32 v215, v27, v23
    v_mfma_f32_16x16x32_bf16 v[152:155], a[28:31], a[64:67], v[152:155]
    s_add_u32 m0, s44, 9216
    v_fmac_f32 v216, v29, v20
    v_mfma_f32_16x16x32_bf16 v[156:159], a[28:31], a[68:71], v[156:159]
    v_fmac_f32 v217, v29, v21
    v_mfma_f32_16x16x32_bf16 v[160:163], a[32:35], a[56:59], v[160:163]
    ds_read_b64_tr_b16 a[28:29], v11 offset:21600
    v_fmac_f32 v218, v29, v22
    v_mfma_f32_16x16x32_bf16 v[164:167], a[32:35], a[60:63], v[164:167]
    ds_read_b64_tr_b16 a[30:31], v11 offset:23392
    v_fmac_f32 v219, v29, v23
    v_mfma_f32_16x16x32_bf16 v[168:171], a[32:35], a[64:67], v[168:171]
    buffer_load_dwordx4 v6, s[8:11], s43 offen lds
    v_mfma_f32_16x16x32_bf16 v[172:175], a[32:35], a[68:71], v[172:175]
    v_fmac_f32 v220, v31, v20
    v_mfma_f32_16x16x32_bf16 v[176:179], a[36:39], a[56:59], v[176:179]
    ds_read_b64_tr_b16 a[32:33], v11 offset:7296
    v_fmac_f32 v221, v31, v21
    v_mfma_f32_16x16x32_bf16 v[180:183], a[36:39], a[60:63], v[180:183]
    ds_read_b64_tr_b16 a[34:35], v11 offset:9088
    v_fmac_f32 v222, v31, v22
    v_mfma_f32_16x16x32_bf16 v[184:187], a[36:39], a[64:67], v[184:187]
    s_add_u32 s43, s43, s47
    v_fmac_f32 v223, v31, v23
    v_mfma_f32_16x16x32_bf16 v[188:191], a[36:39], a[68:71], v[188:191]
    v_mfma_f32_16x16x32_bf16 v[192:195], a[40:43], a[56:59], v[192:195]
    ds_read_b64_tr_b16 a[36:37], v11 offset:21632
    v_mfma_f32_16x16x32_bf16 v[196:199], a[40:43], a[60:63], v[196:199]
    ds_read_b64_tr_b16 a[38:39], v11 offset:23424
    v_mfma_f32_16x16x32_bf16 v[200:203], a[40:43], a[64:67], v[200:203]
    s_add_u32 s44, s44, 16384
    v_mfma_f32_16x16x32_bf16 v[204:207], a[40:43], a[68:71], v[204:207]
    ds_read_b128 v[16:19], v0 offset:384
    v_mfma_f32_16x16x32_bf16 v[208:211], a[44:47], a[56:59], v[208:211]
    ds_read_b64_tr_b16 a[40:41], v11 offset:7328
    v_mfma_f32_16x16x32_bf16 v[212:215], a[44:47], a[60:63], v[212:215]
    ds_read_b64_tr_b16 a[42:43], v11 offset:9120
    v_mfma_f32_16x16x32_bf16 v[216:219], a[44:47], a[64:67], v[216:219]
    s_cmp_eq_u32 s44, s46
    s_cselect_b32 s44, s45, s44
    v_mfma_f32_16x16x32_bf16 v[220:223], a[44:47], a[68:71], v[220:223]
    ds_read_b128 v[20:23], v0 offset:1408
    v_mfma_f32_16x16x32_bf16 v[224:227], a[48:51], a[56:59], v[224:227]
    ds_read_b64_tr_b16 a[44:45], v11 offset:21664
    v_mfma_f32_16x16x32_bf16 v[228:231], a[48:51], a[60:63], v[228:231]
    ds_read_b64_tr_b16 a[46:47], v11 offset:23456
    v_mfma_f32_16x16x32_bf16 v[232:235], a[48:51], a[64:67], v[232:235]
    s_add_u32 s37, s37, 28672
    v_mfma_f32_16x16x32_bf16 v[236:239], a[48:51], a[68:71], v[236:239]
    v_mfma_f32_16x16x32_bf16 v[240:243], a[52:55], a[56:59], v[240:243]
    ds_read_b64_tr_b16 a[48:49], v11 offset:7360
    v_mfma_f32_16x16x32_bf16 v[244:247], a[52:55], a[60:63], v[244:247]
    ds_read_b64_tr_b16 a[50:51], v11 offset:9152
    v_mfma_f32_16x16x32_bf16 v[248:251], a[52:55], a[64:67], v[248:251]
    s_cmp_eq_u32 s37, 139264
    s_cselect_b32 s37, 24576, s37
    v_mfma_f32_16x16x32_bf16 v[252:255], a[52:55], a[68:71], v[252:255]
    s_waitcnt vmcnt(12) lgkmcnt(14)
    v_mfma_f32_16x16x32_bf16 v[32:35], a[0:3], a[72:75], v[32:35]
    ds_read_b64_tr_b16 a[52:53], v11 offset:21696
    v_mfma_f32_16x16x32_bf16 v[36:39], a[0:3], a[76:79], v[36:39]
    ds_read_b64_tr_b16 a[54:55], v11 offset:23488
    v_mfma_f32_16x16x32_bf16 v[40:43], a[0:3], a[80:83], v[40:43]
    v_mfma_f32_16x16x32_bf16 v[44:47], a[0:3], a[84:87], v[44:47]
    s_barrier
    v_add_u32 v11, s37, v10
    v_mfma_f32_16x16x32_bf16 v[48:51], a[4:7], a[72:75], v[48:51]
    ds_read_b64_tr_b16 a[0:1], v11 offset:0
    s_waitcnt lgkmcnt(7)
    v_mfma_f32_16x16x32_bf16 v[52:55], a[4:7], a[76:79], v[52:55]
    ds_read_b64_tr_b16 a[2:3], v11 offset:1792
    v_fmac_f32 v224, v24, v16
    v_mfma_f32_16x16x32_bf16 v[56:59], a[4:7], a[80:83], v[56:59]
    s_add_u32 m0, s44, 0
    v_fmac_f32 v225, v24, v17
    v_mfma_f32_16x16x32_bf16 v[60:63], a[4:7], a[84:87], v[60:63]
    v_fmac_f32 v226, v24, v18
    v_mfma_f32_16x16x32_bf16 v[64:67], a[8:11], a[72:75], v[64:67]
    ds_read_b64_tr_b16 a[4:5], v11 offset:14336
    v_fmac_f32 v227, v24, v19
    v_mfma_f32_16x16x32_bf16 v[68:71], a[8:11], a[76:79], v[68:71]
    ds_read_b64_tr_b16 a[6:7], v11 offset:16128
    v_fmac_f32 v228, v26, v16
    v_mfma_f32_16x16x32_bf16 v[72:75], a[8:11], a[80:83], v[72:75]
    buffer_load_dwordx4 v3, s[8:11], s43 offen lds
    v_mfma_f32_16x16x32_bf16 v[76:79], a[8:11], a[84:87], v[76:79]
    s_add_u32 m0, s44, 1024
    v_fmac_f32 v229, v26, v17
    v_mfma_f32_16x16x32_bf16 v[80:83], a[12:15], a[72:75], v[80:83]
    ds_read_b64_tr_b16 a[8:9], v11 offset:32
    v_fmac_f32 v230, v26, v18
    v_mfma_f32_16x16x32_bf16 v[84:87], a[12:15], a[76:79], v[84:87]
    ds_read_b64_tr_b16 a[10:11], v11 offset:1824
    v_fmac_f32 v231, v26, v19
    v_mfma_f32_16x16x32_bf16 v[88:91], a[12:15], a[80:83], v[88:91]
    buffer_load_dwordx4 v4, s[8:11], s43 offen lds
    v_mfma_f32_16x16x32_bf16 v[92:95], a[12:15], a[84:87], v[92:95]
    v_fmac_f32 v232, v28, v16
    v_mfma_f32_16x16x32_bf16 v[96:99], a[16:19], a[72:75], v[96:99]
    ds_read_b64_tr_b16 a[12:13], v11 offset:14368
    v_fmac_f32 v233, v28, v17
    v_mfma_f32_16x16x32_bf16 v[100:103], a[16:19], a[76:79], v[100:103]
    ds_read_b64_tr_b16 a[14:15], v11 offset:16160
    v_fmac_f32 v234, v28, v18
    v_mfma_f32_16x16x32_bf16 v[104:107], a[16:19], a[80:83], v[104:107]
    s_add_u32 m0, s44, 8192
    v_fmac_f32 v235, v28, v19
    v_mfma_f32_16x16x32_bf16 v[108:111], a[16:19], a[84:87], v[108:111]
    v_fmac_f32 v236, v30, v16
    v_mfma_f32_16x16x32_bf16 v[112:115], a[20:23], a[72:75], v[112:115]
    ds_read_b64_tr_b16 a[16:17], v11 offset:64
    v_fmac_f32 v237, v30, v17
    v_mfma_f32_16x16x32_bf16 v[116:119], a[20:23], a[76:79], v[116:119]
    ds_read_b64_tr_b16 a[18:19], v11 offset:1856
    v_fmac_f32 v238, v30, v18
    v_mfma_f32_16x16x32_bf16 v[120:123], a[20:23], a[80:83], v[120:123]
    buffer_load_dwordx4 v5, s[8:11], s43 offen lds
    v_mfma_f32_16x16x32_bf16 v[124:127], a[20:23], a[84:87], v[124:127]
    v_fmac_f32 v239, v30, v19
    v_mfma_f32_16x16x32_bf16 v[128:131], a[24:27], a[72:75], v[128:131]
    ds_read_b64_tr_b16 a[20:21], v11 offset:14400
    v_fmac_f32 v224, v25, v20
    v_mfma_f32_16x16x32_bf16 v[132:135], a[24:27], a[76:79], v[132:135]
    ds_read_b64_tr_b16 a[22:23], v11 offset:16192
    v_fmac_f32 v225, v25, v21
    v_mfma_f32_16x16x32_bf16 v[136:139], a[24:27], a[80:83], v[136:139]
    s_add_u32 m0, s44, 9216
    v_fmac_f32 v226, v25, v22
    v_mfma_f32_16x16x32_bf16 v[140:143], a[24:27], a[84:87], v[140:143]
    s_waitcnt lgkmcnt(12)
    buffer_load_dwordx4 v6, s[8:11], s43 offen lds
    v_mfma_f32_16x16x32_bf16 v[144:147], a[28:31], a[72:75], v[144:147]
    ds_read_b64_tr_b16 a[24:25], v11 offset:96
    v_fmac_f32 v227, v25, v23
    v_mfma_f32_16x16x32_bf16 v[148:151], a[28:31], a[76:79], v[148:151]
    ds_read_b64_tr_b16 a[26:27], v11 offset:1888
    v_fmac_f32 v228, v27, v20
    v_mfma_f32_16x16x32_bf16 v[152:155], a[28:31], a[80:83], v[152:155]
    s_add_u32 s43, s43, s47
    v_fmac_f32 v229, v27, v21
    v_mfma_f32_16x16x32_bf16 v[156:159], a[28:31], a[84:87], v[156:159]
    v_fmac_f32 v230, v27, v22
    v_mfma_f32_16x16x32_bf16 v[160:163], a[32:35], a[72:75], v[160:163]
    ds_read_b64_tr_b16 a[28:29], v11 offset:14432
    v_fmac_f32 v231, v27, v23
    v_mfma_f32_16x16x32_bf16 v[164:167], a[32:35], a[76:79], v[164:167]
    ds_read_b64_tr_b16 a[30:31], v11 offset:16224
    v_fmac_f32 v232, v29, v20
    v_mfma_f32_16x16x32_bf16 v[168:171], a[32:35], a[80:83], v[168:171]
    s_add_u32 s44, s44, 16384
    v_fmac_f32 v233, v29, v21
    v_mfma_f32_16x16x32_bf16 v[172:175], a[32:35], a[84:87], v[172:175]
    v_fmac_f32 v234, v29, v22
    v_mfma_f32_16x16x32_bf16 v[176:179], a[36:39], a[72:75], v[176:179]
    ds_read_b64_tr_b16 a[32:33], v11 offset:128
    v_fmac_f32 v235, v29, v23
    v_mfma_f32_16x16x32_bf16 v[180:183], a[36:39], a[76:79], v[180:183]
    ds_read_b64_tr_b16 a[34:35], v11 offset:1920
    v_fmac_f32 v236, v31, v20
    v_mfma_f32_16x16x32_bf16 v[184:187], a[36:39], a[80:83], v[184:187]
    s_cmp_eq_u32 s44, s46
    s_cselect_b32 s44, s45, s44
    v_mfma_f32_16x16x32_bf16 v[188:191], a[36:39], a[84:87], v[188:191]
    v_fmac_f32 v237, v31, v21
    v_mfma_f32_16x16x32_bf16 v[192:195], a[40:43], a[72:75], v[192:195]
    ds_read_b64_tr_b16 a[36:37], v11 offset:14464
    v_fmac_f32 v238, v31, v22
    v_mfma_f32_16x16x32_bf16 v[196:199], a[40:43], a[76:79], v[196:199]
    ds_read_b64_tr_b16 a[38:39], v11 offset:16256
    v_fmac_f32 v239, v31, v23
    v_mfma_f32_16x16x32_bf16 v[200:203], a[40:43], a[80:83], v[200:203]
    s_add_u32 m0, s44, 0
    v_mfma_f32_16x16x32_bf16 v[204:207], a[40:43], a[84:87], v[204:207]
    buffer_load_dwordx4 v3, s[8:11], s43 offen lds
    v_mfma_f32_16x16x32_bf16 v[208:211], a[44:47], a[72:75], v[208:211]
    ds_read_b64_tr_b16 a[40:41], v11 offset:160
    v_mfma_f32_16x16x32_bf16 v[212:215], a[44:47], a[76:79], v[212:215]
    ds_read_b64_tr_b16 a[42:43], v11 offset:1952
    v_mfma_f32_16x16x32_bf16 v[216:219], a[44:47], a[80:83], v[216:219]
    s_add_u32 m0, s44, 1024
    v_mfma_f32_16x16x32_bf16 v[220:223], a[44:47], a[84:87], v[220:223]
    ds_read_b128 v[16:19], v0 offset:832
    v_mfma_f32_16x16x32_bf16 v[224:227], a[48:51], a[72:75], v[224:227]
    ds_read_b64_tr_b16 a[44:45], v11 offset:14496
    v_mfma_f32_16x16x32_bf16 v[228:231], a[48:51], a[76:79], v[228:231]
    ds_read_b64_tr_b16 a[46:47], v11 offset:16288
    v_mfma_f32_16x16x32_bf16 v[232:235], a[48:51], a[80:83], v[232:235]
    buffer_load_dwordx4 v4, s[8:11], s43 offen lds
    v_mfma_f32_16x16x32_bf16 v[236:239], a[48:51], a[84:87], v[236:239]
    ds_read_b128 v[20:23], v0 offset:1856
    v_mfma_f32_16x16x32_bf16 v[240:243], a[52:55], a[72:75], v[240:243]
    ds_read_b64_tr_b16 a[48:49], v11 offset:192
    v_mfma_f32_16x16x32_bf16 v[244:247], a[52:55], a[76:79], v[244:247]
    ds_read_b64_tr_b16 a[50:51], v11 offset:1984
    v_mfma_f32_16x16x32_bf16 v[248:251], a[52:55], a[80:83], v[248:251]
    buffer_load_dword a156, v2, s[68:71], 0 offen
    v_mfma_f32_16x16x32_bf16 v[252:255], a[52:55], a[84:87], v[252:255]
    s_waitcnt vmcnt(15) lgkmcnt(14)
    v_mfma_f32_16x16x32_bf16 v[32:35], a[0:3], a[88:91], v[32:35]
    ds_read_b64_tr_b16 a[52:53], v11 offset:14528
    v_mfma_f32_16x16x32_bf16 v[36:39], a[0:3], a[92:95], v[36:39]
    ds_read_b64_tr_b16 a[54:55], v11 offset:16320
    v_mfma_f32_16x16x32_bf16 v[40:43], a[0:3], a[96:99], v[40:43]
    s_add_u32 m0, s44, 8192
    s_nop 0
    buffer_load_dwordx4 v5, s[8:11], s43 offen lds
    v_mfma_f32_16x16x32_bf16 v[44:47], a[0:3], a[100:103], v[44:47]
    v_mfma_f32_16x16x32_bf16 v[48:51], a[4:7], a[88:91], v[48:51]
    ds_read_b64_tr_b16 a[0:1], v11 offset:7168
    v_mfma_f32_16x16x32_bf16 v[52:55], a[4:7], a[92:95], v[52:55]
    ds_read_b64_tr_b16 a[2:3], v11 offset:8960
    v_mfma_f32_16x16x32_bf16 v[56:59], a[4:7], a[96:99], v[56:59]
    s_add_u32 m0, s44, 9216
    v_mfma_f32_16x16x32_bf16 v[60:63], a[4:7], a[100:103], v[60:63]
    v_mfma_f32_16x16x32_bf16 v[64:67], a[8:11], a[88:91], v[64:67]
    ds_read_b64_tr_b16 a[4:5], v11 offset:21504
    s_waitcnt lgkmcnt(7)
    v_mfma_f32_16x16x32_bf16 v[68:71], a[8:11], a[92:95], v[68:71]
    ds_read_b64_tr_b16 a[6:7], v11 offset:23296
    v_fmac_f32 v240, v24, v16
    v_mfma_f32_16x16x32_bf16 v[72:75], a[8:11], a[96:99], v[72:75]
    buffer_load_dwordx4 v6, s[8:11], s43 offen lds
    v_mfma_f32_16x16x32_bf16 v[76:79], a[8:11], a[100:103], v[76:79]
    s_add_u32 s43, s43, s47
    v_fmac_f32 v241, v24, v17
    v_mfma_f32_16x16x32_bf16 v[80:83], a[12:15], a[88:91], v[80:83]
    ds_read_b64_tr_b16 a[8:9], v11 offset:7200
    v_fmac_f32 v242, v24, v18
    v_mfma_f32_16x16x32_bf16 v[84:87], a[12:15], a[92:95], v[84:87]
    ds_read_b64_tr_b16 a[10:11], v11 offset:8992
    v_fmac_f32 v243, v24, v19
    v_mfma_f32_16x16x32_bf16 v[88:91], a[12:15], a[96:99], v[88:91]
    s_add_u32 s44, s44, 16384
    v_fmac_f32 v244, v26, v16
    v_mfma_f32_16x16x32_bf16 v[92:95], a[12:15], a[100:103], v[92:95]
    v_fmac_f32 v245, v26, v17
    v_mfma_f32_16x16x32_bf16 v[96:99], a[16:19], a[88:91], v[96:99]
    ds_read_b64_tr_b16 a[12:13], v11 offset:21536
    v_fmac_f32 v246, v26, v18
    v_mfma_f32_16x16x32_bf16 v[100:103], a[16:19], a[92:95], v[100:103]
    ds_read_b64_tr_b16 a[14:15], v11 offset:23328
    v_fmac_f32 v247, v26, v19
    v_mfma_f32_16x16x32_bf16 v[104:107], a[16:19], a[96:99], v[104:107]
    s_cmp_eq_u32 s44, s46
    s_cselect_b32 s44, s45, s44
    v_mfma_f32_16x16x32_bf16 v[108:111], a[16:19], a[100:103], v[108:111]
    s_add_u32 m0, s44, 0
    v_fmac_f32 v248, v28, v16
    v_mfma_f32_16x16x32_bf16 v[112:115], a[20:23], a[88:91], v[112:115]
    ds_read_b64_tr_b16 a[16:17], v11 offset:7232
    v_fmac_f32 v249, v28, v17
    v_mfma_f32_16x16x32_bf16 v[116:119], a[20:23], a[92:95], v[116:119]
    ds_read_b64_tr_b16 a[18:19], v11 offset:9024
    v_fmac_f32 v250, v28, v18
    v_mfma_f32_16x16x32_bf16 v[120:123], a[20:23], a[96:99], v[120:123]
    buffer_load_dwordx4 v3, s[8:11], s43 offen lds
    v_mfma_f32_16x16x32_bf16 v[124:127], a[20:23], a[100:103], v[124:127]
    v_fmac_f32 v251, v28, v19
    v_mfma_f32_16x16x32_bf16 v[128:131], a[24:27], a[88:91], v[128:131]
    ds_read_b64_tr_b16 a[20:21], v11 offset:21568
    v_fmac_f32 v252, v30, v16
    v_mfma_f32_16x16x32_bf16 v[132:135], a[24:27], a[92:95], v[132:135]
    ds_read_b64_tr_b16 a[22:23], v11 offset:23360
    v_fmac_f32 v253, v30, v17
    v_mfma_f32_16x16x32_bf16 v[136:139], a[24:27], a[96:99], v[136:139]
    s_add_u32 m0, s44, 1024
    v_fmac_f32 v254, v30, v18
    v_mfma_f32_16x16x32_bf16 v[140:143], a[24:27], a[100:103], v[140:143]
    s_waitcnt lgkmcnt(12)
    v_fmac_f32 v255, v30, v19
    v_mfma_f32_16x16x32_bf16 v[144:147], a[28:31], a[88:91], v[144:147]
    ds_read_b64_tr_b16 a[24:25], v11 offset:7264
    v_fmac_f32 v240, v25, v20
    v_mfma_f32_16x16x32_bf16 v[148:151], a[28:31], a[92:95], v[148:151]
    ds_read_b64_tr_b16 a[26:27], v11 offset:9056
    v_fmac_f32 v241, v25, v21
    v_mfma_f32_16x16x32_bf16 v[152:155], a[28:31], a[96:99], v[152:155]
    buffer_load_dwordx4 v4, s[8:11], s43 offen lds
    s_add_u32 m0, s44, 8192
    v_mfma_f32_16x16x32_bf16 v[156:159], a[28:31], a[100:103], v[156:159]
    v_fmac_f32 v242, v25, v22
    v_mfma_f32_16x16x32_bf16 v[160:163], a[32:35], a[88:91], v[160:163]
    ds_read_b64_tr_b16 a[28:29], v11 offset:21600
    v_fmac_f32 v243, v25, v23
    v_mfma_f32_16x16x32_bf16 v[164:167], a[32:35], a[92:95], v[164:167]
    ds_read_b64_tr_b16 a[30:31], v11 offset:23392
    v_fmac_f32 v244, v27, v20
    v_mfma_f32_16x16x32_bf16 v[168:171], a[32:35], a[96:99], v[168:171]
    buffer_load_dwordx4 v5, s[8:11], s43 offen lds
    v_mfma_f32_16x16x32_bf16 v[172:175], a[32:35], a[100:103], v[172:175]
    v_fmac_f32 v245, v27, v21
    v_mfma_f32_16x16x32_bf16 v[176:179], a[36:39], a[88:91], v[176:179]
    ds_read_b64_tr_b16 a[32:33], v11 offset:7296
    v_fmac_f32 v246, v27, v22
    v_mfma_f32_16x16x32_bf16 v[180:183], a[36:39], a[92:95], v[180:183]
    ds_read_b64_tr_b16 a[34:35], v11 offset:9088
    v_fmac_f32 v247, v27, v23
    v_mfma_f32_16x16x32_bf16 v[184:187], a[36:39], a[96:99], v[184:187]
    s_add_u32 m0, s44, 9216
    v_fmac_f32 v248, v29, v20
    v_mfma_f32_16x16x32_bf16 v[188:191], a[36:39], a[100:103], v[188:191]
    buffer_load_dwordx4 v6, s[8:11], s43 offen lds
    v_mfma_f32_16x16x32_bf16 v[192:195], a[40:43], a[88:91], v[192:195]
    ds_read_b64_tr_b16 a[36:37], v11 offset:21632
    v_fmac_f32 v249, v29, v21
    v_mfma_f32_16x16x32_bf16 v[196:199], a[40:43], a[92:95], v[196:199]
    ds_read_b64_tr_b16 a[38:39], v11 offset:23424
    v_fmac_f32 v250, v29, v22
    v_mfma_f32_16x16x32_bf16 v[200:203], a[40:43], a[96:99], v[200:203]
    s_add_u32 s43, s43, s47
    v_fmac_f32 v251, v29, v23
    v_mfma_f32_16x16x32_bf16 v[204:207], a[40:43], a[100:103], v[204:207]
    v_fmac_f32 v252, v31, v20
    v_mfma_f32_16x16x32_bf16 v[208:211], a[44:47], a[88:91], v[208:211]
    ds_read_b64_tr_b16 a[40:41], v11 offset:7328
    v_fmac_f32 v253, v31, v21
    v_mfma_f32_16x16x32_bf16 v[212:215], a[44:47], a[92:95], v[212:215]
    ds_read_b64_tr_b16 a[42:43], v11 offset:9120
    v_fmac_f32 v254, v31, v22
    v_mfma_f32_16x16x32_bf16 v[216:219], a[44:47], a[96:99], v[216:219]
    s_add_u32 s44, s44, 16384
    v_fmac_f32 v255, v31, v23
    v_mfma_f32_16x16x32_bf16 v[220:223], a[44:47], a[100:103], v[220:223]
    s_cmp_eq_u32 s44, s46
    s_cselect_b32 s44, s45, s44
    v_mfma_f32_16x16x32_bf16 v[224:227], a[48:51], a[88:91], v[224:227]
    ds_read_b64_tr_b16 a[44:45], v11 offset:21664
    v_mfma_f32_16x16x32_bf16 v[228:231], a[48:51], a[92:95], v[228:231]
    ds_read_b64_tr_b16 a[46:47], v11 offset:23456
    v_mfma_f32_16x16x32_bf16 v[232:235], a[48:51], a[96:99], v[232:235]
    s_add_u32 s37, s37, 28672
    v_mfma_f32_16x16x32_bf16 v[236:239], a[48:51], a[100:103], v[236:239]
    v_rcp_f32 v24, v25
    v_mfma_f32_16x16x32_bf16 v[240:243], a[52:55], a[88:91], v[240:243]
    ds_read_b64_tr_b16 a[48:49], v11 offset:7360
    v_mfma_f32_16x16x32_bf16 v[244:247], a[52:55], a[92:95], v[244:247]
    ds_read_b64_tr_b16 a[50:51], v11 offset:9152
    v_mfma_f32_16x16x32_bf16 v[248:251], a[52:55], a[96:99], v[248:251]
    s_cmp_eq_u32 s37, 139264
    s_cselect_b32 s37, 24576, s37
    v_mfma_f32_16x16x32_bf16 v[252:255], a[52:55], a[100:103], v[252:255]
    s_waitcnt vmcnt(15) lgkmcnt(12)
    v_mfma_f32_16x16x32_bf16 v[32:35], a[0:3], a[104:107], v[32:35]
    ds_read_b64_tr_b16 a[52:53], v11 offset:21696
    v_mfma_f32_16x16x32_bf16 v[36:39], a[0:3], a[108:111], v[36:39]
    ds_read_b64_tr_b16 a[54:55], v11 offset:23488
    v_mfma_f32_16x16x32_bf16 v[40:43], a[0:3], a[112:115], v[40:43]
    v_rcp_f32 v26, v27
    v_mfma_f32_16x16x32_bf16 v[44:47], a[0:3], a[116:119], v[44:47]
    s_barrier
    v_add_u32 v11, s37, v10
    v_mfma_f32_16x16x32_bf16 v[48:51], a[4:7], a[104:107], v[48:51]
    ds_read_b64_tr_b16 a[0:1], v11 offset:0
    v_mfma_f32_16x16x32_bf16 v[52:55], a[4:7], a[108:111], v[52:55]
    ds_read_b64_tr_b16 a[2:3], v11 offset:1792
    v_mfma_f32_16x16x32_bf16 v[56:59], a[4:7], a[112:115], v[56:59]
    s_add_u32 m0, s44, 0
    v_mfma_f32_16x16x32_bf16 v[60:63], a[4:7], a[116:119], v[60:63]
    v_rcp_f32 v28, v29
    v_mfma_f32_16x16x32_bf16 v[64:67], a[8:11], a[104:107], v[64:67]
    ds_read_b64_tr_b16 a[4:5], v11 offset:14336
    v_mfma_f32_16x16x32_bf16 v[68:71], a[8:11], a[108:111], v[68:71]
    ds_read_b64_tr_b16 a[6:7], v11 offset:16128
    v_mfma_f32_16x16x32_bf16 v[72:75], a[8:11], a[112:115], v[72:75]
    buffer_load_dwordx4 v3, s[8:11], s43 offen lds
    v_mfma_f32_16x16x32_bf16 v[76:79], a[8:11], a[116:119], v[76:79]
    v_rcp_f32 v30, v31
    v_mfma_f32_16x16x32_bf16 v[80:83], a[12:15], a[104:107], v[80:83]
    ds_read_b64_tr_b16 a[8:9], v11 offset:32
    v_bfe_u32 v14, v1, 4, 1
    v_mfma_f32_16x16x32_bf16 v[84:87], a[12:15], a[108:111], v[84:87]
    ds_read_b64_tr_b16 a[10:11], v11 offset:1824
    v_lshrrev_b32 v15, 5, v1
    v_mfma_f32_16x16x32_bf16 v[88:91], a[12:15], a[112:115], v[88:91]
    s_add_u32 m0, s44, 1024
    v_lshl_add_u32 v14, v14, 1, v15
    v_mfma_f32_16x16x32_bf16 v[92:95], a[12:15], a[116:119], v[92:95]
    v_bfe_u32 v15, v1, 3, 1
    v_mfma_f32_16x16x32_bf16 v[96:99], a[16:19], a[104:107], v[96:99]
    ds_read_b64_tr_b16 a[12:13], v11 offset:14368
    v_lshl_add_u32 v14, v14, 1, v15
    v_mfma_f32_16x16x32_bf16 v[100:103], a[16:19], a[108:111], v[100:103]
    ds_read_b64_tr_b16 a[14:15], v11 offset:16160
    s_lshl_b32 s32, s50, 3
    v_mfma_f32_16x16x32_bf16 v[104:107], a[16:19], a[112:115], v[104:107]
    buffer_load_dwordx4 v4, s[8:11], s43 offen lds
    s_add_u32 s32, s32, 0
    v_mfma_f32_16x16x32_bf16 v[108:111], a[16:19], a[116:119], v[108:111]
    v_add_u32 v14, s32, v14
    v_mfma_f32_16x16x32_bf16 v[112:115], a[20:23], a[104:107], v[112:115]
    ds_read_b64_tr_b16 a[16:17], v11 offset:64
    v_mul_u32_u24 v15, 9363, v14
    v_mfma_f32_16x16x32_bf16 v[116:119], a[20:23], a[108:111], v[116:119]
    ds_read_b64_tr_b16 a[18:19], v11 offset:1856
    v_lshrrev_b32 v15, 16, v15
    v_mfma_f32_16x16x32_bf16 v[120:123], a[20:23], a[112:115], v[120:123]
    v_add_u32 v12, v14, v15
    v_mfma_f32_16x16x32_bf16 v[124:127], a[20:23], a[116:119], v[124:127]
    s_add_u32 m0, s44, 8192
    v_mul_u32_u24 v15, 7, v15
    v_mfma_f32_16x16x32_bf16 v[128:131], a[24:27], a[104:107], v[128:131]
    ds_read_b64_tr_b16 a[20:21], v11 offset:14400
    v_sub_u32 v15, v14, v15
    v_mfma_f32_16x16x32_bf16 v[132:135], a[24:27], a[108:111], v[132:135]
    ds_read_b64_tr_b16 a[22:23], v11 offset:16192
    v_add_u32 v15, 5, v15
    v_mfma_f32_16x16x32_bf16 v[136:139], a[24:27], a[112:115], v[136:139]
    v_lshrrev_b32 v15, 3, v15
    v_mfma_f32_16x16x32_bf16 v[140:143], a[24:27], a[116:119], v[140:143]
    s_waitcnt lgkmcnt(12)
    v_add_lshl_u32 v12, v12, v15, 7
    v_mfma_f32_16x16x32_bf16 v[144:147], a[28:31], a[104:107], v[144:147]
    ds_read_b64_tr_b16 a[24:25], v11 offset:96
    v_and_b32 v14, 7, v1
    v_mfma_f32_16x16x32_bf16 v[148:151], a[28:31], a[108:111], v[148:151]
    ds_read_b64_tr_b16 a[26:27], v11 offset:1888
    v_lshl_add_u32 v12, v14, 4, v12
    v_mfma_f32_16x16x32_bf16 v[152:155], a[28:31], a[112:115], v[152:155]
    buffer_load_dwordx4 v5, s[8:11], s43 offen lds
    v_bfe_u32 v14, v1, 4, 1
    v_mfma_f32_16x16x32_bf16 v[156:159], a[28:31], a[116:119], v[156:159]
    v_lshrrev_b32 v15, 5, v1
    v_mfma_f32_16x16x32_bf16 v[160:163], a[32:35], a[104:107], v[160:163]
    ds_read_b64_tr_b16 a[28:29], v11 offset:14432
    v_lshl_add_u32 v14, v14, 1, v15
    v_mfma_f32_16x16x32_bf16 v[164:167], a[32:35], a[108:111], v[164:167]
    ds_read_b64_tr_b16 a[30:31], v11 offset:16224
    v_bfe_u32 v15, v1, 3, 1
    v_mfma_f32_16x16x32_bf16 v[168:171], a[32:35], a[112:115], v[168:171]
    s_add_u32 m0, s44, 9216
    v_lshl_add_u32 v14, v14, 1, v15
    v_mfma_f32_16x16x32_bf16 v[172:175], a[32:35], a[116:119], v[172:175]
    s_lshl_b32 s32, s50, 3
    v_mfma_f32_16x16x32_bf16 v[176:179], a[36:39], a[104:107], v[176:179]
    ds_read_b64_tr_b16 a[32:33], v11 offset:128
    s_add_u32 s32, s32, 8
    v_mfma_f32_16x16x32_bf16 v[180:183], a[36:39], a[108:111], v[180:183]
    ds_read_b64_tr_b16 a[34:35], v11 offset:1920
    v_add_u32 v14, s32, v14
    v_mfma_f32_16x16x32_bf16 v[184:187], a[36:39], a[112:115], v[184:187]
    buffer_load_dwordx4 v6, s[8:11], s43 offen lds
    v_mul_u32_u24 v15, 9363, v14
    v_mfma_f32_16x16x32_bf16 v[188:191], a[36:39], a[116:119], v[188:191]
    v_lshrrev_b32 v15, 16, v15
    v_mfma_f32_16x16x32_bf16 v[192:195], a[40:43], a[104:107], v[192:195]
    ds_read_b64_tr_b16 a[36:37], v11 offset:14464
    v_add_u32 v13, v14, v15
    v_mfma_f32_16x16x32_bf16 v[196:199], a[40:43], a[108:111], v[196:199]
    ds_read_b64_tr_b16 a[38:39], v11 offset:16256
    v_mul_u32_u24 v15, 7, v15
    v_mfma_f32_16x16x32_bf16 v[200:203], a[40:43], a[112:115], v[200:203]
    s_add_u32 s43, s43, s47
    v_sub_u32 v15, v14, v15
    v_mfma_f32_16x16x32_bf16 v[204:207], a[40:43], a[116:119], v[204:207]
    v_add_u32 v15, 5, v15
    v_mfma_f32_16x16x32_bf16 v[208:211], a[44:47], a[104:107], v[208:211]
    ds_read_b64_tr_b16 a[40:41], v11 offset:160
    v_lshrrev_b32 v15, 3, v15
    v_mfma_f32_16x16x32_bf16 v[212:215], a[44:47], a[108:111], v[212:215]
    ds_read_b64_tr_b16 a[42:43], v11 offset:1952
    v_add_lshl_u32 v13, v13, v15, 7
    v_mfma_f32_16x16x32_bf16 v[216:219], a[44:47], a[112:115], v[216:219]
    s_add_u32 s44, s44, 16384
    v_and_b32 v14, 7, v1
    v_mfma_f32_16x16x32_bf16 v[220:223], a[44:47], a[116:119], v[220:223]
    v_lshl_add_u32 v13, v14, 4, v13
    v_mfma_f32_16x16x32_bf16 v[224:227], a[48:51], a[104:107], v[224:227]
    ds_read_b64_tr_b16 a[44:45], v11 offset:14496
    s_mul_i32 s58, s49, 530432
    v_mfma_f32_16x16x32_bf16 v[228:231], a[48:51], a[108:111], v[228:231]
    ds_read_b64_tr_b16 a[46:47], v11 offset:16288
    s_mov_b32 s24, 0xbdd2d3e8
    v_mfma_f32_16x16x32_bf16 v[232:235], a[48:51], a[112:115], v[232:235]
    s_mov_b32 s25, 0xbdd2d3e8
    v_mfma_f32_16x16x32_bf16 v[236:239], a[48:51], a[116:119], v[236:239]
    s_cmp_eq_u32 s44, s46
    s_cselect_b32 s44, s45, s44
    v_mov_b32 v14, 0xc0135761
    v_mfma_f32_16x16x32_bf16 v[240:243], a[52:55], a[104:107], v[240:243]
    ds_read_b64_tr_b16 a[48:49], v11 offset:192
    s_add_u32 s12, s38, 38797312
    s_addc_u32 s13, s39, 0
    v_mfma_f32_16x16x32_bf16 v[244:247], a[52:55], a[108:111], v[244:247]
    ds_read_b64_tr_b16 a[50:51], v11 offset:1984
    s_mov_b32 s14, 16973824
    v_mfma_f32_16x16x32_bf16 v[248:251], a[52:55], a[112:115], v[248:251]
    s_mov_b32 s15, 0x20000
    v_mfma_f32_16x16x32_bf16 v[252:255], a[52:55], a[116:119], v[252:255]
    s_waitcnt lgkmcnt(12)
    ds_read_b64_tr_b16 a[52:53], v11 offset:14528
    ds_read_b64_tr_b16 a[54:55], v11 offset:16320
gu_epi:
    v_pk_mul_f32 v[32:33], v[32:33], v[24:25] op_sel_hi:[1,0]
    v_pk_mul_f32 v[34:35], v[34:35], v[24:25] op_sel_hi:[1,0]
    v_pk_mul_f32 v[36:37], v[36:37], v[26:27] op_sel_hi:[1,0]
    v_pk_mul_f32 v[38:39], v[38:39], v[26:27] op_sel_hi:[1,0]
    v_pk_mul_f32 v[16:17], v[32:33], v[32:33]
    v_pk_mul_f32 v[18:19], v[34:35], v[34:35]
    v_pk_mul_f32 v[20:21], v[36:37], v[36:37]
    v_pk_mul_f32 v[22:23], v[38:39], v[38:39]
    v_pk_mul_f32 v[48:49], v[48:49], v[32:33]
    v_pk_mul_f32 v[50:51], v[50:51], v[34:35]
    v_pk_mul_f32 v[52:53], v[52:53], v[36:37]
    v_pk_mul_f32 v[54:55], v[54:55], v[38:39]
    v_pk_fma_f32 v[16:17], v[16:17], s[24:25], v[14:15] op_sel_hi:[1,1,0]
    v_pk_fma_f32 v[18:19], v[18:19], s[24:25], v[14:15] op_sel_hi:[1,1,0]
    v_pk_fma_f32 v[20:21], v[20:21], s[24:25], v[14:15] op_sel_hi:[1,1,0]
    v_pk_fma_f32 v[22:23], v[22:23], s[24:25], v[14:15] op_sel_hi:[1,1,0]
    v_pk_mul_f32 v[32:33], v[16:17], v[32:33]
    v_pk_mul_f32 v[34:35], v[18:19], v[34:35]
    v_pk_mul_f32 v[36:37], v[20:21], v[36:37]
    v_pk_mul_f32 v[38:39], v[22:23], v[38:39]
    v_pk_mul_f32 v[40:41], v[40:41], v[28:29] op_sel_hi:[1,0]
    v_pk_mul_f32 v[42:43], v[42:43], v[28:29] op_sel_hi:[1,0]
    v_pk_mul_f32 v[44:45], v[44:45], v[30:31] op_sel_hi:[1,0]
    v_pk_mul_f32 v[46:47], v[46:47], v[30:31] op_sel_hi:[1,0]
    v_pk_mul_f32 v[16:17], v[40:41], v[40:41]
    v_pk_mul_f32 v[18:19], v[42:43], v[42:43]
    v_pk_mul_f32 v[20:21], v[44:45], v[44:45]
    v_pk_mul_f32 v[22:23], v[46:47], v[46:47]
    v_pk_mul_f32 v[56:57], v[56:57], v[40:41]
    v_pk_mul_f32 v[58:59], v[58:59], v[42:43]
    v_pk_mul_f32 v[60:61], v[60:61], v[44:45]
    v_pk_mul_f32 v[62:63], v[62:63], v[46:47]
    v_pk_fma_f32 v[16:17], v[16:17], s[24:25], v[14:15] op_sel_hi:[1,1,0]
    v_pk_fma_f32 v[18:19], v[18:19], s[24:25], v[14:15] op_sel_hi:[1,1,0]
    v_pk_fma_f32 v[20:21], v[20:21], s[24:25], v[14:15] op_sel_hi:[1,1,0]
    v_pk_fma_f32 v[22:23], v[22:23], s[24:25], v[14:15] op_sel_hi:[1,1,0]
    v_pk_mul_f32 v[40:41], v[16:17], v[40:41]
    v_pk_mul_f32 v[42:43], v[18:19], v[42:43]
    v_pk_mul_f32 v[44:45], v[20:21], v[44:45]
    v_pk_mul_f32 v[46:47], v[22:23], v[46:47]
    v_exp_f32 v32, v32
    v_exp_f32 v33, v33
    v_exp_f32 v34, v34
    v_exp_f32 v35, v35
    v_exp_f32 v36, v36
    v_exp_f32 v37, v37
    v_exp_f32 v38, v38
    v_exp_f32 v39, v39
    v_exp_f32 v40, v40
    v_exp_f32 v41, v41
    v_exp_f32 v42, v42
    v_exp_f32 v43, v43
    v_exp_f32 v44, v44
    v_exp_f32 v45, v45
    v_exp_f32 v46, v46
    v_exp_f32 v47, v47
    v_pk_fma_f32 v[32:33], v[32:33], v[24:25], v[24:25] op_sel:[0,1,1]
    v_pk_fma_f32 v[34:35], v[34:35], v[24:25], v[24:25] op_sel:[0,1,1]
    v_pk_fma_f32 v[36:37], v[36:37], v[26:27], v[26:27] op_sel:[0,1,1]
    v_pk_fma_f32 v[38:39], v[38:39], v[26:27], v[26:27] op_sel:[0,1,1]
    v_pk_fma_f32 v[40:41], v[40:41], v[28:29], v[28:29] op_sel:[0,1,1]
    v_pk_fma_f32 v[42:43], v[42:43], v[28:29], v[28:29] op_sel:[0,1,1]
    v_pk_fma_f32 v[44:45], v[44:45], v[30:31], v[30:31] op_sel:[0,1,1]
    v_pk_fma_f32 v[46:47], v[46:47], v[30:31], v[30:31] op_sel:[0,1,1]
    v_rcp_f32 v32, v32
    v_rcp_f32 v33, v33
    v_rcp_f32 v34, v34
    v_rcp_f32 v35, v35
    v_rcp_f32 v36, v36
    v_rcp_f32 v37, v37
    v_rcp_f32 v38, v38
    v_rcp_f32 v39, v39
    v_rcp_f32 v40, v40
    v_rcp_f32 v41, v41
    v_rcp_f32 v42, v42
    v_rcp_f32 v43, v43
    v_rcp_f32 v44, v44
    v_rcp_f32 v45, v45
    v_rcp_f32 v46, v46
    v_rcp_f32 v47, v47
    v_pk_mul_f32 v[48:49], v[32:33], v[48:49]
    v_pk_mul_f32 v[50:51], v[34:35], v[50:51]
    v_pk_mul_f32 v[52:53], v[36:37], v[52:53]
    v_pk_mul_f32 v[54:55], v[38:39], v[54:55]
    v_pk_mul_f32 v[56:57], v[40:41], v[56:57]
    v_pk_mul_f32 v[58:59], v[42:43], v[58:59]
    v_pk_mul_f32 v[60:61], v[44:45], v[60:61]
    v_pk_mul_f32 v[62:63], v[46:47], v[62:63]
    v_cvt_pk_bf16_f32 v32, v48, v49
    v_cvt_pk_bf16_f32 v33, v50, v51
    v_cvt_pk_bf16_f32 v34, v52, v53
    v_cvt_pk_bf16_f32 v35, v54, v55
    v_cvt_pk_bf16_f32 v36, v56, v57
    v_cvt_pk_bf16_f32 v37, v58, v59
    v_cvt_pk_bf16_f32 v38, v60, v61
    v_cvt_pk_bf16_f32 v39, v62, v63
    v_permlane32_swap_b32 v32, v34
    v_permlane32_swap_b32 v33, v35
    v_permlane32_swap_b32 v36, v38
    v_permlane32_swap_b32 v37, v39
    buffer_store_dwordx4 v[32:35], v12, s[12:15], s58 offen sc1
    buffer_store_dwordx4 v[36:39], v13, s[12:15], s58 offen sc1
    s_add_u32 s58, s58, 75776
    v_pk_mul_f32 v[64:65], v[64:65], v[24:25] op_sel_hi:[1,0]
    v_pk_mul_f32 v[66:67], v[66:67], v[24:25] op_sel_hi:[1,0]
    v_pk_mul_f32 v[68:69], v[68:69], v[26:27] op_sel_hi:[1,0]
    v_pk_mul_f32 v[70:71], v[70:71], v[26:27] op_sel_hi:[1,0]
    v_pk_mul_f32 v[72:73], v[72:73], v[28:29] op_sel_hi:[1,0]
    v_pk_mul_f32 v[74:75], v[74:75], v[28:29] op_sel_hi:[1,0]
    v_pk_mul_f32 v[76:77], v[76:77], v[30:31] op_sel_hi:[1,0]
    v_pk_mul_f32 v[78:79], v[78:79], v[30:31] op_sel_hi:[1,0]
    v_pk_mul_f32 v[48:49], v[64:65], v[64:65]
    v_pk_mul_f32 v[50:51], v[66:67], v[66:67]
    v_pk_mul_f32 v[52:53], v[68:69], v[68:69]
    v_pk_mul_f32 v[54:55], v[70:71], v[70:71]
    v_pk_mul_f32 v[56:57], v[72:73], v[72:73]
    v_pk_mul_f32 v[58:59], v[74:75], v[74:75]
    v_pk_mul_f32 v[60:61], v[76:77], v[76:77]
    v_pk_mul_f32 v[62:63], v[78:79], v[78:79]
    v_pk_mul_f32 v[80:81], v[80:81], v[64:65]
    v_pk_mul_f32 v[82:83], v[82:83], v[66:67]
    v_pk_mul_f32 v[84:85], v[84:85], v[68:69]
    v_pk_mul_f32 v[86:87], v[86:87], v[70:71]
    v_pk_mul_f32 v[88:89], v[88:89], v[72:73]
    v_pk_mul_f32 v[90:91], v[90:91], v[74:75]
    v_pk_mul_f32 v[92:93], v[92:93], v[76:77]
    v_pk_mul_f32 v[94:95], v[94:95], v[78:79]
    v_pk_fma_f32 v[48:49], v[48:49], s[24:25], v[14:15] op_sel_hi:[1,1,0]
    v_pk_fma_f32 v[50:51], v[50:51], s[24:25], v[14:15] op_sel_hi:[1,1,0]
    v_pk_fma_f32 v[52:53], v[52:53], s[24:25], v[14:15] op_sel_hi:[1,1,0]
    v_pk_fma_f32 v[54:55], v[54:55], s[24:25], v[14:15] op_sel_hi:[1,1,0]
    v_pk_fma_f32 v[56:57], v[56:57], s[24:25], v[14:15] op_sel_hi:[1,1,0]
    v_pk_fma_f32 v[58:59], v[58:59], s[24:25], v[14:15] op_sel_hi:[1,1,0]
    v_pk_fma_f32 v[60:61], v[60:61], s[24:25], v[14:15] op_sel_hi:[1,1,0]
    v_pk_fma_f32 v[62:63], v[62:63], s[24:25], v[14:15] op_sel_hi:[1,1,0]
    v_pk_mul_f32 v[64:65], v[48:49], v[64:65]
    v_pk_mul_f32 v[66:67], v[50:51], v[66:67]
    v_pk_mul_f32 v[68:69], v[52:53], v[68:69]
    v_pk_mul_f32 v[70:71], v[54:55], v[70:71]
    v_pk_mul_f32 v[72:73], v[56:57], v[72:73]
    v_pk_mul_f32 v[74:75], v[58:59], v[74:75]
    v_pk_mul_f32 v[76:77], v[60:61], v[76:77]
    v_pk_mul_f32 v[78:79], v[62:63], v[78:79]
    v_exp_f32 v64, v64
    v_exp_f32 v65, v65
    v_exp_f32 v66, v66
    v_exp_f32 v67, v67
    v_exp_f32 v68, v68
    v_exp_f32 v69, v69
    v_exp_f32 v70, v70
    v_exp_f32 v71, v71
    v_exp_f32 v72, v72
    v_exp_f32 v73, v73
    v_exp_f32 v74, v74
    v_exp_f32 v75, v75
    v_exp_f32 v76, v76
    v_exp_f32 v77, v77
    v_exp_f32 v78, v78
    v_exp_f32 v79, v79
    v_pk_fma_f32 v[64:65], v[64:65], v[24:25], v[24:25] op_sel:[0,1,1]
    v_pk_fma_f32 v[66:67], v[66:67], v[24:25], v[24:25] op_sel:[0,1,1]
    v_pk_fma_f32 v[68:69], v[68:69], v[26:27], v[26:27] op_sel:[0,1,1]
    v_pk_fma_f32 v[70:71], v[70:71], v[26:27], v[26:27] op_sel:[0,1,1]
    v_pk_fma_f32 v[72:73], v[72:73], v[28:29], v[28:29] op_sel:[0,1,1]
    v_pk_fma_f32 v[74:75], v[74:75], v[28:29], v[28:29] op_sel:[0,1,1]
    v_pk_fma_f32 v[76:77], v[76:77], v[30:31], v[30:31] op_sel:[0,1,1]
    v_pk_fma_f32 v[78:79], v[78:79], v[30:31], v[30:31] op_sel:[0,1,1]
    v_rcp_f32 v64, v64
    v_rcp_f32 v65, v65
    v_rcp_f32 v66, v66
    v_rcp_f32 v67, v67
    v_rcp_f32 v68, v68
    v_rcp_f32 v69, v69
    v_rcp_f32 v70, v70
    v_rcp_f32 v71, v71
    v_rcp_f32 v72, v72
    v_rcp_f32 v73, v73
    v_rcp_f32 v74, v74
    v_rcp_f32 v75, v75
    v_rcp_f32 v76, v76
    v_rcp_f32 v77, v77
    v_rcp_f32 v78, v78
    v_rcp_f32 v79, v79
    v_pk_mul_f32 v[80:81], v[64:65], v[80:81]
    v_pk_mul_f32 v[82:83], v[66:67], v[82:83]
    v_pk_mul_f32 v[84:85], v[68:69], v[84:85]
    v_pk_mul_f32 v[86:87], v[70:71], v[86:87]
    v_pk_mul_f32 v[88:89], v[72:73], v[88:89]
    v_pk_mul_f32 v[90:91], v[74:75], v[90:91]
    v_pk_mul_f32 v[92:93], v[76:77], v[92:93]
    v_pk_mul_f32 v[94:95], v[78:79], v[94:95]
    v_cvt_pk_bf16_f32 v64, v80, v81
    v_cvt_pk_bf16_f32 v65, v82, v83
    v_cvt_pk_bf16_f32 v66, v84, v85
    v_cvt_pk_bf16_f32 v67, v86, v87
    v_cvt_pk_bf16_f32 v68, v88, v89
    v_cvt_pk_bf16_f32 v69, v90, v91
    v_cvt_pk_bf16_f32 v70, v92, v93
    v_cvt_pk_bf16_f32 v71, v94, v95
    v_permlane32_swap_b32 v64, v66
    v_permlane32_swap_b32 v65, v67
    v_permlane32_swap_b32 v68, v70
    v_permlane32_swap_b32 v69, v71
    buffer_store_dwordx4 v[64:67], v12, s[12:15], s58 offen sc1
    buffer_store_dwordx4 v[68:71], v13, s[12:15], s58 offen sc1
    s_add_u32 s58, s58, 75776
    v_pk_mul_f32 v[96:97], v[96:97], v[24:25] op_sel_hi:[1,0]
    v_pk_mul_f32 v[98:99], v[98:99], v[24:25] op_sel_hi:[1,0]
    v_pk_mul_f32 v[100:101], v[100:101], v[26:27] op_sel_hi:[1,0]
    v_pk_mul_f32 v[102:103], v[102:103], v[26:27] op_sel_hi:[1,0]
    v_pk_mul_f32 v[104:105], v[104:105], v[28:29] op_sel_hi:[1,0]
    v_pk_mul_f32 v[106:107], v[106:107], v[28:29] op_sel_hi:[1,0]
    v_pk_mul_f32 v[108:109], v[108:109], v[30:31] op_sel_hi:[1,0]
    v_pk_mul_f32 v[110:111], v[110:111], v[30:31] op_sel_hi:[1,0]
    v_pk_mul_f32 v[80:81], v[96:97], v[96:97]
    v_pk_mul_f32 v[82:83], v[98:99], v[98:99]
    v_pk_mul_f32 v[84:85], v[100:101], v[100:101]
    v_pk_mul_f32 v[86:87], v[102:103], v[102:103]
    v_pk_mul_f32 v[88:89], v[104:105], v[104:105]
    v_pk_mul_f32 v[90:91], v[106:107], v[106:107]
    v_pk_mul_f32 v[92:93], v[108:109], v[108:109]
    v_pk_mul_f32 v[94:95], v[110:111], v[110:111]
    v_pk_mul_f32 v[112:113], v[112:113], v[96:97]
    v_pk_mul_f32 v[114:115], v[114:115], v[98:99]
    v_pk_mul_f32 v[116:117], v[116:117], v[100:101]
    v_pk_mul_f32 v[118:119], v[118:119], v[102:103]
    v_pk_mul_f32 v[120:121], v[120:121], v[104:105]
    v_pk_mul_f32 v[122:123], v[122:123], v[106:107]
    v_pk_mul_f32 v[124:125], v[124:125], v[108:109]
    v_pk_mul_f32 v[126:127], v[126:127], v[110:111]
    v_pk_fma_f32 v[80:81], v[80:81], s[24:25], v[14:15] op_sel_hi:[1,1,0]
    v_pk_fma_f32 v[82:83], v[82:83], s[24:25], v[14:15] op_sel_hi:[1,1,0]
    v_pk_fma_f32 v[84:85], v[84:85], s[24:25], v[14:15] op_sel_hi:[1,1,0]
    v_pk_fma_f32 v[86:87], v[86:87], s[24:25], v[14:15] op_sel_hi:[1,1,0]
    v_pk_fma_f32 v[88:89], v[88:89], s[24:25], v[14:15] op_sel_hi:[1,1,0]
    v_pk_fma_f32 v[90:91], v[90:91], s[24:25], v[14:15] op_sel_hi:[1,1,0]
    v_pk_fma_f32 v[92:93], v[92:93], s[24:25], v[14:15] op_sel_hi:[1,1,0]
    v_pk_fma_f32 v[94:95], v[94:95], s[24:25], v[14:15] op_sel_hi:[1,1,0]
    v_pk_mul_f32 v[96:97], v[80:81], v[96:97]
    v_pk_mul_f32 v[98:99], v[82:83], v[98:99]
    v_pk_mul_f32 v[100:101], v[84:85], v[100:101]
    v_pk_mul_f32 v[102:103], v[86:87], v[102:103]
    v_pk_mul_f32 v[104:105], v[88:89], v[104:105]
    v_pk_mul_f32 v[106:107], v[90:91], v[106:107]
    v_pk_mul_f32 v[108:109], v[92:93], v[108:109]
    v_pk_mul_f32 v[110:111], v[94:95], v[110:111]
    v_exp_f32 v96, v96
    v_exp_f32 v97, v97
    v_exp_f32 v98, v98
    v_exp_f32 v99, v99
    v_exp_f32 v100, v100
    v_exp_f32 v101, v101
    v_exp_f32 v102, v102
    v_exp_f32 v103, v103
    v_exp_f32 v104, v104
    v_exp_f32 v105, v105
    v_exp_f32 v106, v106
    v_exp_f32 v107, v107
    v_exp_f32 v108, v108
    v_exp_f32 v109, v109
    v_exp_f32 v110, v110
    v_exp_f32 v111, v111
    v_pk_fma_f32 v[96:97], v[96:97], v[24:25], v[24:25] op_sel:[0,1,1]
    v_pk_fma_f32 v[98:99], v[98:99], v[24:25], v[24:25] op_sel:[0,1,1]
    v_pk_fma_f32 v[100:101], v[100:101], v[26:27], v[26:27] op_sel:[0,1,1]
    v_pk_fma_f32 v[102:103], v[102:103], v[26:27], v[26:27] op_sel:[0,1,1]
    v_pk_fma_f32 v[104:105], v[104:105], v[28:29], v[28:29] op_sel:[0,1,1]
    v_pk_fma_f32 v[106:107], v[106:107], v[28:29], v[28:29] op_sel:[0,1,1]
    v_pk_fma_f32 v[108:109], v[108:109], v[30:31], v[30:31] op_sel:[0,1,1]
    v_pk_fma_f32 v[110:111], v[110:111], v[30:31], v[30:31] op_sel:[0,1,1]
    v_rcp_f32 v96, v96
    v_rcp_f32 v97, v97
    v_rcp_f32 v98, v98
    v_rcp_f32 v99, v99
    v_rcp_f32 v100, v100
    v_rcp_f32 v101, v101
    v_rcp_f32 v102, v102
    v_rcp_f32 v103, v103
    v_rcp_f32 v104, v104
    v_rcp_f32 v105, v105
    v_rcp_f32 v106, v106
    v_rcp_f32 v107, v107
    v_rcp_f32 v108, v108
    v_rcp_f32 v109, v109
    v_rcp_f32 v110, v110
    v_rcp_f32 v111, v111
    v_pk_mul_f32 v[112:113], v[96:97], v[112:113]
    v_pk_mul_f32 v[114:115], v[98:99], v[114:115]
    v_pk_mul_f32 v[116:117], v[100:101], v[116:117]
    v_pk_mul_f32 v[118:119], v[102:103], v[118:119]
    v_pk_mul_f32 v[120:121], v[104:105], v[120:121]
    v_pk_mul_f32 v[122:123], v[106:107], v[122:123]
    v_pk_mul_f32 v[124:125], v[108:109], v[124:125]
    v_pk_mul_f32 v[126:127], v[110:111], v[126:127]
    v_cvt_pk_bf16_f32 v96, v112, v113
    v_cvt_pk_bf16_f32 v97, v114, v115
    v_cvt_pk_bf16_f32 v98, v116, v117
    v_cvt_pk_bf16_f32 v99, v118, v119
    v_cvt_pk_bf16_f32 v100, v120, v121
    v_cvt_pk_bf16_f32 v101, v122, v123
    v_cvt_pk_bf16_f32 v102, v124, v125
    v_cvt_pk_bf16_f32 v103, v126, v127
    v_permlane32_swap_b32 v96, v98
    v_permlane32_swap_b32 v97, v99
    v_permlane32_swap_b32 v100, v102
    v_permlane32_swap_b32 v101, v103
    buffer_store_dwordx4 v[96:99], v12, s[12:15], s58 offen sc1
    buffer_store_dwordx4 v[100:103], v13, s[12:15], s58 offen sc1
    s_add_u32 s58, s58, 75776
    v_pk_mul_f32 v[128:129], v[128:129], v[24:25] op_sel_hi:[1,0]
    v_pk_mul_f32 v[130:131], v[130:131], v[24:25] op_sel_hi:[1,0]
    v_pk_mul_f32 v[132:133], v[132:133], v[26:27] op_sel_hi:[1,0]
    v_pk_mul_f32 v[134:135], v[134:135], v[26:27] op_sel_hi:[1,0]
    v_pk_mul_f32 v[136:137], v[136:137], v[28:29] op_sel_hi:[1,0]
    v_pk_mul_f32 v[138:139], v[138:139], v[28:29] op_sel_hi:[1,0]
    v_pk_mul_f32 v[140:141], v[140:141], v[30:31] op_sel_hi:[1,0]
    v_pk_mul_f32 v[142:143], v[142:143], v[30:31] op_sel_hi:[1,0]
    v_pk_mul_f32 v[112:113], v[128:129], v[128:129]
    v_pk_mul_f32 v[114:115], v[130:131], v[130:131]
    v_pk_mul_f32 v[116:117], v[132:133], v[132:133]
    v_pk_mul_f32 v[118:119], v[134:135], v[134:135]
    v_pk_mul_f32 v[120:121], v[136:137], v[136:137]
    v_pk_mul_f32 v[122:123], v[138:139], v[138:139]
    v_pk_mul_f32 v[124:125], v[140:141], v[140:141]
    v_pk_mul_f32 v[126:127], v[142:143], v[142:143]
    v_pk_mul_f32 v[144:145], v[144:145], v[128:129]
    v_pk_mul_f32 v[146:147], v[146:147], v[130:131]
    v_pk_mul_f32 v[148:149], v[148:149], v[132:133]
    v_pk_mul_f32 v[150:151], v[150:151], v[134:135]
    v_pk_mul_f32 v[152:153], v[152:153], v[136:137]
    v_pk_mul_f32 v[154:155], v[154:155], v[138:139]
    v_pk_mul_f32 v[156:157], v[156:157], v[140:141]
    v_pk_mul_f32 v[158:159], v[158:159], v[142:143]
    v_pk_fma_f32 v[112:113], v[112:113], s[24:25], v[14:15] op_sel_hi:[1,1,0]
    v_pk_fma_f32 v[114:115], v[114:115], s[24:25], v[14:15] op_sel_hi:[1,1,0]
    v_pk_fma_f32 v[116:117], v[116:117], s[24:25], v[14:15] op_sel_hi:[1,1,0]
    v_pk_fma_f32 v[118:119], v[118:119], s[24:25], v[14:15] op_sel_hi:[1,1,0]
    v_pk_fma_f32 v[120:121], v[120:121], s[24:25], v[14:15] op_sel_hi:[1,1,0]
    v_pk_fma_f32 v[122:123], v[122:123], s[24:25], v[14:15] op_sel_hi:[1,1,0]
    v_pk_fma_f32 v[124:125], v[124:125], s[24:25], v[14:15] op_sel_hi:[1,1,0]
    v_pk_fma_f32 v[126:127], v[126:127], s[24:25], v[14:15] op_sel_hi:[1,1,0]
    v_pk_mul_f32 v[128:129], v[112:113], v[128:129]
    v_pk_mul_f32 v[130:131], v[114:115], v[130:131]
    v_pk_mul_f32 v[132:133], v[116:117], v[132:133]
    v_pk_mul_f32 v[134:135], v[118:119], v[134:135]
    v_pk_mul_f32 v[136:137], v[120:121], v[136:137]
    v_pk_mul_f32 v[138:139], v[122:123], v[138:139]
    v_pk_mul_f32 v[140:141], v[124:125], v[140:141]
    v_pk_mul_f32 v[142:143], v[126:127], v[142:143]
    v_exp_f32 v128, v128
    v_exp_f32 v129, v129
    v_exp_f32 v130, v130
    v_exp_f32 v131, v131
    v_exp_f32 v132, v132
    v_exp_f32 v133, v133
    v_exp_f32 v134, v134
    v_exp_f32 v135, v135
    v_exp_f32 v136, v136
    v_exp_f32 v137, v137
    v_exp_f32 v138, v138
    v_exp_f32 v139, v139
    v_exp_f32 v140, v140
    v_exp_f32 v141, v141
    v_exp_f32 v142, v142
    v_exp_f32 v143, v143
    v_pk_fma_f32 v[128:129], v[128:129], v[24:25], v[24:25] op_sel:[0,1,1]
    v_pk_fma_f32 v[130:131], v[130:131], v[24:25], v[24:25] op_sel:[0,1,1]
    v_pk_fma_f32 v[132:133], v[132:133], v[26:27], v[26:27] op_sel:[0,1,1]
    v_pk_fma_f32 v[134:135], v[134:135], v[26:27], v[26:27] op_sel:[0,1,1]
    v_pk_fma_f32 v[136:137], v[136:137], v[28:29], v[28:29] op_sel:[0,1,1]
    v_pk_fma_f32 v[138:139], v[138:139], v[28:29], v[28:29] op_sel:[0,1,1]
    v_pk_fma_f32 v[140:141], v[140:141], v[30:31], v[30:31] op_sel:[0,1,1]
    v_pk_fma_f32 v[142:143], v[142:143], v[30:31], v[30:31] op_sel:[0,1,1]
    v_rcp_f32 v128, v128
    v_rcp_f32 v129, v129
    v_rcp_f32 v130, v130
    v_rcp_f32 v131, v131
    v_rcp_f32 v132, v132
    v_rcp_f32 v133, v133
    v_rcp_f32 v134, v134
    v_rcp_f32 v135, v135
    v_rcp_f32 v136, v136
    v_rcp_f32 v137, v137
    v_rcp_f32 v138, v138
    v_rcp_f32 v139, v139
    v_rcp_f32 v140, v140
    v_rcp_f32 v141, v141
    v_rcp_f32 v142, v142
    v_rcp_f32 v143, v143
    v_pk_mul_f32 v[144:145], v[128:129], v[144:145]
    v_pk_mul_f32 v[146:147], v[130:131], v[146:147]
    v_pk_mul_f32 v[148:149], v[132:133], v[148:149]
    v_pk_mul_f32 v[150:151], v[134:135], v[150:151]
    v_pk_mul_f32 v[152:153], v[136:137], v[152:153]
    v_pk_mul_f32 v[154:155], v[138:139], v[154:155]
    v_pk_mul_f32 v[156:157], v[140:141], v[156:157]
    v_pk_mul_f32 v[158:159], v[142:143], v[158:159]
    v_cvt_pk_bf16_f32 v128, v144, v145
    v_cvt_pk_bf16_f32 v129, v146, v147
    v_cvt_pk_bf16_f32 v130, v148, v149
    v_cvt_pk_bf16_f32 v131, v150, v151
    v_cvt_pk_bf16_f32 v132, v152, v153
    v_cvt_pk_bf16_f32 v133, v154, v155
    v_cvt_pk_bf16_f32 v134, v156, v157
    v_cvt_pk_bf16_f32 v135, v158, v159
    v_permlane32_swap_b32 v128, v130
    v_permlane32_swap_b32 v129, v131
    v_permlane32_swap_b32 v132, v134
    v_permlane32_swap_b32 v133, v135
    buffer_store_dwordx4 v[128:131], v12, s[12:15], s58 offen sc1
    buffer_store_dwordx4 v[132:135], v13, s[12:15], s58 offen sc1
    s_add_u32 s58, s58, 75776
    v_pk_mul_f32 v[160:161], v[160:161], v[24:25] op_sel_hi:[1,0]
    v_pk_mul_f32 v[162:163], v[162:163], v[24:25] op_sel_hi:[1,0]
    v_pk_mul_f32 v[164:165], v[164:165], v[26:27] op_sel_hi:[1,0]
    v_pk_mul_f32 v[166:167], v[166:167], v[26:27] op_sel_hi:[1,0]
    v_pk_mul_f32 v[168:169], v[168:169], v[28:29] op_sel_hi:[1,0]
    v_pk_mul_f32 v[170:171], v[170:171], v[28:29] op_sel_hi:[1,0]
    v_pk_mul_f32 v[172:173], v[172:173], v[30:31] op_sel_hi:[1,0]
    v_pk_mul_f32 v[174:175], v[174:175], v[30:31] op_sel_hi:[1,0]
    v_pk_mul_f32 v[144:145], v[160:161], v[160:161]
    v_pk_mul_f32 v[146:147], v[162:163], v[162:163]
    v_pk_mul_f32 v[148:149], v[164:165], v[164:165]
    v_pk_mul_f32 v[150:151], v[166:167], v[166:167]
    v_pk_mul_f32 v[152:153], v[168:169], v[168:169]
    v_pk_mul_f32 v[154:155], v[170:171], v[170:171]
    v_pk_mul_f32 v[156:157], v[172:173], v[172:173]
    v_pk_mul_f32 v[158:159], v[174:175], v[174:175]
    v_pk_mul_f32 v[176:177], v[176:177], v[160:161]
    v_pk_mul_f32 v[178:179], v[178:179], v[162:163]
    v_pk_mul_f32 v[180:181], v[180:181], v[164:165]
    v_pk_mul_f32 v[182:183], v[182:183], v[166:167]
    v_pk_mul_f32 v[184:185], v[184:185], v[168:169]
    v_pk_mul_f32 v[186:187], v[186:187], v[170:171]
    v_pk_mul_f32 v[188:189], v[188:189], v[172:173]
    v_pk_mul_f32 v[190:191], v[190:191], v[174:175]
    v_pk_fma_f32 v[144:145], v[144:145], s[24:25], v[14:15] op_sel_hi:[1,1,0]
    v_pk_fma_f32 v[146:147], v[146:147], s[24:25], v[14:15] op_sel_hi:[1,1,0]
    v_pk_fma_f32 v[148:149], v[148:149], s[24:25], v[14:15] op_sel_hi:[1,1,0]
    v_pk_fma_f32 v[150:151], v[150:151], s[24:25], v[14:15] op_sel_hi:[1,1,0]
    v_pk_fma_f32 v[152:153], v[152:153], s[24:25], v[14:15] op_sel_hi:[1,1,0]
    v_pk_fma_f32 v[154:155], v[154:155], s[24:25], v[14:15] op_sel_hi:[1,1,0]
    v_pk_fma_f32 v[156:157], v[156:157], s[24:25], v[14:15] op_sel_hi:[1,1,0]
    v_pk_fma_f32 v[158:159], v[158:159], s[24:25], v[14:15] op_sel_hi:[1,1,0]
    v_pk_mul_f32 v[160:161], v[144:145], v[160:161]
    v_pk_mul_f32 v[162:163], v[146:147], v[162:163]
    v_pk_mul_f32 v[164:165], v[148:149], v[164:165]
    v_pk_mul_f32 v[166:167], v[150:151], v[166:167]
    v_pk_mul_f32 v[168:169], v[152:153], v[168:169]
    v_pk_mul_f32 v[170:171], v[154:155], v[170:171]
    v_pk_mul_f32 v[172:173], v[156:157], v[172:173]
    v_pk_mul_f32 v[174:175], v[158:159], v[174:175]
    v_exp_f32 v160, v160
    v_exp_f32 v161, v161
    v_exp_f32 v162, v162
    v_exp_f32 v163, v163
    v_exp_f32 v164, v164
    v_exp_f32 v165, v165
    v_exp_f32 v166, v166
    v_exp_f32 v167, v167
    v_exp_f32 v168, v168
    v_exp_f32 v169, v169
    v_exp_f32 v170, v170
    v_exp_f32 v171, v171
    v_exp_f32 v172, v172
    v_exp_f32 v173, v173
    v_exp_f32 v174, v174
    v_exp_f32 v175, v175
    v_pk_fma_f32 v[160:161], v[160:161], v[24:25], v[24:25] op_sel:[0,1,1]
    v_pk_fma_f32 v[162:163], v[162:163], v[24:25], v[24:25] op_sel:[0,1,1]
    v_pk_fma_f32 v[164:165], v[164:165], v[26:27], v[26:27] op_sel:[0,1,1]
    v_pk_fma_f32 v[166:167], v[166:167], v[26:27], v[26:27] op_sel:[0,1,1]
    v_pk_fma_f32 v[168:169], v[168:169], v[28:29], v[28:29] op_sel:[0,1,1]
    v_pk_fma_f32 v[170:171], v[170:171], v[28:29], v[28:29] op_sel:[0,1,1]
    v_pk_fma_f32 v[172:173], v[172:173], v[30:31], v[30:31] op_sel:[0,1,1]
    v_pk_fma_f32 v[174:175], v[174:175], v[30:31], v[30:31] op_sel:[0,1,1]
    v_rcp_f32 v160, v160
    v_rcp_f32 v161, v161
    v_rcp_f32 v162, v162
    v_rcp_f32 v163, v163
    v_rcp_f32 v164, v164
    v_rcp_f32 v165, v165
    v_rcp_f32 v166, v166
    v_rcp_f32 v167, v167
    v_rcp_f32 v168, v168
    v_rcp_f32 v169, v169
    v_rcp_f32 v170, v170
    v_rcp_f32 v171, v171
    v_rcp_f32 v172, v172
    v_rcp_f32 v173, v173
    v_rcp_f32 v174, v174
    v_rcp_f32 v175, v175
    v_pk_mul_f32 v[176:177], v[160:161], v[176:177]
    v_pk_mul_f32 v[178:179], v[162:163], v[178:179]
    v_pk_mul_f32 v[180:181], v[164:165], v[180:181]
    v_pk_mul_f32 v[182:183], v[166:167], v[182:183]
    v_pk_mul_f32 v[184:185], v[168:169], v[184:185]
    v_pk_mul_f32 v[186:187], v[170:171], v[186:187]
    v_pk_mul_f32 v[188:189], v[172:173], v[188:189]
    v_pk_mul_f32 v[190:191], v[174:175], v[190:191]
    v_cvt_pk_bf16_f32 v160, v176, v177
    v_cvt_pk_bf16_f32 v161, v178, v179
    v_cvt_pk_bf16_f32 v162, v180, v181
    v_cvt_pk_bf16_f32 v163, v182, v183
    v_cvt_pk_bf16_f32 v164, v184, v185
    v_cvt_pk_bf16_f32 v165, v186, v187
    v_cvt_pk_bf16_f32 v166, v188, v189
    v_cvt_pk_bf16_f32 v167, v190, v191
    v_permlane32_swap_b32 v160, v162
    v_permlane32_swap_b32 v161, v163
    v_permlane32_swap_b32 v164, v166
    v_permlane32_swap_b32 v165, v167
    buffer_store_dwordx4 v[160:163], v12, s[12:15], s58 offen sc1
    buffer_store_dwordx4 v[164:167], v13, s[12:15], s58 offen sc1
    s_add_u32 s58, s58, 75776
    v_pk_mul_f32 v[192:193], v[192:193], v[24:25] op_sel_hi:[1,0]
    v_pk_mul_f32 v[194:195], v[194:195], v[24:25] op_sel_hi:[1,0]
    v_pk_mul_f32 v[196:197], v[196:197], v[26:27] op_sel_hi:[1,0]
    v_pk_mul_f32 v[198:199], v[198:199], v[26:27] op_sel_hi:[1,0]
    v_pk_mul_f32 v[200:201], v[200:201], v[28:29] op_sel_hi:[1,0]
    v_pk_mul_f32 v[202:203], v[202:203], v[28:29] op_sel_hi:[1,0]
    v_pk_mul_f32 v[204:205], v[204:205], v[30:31] op_sel_hi:[1,0]
    v_pk_mul_f32 v[206:207], v[206:207], v[30:31] op_sel_hi:[1,0]
    v_pk_mul_f32 v[176:177], v[192:193], v[192:193]
    v_pk_mul_f32 v[178:179], v[194:195], v[194:195]
    v_pk_mul_f32 v[180:181], v[196:197], v[196:197]
    v_pk_mul_f32 v[182:183], v[198:199], v[198:199]
    v_pk_mul_f32 v[184:185], v[200:201], v[200:201]
    v_pk_mul_f32 v[186:187], v[202:203], v[202:203]
    v_pk_mul_f32 v[188:189], v[204:205], v[204:205]
    v_pk_mul_f32 v[190:191], v[206:207], v[206:207]
    v_pk_mul_f32 v[208:209], v[208:209], v[192:193]
    v_pk_mul_f32 v[210:211], v[210:211], v[194:195]
    v_pk_mul_f32 v[212:213], v[212:213], v[196:197]
    v_pk_mul_f32 v[214:215], v[214:215], v[198:199]
    v_pk_mul_f32 v[216:217], v[216:217], v[200:201]
    v_pk_mul_f32 v[218:219], v[218:219], v[202:203]
    v_pk_mul_f32 v[220:221], v[220:221], v[204:205]
    v_pk_mul_f32 v[222:223], v[222:223], v[206:207]
    v_pk_fma_f32 v[176:177], v[176:177], s[24:25], v[14:15] op_sel_hi:[1,1,0]
    v_pk_fma_f32 v[178:179], v[178:179], s[24:25], v[14:15] op_sel_hi:[1,1,0]
    v_pk_fma_f32 v[180:181], v[180:181], s[24:25], v[14:15] op_sel_hi:[1,1,0]
    v_pk_fma_f32 v[182:183], v[182:183], s[24:25], v[14:15] op_sel_hi:[1,1,0]
    v_pk_fma_f32 v[184:185], v[184:185], s[24:25], v[14:15] op_sel_hi:[1,1,0]
    v_pk_fma_f32 v[186:187], v[186:187], s[24:25], v[14:15] op_sel_hi:[1,1,0]
    v_pk_fma_f32 v[188:189], v[188:189], s[24:25], v[14:15] op_sel_hi:[1,1,0]
    v_pk_fma_f32 v[190:191], v[190:191], s[24:25], v[14:15] op_sel_hi:[1,1,0]
    v_pk_mul_f32 v[192:193], v[176:177], v[192:193]
    v_pk_mul_f32 v[194:195], v[178:179], v[194:195]
    v_pk_mul_f32 v[196:197], v[180:181], v[196:197]
    v_pk_mul_f32 v[198:199], v[182:183], v[198:199]
    v_pk_mul_f32 v[200:201], v[184:185], v[200:201]
    v_pk_mul_f32 v[202:203], v[186:187], v[202:203]
    v_pk_mul_f32 v[204:205], v[188:189], v[204:205]
    v_pk_mul_f32 v[206:207], v[190:191], v[206:207]
    v_exp_f32 v192, v192
    v_exp_f32 v193, v193
    v_exp_f32 v194, v194
    v_exp_f32 v195, v195
    v_exp_f32 v196, v196
    v_exp_f32 v197, v197
    v_exp_f32 v198, v198
    v_exp_f32 v199, v199
    v_exp_f32 v200, v200
    v_exp_f32 v201, v201
    v_exp_f32 v202, v202
    v_exp_f32 v203, v203
    v_exp_f32 v204, v204
    v_exp_f32 v205, v205
    v_exp_f32 v206, v206
    v_exp_f32 v207, v207
    v_pk_fma_f32 v[192:193], v[192:193], v[24:25], v[24:25] op_sel:[0,1,1]
    v_pk_fma_f32 v[194:195], v[194:195], v[24:25], v[24:25] op_sel:[0,1,1]
    v_pk_fma_f32 v[196:197], v[196:197], v[26:27], v[26:27] op_sel:[0,1,1]
    v_pk_fma_f32 v[198:199], v[198:199], v[26:27], v[26:27] op_sel:[0,1,1]
    v_pk_fma_f32 v[200:201], v[200:201], v[28:29], v[28:29] op_sel:[0,1,1]
    v_pk_fma_f32 v[202:203], v[202:203], v[28:29], v[28:29] op_sel:[0,1,1]
    v_pk_fma_f32 v[204:205], v[204:205], v[30:31], v[30:31] op_sel:[0,1,1]
    v_pk_fma_f32 v[206:207], v[206:207], v[30:31], v[30:31] op_sel:[0,1,1]
    v_rcp_f32 v192, v192
    v_rcp_f32 v193, v193
    v_rcp_f32 v194, v194
    v_rcp_f32 v195, v195
    v_rcp_f32 v196, v196
    v_rcp_f32 v197, v197
    v_rcp_f32 v198, v198
    v_rcp_f32 v199, v199
    v_rcp_f32 v200, v200
    v_rcp_f32 v201, v201
    v_rcp_f32 v202, v202
    v_rcp_f32 v203, v203
    v_rcp_f32 v204, v204
    v_rcp_f32 v205, v205
    v_rcp_f32 v206, v206
    v_rcp_f32 v207, v207
    v_pk_mul_f32 v[208:209], v[192:193], v[208:209]
    v_pk_mul_f32 v[210:211], v[194:195], v[210:211]
    v_pk_mul_f32 v[212:213], v[196:197], v[212:213]
    v_pk_mul_f32 v[214:215], v[198:199], v[214:215]
    v_pk_mul_f32 v[216:217], v[200:201], v[216:217]
    v_pk_mul_f32 v[218:219], v[202:203], v[218:219]
    v_pk_mul_f32 v[220:221], v[204:205], v[220:221]
    v_pk_mul_f32 v[222:223], v[206:207], v[222:223]
    v_cvt_pk_bf16_f32 v192, v208, v209
    v_cvt_pk_bf16_f32 v193, v210, v211
    v_cvt_pk_bf16_f32 v194, v212, v213
    v_cvt_pk_bf16_f32 v195, v214, v215
    v_cvt_pk_bf16_f32 v196, v216, v217
    v_cvt_pk_bf16_f32 v197, v218, v219
    v_cvt_pk_bf16_f32 v198, v220, v221
    v_cvt_pk_bf16_f32 v199, v222, v223
    v_permlane32_swap_b32 v192, v194
    v_permlane32_swap_b32 v193, v195
    v_permlane32_swap_b32 v196, v198
    v_permlane32_swap_b32 v197, v199
    buffer_store_dwordx4 v[192:195], v12, s[12:15], s58 offen sc1
    buffer_store_dwordx4 v[196:199], v13, s[12:15], s58 offen sc1
    s_add_u32 s58, s58, 75776
    v_pk_mul_f32 v[224:225], v[224:225], v[24:25] op_sel_hi:[1,0]
    v_pk_mul_f32 v[226:227], v[226:227], v[24:25] op_sel_hi:[1,0]
    v_pk_mul_f32 v[228:229], v[228:229], v[26:27] op_sel_hi:[1,0]
    v_pk_mul_f32 v[230:231], v[230:231], v[26:27] op_sel_hi:[1,0]
    v_pk_mul_f32 v[232:233], v[232:233], v[28:29] op_sel_hi:[1,0]
    v_pk_mul_f32 v[234:235], v[234:235], v[28:29] op_sel_hi:[1,0]
    v_pk_mul_f32 v[236:237], v[236:237], v[30:31] op_sel_hi:[1,0]
    v_pk_mul_f32 v[238:239], v[238:239], v[30:31] op_sel_hi:[1,0]
    v_pk_mul_f32 v[208:209], v[224:225], v[224:225]
    v_pk_mul_f32 v[210:211], v[226:227], v[226:227]
    v_pk_mul_f32 v[212:213], v[228:229], v[228:229]
    v_pk_mul_f32 v[214:215], v[230:231], v[230:231]
    v_pk_mul_f32 v[216:217], v[232:233], v[232:233]
    v_pk_mul_f32 v[218:219], v[234:235], v[234:235]
    v_pk_mul_f32 v[220:221], v[236:237], v[236:237]
    v_pk_mul_f32 v[222:223], v[238:239], v[238:239]
    v_pk_mul_f32 v[240:241], v[240:241], v[224:225]
    v_pk_mul_f32 v[242:243], v[242:243], v[226:227]
    v_pk_mul_f32 v[244:245], v[244:245], v[228:229]
    v_pk_mul_f32 v[246:247], v[246:247], v[230:231]
    v_pk_mul_f32 v[248:249], v[248:249], v[232:233]
    v_pk_mul_f32 v[250:251], v[250:251], v[234:235]
    v_pk_mul_f32 v[252:253], v[252:253], v[236:237]
    v_pk_mul_f32 v[254:255], v[254:255], v[238:239]
    v_pk_fma_f32 v[208:209], v[208:209], s[24:25], v[14:15] op_sel_hi:[1,1,0]
    v_pk_fma_f32 v[210:211], v[210:211], s[24:25], v[14:15] op_sel_hi:[1,1,0]
    v_pk_fma_f32 v[212:213], v[212:213], s[24:25], v[14:15] op_sel_hi:[1,1,0]
    v_pk_fma_f32 v[214:215], v[214:215], s[24:25], v[14:15] op_sel_hi:[1,1,0]
    v_pk_fma_f32 v[216:217], v[216:217], s[24:25], v[14:15] op_sel_hi:[1,1,0]
    v_pk_fma_f32 v[218:219], v[218:219], s[24:25], v[14:15] op_sel_hi:[1,1,0]
    v_pk_fma_f32 v[220:221], v[220:221], s[24:25], v[14:15] op_sel_hi:[1,1,0]
    v_pk_fma_f32 v[222:223], v[222:223], s[24:25], v[14:15] op_sel_hi:[1,1,0]
    v_pk_mul_f32 v[224:225], v[208:209], v[224:225]
    v_pk_mul_f32 v[226:227], v[210:211], v[226:227]
    v_pk_mul_f32 v[228:229], v[212:213], v[228:229]
    v_pk_mul_f32 v[230:231], v[214:215], v[230:231]
    v_pk_mul_f32 v[232:233], v[216:217], v[232:233]
    v_pk_mul_f32 v[234:235], v[218:219], v[234:235]
    v_pk_mul_f32 v[236:237], v[220:221], v[236:237]
    v_pk_mul_f32 v[238:239], v[222:223], v[238:239]
    v_exp_f32 v224, v224
    v_exp_f32 v225, v225
    v_exp_f32 v226, v226
    v_exp_f32 v227, v227
    v_exp_f32 v228, v228
    v_exp_f32 v229, v229
    v_exp_f32 v230, v230
    v_exp_f32 v231, v231
    v_exp_f32 v232, v232
    v_exp_f32 v233, v233
    v_exp_f32 v234, v234
    v_exp_f32 v235, v235
    v_exp_f32 v236, v236
    v_exp_f32 v237, v237
    v_exp_f32 v238, v238
    v_exp_f32 v239, v239
    v_pk_fma_f32 v[224:225], v[224:225], v[24:25], v[24:25] op_sel:[0,1,1]
    v_pk_fma_f32 v[226:227], v[226:227], v[24:25], v[24:25] op_sel:[0,1,1]
    v_pk_fma_f32 v[228:229], v[228:229], v[26:27], v[26:27] op_sel:[0,1,1]
    v_pk_fma_f32 v[230:231], v[230:231], v[26:27], v[26:27] op_sel:[0,1,1]
    v_pk_fma_f32 v[232:233], v[232:233], v[28:29], v[28:29] op_sel:[0,1,1]
    v_pk_fma_f32 v[234:235], v[234:235], v[28:29], v[28:29] op_sel:[0,1,1]
    v_pk_fma_f32 v[236:237], v[236:237], v[30:31], v[30:31] op_sel:[0,1,1]
    v_pk_fma_f32 v[238:239], v[238:239], v[30:31], v[30:31] op_sel:[0,1,1]
    v_rcp_f32 v224, v224
    v_rcp_f32 v225, v225
    v_rcp_f32 v226, v226
    v_rcp_f32 v227, v227
    v_rcp_f32 v228, v228
    v_rcp_f32 v229, v229
    v_rcp_f32 v230, v230
    v_rcp_f32 v231, v231
    v_rcp_f32 v232, v232
    v_rcp_f32 v233, v233
    v_rcp_f32 v234, v234
    v_rcp_f32 v235, v235
    v_rcp_f32 v236, v236
    v_rcp_f32 v237, v237
    v_rcp_f32 v238, v238
    v_rcp_f32 v239, v239
    v_pk_mul_f32 v[240:241], v[224:225], v[240:241]
    v_pk_mul_f32 v[242:243], v[226:227], v[242:243]
    v_pk_mul_f32 v[244:245], v[228:229], v[244:245]
    v_pk_mul_f32 v[246:247], v[230:231], v[246:247]
    v_pk_mul_f32 v[248:249], v[232:233], v[248:249]
    v_pk_mul_f32 v[250:251], v[234:235], v[250:251]
    v_pk_mul_f32 v[252:253], v[236:237], v[252:253]
    v_pk_mul_f32 v[254:255], v[238:239], v[254:255]
    v_cvt_pk_bf16_f32 v224, v240, v241
    v_cvt_pk_bf16_f32 v225, v242, v243
    v_cvt_pk_bf16_f32 v226, v244, v245
    v_cvt_pk_bf16_f32 v227, v246, v247
    v_cvt_pk_bf16_f32 v228, v248, v249
    v_cvt_pk_bf16_f32 v229, v250, v251
    v_cvt_pk_bf16_f32 v230, v252, v253
    v_cvt_pk_bf16_f32 v231, v254, v255
    v_permlane32_swap_b32 v224, v226
    v_permlane32_swap_b32 v225, v227
    v_permlane32_swap_b32 v228, v230
    v_permlane32_swap_b32 v229, v231
    buffer_store_dwordx4 v[224:227], v12, s[12:15], s58 offen sc1
    buffer_store_dwordx4 v[228:231], v13, s[12:15], s58 offen sc1
    s_add_u32 s58, s58, 75776
    v_lshl_add_u32 v0, s26, 6, v1
    s_lshl_b32 s56, s48, 5
    s_add_u32 s56, s56, s49
    s_add_u32 s56, s56, 256
    s_lshr_b32 s57, s40, 1
    s_lshl_b32 s57, s57, 5
    s_add_u32 s57, s57, 256
    s_and_b32 s32, s41, 1
    s_lshl_b32 s32, s32, 4
    s_add_u32 s57, s57, s32
    s_add_u32 s12, s38, 720896
    s_addc_u32 s13, s39, 0
    s_mov_b32 s14, 294912
    s_mov_b32 s15, 0x20000
    s_lshl_b32 s32, s56, 7
    s_lshl_b32 s59, s57, 7
    v_mov_b32 v30, 1
    v_mov_b32 v31, s32
    s_waitcnt vmcnt(0)
    s_barrier
    s_cmp_lg_u32 s26, 0
    s_cbranch_scc1 h2_nf
    s_mov_b64 exec, 1
    buffer_store_dword v30, v31, s[12:15], 0 offen sc1
    s_mov_b64 exec, -1
h2_nf:
    s_add_u32 m0, s44, 0
    s_nop 0
    buffer_load_dwordx4 v3, s[8:11], s43 offen lds
    s_add_u32 m0, s44, 1024
    s_nop 0
    buffer_load_dwordx4 v4, s[8:11], s43 offen lds
    s_add_u32 m0, s44, 8192
    s_nop 0
    buffer_load_dwordx4 v5, s[8:11], s43 offen lds
    s_add_u32 m0, s44, 9216
    s_nop 0
    buffer_load_dwordx4 v6, s[8:11], s43 offen lds
    s_add_u32 s43, s43, s47
    s_add_u32 s44, s44, 16384
    s_cmp_eq_u32 s44, s46
    s_cselect_b32 s44, s45, s44
    s_add_u32 m0, s44, 0
    s_nop 0
    buffer_load_dwordx4 v3, s[8:11], s43 offen lds
    s_add_u32 m0, s44, 1024
    s_nop 0
    buffer_load_dwordx4 v4, s[8:11], s43 offen lds
    s_add_u32 m0, s44, 8192
    s_nop 0
    buffer_load_dwordx4 v5, s[8:11], s43 offen lds
    s_add_u32 m0, s44, 9216
    s_nop 0
    buffer_load_dwordx4 v6, s[8:11], s43 offen lds
    s_add_u32 s43, s43, s47
    s_add_u32 s44, s44, 16384
    s_cmp_eq_u32 s44, s46
    s_cselect_b32 s44, s45, s44
    v_bfe_u32 v18, v1, 4, 1
    v_bfe_u32 v19, v1, 3, 1
    v_lshl_add_u32 v18, v18, 2, v19
    s_lshl_b32 s32, s42, 3
    v_add_u32 v18, s32, v18
    v_lshrrev_b32 v19, 5, v1
    v_mul_u32_u24 v19, 75776, v19
    v_and_b32 v16, 7, v1
    v_lshl_add_u32 v19, v16, 4, v19
    v_add_u32 v16, 0, v18
    v_mul_u32_u24 v17, 9363, v16
    v_lshrrev_b32 v17, 16, v17
    v_add_u32 v12, v16, v17
    v_mul_u32_u24 v17, 7, v17
    v_sub_u32 v17, v16, v17
    v_add_u32 v17, 5, v17
    v_lshrrev_b32 v17, 3, v17
    v_add_lshl_u32 v12, v12, v17, 7
    v_add_u32 v12, v12, v19
    v_add_u32 v16, 2, v18
    v_mul_u32_u24 v17, 9363, v16
    v_lshrrev_b32 v17, 16, v17
    v_add_u32 v13, v16, v17
    v_mul_u32_u24 v17, 7, v17
    v_sub_u32 v17, v16, v17
    v_add_u32 v17, 5, v17
    v_lshrrev_b32 v17, 3, v17
    v_add_lshl_u32 v13, v13, v17, 7
    v_add_u32 v13, v13, v19
    s_mov_b32 s27, 0
    s_add_u32 s4, s38, 38797312
    s_addc_u32 s5, s39, 0
    s_mov_b32 s6, 8486912
    s_mov_b32 s7, 0x20000
    s_and_b32 s32, s41, 1
    s_mul_i32 s32, s32, s6
    s_add_u32 s4, s4, s32
    s_addc_u32 s5, s5, 0
    s_add_u32 s20, s38, 196608
    s_addc_u32 s21, s39, 0
    s_mov_b32 s22, 65536
    s_mov_b32 s23, 0x20000
    v_lshrrev_b32 v16, 5, v1
    v_bfe_u32 v17, v1, 2, 3
    v_lshl_add_u32 v16, v16, 4, v17
    v_and_b32 v18, 3, v1
    v_lshlrev_b32 v16, 7, v16
    v_lshl_add_u32 v16, v18, 3, v16
    v_lshrrev_b32 v17, 1, v17
    v_lshl_add_u32 v7, v17, 5, v16
    s_mov_b32 s37, 73728
    s_getpc_b64 s[68:69]
mlp_kernel_pc5:
    s_add_u32 s68, s68, down_epi-mlp_kernel_pc5
    s_addc_u32 s69, s69, 0
    s_mov_b32 s70, mlp_kernel_end-down_epi+4
    s_cmp_lt_u32 s2, 256
    s_cselect_b32 s70, s70, 0
    s_mov_b32 s71, 0x20000
    s_lshr_b32 s32, s2, 3
    s_lshl_b32 s32, s32, 2
    s_add_u32 s32, s32, s26
    s_lshl_b32 s32, s32, 9
    v_lshrrev_b32 v2, 2, v1
    v_lshlrev_b32 v2, 20, v2
    v_lshl_add_u32 v2, v1, 7, v2
    v_add_u32 v2, s32, v2
    s_add_u32 s37, s37, 16384
    s_cmp_eq_u32 s37, 139264
    s_cselect_b32 s37, 8192, s37
    v_add_u32 v8, s37, v7
    v_xor_b32 v9, 32, v8
    v_xor_b32 v10, 64, v8
    v_xor_b32 v11, 96, v8
    ds_read_b64_tr_b16 a[0:1], v8 offset:0
    ds_read_b64_tr_b16 a[2:3], v8 offset:1024
    ds_read_b64_tr_b16 a[4:5], v9 offset:0
    ds_read_b64_tr_b16 a[6:7], v9 offset:1024
    ds_read_b64_tr_b16 a[8:9], v10 offset:0
    ds_read_b64_tr_b16 a[10:11], v10 offset:1024
    ds_read_b64_tr_b16 a[12:13], v11 offset:0
    ds_read_b64_tr_b16 a[14:15], v11 offset:1024
    ds_read_b64_tr_b16 a[16:17], v8 offset:8192
    ds_read_b64_tr_b16 a[18:19], v8 offset:9216
    ds_read_b64_tr_b16 a[20:21], v9 offset:8192
    ds_read_b64_tr_b16 a[22:23], v9 offset:9216
    ds_read_b64_tr_b16 a[24:25], v10 offset:8192
    ds_read_b64_tr_b16 a[26:27], v10 offset:9216
    ds_read_b64_tr_b16 a[28:29], v11 offset:8192
    ds_read_b64_tr_b16 a[30:31], v11 offset:9216
    s_cmp_lg_u32 s26, 0
    s_cbranch_scc1 h2_go
    v_and_b32 v30, 15, v1
    v_lshlrev_b32 v30, 7, v30
    v_add_u32 v30, s59, v30
h2_poll:
    buffer_load_dword v31, v30, s[12:15], 0 offen sc1
    s_waitcnt vmcnt(0)
    v_cmp_eq_u32 vcc, 1, v31
    s_cmp_eq_u64 vcc, -1
    s_cbranch_scc0 h2_poll
h2_go:
    s_waitcnt vmcnt(0)
    s_barrier
    buffer_load_dwordx4 a[32:35], v12, s[4:7], s27 offen sc1
    buffer_load_dwordx4 a[36:39], v13, s[4:7], s27 offen sc1
    s_add_u32 s27, s27, 151552
    buffer_load_dwordx4 a[40:43], v12, s[4:7], s27 offen sc1
    buffer_load_dwordx4 a[44:47], v13, s[4:7], s27 offen sc1
    s_add_u32 s27, s27, 151552
    buffer_load_dwordx4 a[48:51], v12, s[4:7], s27 offen sc1
    buffer_load_dwordx4 a[52:55], v13, s[4:7], s27 offen sc1
    s_add_u32 s27, s27, 151552
    buffer_load_dwordx4 a[56:59], v12, s[4:7], s27 offen sc1
    buffer_load_dwordx4 a[60:63], v13, s[4:7], s27 offen sc1
    s_add_u32 s27, s27, 151552
    buffer_load_dwordx4 a[64:67], v12, s[4:7], s27 offen sc1
    buffer_load_dwordx4 a[68:71], v13, s[4:7], s27 offen sc1
    s_add_u32 s27, s27, 151552
    buffer_load_dwordx4 a[72:75], v12, s[4:7], s27 offen sc1
    buffer_load_dwordx4 a[76:79], v13, s[4:7], s27 offen sc1
    s_add_u32 s27, s27, 151552
    s_lshl_b32 s32, s41, 8
    v_lshl_add_u32 v22, v1, 2, s32
    s_mov_b32 s56, 0
    buffer_load_dword v176, v22, s[20:23], s56 offen sc1
    s_add_u32 s56, s56, 4096
    buffer_load_dword v177, v22, s[20:23], s56 offen sc1
    s_add_u32 s56, s56, 4096
    buffer_load_dword v178, v22, s[20:23], s56 offen sc1
    s_add_u32 s56, s56, 4096
    buffer_load_dword v179, v22, s[20:23], s56 offen sc1
    s_add_u32 s56, s56, 4096
    buffer_load_dword v180, v22, s[20:23], s56 offen sc1
    s_add_u32 s56, s56, 4096
    buffer_load_dword v181, v22, s[20:23], s56 offen sc1
    s_add_u32 s56, s56, 4096
    buffer_load_dword v182, v22, s[20:23], s56 offen sc1
    s_add_u32 s56, s56, 4096
    buffer_load_dword v183, v22, s[20:23], s56 offen sc1
    s_add_u32 s56, s56, 4096
    buffer_load_dword v184, v22, s[20:23], s56 offen sc1
    s_add_u32 s56, s56, 4096
    buffer_load_dword v185, v22, s[20:23], s56 offen sc1
    s_add_u32 s56, s56, 4096
    buffer_load_dword v186, v22, s[20:23], s56 offen sc1
    s_add_u32 s56, s56, 4096
    buffer_load_dword v187, v22, s[20:23], s56 offen sc1
    s_add_u32 s56, s56, 4096
    buffer_load_dword v188, v22, s[20:23], s56 offen sc1
    s_add_u32 s56, s56, 4096
    buffer_load_dword v189, v22, s[20:23], s56 offen sc1
    s_add_u32 s56, s56, 4096
    buffer_load_dword v190, v22, s[20:23], s56 offen sc1
    s_add_u32 s56, s56, 4096
    buffer_load_dword v191, v22, s[20:23], s56 offen sc1
    s_add_u32 s56, s56, 4096
    s_waitcnt vmcnt(26) lgkmcnt(12)
    v_mfma_f32_16x16x32_bf16 v[32:35], a[0:3], a[32:35], 0
    buffer_load_dwordx4 a[80:83], v12, s[4:7], s27 offen sc1
    v_mfma_f32_16x16x32_bf16 v[36:39], a[0:3], a[36:39], 0
    v_mfma_f32_16x16x32_bf16 v[40:43], a[4:7], a[32:35], 0
    ds_read_b64_tr_b16 a[0:1], v8 offset:4096
    buffer_load_dwordx4 a[84:87], v13, s[4:7], s27 offen sc1
    v_mfma_f32_16x16x32_bf16 v[44:47], a[4:7], a[36:39], 0
    s_waitcnt lgkmcnt(9)
    ds_read_b64_tr_b16 a[2:3], v8 offset:5120
    v_mfma_f32_16x16x32_bf16 v[48:51], a[8:11], a[32:35], 0
    ds_read_b64_tr_b16 a[4:5], v9 offset:4096
    s_add_u32 s27, s27, 151552
    v_mfma_f32_16x16x32_bf16 v[52:55], a[8:11], a[36:39], 0
    ds_read_b64_tr_b16 a[6:7], v9 offset:5120
    v_mfma_f32_16x16x32_bf16 v[56:59], a[12:15], a[32:35], 0
    ds_read_b64_tr_b16 a[8:9], v10 offset:4096
    buffer_load_dwordx4 a[88:91], v12, s[4:7], s27 offen sc1
    v_mfma_f32_16x16x32_bf16 v[60:63], a[12:15], a[36:39], 0
    s_waitcnt lgkmcnt(9)
    ds_read_b64_tr_b16 a[10:11], v10 offset:5120
    v_mfma_f32_16x16x32_bf16 v[64:67], a[16:19], a[32:35], 0
    ds_read_b64_tr_b16 a[12:13], v11 offset:4096
    buffer_load_dwordx4 a[92:95], v13, s[4:7], s27 offen sc1
    v_mfma_f32_16x16x32_bf16 v[68:71], a[16:19], a[36:39], 0
    ds_read_b64_tr_b16 a[14:15], v11 offset:5120
    v_mfma_f32_16x16x32_bf16 v[72:75], a[20:23], a[32:35], 0
    ds_read_b64_tr_b16 a[16:17], v8 offset:12288
    s_add_u32 s27, s27, 151552
    v_mfma_f32_16x16x32_bf16 v[76:79], a[20:23], a[36:39], 0
    s_waitcnt lgkmcnt(9)
    ds_read_b64_tr_b16 a[18:19], v8 offset:13312
    v_mfma_f32_16x16x32_bf16 v[80:83], a[24:27], a[32:35], 0
    ds_read_b64_tr_b16 a[20:21], v9 offset:12288
    s_add_u32 s37, s37, 16384
    v_mfma_f32_16x16x32_bf16 v[84:87], a[24:27], a[36:39], 0
    ds_read_b64_tr_b16 a[22:23], v9 offset:13312
    v_mfma_f32_16x16x32_bf16 v[88:91], a[28:31], a[32:35], 0
    ds_read_b64_tr_b16 a[24:25], v10 offset:12288
    s_cmp_eq_u32 s37, 139264
    s_cselect_b32 s37, 8192, s37
    v_mfma_f32_16x16x32_bf16 v[92:95], a[28:31], a[36:39], 0
    s_waitcnt vmcnt(28) lgkmcnt(9)
    ds_read_b64_tr_b16 a[26:27], v10 offset:13312
    v_mfma_f32_16x16x32_bf16 v[32:35], a[0:3], a[40:43], v[32:35]
    ds_read_b64_tr_b16 a[28:29], v11 offset:12288
    v_mfma_f32_16x16x32_bf16 v[36:39], a[0:3], a[44:47], v[36:39]
    ds_read_b64_tr_b16 a[30:31], v11 offset:13312
    s_barrier
    v_add_u32 v8, s37, v7
    v_xor_b32 v9, 32, v8
    v_xor_b32 v10, 64, v8
    v_xor_b32 v11, 96, v8
    v_mfma_f32_16x16x32_bf16 v[40:43], a[4:7], a[40:43], v[40:43]
    ds_read_b64_tr_b16 a[0:1], v8 offset:0
    v_mfma_f32_16x16x32_bf16 v[44:47], a[4:7], a[44:47], v[44:47]
    s_waitcnt lgkmcnt(9)
    ds_read_b64_tr_b16 a[2:3], v8 offset:1024
    buffer_load_dwordx4 a[32:35], v12, s[4:7], s27 offen sc1
    v_mfma_f32_16x16x32_bf16 v[48:51], a[8:11], a[40:43], v[48:51]
    ds_read_b64_tr_b16 a[4:5], v9 offset:0
    buffer_load_dwordx4 a[36:39], v13, s[4:7], s27 offen sc1
    v_mfma_f32_16x16x32_bf16 v[52:55], a[8:11], a[44:47], v[52:55]
    ds_read_b64_tr_b16 a[6:7], v9 offset:1024
    v_mfma_f32_16x16x32_bf16 v[56:59], a[12:15], a[40:43], v[56:59]
    ds_read_b64_tr_b16 a[8:9], v10 offset:0
    s_add_u32 s27, s27, 151552
    v_mfma_f32_16x16x32_bf16 v[60:63], a[12:15], a[44:47], v[60:63]
    s_waitcnt lgkmcnt(9)
    ds_read_b64_tr_b16 a[10:11], v10 offset:1024
    v_mfma_f32_16x16x32_bf16 v[64:67], a[16:19], a[40:43], v[64:67]
    ds_read_b64_tr_b16 a[12:13], v11 offset:0
    s_add_u32 m0, s44, 0
    v_mfma_f32_16x16x32_bf16 v[68:71], a[16:19], a[44:47], v[68:71]
    ds_read_b64_tr_b16 a[14:15], v11 offset:1024
    v_mfma_f32_16x16x32_bf16 v[72:75], a[20:23], a[40:43], v[72:75]
    ds_read_b64_tr_b16 a[16:17], v8 offset:8192
    buffer_load_dwordx4 v3, s[8:11], s43 offen lds
    v_mfma_f32_16x16x32_bf16 v[76:79], a[20:23], a[44:47], v[76:79]
    s_waitcnt lgkmcnt(9)
    ds_read_b64_tr_b16 a[18:19], v8 offset:9216
    v_mfma_f32_16x16x32_bf16 v[80:83], a[24:27], a[40:43], v[80:83]
    ds_read_b64_tr_b16 a[20:21], v9 offset:8192
    s_add_u32 m0, s44, 1024
    v_mfma_f32_16x16x32_bf16 v[84:87], a[24:27], a[44:47], v[84:87]
    ds_read_b64_tr_b16 a[22:23], v9 offset:9216
    v_mfma_f32_16x16x32_bf16 v[88:91], a[28:31], a[40:43], v[88:91]
    ds_read_b64_tr_b16 a[24:25], v10 offset:8192
    buffer_load_dwordx4 v4, s[8:11], s43 offen lds
    v_mfma_f32_16x16x32_bf16 v[92:95], a[28:31], a[44:47], v[92:95]
    s_waitcnt vmcnt(30) lgkmcnt(9)
    ds_read_b64_tr_b16 a[26:27], v10 offset:9216
    v_mfma_f32_16x16x32_bf16 v[32:35], a[0:3], a[48:51], v[32:35]
    ds_read_b64_tr_b16 a[28:29], v11 offset:8192
    buffer_load_dwordx4 a[40:43], v12, s[4:7], s27 offen sc1
    v_mfma_f32_16x16x32_bf16 v[36:39], a[0:3], a[52:55], v[36:39]
    ds_read_b64_tr_b16 a[30:31], v11 offset:9216
    buffer_load_dwordx4 a[44:47], v13, s[4:7], s27 offen sc1
    v_mfma_f32_16x16x32_bf16 v[40:43], a[4:7], a[48:51], v[40:43]
    ds_read_b64_tr_b16 a[0:1], v8 offset:4096
    s_add_u32 s27, s27, 151552
    v_mfma_f32_16x16x32_bf16 v[44:47], a[4:7], a[52:55], v[44:47]
    s_waitcnt lgkmcnt(9)
    ds_read_b64_tr_b16 a[2:3], v8 offset:5120
    v_mfma_f32_16x16x32_bf16 v[48:51], a[8:11], a[48:51], v[48:51]
    ds_read_b64_tr_b16 a[4:5], v9 offset:4096
    s_add_u32 m0, s44, 8192
    v_mfma_f32_16x16x32_bf16 v[52:55], a[8:11], a[52:55], v[52:55]
    ds_read_b64_tr_b16 a[6:7], v9 offset:5120
    buffer_load_dwordx4 v5, s[8:11], s43 offen lds
    v_mfma_f32_16x16x32_bf16 v[56:59], a[12:15], a[48:51], v[56:59]
    ds_read_b64_tr_b16 a[8:9], v10 offset:4096
    s_add_u32 m0, s44, 9216
    v_mfma_f32_16x16x32_bf16 v[60:63], a[12:15], a[52:55], v[60:63]
    s_waitcnt lgkmcnt(9)
    ds_read_b64_tr_b16 a[10:11], v10 offset:5120
    v_mfma_f32_16x16x32_bf16 v[64:67], a[16:19], a[48:51], v[64:67]
    ds_read_b64_tr_b16 a[12:13], v11 offset:4096
    buffer_load_dwordx4 v6, s[8:11], s43 offen lds
    v_mfma_f32_16x16x32_bf16 v[68:71], a[16:19], a[52:55], v[68:71]
    ds_read_b64_tr_b16 a[14:15], v11 offset:5120
    s_add_u32 s43, s43, s47
    v_mfma_f32_16x16x32_bf16 v[72:75], a[20:23], a[48:51], v[72:75]
    ds_read_b64_tr_b16 a[16:17], v8 offset:12288
    s_add_u32 s44, s44, 16384
    v_mfma_f32_16x16x32_bf16 v[76:79], a[20:23], a[52:55], v[76:79]
    s_waitcnt lgkmcnt(9)
    ds_read_b64_tr_b16 a[18:19], v8 offset:13312
    v_mfma_f32_16x16x32_bf16 v[80:83], a[24:27], a[48:51], v[80:83]
    ds_read_b64_tr_b16 a[20:21], v9 offset:12288
    s_cmp_eq_u32 s44, s46
    s_cselect_b32 s44, s45, s44
    v_mfma_f32_16x16x32_bf16 v[84:87], a[24:27], a[52:55], v[84:87]
    ds_read_b64_tr_b16 a[22:23], v9 offset:13312
    s_add_u32 s37, s37, 16384
    v_mfma_f32_16x16x32_bf16 v[88:91], a[28:31], a[48:51], v[88:91]
    ds_read_b64_tr_b16 a[24:25], v10 offset:12288
    s_cmp_eq_u32 s37, 139264
    s_cselect_b32 s37, 8192, s37
    v_mfma_f32_16x16x32_bf16 v[92:95], a[28:31], a[52:55], v[92:95]
    s_waitcnt vmcnt(32) lgkmcnt(9)
    ds_read_b64_tr_b16 a[26:27], v10 offset:13312
    v_mfma_f32_16x16x32_bf16 v[32:35], a[0:3], a[56:59], v[32:35]
    ds_read_b64_tr_b16 a[28:29], v11 offset:12288
    v_mfma_f32_16x16x32_bf16 v[36:39], a[0:3], a[60:63], v[36:39]
    ds_read_b64_tr_b16 a[30:31], v11 offset:13312
    s_barrier
    v_add_u32 v8, s37, v7
    v_xor_b32 v9, 32, v8
    v_xor_b32 v10, 64, v8
    v_xor_b32 v11, 96, v8
    v_mfma_f32_16x16x32_bf16 v[40:43], a[4:7], a[56:59], v[40:43]
    ds_read_b64_tr_b16 a[0:1], v8 offset:0
    v_mfma_f32_16x16x32_bf16 v[44:47], a[4:7], a[60:63], v[44:47]
    s_waitcnt lgkmcnt(9)
    ds_read_b64_tr_b16 a[2:3], v8 offset:1024
    buffer_load_dwordx4 a[48:51], v12, s[4:7], s27 offen sc1
    v_mfma_f32_16x16x32_bf16 v[48:51], a[8:11], a[56:59], v[48:51]
    ds_read_b64_tr_b16 a[4:5], v9 offset:0
    buffer_load_dwordx4 a[52:55], v13, s[4:7], s27 offen sc1
    v_mfma_f32_16x16x32_bf16 v[52:55], a[8:11], a[60:63], v[52:55]
    ds_read_b64_tr_b16 a[6:7], v9 offset:1024
    v_mfma_f32_16x16x32_bf16 v[56:59], a[12:15], a[56:59], v[56:59]
    ds_read_b64_tr_b16 a[8:9], v10 offset:0
    s_add_u32 s27, s27, 151552
    v_mfma_f32_16x16x32_bf16 v[60:63], a[12:15], a[60:63], v[60:63]
    s_waitcnt lgkmcnt(9)
    ds_read_b64_tr_b16 a[10:11], v10 offset:1024
    v_mfma_f32_16x16x32_bf16 v[64:67], a[16:19], a[56:59], v[64:67]
    ds_read_b64_tr_b16 a[12:13], v11 offset:0
    s_add_u32 m0, s44, 0
    v_mfma_f32_16x16x32_bf16 v[68:71], a[16:19], a[60:63], v[68:71]
    ds_read_b64_tr_b16 a[14:15], v11 offset:1024
    v_mfma_f32_16x16x32_bf16 v[72:75], a[20:23], a[56:59], v[72:75]
    ds_read_b64_tr_b16 a[16:17], v8 offset:8192
    buffer_load_dwordx4 v3, s[8:11], s43 offen lds
    v_mfma_f32_16x16x32_bf16 v[76:79], a[20:23], a[60:63], v[76:79]
    s_waitcnt lgkmcnt(9)
    ds_read_b64_tr_b16 a[18:19], v8 offset:9216
    v_mfma_f32_16x16x32_bf16 v[80:83], a[24:27], a[56:59], v[80:83]
    ds_read_b64_tr_b16 a[20:21], v9 offset:8192
    s_add_u32 m0, s44, 1024
    v_mfma_f32_16x16x32_bf16 v[84:87], a[24:27], a[60:63], v[84:87]
    ds_read_b64_tr_b16 a[22:23], v9 offset:9216
    v_mfma_f32_16x16x32_bf16 v[88:91], a[28:31], a[56:59], v[88:91]
    ds_read_b64_tr_b16 a[24:25], v10 offset:8192
    buffer_load_dwordx4 v4, s[8:11], s43 offen lds
    v_mfma_f32_16x16x32_bf16 v[92:95], a[28:31], a[60:63], v[92:95]
    s_waitcnt vmcnt(34) lgkmcnt(9)
    ds_read_b64_tr_b16 a[26:27], v10 offset:9216
    v_mfma_f32_16x16x32_bf16 v[32:35], a[0:3], a[64:67], v[32:35]
    ds_read_b64_tr_b16 a[28:29], v11 offset:8192
    buffer_load_dwordx4 a[56:59], v12, s[4:7], s27 offen sc1
    v_mfma_f32_16x16x32_bf16 v[36:39], a[0:3], a[68:71], v[36:39]
    ds_read_b64_tr_b16 a[30:31], v11 offset:9216
    buffer_load_dwordx4 a[60:63], v13, s[4:7], s27 offen sc1
    v_mfma_f32_16x16x32_bf16 v[40:43], a[4:7], a[64:67], v[40:43]
    ds_read_b64_tr_b16 a[0:1], v8 offset:4096
    s_add_u32 s27, s27, 151552
    v_mfma_f32_16x16x32_bf16 v[44:47], a[4:7], a[68:71], v[44:47]
    s_waitcnt lgkmcnt(9)
    ds_read_b64_tr_b16 a[2:3], v8 offset:5120
    v_mfma_f32_16x16x32_bf16 v[48:51], a[8:11], a[64:67], v[48:51]
    ds_read_b64_tr_b16 a[4:5], v9 offset:4096
    s_add_u32 m0, s44, 8192
    v_mfma_f32_16x16x32_bf16 v[52:55], a[8:11], a[68:71], v[52:55]
    ds_read_b64_tr_b16 a[6:7], v9 offset:5120
    buffer_load_dwordx4 v5, s[8:11], s43 offen lds
    v_mfma_f32_16x16x32_bf16 v[56:59], a[12:15], a[64:67], v[56:59]
    ds_read_b64_tr_b16 a[8:9], v10 offset:4096
    s_add_u32 m0, s44, 9216
    v_mfma_f32_16x16x32_bf16 v[60:63], a[12:15], a[68:71], v[60:63]
    s_waitcnt lgkmcnt(9)
    ds_read_b64_tr_b16 a[10:11], v10 offset:5120
    v_mfma_f32_16x16x32_bf16 v[64:67], a[16:19], a[64:67], v[64:67]
    ds_read_b64_tr_b16 a[12:13], v11 offset:4096
    buffer_load_dwordx4 v6, s[8:11], s43 offen lds
    v_mfma_f32_16x16x32_bf16 v[68:71], a[16:19], a[68:71], v[68:71]
    ds_read_b64_tr_b16 a[14:15], v11 offset:5120
    s_add_u32 s43, s43, s47
    v_mfma_f32_16x16x32_bf16 v[72:75], a[20:23], a[64:67], v[72:75]
    ds_read_b64_tr_b16 a[16:17], v8 offset:12288
    s_add_u32 s44, s44, 16384
    v_mfma_f32_16x16x32_bf16 v[76:79], a[20:23], a[68:71], v[76:79]
    s_waitcnt lgkmcnt(9)
    ds_read_b64_tr_b16 a[18:19], v8 offset:13312
    v_mfma_f32_16x16x32_bf16 v[80:83], a[24:27], a[64:67], v[80:83]
    ds_read_b64_tr_b16 a[20:21], v9 offset:12288
    s_cmp_eq_u32 s44, s46
    s_cselect_b32 s44, s45, s44
    v_mfma_f32_16x16x32_bf16 v[84:87], a[24:27], a[68:71], v[84:87]
    ds_read_b64_tr_b16 a[22:23], v9 offset:13312
    s_add_u32 s37, s37, 16384
    v_mfma_f32_16x16x32_bf16 v[88:91], a[28:31], a[64:67], v[88:91]
    ds_read_b64_tr_b16 a[24:25], v10 offset:12288
    s_cmp_eq_u32 s37, 139264
    s_cselect_b32 s37, 8192, s37
    v_mfma_f32_16x16x32_bf16 v[92:95], a[28:31], a[68:71], v[92:95]
    s_waitcnt vmcnt(36) lgkmcnt(9)
    ds_read_b64_tr_b16 a[26:27], v10 offset:13312
    v_mfma_f32_16x16x32_bf16 v[32:35], a[0:3], a[72:75], v[32:35]
    ds_read_b64_tr_b16 a[28:29], v11 offset:12288
    v_mfma_f32_16x16x32_bf16 v[36:39], a[0:3], a[76:79], v[36:39]
    ds_read_b64_tr_b16 a[30:31], v11 offset:13312
    s_barrier
    v_add_u32 v8, s37, v7
    v_xor_b32 v9, 32, v8
    v_xor_b32 v10, 64, v8
    v_xor_b32 v11, 96, v8
    v_mfma_f32_16x16x32_bf16 v[40:43], a[4:7], a[72:75], v[40:43]
    ds_read_b64_tr_b16 a[0:1], v8 offset:0
    v_mfma_f32_16x16x32_bf16 v[44:47], a[4:7], a[76:79], v[44:47]
    s_waitcnt lgkmcnt(9)
    ds_read_b64_tr_b16 a[2:3], v8 offset:1024
    buffer_load_dwordx4 a[64:67], v12, s[4:7], s27 offen sc1
    v_mfma_f32_16x16x32_bf16 v[48:51], a[8:11], a[72:75], v[48:51]
    ds_read_b64_tr_b16 a[4:5], v9 offset:0
    buffer_load_dwordx4 a[68:71], v13, s[4:7], s27 offen sc1
    v_mfma_f32_16x16x32_bf16 v[52:55], a[8:11], a[76:79], v[52:55]
    ds_read_b64_tr_b16 a[6:7], v9 offset:1024
    v_mfma_f32_16x16x32_bf16 v[56:59], a[12:15], a[72:75], v[56:59]
    ds_read_b64_tr_b16 a[8:9], v10 offset:0
    s_add_u32 s27, s27, 151552
    v_mfma_f32_16x16x32_bf16 v[60:63], a[12:15], a[76:79], v[60:63]
    s_waitcnt lgkmcnt(9)
    ds_read_b64_tr_b16 a[10:11], v10 offset:1024
    v_mfma_f32_16x16x32_bf16 v[64:67], a[16:19], a[72:75], v[64:67]
    ds_read_b64_tr_b16 a[12:13], v11 offset:0
    s_add_u32 m0, s44, 0
    v_mfma_f32_16x16x32_bf16 v[68:71], a[16:19], a[76:79], v[68:71]
    ds_read_b64_tr_b16 a[14:15], v11 offset:1024
    v_mfma_f32_16x16x32_bf16 v[72:75], a[20:23], a[72:75], v[72:75]
    ds_read_b64_tr_b16 a[16:17], v8 offset:8192
    buffer_load_dwordx4 v3, s[8:11], s43 offen lds
    v_mfma_f32_16x16x32_bf16 v[76:79], a[20:23], a[76:79], v[76:79]
    s_waitcnt lgkmcnt(9)
    ds_read_b64_tr_b16 a[18:19], v8 offset:9216
    v_mfma_f32_16x16x32_bf16 v[80:83], a[24:27], a[72:75], v[80:83]
    ds_read_b64_tr_b16 a[20:21], v9 offset:8192
    s_add_u32 m0, s44, 1024
    v_mfma_f32_16x16x32_bf16 v[84:87], a[24:27], a[76:79], v[84:87]
    ds_read_b64_tr_b16 a[22:23], v9 offset:9216
    v_mfma_f32_16x16x32_bf16 v[88:91], a[28:31], a[72:75], v[88:91]
    ds_read_b64_tr_b16 a[24:25], v10 offset:8192
    buffer_load_dwordx4 v4, s[8:11], s43 offen lds
    v_mfma_f32_16x16x32_bf16 v[92:95], a[28:31], a[76:79], v[92:95]
    s_waitcnt vmcnt(22) lgkmcnt(9)
    ds_read_b64_tr_b16 a[26:27], v10 offset:9216
    v_mfma_f32_16x16x32_bf16 v[32:35], a[0:3], a[80:83], v[32:35]
    ds_read_b64_tr_b16 a[28:29], v11 offset:8192
    buffer_load_dwordx4 a[72:75], v12, s[4:7], s27 offen sc1
    v_mfma_f32_16x16x32_bf16 v[36:39], a[0:3], a[84:87], v[36:39]
    ds_read_b64_tr_b16 a[30:31], v11 offset:9216
    buffer_load_dwordx4 a[76:79], v13, s[4:7], s27 offen sc1
    v_mfma_f32_16x16x32_bf16 v[40:43], a[4:7], a[80:83], v[40:43]
    ds_read_b64_tr_b16 a[0:1], v8 offset:4096
    s_add_u32 s27, s27, 151552
    v_mfma_f32_16x16x32_bf16 v[44:47], a[4:7], a[84:87], v[44:47]
    s_waitcnt lgkmcnt(9)
    ds_read_b64_tr_b16 a[2:3], v8 offset:5120
    v_mfma_f32_16x16x32_bf16 v[48:51], a[8:11], a[80:83], v[48:51]
    ds_read_b64_tr_b16 a[4:5], v9 offset:4096
    s_add_u32 m0, s44, 8192
    v_mfma_f32_16x16x32_bf16 v[52:55], a[8:11], a[84:87], v[52:55]
    ds_read_b64_tr_b16 a[6:7], v9 offset:5120
    buffer_load_dwordx4 v5, s[8:11], s43 offen lds
    v_mfma_f32_16x16x32_bf16 v[56:59], a[12:15], a[80:83], v[56:59]
    ds_read_b64_tr_b16 a[8:9], v10 offset:4096
    s_add_u32 m0, s44, 9216
    v_mfma_f32_16x16x32_bf16 v[60:63], a[12:15], a[84:87], v[60:63]
    s_waitcnt lgkmcnt(9)
    ds_read_b64_tr_b16 a[10:11], v10 offset:5120
    v_mfma_f32_16x16x32_bf16 v[64:67], a[16:19], a[80:83], v[64:67]
    ds_read_b64_tr_b16 a[12:13], v11 offset:4096
    buffer_load_dwordx4 v6, s[8:11], s43 offen lds
    v_mfma_f32_16x16x32_bf16 v[68:71], a[16:19], a[84:87], v[68:71]
    ds_read_b64_tr_b16 a[14:15], v11 offset:5120
    s_add_u32 s43, s43, s47
    v_mfma_f32_16x16x32_bf16 v[72:75], a[20:23], a[80:83], v[72:75]
    ds_read_b64_tr_b16 a[16:17], v8 offset:12288
    s_add_u32 s44, s44, 16384
    v_mfma_f32_16x16x32_bf16 v[76:79], a[20:23], a[84:87], v[76:79]
    s_waitcnt lgkmcnt(9)
    ds_read_b64_tr_b16 a[18:19], v8 offset:13312
    v_mfma_f32_16x16x32_bf16 v[80:83], a[24:27], a[80:83], v[80:83]
    ds_read_b64_tr_b16 a[20:21], v9 offset:12288
    s_cmp_eq_u32 s44, s46
    s_cselect_b32 s44, s45, s44
    v_mfma_f32_16x16x32_bf16 v[84:87], a[24:27], a[84:87], v[84:87]
    ds_read_b64_tr_b16 a[22:23], v9 offset:13312
    s_add_u32 s37, s37, 16384
    v_mfma_f32_16x16x32_bf16 v[88:91], a[28:31], a[80:83], v[88:91]
    ds_read_b64_tr_b16 a[24:25], v10 offset:12288
    s_cmp_eq_u32 s37, 139264
    s_cselect_b32 s37, 8192, s37
    v_mfma_f32_16x16x32_bf16 v[92:95], a[28:31], a[84:87], v[92:95]
    s_waitcnt vmcnt(24) lgkmcnt(9)
    ds_read_b64_tr_b16 a[26:27], v10 offset:13312
    v_mfma_f32_16x16x32_bf16 v[32:35], a[0:3], a[88:91], v[32:35]
    ds_read_b64_tr_b16 a[28:29], v11 offset:12288
    v_mfma_f32_16x16x32_bf16 v[36:39], a[0:3], a[92:95], v[36:39]
    ds_read_b64_tr_b16 a[30:31], v11 offset:13312
    s_barrier
    v_add_u32 v8, s37, v7
    v_xor_b32 v9, 32, v8
    v_xor_b32 v10, 64, v8
    v_xor_b32 v11, 96, v8
    v_mfma_f32_16x16x32_bf16 v[40:43], a[4:7], a[88:91], v[40:43]
    ds_read_b64_tr_b16 a[0:1], v8 offset:0
    v_mfma_f32_16x16x32_bf16 v[44:47], a[4:7], a[92:95], v[44:47]
    s_waitcnt lgkmcnt(9)
    ds_read_b64_tr_b16 a[2:3], v8 offset:1024
    buffer_load_dwordx4 a[80:83], v12, s[4:7], s27 offen sc1
    v_mfma_f32_16x16x32_bf16 v[48:51], a[8:11], a[88:91], v[48:51]
    ds_read_b64_tr_b16 a[4:5], v9 offset:0
    buffer_load_dwordx4 a[84:87], v13, s[4:7], s27 offen sc1
    v_mfma_f32_16x16x32_bf16 v[52:55], a[8:11], a[92:95], v[52:55]
    ds_read_b64_tr_b16 a[6:7], v9 offset:1024
    v_mfma_f32_16x16x32_bf16 v[56:59], a[12:15], a[88:91], v[56:59]
    ds_read_b64_tr_b16 a[8:9], v10 offset:0
    s_add_u32 s27, s27, 151552
    v_mfma_f32_16x16x32_bf16 v[60:63], a[12:15], a[92:95], v[60:63]
    s_waitcnt lgkmcnt(9)
    ds_read_b64_tr_b16 a[10:11], v10 offset:1024
    v_mfma_f32_16x16x32_bf16 v[64:67], a[16:19], a[88:91], v[64:67]
    ds_read_b64_tr_b16 a[12:13], v11 offset:0
    s_add_u32 m0, s44, 0
    v_mfma_f32_16x16x32_bf16 v[68:71], a[16:19], a[92:95], v[68:71]
    ds_read_b64_tr_b16 a[14:15], v11 offset:1024
    v_mfma_f32_16x16x32_bf16 v[72:75], a[20:23], a[88:91], v[72:75]
    ds_read_b64_tr_b16 a[16:17], v8 offset:8192
    buffer_load_dwordx4 v3, s[8:11], s43 offen lds
    v_mfma_f32_16x16x32_bf16 v[76:79], a[20:23], a[92:95], v[76:79]
    s_waitcnt lgkmcnt(9)
    ds_read_b64_tr_b16 a[18:19], v8 offset:9216
    v_mfma_f32_16x16x32_bf16 v[80:83], a[24:27], a[88:91], v[80:83]
    ds_read_b64_tr_b16 a[20:21], v9 offset:8192
    s_add_u32 m0, s44, 1024
    v_mfma_f32_16x16x32_bf16 v[84:87], a[24:27], a[92:95], v[84:87]
    ds_read_b64_tr_b16 a[22:23], v9 offset:9216
    v_mfma_f32_16x16x32_bf16 v[88:91], a[28:31], a[88:91], v[88:91]
    ds_read_b64_tr_b16 a[24:25], v10 offset:8192
    buffer_load_dwordx4 v4, s[8:11], s43 offen lds
    v_mfma_f32_16x16x32_bf16 v[92:95], a[28:31], a[92:95], v[92:95]
    s_waitcnt vmcnt(26) lgkmcnt(9)
    ds_read_b64_tr_b16 a[26:27], v10 offset:9216
    ds_read_b64_tr_b16 a[28:29], v11 offset:8192
    ds_read_b64_tr_b16 a[30:31], v11 offset:9216
    s_mov_b32 s36, 6
.p2align 6
down_loop:
    v_mfma_f32_16x16x32_bf16 v[32:35], a[0:3], a[32:35], v[32:35]
    buffer_load_dwordx4 a[88:91], v12, s[4:7], s27 offen sc1
    v_mfma_f32_16x16x32_bf16 v[36:39], a[0:3], a[36:39], v[36:39]
    buffer_load_dwordx4 a[92:95], v13, s[4:7], s27 offen sc1
    v_mfma_f32_16x16x32_bf16 v[40:43], a[4:7], a[32:35], v[40:43]
    ds_read_b64_tr_b16 a[0:1], v8 offset:4096
    s_add_u32 s27, s27, 151552
    v_mfma_f32_16x16x32_bf16 v[44:47], a[4:7], a[36:39], v[44:47]
    s_waitcnt lgkmcnt(9)
    ds_read_b64_tr_b16 a[2:3], v8 offset:5120
    v_mfma_f32_16x16x32_bf16 v[48:51], a[8:11], a[32:35], v[48:51]
    ds_read_b64_tr_b16 a[4:5], v9 offset:4096
    s_add_u32 m0, s44, 8192
    v_mfma_f32_16x16x32_bf16 v[52:55], a[8:11], a[36:39], v[52:55]
    ds_read_b64_tr_b16 a[6:7], v9 offset:5120
    buffer_load_dwordx4 v5, s[8:11], s43 offen lds
    v_mfma_f32_16x16x32_bf16 v[56:59], a[12:15], a[32:35], v[56:59]
    ds_read_b64_tr_b16 a[8:9], v10 offset:4096
    s_add_u32 m0, s44, 9216
    v_mfma_f32_16x16x32_bf16 v[60:63], a[12:15], a[36:39], v[60:63]
    s_waitcnt lgkmcnt(9)
    ds_read_b64_tr_b16 a[10:11], v10 offset:5120
    v_mfma_f32_16x16x32_bf16 v[64:67], a[16:19], a[32:35], v[64:67]
    ds_read_b64_tr_b16 a[12:13], v11 offset:4096
    buffer_load_dwordx4 v6, s[8:11], s43 offen lds
    v_mfma_f32_16x16x32_bf16 v[68:71], a[16:19], a[36:39], v[68:71]
    ds_read_b64_tr_b16 a[14:15], v11 offset:5120
    s_add_u32 s43, s43, s47
    v_mfma_f32_16x16x32_bf16 v[72:75], a[20:23], a[32:35], v[72:75]
    ds_read_b64_tr_b16 a[16:17], v8 offset:12288
    s_add_u32 s44, s44, 16384
    v_mfma_f32_16x16x32_bf16 v[76:79], a[20:23], a[36:39], v[76:79]
    s_waitcnt lgkmcnt(9)
    ds_read_b64_tr_b16 a[18:19], v8 offset:13312
    v_mfma_f32_16x16x32_bf16 v[80:83], a[24:27], a[32:35], v[80:83]
    ds_read_b64_tr_b16 a[20:21], v9 offset:12288
    s_cmp_eq_u32 s44, s46
    s_cselect_b32 s44, s45, s44
    v_mfma_f32_16x16x32_bf16 v[84:87], a[24:27], a[36:39], v[84:87]
    ds_read_b64_tr_b16 a[22:23], v9 offset:13312
    s_add_u32 s37, s37, 16384
    v_mfma_f32_16x16x32_bf16 v[88:91], a[28:31], a[32:35], v[88:91]
    ds_read_b64_tr_b16 a[24:25], v10 offset:12288
    s_cmp_eq_u32 s37, 139264
    s_cselect_b32 s37, 8192, s37
    v_mfma_f32_16x16x32_bf16 v[92:95], a[28:31], a[36:39], v[92:95]
    s_waitcnt vmcnt(26) lgkmcnt(9)
    ds_read_b64_tr_b16 a[26:27], v10 offset:13312
    v_mfma_f32_16x16x32_bf16 v[32:35], a[0:3], a[40:43], v[32:35]
    ds_read_b64_tr_b16 a[28:29], v11 offset:12288
    v_mfma_f32_16x16x32_bf16 v[36:39], a[0:3], a[44:47], v[36:39]
    ds_read_b64_tr_b16 a[30:31], v11 offset:13312
    s_barrier
    v_add_u32 v8, s37, v7
    v_xor_b32 v9, 32, v8
    v_xor_b32 v10, 64, v8
    v_xor_b32 v11, 96, v8
    v_mfma_f32_16x16x32_bf16 v[40:43], a[4:7], a[40:43], v[40:43]
    ds_read_b64_tr_b16 a[0:1], v8 offset:0
    v_mfma_f32_16x16x32_bf16 v[44:47], a[4:7], a[44:47], v[44:47]
    s_waitcnt lgkmcnt(9)
    ds_read_b64_tr_b16 a[2:3], v8 offset:1024
    buffer_load_dwordx4 a[32:35], v12, s[4:7], s27 offen sc1
    v_mfma_f32_16x16x32_bf16 v[48:51], a[8:11], a[40:43], v[48:51]
    ds_read_b64_tr_b16 a[4:5], v9 offset:0
    buffer_load_dwordx4 a[36:39], v13, s[4:7], s27 offen sc1
    v_mfma_f32_16x16x32_bf16 v[52:55], a[8:11], a[44:47], v[52:55]
    ds_read_b64_tr_b16 a[6:7], v9 offset:1024
    v_mfma_f32_16x16x32_bf16 v[56:59], a[12:15], a[40:43], v[56:59]
    ds_read_b64_tr_b16 a[8:9], v10 offset:0
    s_add_u32 s27, s27, 151552
    v_mfma_f32_16x16x32_bf16 v[60:63], a[12:15], a[44:47], v[60:63]
    s_waitcnt lgkmcnt(9)
    ds_read_b64_tr_b16 a[10:11], v10 offset:1024
    s_add_u32 m0, s44, 0
    v_mfma_f32_16x16x32_bf16 v[64:67], a[16:19], a[40:43], v[64:67]
    ds_read_b64_tr_b16 a[12:13], v11 offset:0
    v_mfma_f32_16x16x32_bf16 v[68:71], a[16:19], a[44:47], v[68:71]
    ds_read_b64_tr_b16 a[14:15], v11 offset:1024
    buffer_load_dwordx4 v3, s[8:11], s43 offen lds
    v_mfma_f32_16x16x32_bf16 v[72:75], a[20:23], a[40:43], v[72:75]
    ds_read_b64_tr_b16 a[16:17], v8 offset:8192
    v_mfma_f32_16x16x32_bf16 v[76:79], a[20:23], a[44:47], v[76:79]
    s_waitcnt lgkmcnt(9)
    ds_read_b64_tr_b16 a[18:19], v8 offset:9216
    s_add_u32 m0, s44, 1024
    v_mfma_f32_16x16x32_bf16 v[80:83], a[24:27], a[40:43], v[80:83]
    ds_read_b64_tr_b16 a[20:21], v9 offset:8192
    buffer_load_dwordx4 v4, s[8:11], s43 offen lds
    v_mfma_f32_16x16x32_bf16 v[84:87], a[24:27], a[44:47], v[84:87]
    ds_read_b64_tr_b16 a[22:23], v9 offset:9216
    v_mfma_f32_16x16x32_bf16 v[88:91], a[28:31], a[40:43], v[88:91]
    ds_read_b64_tr_b16 a[24:25], v10 offset:8192
    buffer_load_dword v31, v2, s[68:71], 0 offen
    v_mfma_f32_16x16x32_bf16 v[92:95], a[28:31], a[44:47], v[92:95]
    s_waitcnt vmcnt(27) lgkmcnt(9)
    ds_read_b64_tr_b16 a[26:27], v10 offset:9216
    v_mfma_f32_16x16x32_bf16 v[32:35], a[0:3], a[48:51], v[32:35]
    ds_read_b64_tr_b16 a[28:29], v11 offset:8192
    buffer_load_dwordx4 a[40:43], v12, s[4:7], s27 offen sc1
    v_mfma_f32_16x16x32_bf16 v[36:39], a[0:3], a[52:55], v[36:39]
    ds_read_b64_tr_b16 a[30:31], v11 offset:9216
    buffer_load_dwordx4 a[44:47], v13, s[4:7], s27 offen sc1
    v_mfma_f32_16x16x32_bf16 v[40:43], a[4:7], a[48:51], v[40:43]
    ds_read_b64_tr_b16 a[0:1], v8 offset:4096
    s_add_u32 s27, s27, 151552
    v_mfma_f32_16x16x32_bf16 v[44:47], a[4:7], a[52:55], v[44:47]
    s_waitcnt lgkmcnt(9)
    ds_read_b64_tr_b16 a[2:3], v8 offset:5120
    v_mfma_f32_16x16x32_bf16 v[48:51], a[8:11], a[48:51], v[48:51]
    ds_read_b64_tr_b16 a[4:5], v9 offset:4096
    s_add_u32 m0, s44, 8192
    v_mfma_f32_16x16x32_bf16 v[52:55], a[8:11], a[52:55], v[52:55]
    ds_read_b64_tr_b16 a[6:7], v9 offset:5120
    buffer_load_dwordx4 v5, s[8:11], s43 offen lds
    v_mfma_f32_16x16x32_bf16 v[56:59], a[12:15], a[48:51], v[56:59]
    ds_read_b64_tr_b16 a[8:9], v10 offset:4096
    s_add_u32 m0, s44, 9216
    v_mfma_f32_16x16x32_bf16 v[60:63], a[12:15], a[52:55], v[60:63]
    s_waitcnt lgkmcnt(9)
    ds_read_b64_tr_b16 a[10:11], v10 offset:5120
    v_mfma_f32_16x16x32_bf16 v[64:67], a[16:19], a[48:51], v[64:67]
    ds_read_b64_tr_b16 a[12:13], v11 offset:4096
    buffer_load_dwordx4 v6, s[8:11], s43 offen lds
    v_mfma_f32_16x16x32_bf16 v[68:71], a[16:19], a[52:55], v[68:71]
    ds_read_b64_tr_b16 a[14:15], v11 offset:5120
    s_add_u32 s43, s43, s47
    v_mfma_f32_16x16x32_bf16 v[72:75], a[20:23], a[48:51], v[72:75]
    ds_read_b64_tr_b16 a[16:17], v8 offset:12288
    s_add_u32 s44, s44, 16384
    v_mfma_f32_16x16x32_bf16 v[76:79], a[20:23], a[52:55], v[76:79]
    s_waitcnt lgkmcnt(9)
    ds_read_b64_tr_b16 a[18:19], v8 offset:13312
    v_mfma_f32_16x16x32_bf16 v[80:83], a[24:27], a[48:51], v[80:83]
    ds_read_b64_tr_b16 a[20:21], v9 offset:12288
    s_cmp_eq_u32 s44, s46
    s_cselect_b32 s44, s45, s44
    v_mfma_f32_16x16x32_bf16 v[84:87], a[24:27], a[52:55], v[84:87]
    ds_read_b64_tr_b16 a[22:23], v9 offset:13312
    s_add_u32 s37, s37, 16384
    v_mfma_f32_16x16x32_bf16 v[88:91], a[28:31], a[48:51], v[88:91]
    ds_read_b64_tr_b16 a[24:25], v10 offset:12288
    s_cmp_eq_u32 s37, 139264
    s_cselect_b32 s37, 8192, s37
    v_mfma_f32_16x16x32_bf16 v[92:95], a[28:31], a[52:55], v[92:95]
    s_waitcnt vmcnt(27) lgkmcnt(9)
    ds_read_b64_tr_b16 a[26:27], v10 offset:13312
    v_mfma_f32_16x16x32_bf16 v[32:35], a[0:3], a[56:59], v[32:35]
    ds_read_b64_tr_b16 a[28:29], v11 offset:12288
    v_mfma_f32_16x16x32_bf16 v[36:39], a[0:3], a[60:63], v[36:39]
    ds_read_b64_tr_b16 a[30:31], v11 offset:13312
    s_barrier
    v_add_u32 v8, s37, v7
    v_xor_b32 v9, 32, v8
    v_xor_b32 v10, 64, v8
    v_xor_b32 v11, 96, v8
    v_mfma_f32_16x16x32_bf16 v[40:43], a[4:7], a[56:59], v[40:43]
    ds_read_b64_tr_b16 a[0:1], v8 offset:0
    v_mfma_f32_16x16x32_bf16 v[44:47], a[4:7], a[60:63], v[44:47]
    s_waitcnt lgkmcnt(9)
    ds_read_b64_tr_b16 a[2:3], v8 offset:1024
    buffer_load_dwordx4 a[48:51], v12, s[4:7], s27 offen sc1
    v_mfma_f32_16x16x32_bf16 v[48:51], a[8:11], a[56:59], v[48:51]
    ds_read_b64_tr_b16 a[4:5], v9 offset:0
    buffer_load_dwordx4 a[52:55], v13, s[4:7], s27 offen sc1
    v_mfma_f32_16x16x32_bf16 v[52:55], a[8:11], a[60:63], v[52:55]
    ds_read_b64_tr_b16 a[6:7], v9 offset:1024
    v_mfma_f32_16x16x32_bf16 v[56:59], a[12:15], a[56:59], v[56:59]
    ds_read_b64_tr_b16 a[8:9], v10 offset:0
    s_add_u32 s27, s27, 151552
    v_mfma_f32_16x16x32_bf16 v[60:63], a[12:15], a[60:63], v[60:63]
    s_waitcnt lgkmcnt(9)
    ds_read_b64_tr_b16 a[10:11], v10 offset:1024
    v_mfma_f32_16x16x32_bf16 v[64:67], a[16:19], a[56:59], v[64:67]
    ds_read_b64_tr_b16 a[12:13], v11 offset:0
    s_add_u32 m0, s44, 0
    v_mfma_f32_16x16x32_bf16 v[68:71], a[16:19], a[60:63], v[68:71]
    ds_read_b64_tr_b16 a[14:15], v11 offset:1024
    v_mfma_f32_16x16x32_bf16 v[72:75], a[20:23], a[56:59], v[72:75]
    ds_read_b64_tr_b16 a[16:17], v8 offset:8192
    buffer_load_dwordx4 v3, s[8:11], s43 offen lds
    v_mfma_f32_16x16x32_bf16 v[76:79], a[20:23], a[60:63], v[76:79]
    s_waitcnt lgkmcnt(9)
    ds_read_b64_tr_b16 a[18:19], v8 offset:9216
    v_mfma_f32_16x16x32_bf16 v[80:83], a[24:27], a[56:59], v[80:83]
    ds_read_b64_tr_b16 a[20:21], v9 offset:8192
    s_add_u32 m0, s44, 1024
    v_mfma_f32_16x16x32_bf16 v[84:87], a[24:27], a[60:63], v[84:87]
    ds_read_b64_tr_b16 a[22:23], v9 offset:9216
    v_mfma_f32_16x16x32_bf16 v[88:91], a[28:31], a[56:59], v[88:91]
    ds_read_b64_tr_b16 a[24:25], v10 offset:8192
    buffer_load_dwordx4 v4, s[8:11], s43 offen lds
    v_mfma_f32_16x16x32_bf16 v[92:95], a[28:31], a[60:63], v[92:95]
    s_waitcnt vmcnt(27) lgkmcnt(9)
    ds_read_b64_tr_b16 a[26:27], v10 offset:9216
    v_mfma_f32_16x16x32_bf16 v[32:35], a[0:3], a[64:67], v[32:35]
    ds_read_b64_tr_b16 a[28:29], v11 offset:8192
    buffer_load_dwordx4 a[56:59], v12, s[4:7], s27 offen sc1
    v_mfma_f32_16x16x32_bf16 v[36:39], a[0:3], a[68:71], v[36:39]
    ds_read_b64_tr_b16 a[30:31], v11 offset:9216
    buffer_load_dwordx4 a[60:63], v13, s[4:7], s27 offen sc1
    v_mfma_f32_16x16x32_bf16 v[40:43], a[4:7], a[64:67], v[40:43]
    ds_read_b64_tr_b16 a[0:1], v8 offset:4096
    s_add_u32 s27, s27, 151552
    v_mfma_f32_16x16x32_bf16 v[44:47], a[4:7], a[68:71], v[44:47]
    s_waitcnt lgkmcnt(9)
    ds_read_b64_tr_b16 a[2:3], v8 offset:5120
    v_mfma_f32_16x16x32_bf16 v[48:51], a[8:11], a[64:67], v[48:51]
    ds_read_b64_tr_b16 a[4:5], v9 offset:4096
    s_add_u32 m0, s44, 8192
    v_mfma_f32_16x16x32_bf16 v[52:55], a[8:11], a[68:71], v[52:55]
    ds_read_b64_tr_b16 a[6:7], v9 offset:5120
    buffer_load_dwordx4 v5, s[8:11], s43 offen lds
    v_mfma_f32_16x16x32_bf16 v[56:59], a[12:15], a[64:67], v[56:59]
    ds_read_b64_tr_b16 a[8:9], v10 offset:4096
    s_add_u32 m0, s44, 9216
    v_mfma_f32_16x16x32_bf16 v[60:63], a[12:15], a[68:71], v[60:63]
    s_waitcnt lgkmcnt(9)
    ds_read_b64_tr_b16 a[10:11], v10 offset:5120
    v_mfma_f32_16x16x32_bf16 v[64:67], a[16:19], a[64:67], v[64:67]
    ds_read_b64_tr_b16 a[12:13], v11 offset:4096
    buffer_load_dwordx4 v6, s[8:11], s43 offen lds
    v_mfma_f32_16x16x32_bf16 v[68:71], a[16:19], a[68:71], v[68:71]
    ds_read_b64_tr_b16 a[14:15], v11 offset:5120
    s_add_u32 s43, s43, s47
    v_mfma_f32_16x16x32_bf16 v[72:75], a[20:23], a[64:67], v[72:75]
    ds_read_b64_tr_b16 a[16:17], v8 offset:12288
    s_add_u32 s44, s44, 16384
    v_mfma_f32_16x16x32_bf16 v[76:79], a[20:23], a[68:71], v[76:79]
    s_waitcnt lgkmcnt(9)
    ds_read_b64_tr_b16 a[18:19], v8 offset:13312
    v_mfma_f32_16x16x32_bf16 v[80:83], a[24:27], a[64:67], v[80:83]
    ds_read_b64_tr_b16 a[20:21], v9 offset:12288
    s_cmp_eq_u32 s44, s46
    s_cselect_b32 s44, s45, s44
    v_mfma_f32_16x16x32_bf16 v[84:87], a[24:27], a[68:71], v[84:87]
    ds_read_b64_tr_b16 a[22:23], v9 offset:13312
    s_add_u32 s37, s37, 16384
    v_mfma_f32_16x16x32_bf16 v[88:91], a[28:31], a[64:67], v[88:91]
    ds_read_b64_tr_b16 a[24:25], v10 offset:12288
    s_cmp_eq_u32 s37, 139264
    s_cselect_b32 s37, 8192, s37
    v_mfma_f32_16x16x32_bf16 v[92:95], a[28:31], a[68:71], v[92:95]
    s_waitcnt vmcnt(27) lgkmcnt(9)
    ds_read_b64_tr_b16 a[26:27], v10 offset:13312
    v_mfma_f32_16x16x32_bf16 v[32:35], a[0:3], a[72:75], v[32:35]
    ds_read_b64_tr_b16 a[28:29], v11 offset:12288
    v_mfma_f32_16x16x32_bf16 v[36:39], a[0:3], a[76:79], v[36:39]
    ds_read_b64_tr_b16 a[30:31], v11 offset:13312
    s_barrier
    v_add_u32 v8, s37, v7
    v_xor_b32 v9, 32, v8
    v_xor_b32 v10, 64, v8
    v_xor_b32 v11, 96, v8
    v_mfma_f32_16x16x32_bf16 v[40:43], a[4:7], a[72:75], v[40:43]
    ds_read_b64_tr_b16 a[0:1], v8 offset:0
    v_mfma_f32_16x16x32_bf16 v[44:47], a[4:7], a[76:79], v[44:47]
    s_waitcnt lgkmcnt(9)
    ds_read_b64_tr_b16 a[2:3], v8 offset:1024
    buffer_load_dwordx4 a[64:67], v12, s[4:7], s27 offen sc1
    v_mfma_f32_16x16x32_bf16 v[48:51], a[8:11], a[72:75], v[48:51]
    ds_read_b64_tr_b16 a[4:5], v9 offset:0
    buffer_load_dwordx4 a[68:71], v13, s[4:7], s27 offen sc1
    v_mfma_f32_16x16x32_bf16 v[52:55], a[8:11], a[76:79], v[52:55]
    ds_read_b64_tr_b16 a[6:7], v9 offset:1024
    v_mfma_f32_16x16x32_bf16 v[56:59], a[12:15], a[72:75], v[56:59]
    ds_read_b64_tr_b16 a[8:9], v10 offset:0
    s_add_u32 s27, s27, 151552
    v_mfma_f32_16x16x32_bf16 v[60:63], a[12:15], a[76:79], v[60:63]
    s_waitcnt lgkmcnt(9)
    ds_read_b64_tr_b16 a[10:11], v10 offset:1024
    v_mfma_f32_16x16x32_bf16 v[64:67], a[16:19], a[72:75], v[64:67]
    ds_read_b64_tr_b16 a[12:13], v11 offset:0
    s_add_u32 m0, s44, 0
    v_mfma_f32_16x16x32_bf16 v[68:71], a[16:19], a[76:79], v[68:71]
    ds_read_b64_tr_b16 a[14:15], v11 offset:1024
    v_mfma_f32_16x16x32_bf16 v[72:75], a[20:23], a[72:75], v[72:75]
    ds_read_b64_tr_b16 a[16:17], v8 offset:8192
    buffer_load_dwordx4 v3, s[8:11], s43 offen lds
    v_mfma_f32_16x16x32_bf16 v[76:79], a[20:23], a[76:79], v[76:79]
    s_waitcnt lgkmcnt(9)
    ds_read_b64_tr_b16 a[18:19], v8 offset:9216
    v_mfma_f32_16x16x32_bf16 v[80:83], a[24:27], a[72:75], v[80:83]
    ds_read_b64_tr_b16 a[20:21], v9 offset:8192
    s_add_u32 m0, s44, 1024
    v_mfma_f32_16x16x32_bf16 v[84:87], a[24:27], a[76:79], v[84:87]
    ds_read_b64_tr_b16 a[22:23], v9 offset:9216
    v_mfma_f32_16x16x32_bf16 v[88:91], a[28:31], a[72:75], v[88:91]
    ds_read_b64_tr_b16 a[24:25], v10 offset:8192
    buffer_load_dwordx4 v4, s[8:11], s43 offen lds
    v_mfma_f32_16x16x32_bf16 v[92:95], a[28:31], a[76:79], v[92:95]
    s_waitcnt vmcnt(27) lgkmcnt(9)
    ds_read_b64_tr_b16 a[26:27], v10 offset:9216
    v_mfma_f32_16x16x32_bf16 v[32:35], a[0:3], a[80:83], v[32:35]
    ds_read_b64_tr_b16 a[28:29], v11 offset:8192
    buffer_load_dwordx4 a[72:75], v12, s[4:7], s27 offen sc1
    v_mfma_f32_16x16x32_bf16 v[36:39], a[0:3], a[84:87], v[36:39]
    ds_read_b64_tr_b16 a[30:31], v11 offset:9216
    buffer_load_dwordx4 a[76:79], v13, s[4:7], s27 offen sc1
    v_mfma_f32_16x16x32_bf16 v[40:43], a[4:7], a[80:83], v[40:43]
    ds_read_b64_tr_b16 a[0:1], v8 offset:4096
    s_add_u32 s27, s27, 151552
    v_mfma_f32_16x16x32_bf16 v[44:47], a[4:7], a[84:87], v[44:47]
    s_waitcnt lgkmcnt(9)
    ds_read_b64_tr_b16 a[2:3], v8 offset:5120
    v_mfma_f32_16x16x32_bf16 v[48:51], a[8:11], a[80:83], v[48:51]
    ds_read_b64_tr_b16 a[4:5], v9 offset:4096
    s_add_u32 m0, s44, 8192
    v_mfma_f32_16x16x32_bf16 v[52:55], a[8:11], a[84:87], v[52:55]
    ds_read_b64_tr_b16 a[6:7], v9 offset:5120
    buffer_load_dwordx4 v5, s[8:11], s43 offen lds
    v_mfma_f32_16x16x32_bf16 v[56:59], a[12:15], a[80:83], v[56:59]
    ds_read_b64_tr_b16 a[8:9], v10 offset:4096
    s_add_u32 m0, s44, 9216
    v_mfma_f32_16x16x32_bf16 v[60:63], a[12:15], a[84:87], v[60:63]
    s_waitcnt lgkmcnt(9)
    ds_read_b64_tr_b16 a[10:11], v10 offset:5120
    v_mfma_f32_16x16x32_bf16 v[64:67], a[16:19], a[80:83], v[64:67]
    ds_read_b64_tr_b16 a[12:13], v11 offset:4096
    buffer_load_dwordx4 v6, s[8:11], s43 offen lds
    v_mfma_f32_16x16x32_bf16 v[68:71], a[16:19], a[84:87], v[68:71]
    ds_read_b64_tr_b16 a[14:15], v11 offset:5120
    s_add_u32 s43, s43, s47
    v_mfma_f32_16x16x32_bf16 v[72:75], a[20:23], a[80:83], v[72:75]
    ds_read_b64_tr_b16 a[16:17], v8 offset:12288
    s_add_u32 s44, s44, 16384
    v_mfma_f32_16x16x32_bf16 v[76:79], a[20:23], a[84:87], v[76:79]
    s_waitcnt lgkmcnt(9)
    ds_read_b64_tr_b16 a[18:19], v8 offset:13312
    v_mfma_f32_16x16x32_bf16 v[80:83], a[24:27], a[80:83], v[80:83]
    ds_read_b64_tr_b16 a[20:21], v9 offset:12288
    s_cmp_eq_u32 s44, s46
    s_cselect_b32 s44, s45, s44
    v_mfma_f32_16x16x32_bf16 v[84:87], a[24:27], a[84:87], v[84:87]
    ds_read_b64_tr_b16 a[22:23], v9 offset:13312
    s_add_u32 s37, s37, 16384
    v_mfma_f32_16x16x32_bf16 v[88:91], a[28:31], a[80:83], v[88:91]
    ds_read_b64_tr_b16 a[24:25], v10 offset:12288
    s_cmp_eq_u32 s37, 139264
    s_cselect_b32 s37, 8192, s37
    v_mfma_f32_16x16x32_bf16 v[92:95], a[28:31], a[84:87], v[92:95]
    s_waitcnt vmcnt(27) lgkmcnt(9)
    ds_read_b64_tr_b16 a[26:27], v10 offset:13312
    v_mfma_f32_16x16x32_bf16 v[32:35], a[0:3], a[88:91], v[32:35]
    ds_read_b64_tr_b16 a[28:29], v11 offset:12288
    v_mfma_f32_16x16x32_bf16 v[36:39], a[0:3], a[92:95], v[36:39]
    ds_read_b64_tr_b16 a[30:31], v11 offset:13312
    s_barrier
    v_add_u32 v8, s37, v7
    v_xor_b32 v9, 32, v8
    v_xor_b32 v10, 64, v8
    v_xor_b32 v11, 96, v8
    v_mfma_f32_16x16x32_bf16 v[40:43], a[4:7], a[88:91], v[40:43]
    ds_read_b64_tr_b16 a[0:1], v8 offset:0
    v_mfma_f32_16x16x32_bf16 v[44:47], a[4:7], a[92:95], v[44:47]
    s_waitcnt lgkmcnt(9)
    ds_read_b64_tr_b16 a[2:3], v8 offset:1024
    buffer_load_dwordx4 a[80:83], v12, s[4:7], s27 offen sc1
    v_mfma_f32_16x16x32_bf16 v[48:51], a[8:11], a[88:91], v[48:51]
    ds_read_b64_tr_b16 a[4:5], v9 offset:0
    buffer_load_dwordx4 a[84:87], v13, s[4:7], s27 offen sc1
    v_mfma_f32_16x16x32_bf16 v[52:55], a[8:11], a[92:95], v[52:55]
    ds_read_b64_tr_b16 a[6:7], v9 offset:1024
    v_mfma_f32_16x16x32_bf16 v[56:59], a[12:15], a[88:91], v[56:59]
    ds_read_b64_tr_b16 a[8:9], v10 offset:0
    s_add_u32 s27, s27, 151552
    v_mfma_f32_16x16x32_bf16 v[60:63], a[12:15], a[92:95], v[60:63]
    s_waitcnt lgkmcnt(9)
    ds_read_b64_tr_b16 a[10:11], v10 offset:1024
    s_add_u32 m0, s44, 0
    v_mfma_f32_16x16x32_bf16 v[64:67], a[16:19], a[88:91], v[64:67]
    ds_read_b64_tr_b16 a[12:13], v11 offset:0
    v_mfma_f32_16x16x32_bf16 v[68:71], a[16:19], a[92:95], v[68:71]
    ds_read_b64_tr_b16 a[14:15], v11 offset:1024
    buffer_load_dwordx4 v3, s[8:11], s43 offen lds
    v_mfma_f32_16x16x32_bf16 v[72:75], a[20:23], a[88:91], v[72:75]
    ds_read_b64_tr_b16 a[16:17], v8 offset:8192
    v_mfma_f32_16x16x32_bf16 v[76:79], a[20:23], a[92:95], v[76:79]
    s_waitcnt lgkmcnt(9)
    ds_read_b64_tr_b16 a[18:19], v8 offset:9216
    s_add_u32 m0, s44, 1024
    v_mfma_f32_16x16x32_bf16 v[80:83], a[24:27], a[88:91], v[80:83]
    ds_read_b64_tr_b16 a[20:21], v9 offset:8192
    buffer_load_dwordx4 v4, s[8:11], s43 offen lds
    v_mfma_f32_16x16x32_bf16 v[84:87], a[24:27], a[92:95], v[84:87]
    ds_read_b64_tr_b16 a[22:23], v9 offset:9216
    v_mfma_f32_16x16x32_bf16 v[88:91], a[28:31], a[88:91], v[88:91]
    ds_read_b64_tr_b16 a[24:25], v10 offset:8192
    s_sub_u32 s36, s36, 1
    s_cmp_lg_u32 s36, 0
    v_mfma_f32_16x16x32_bf16 v[92:95], a[28:31], a[92:95], v[92:95]
    s_waitcnt vmcnt(27) lgkmcnt(9)
    ds_read_b64_tr_b16 a[26:27], v10 offset:9216
    ds_read_b64_tr_b16 a[28:29], v11 offset:8192
    ds_read_b64_tr_b16 a[30:31], v11 offset:9216
    s_cbranch_scc1 down_loop
down_epi:
    s_add_u32 s16, s38, 65011712
    s_addc_u32 s17, s39, 0
    s_mov_b32 s18, 4194304
    s_mov_b32 s19, 0x20000
    s_lshl_b32 s33, s42, 4
    s_add_u32 s33, s33, s41
    s_lshl_b32 s58, s33, 12
    s_xor_b32 s34, s58, 0x1000
    v_lshlrev_b32 v27, 4, v1
    v_cvt_pk_bf16_f32 v64, v64, v65
    v_cvt_pk_bf16_f32 v65, v66, v67
    v_cvt_pk_bf16_f32 v66, v68, v69
    v_cvt_pk_bf16_f32 v67, v70, v71
    buffer_store_dwordx4 v[64:67], v27, s[16:19], s34 offen offset:0 sc1
    v_cvt_pk_bf16_f32 v72, v72, v73
    v_cvt_pk_bf16_f32 v73, v74, v75
    v_cvt_pk_bf16_f32 v74, v76, v77
    v_cvt_pk_bf16_f32 v75, v78, v79
    buffer_store_dwordx4 v[72:75], v27, s[16:19], s34 offen offset:1024 sc1
    v_cvt_pk_bf16_f32 v80, v80, v81
    v_cvt_pk_bf16_f32 v81, v82, v83
    v_cvt_pk_bf16_f32 v82, v84, v85
    v_cvt_pk_bf16_f32 v83, v86, v87
    buffer_store_dwordx4 v[80:83], v27, s[16:19], s34 offen offset:2048 sc1
    v_cvt_pk_bf16_f32 v88, v88, v89
    v_cvt_pk_bf16_f32 v89, v90, v91
    v_cvt_pk_bf16_f32 v90, v92, v93
    v_cvt_pk_bf16_f32 v91, v94, v95
    buffer_store_dwordx4 v[88:91], v27, s[16:19], s34 offen offset:3072 sc1
    s_mov_b32 s20, s62
    s_mov_b32 s21, s63
    s_mov_b32 s22, 4194304
    s_mov_b32 s23, 0x20000
    v_add_f32 v176, v176, v184
    v_add_f32 v177, v177, v185
    v_add_f32 v178, v178, v186
    v_add_f32 v179, v179, v187
    v_add_f32 v180, v180, v188
    v_add_f32 v181, v181, v189
    v_add_f32 v182, v182, v190
    v_add_f32 v183, v183, v191
    v_add_f32 v176, v176, v180
    v_add_f32 v177, v177, v181
    v_add_f32 v178, v178, v182
    v_add_f32 v179, v179, v183
    v_add_f32 v176, v176, v178
    v_add_f32 v177, v177, v179
    v_add_f32 v24, v176, v177
    v_cvt_pk_bf16_f32 v24, v24, v24
    v_and_b32 v24, 0xffff0000, v24
    s_lshl_b32 s33, s26, 8
    s_add_u32 s33, s33, 155648
    v_lshl_add_u32 v16, v1, 2, s33
    ds_write_b32 v16, v24
    s_lshl_b32 s57, s26, 12
    s_add_u32 s57, s57, 139264
    v_lshrrev_b32 v16, 4, v1
    v_lshl_add_u32 v16, v16, 4, s33
    v_and_b32 v19, 15, v1
    v_lshlrev_b32 v19, 7, v19
    v_lshrrev_b32 v17, 5, v1
    v_and_b32 v18, 7, v1
    v_xor_b32 v17, v17, v18
    v_lshl_add_u32 v19, v17, 4, v19
    v_bfe_u32 v17, v1, 4, 1
    v_lshl_add_u32 v19, v17, 3, v19
    v_add_u32 v19, s57, v19
    s_waitcnt lgkmcnt(0)
    ds_read_b128 v[112:115], v16 offset:0
    ds_read_b128 v[116:119], v16 offset:64
    ds_read_b128 v[120:123], v16 offset:128
    ds_read_b128 v[124:127], v16 offset:192
    v_xor_b32 v20, 32, v19
    v_xor_b32 v21, 64, v19
    v_xor_b32 v22, 96, v19
    v_accvgpr_read_b32 v96, a158
    v_accvgpr_read_b32 v97, a159
    v_accvgpr_read_b32 v98, a160
    v_accvgpr_read_b32 v99, a161
    v_accvgpr_read_b32 v100, a162
    v_accvgpr_read_b32 v101, a163
    v_accvgpr_read_b32 v102, a164
    v_accvgpr_read_b32 v103, a165
    v_accvgpr_read_b32 v104, a166
    v_accvgpr_read_b32 v105, a167
    v_accvgpr_read_b32 v106, a168
    v_accvgpr_read_b32 v107, a169
    v_accvgpr_read_b32 v108, a170
    v_accvgpr_read_b32 v109, a171
    v_accvgpr_read_b32 v110, a172
    v_accvgpr_read_b32 v111, a173
    v_lshlrev_b32 v128, 16, v96
    v_and_b32 v129, 0xffff0000, v96
    v_lshlrev_b32 v130, 16, v97
    v_and_b32 v131, 0xffff0000, v97
    v_lshlrev_b32 v132, 16, v98
    v_and_b32 v133, 0xffff0000, v98
    v_lshlrev_b32 v134, 16, v99
    v_and_b32 v135, 0xffff0000, v99
    v_lshlrev_b32 v136, 16, v100
    v_and_b32 v137, 0xffff0000, v100
    v_lshlrev_b32 v138, 16, v101
    v_and_b32 v139, 0xffff0000, v101
    v_lshlrev_b32 v140, 16, v102
    v_and_b32 v141, 0xffff0000, v102
    v_lshlrev_b32 v142, 16, v103
    v_and_b32 v143, 0xffff0000, v103
    v_lshlrev_b32 v144, 16, v104
    v_and_b32 v145, 0xffff0000, v104
    v_lshlrev_b32 v146, 16, v105
    v_and_b32 v147, 0xffff0000, v105
    v_lshlrev_b32 v148, 16, v106
    v_and_b32 v149, 0xffff0000, v106
    v_lshlrev_b32 v150, 16, v107
    v_and_b32 v151, 0xffff0000, v107
    v_lshlrev_b32 v152, 16, v108
    v_and_b32 v153, 0xffff0000, v108
    v_lshlrev_b32 v154, 16, v109
    v_and_b32 v155, 0xffff0000, v109
    v_lshlrev_b32 v156, 16, v110
    v_and_b32 v157, 0xffff0000, v110
    v_lshlrev_b32 v158, 16, v111
    v_and_b32 v159, 0xffff0000, v111
    v_lshrrev_b32 v24, 3, v1
    v_and_b32 v25, 7, v1
    v_xor_b32 v25, v25, v24
    v_lshlrev_b32 v25, 4, v25
    v_lshl_add_u32 v25, v24, 11, v25
    v_lshl_add_u32 v26, v1, 4, s57
    s_lshl_b32 s33, s42, 16
    s_lshl_b32 s32, s41, 7
    s_add_u32 s33, s33, s32
    s_waitcnt lgkmcnt(0)
    s_lshr_b32 s59, s58, 5
    s_add_u32 s59, s59, 65536
    s_xor_b32 s56, s59, 128
    v_mov_b32 v28, 1
    v_mov_b32 v29, 0
    s_mov_b64 exec, 1
    s_waitcnt vmcnt(0)
    buffer_store_dword v28, v29, s[12:15], s59 offen sc1
    s_mov_b64 exec, -1
    s_branch ex_first
ex_poll:
    s_sleep 2
ex_first:
    buffer_load_dword v30, v29, s[12:15], s56 offen sc1
    s_waitcnt vmcnt(0)
    v_cmp_eq_u32 vcc, 1, v30
    s_cbranch_vccz ex_poll
    buffer_load_dwordx4 v[160:163], v27, s[16:19], s58 offen offset:0 sc1
    buffer_load_dwordx4 v[164:167], v27, s[16:19], s58 offen offset:1024 sc1
    buffer_load_dwordx4 v[168:171], v27, s[16:19], s58 offen offset:2048 sc1
    buffer_load_dwordx4 v[172:175], v27, s[16:19], s58 offen offset:3072 sc1
    s_waitcnt vmcnt(3)
    v_lshlrev_b32 v64, 16, v160
    v_and_b32 v65, 0xffff0000, v160
    v_lshlrev_b32 v66, 16, v161
    v_and_b32 v67, 0xffff0000, v161
    v_lshlrev_b32 v68, 16, v162
    v_and_b32 v69, 0xffff0000, v162
    v_lshlrev_b32 v70, 16, v163
    v_and_b32 v71, 0xffff0000, v163
    v_add_f32 v32, v32, v64
    v_add_f32 v33, v33, v65
    v_add_f32 v34, v34, v66
    v_add_f32 v35, v35, v67
    v_add_f32 v36, v36, v68
    v_add_f32 v37, v37, v69
    v_add_f32 v38, v38, v70
    v_add_f32 v39, v39, v71
    v_fmac_f32 v128, v112, v32
    v_fmac_f32 v129, v113, v33
    v_fmac_f32 v130, v114, v34
    v_fmac_f32 v131, v115, v35
    v_fmac_f32 v132, v112, v36
    v_fmac_f32 v133, v113, v37
    v_fmac_f32 v134, v114, v38
    v_fmac_f32 v135, v115, v39
    v_cvt_pk_bf16_f32 v96, v128, v129
    v_cvt_pk_bf16_f32 v97, v130, v131
    v_cvt_pk_bf16_f32 v98, v132, v133
    v_cvt_pk_bf16_f32 v99, v134, v135
    ds_write_b64 v19, v[96:97] offset:0
    ds_write_b64 v19, v[98:99] offset:2048
    s_waitcnt vmcnt(2)
    v_lshlrev_b32 v72, 16, v164
    v_and_b32 v73, 0xffff0000, v164
    v_lshlrev_b32 v74, 16, v165
    v_and_b32 v75, 0xffff0000, v165
    v_lshlrev_b32 v76, 16, v166
    v_and_b32 v77, 0xffff0000, v166
    v_lshlrev_b32 v78, 16, v167
    v_and_b32 v79, 0xffff0000, v167
    v_add_f32 v40, v40, v72
    v_add_f32 v41, v41, v73
    v_add_f32 v42, v42, v74
    v_add_f32 v43, v43, v75
    v_add_f32 v44, v44, v76
    v_add_f32 v45, v45, v77
    v_add_f32 v46, v46, v78
    v_add_f32 v47, v47, v79
    v_fmac_f32 v136, v116, v40
    v_fmac_f32 v137, v117, v41
    v_fmac_f32 v138, v118, v42
    v_fmac_f32 v139, v119, v43
    v_fmac_f32 v140, v116, v44
    v_fmac_f32 v141, v117, v45
    v_fmac_f32 v142, v118, v46
    v_fmac_f32 v143, v119, v47
    v_cvt_pk_bf16_f32 v100, v136, v137
    v_cvt_pk_bf16_f32 v101, v138, v139
    v_cvt_pk_bf16_f32 v102, v140, v141
    v_cvt_pk_bf16_f32 v103, v142, v143
    ds_write_b64 v20, v[100:101] offset:0
    ds_write_b64 v20, v[102:103] offset:2048
    s_waitcnt vmcnt(1)
    v_lshlrev_b32 v80, 16, v168
    v_and_b32 v81, 0xffff0000, v168
    v_lshlrev_b32 v82, 16, v169
    v_and_b32 v83, 0xffff0000, v169
    v_lshlrev_b32 v84, 16, v170
    v_and_b32 v85, 0xffff0000, v170
    v_lshlrev_b32 v86, 16, v171
    v_and_b32 v87, 0xffff0000, v171
    v_add_f32 v48, v48, v80
    v_add_f32 v49, v49, v81
    v_add_f32 v50, v50, v82
    v_add_f32 v51, v51, v83
    v_add_f32 v52, v52, v84
    v_add_f32 v53, v53, v85
    v_add_f32 v54, v54, v86
    v_add_f32 v55, v55, v87
    v_fmac_f32 v144, v120, v48
    v_fmac_f32 v145, v121, v49
    v_fmac_f32 v146, v122, v50
    v_fmac_f32 v147, v123, v51
    v_fmac_f32 v148, v120, v52
    v_fmac_f32 v149, v121, v53
    v_fmac_f32 v150, v122, v54
    v_fmac_f32 v151, v123, v55
    v_cvt_pk_bf16_f32 v104, v144, v145
    v_cvt_pk_bf16_f32 v105, v146, v147
    v_cvt_pk_bf16_f32 v106, v148, v149
    v_cvt_pk_bf16_f32 v107, v150, v151
    ds_write_b64 v21, v[104:105] offset:0
    ds_write_b64 v21, v[106:107] offset:2048
    s_waitcnt vmcnt(0)
    v_lshlrev_b32 v88, 16, v172
    v_and_b32 v89, 0xffff0000, v172
    v_lshlrev_b32 v90, 16, v173
    v_and_b32 v91, 0xffff0000, v173
    v_lshlrev_b32 v92, 16, v174
    v_and_b32 v93, 0xffff0000, v174
    v_lshlrev_b32 v94, 16, v175
    v_and_b32 v95, 0xffff0000, v175
    v_add_f32 v56, v56, v88
    v_add_f32 v57, v57, v89
    v_add_f32 v58, v58, v90
    v_add_f32 v59, v59, v91
    v_add_f32 v60, v60, v92
    v_add_f32 v61, v61, v93
    v_add_f32 v62, v62, v94
    v_add_f32 v63, v63, v95
    v_fmac_f32 v152, v124, v56
    v_fmac_f32 v153, v125, v57
    v_fmac_f32 v154, v126, v58
    v_fmac_f32 v155, v127, v59
    v_fmac_f32 v156, v124, v60
    v_fmac_f32 v157, v125, v61
    v_fmac_f32 v158, v126, v62
    v_fmac_f32 v159, v127, v63
    v_cvt_pk_bf16_f32 v108, v152, v153
    v_cvt_pk_bf16_f32 v109, v154, v155
    v_cvt_pk_bf16_f32 v110, v156, v157
    v_cvt_pk_bf16_f32 v111, v158, v159
    ds_write_b64 v22, v[108:109] offset:0
    ds_write_b64 v22, v[110:111] offset:2048
    s_waitcnt lgkmcnt(0)
    ds_read_b128 v[112:115], v26 offset:0
    ds_read_b128 v[116:119], v26 offset:1024
    ds_read_b128 v[120:123], v26 offset:2048
    ds_read_b128 v[124:127], v26 offset:3072
    s_waitcnt lgkmcnt(3)
    buffer_store_dwordx4 v[112:115], v25, s[20:23], s33 offen sc1
    s_add_u32 s33, s33, 0x4000
    s_waitcnt lgkmcnt(2)
    buffer_store_dwordx4 v[116:119], v25, s[20:23], s33 offen sc1
    s_add_u32 s33, s33, 0x4000
    s_waitcnt lgkmcnt(1)
    buffer_store_dwordx4 v[120:123], v25, s[20:23], s33 offen sc1
    s_add_u32 s33, s33, 0x4000
    s_waitcnt lgkmcnt(0)
    buffer_store_dwordx4 v[124:127], v25, s[20:23], s33 offen sc1
    s_add_u32 s33, s33, 0x4000
    s_endpgm
attn_slow:
    v_mov_b32 v176, 0xff800000
    v_mov_b32 v178, 0xff800000
    s_mov_b32 s52, 0
    s_waitcnt lgkmcnt(0)
attn_slow1:
    buffer_load_dwordx4 v[152:155], v2, s[28:31], s52 offen sc1
    buffer_load_dwordx4 v[156:159], v2, s[28:31], s52 offen offset:1024 sc1
    s_waitcnt vmcnt(0)
    v_mfma_f32_32x32x16_bf16 v[64:79], v[152:155], v[8:11], 0
    v_mfma_f32_32x32x16_bf16 v[64:79], v[156:159], v[12:15], v[64:79]
    v_mfma_f32_32x32x16_bf16 v[80:95], v[152:155], v[16:19], 0
    v_mfma_f32_32x32x16_bf16 v[80:95], v[156:159], v[20:23], v[80:95]
    s_nop 9
    v_max3_f32 v176, v64, v65, v176
    v_max3_f32 v176, v66, v67, v176
    v_max3_f32 v176, v68, v69, v176
    v_max3_f32 v176, v70, v71, v176
    v_max3_f32 v176, v72, v73, v176
    v_max3_f32 v176, v74, v75, v176
    v_max3_f32 v176, v76, v77, v176
    v_max3_f32 v176, v78, v79, v176
    v_max3_f32 v178, v80, v81, v178
    v_max3_f32 v178, v82, v83, v178
    v_max3_f32 v178, v84, v85, v178
    v_max3_f32 v178, v86, v87, v178
    v_max3_f32 v178, v88, v89, v178
    v_max3_f32 v178, v90, v91, v178
    v_max3_f32 v178, v92, v93, v178
    v_max3_f32 v178, v94, v95, v178
    s_add_u32 s52, s52, 4096
    s_cmp_lt_u32 s52, 0x40000
    s_cbranch_scc1 attn_slow1
    v_mov_b32 v177, v176
    s_nop 1
    v_permlane32_swap_b32 v176, v177
    v_max_f32 v176, v176, v177
    v_sub_f32 v32, 0, v176
    v_sub_f32 v33, 0, v176
    v_sub_f32 v34, 0, v176
    v_sub_f32 v35, 0, v176
    v_sub_f32 v36, 0, v176
    v_sub_f32 v37, 0, v176
    v_sub_f32 v38, 0, v176
    v_sub_f32 v39, 0, v176
    v_sub_f32 v40, 0, v176
    v_sub_f32 v41, 0, v176
    v_sub_f32 v42, 0, v176
    v_sub_f32 v43, 0, v176
    v_sub_f32 v44, 0, v176
    v_sub_f32 v45, 0, v176
    v_sub_f32 v46, 0, v176
    v_sub_f32 v47, 0, v176
    v_mov_b32 v179, v178
    s_nop 1
    v_permlane32_swap_b32 v178, v179
    v_max_f32 v178, v178, v179
    v_sub_f32 v48, 0, v178
    v_sub_f32 v49, 0, v178
    v_sub_f32 v50, 0, v178
    v_sub_f32 v51, 0, v178
    v_sub_f32 v52, 0, v178
    v_sub_f32 v53, 0, v178
    v_sub_f32 v54, 0, v178
    v_sub_f32 v55, 0, v178
    v_sub_f32 v56, 0, v178
    v_sub_f32 v57, 0, v178
    v_sub_f32 v58, 0, v178
    v_sub_f32 v59, 0, v178
    v_sub_f32 v60, 0, v178
    v_sub_f32 v61, 0, v178
    v_sub_f32 v62, 0, v178
    v_sub_f32 v63, 0, v178
    v_mov_b32 v96, 0
    v_mov_b32 v97, 0
    v_mov_b32 v98, 0
    v_mov_b32 v99, 0
    v_mov_b32 v100, 0
    v_mov_b32 v101, 0
    v_mov_b32 v102, 0
    v_mov_b32 v103, 0
    v_mov_b32 v104, 0
    v_mov_b32 v105, 0
    v_mov_b32 v106, 0
    v_mov_b32 v107, 0
    v_mov_b32 v108, 0
    v_mov_b32 v109, 0
    v_mov_b32 v110, 0
    v_mov_b32 v111, 0
    v_mov_b32 v112, 0
    v_mov_b32 v113, 0
    v_mov_b32 v114, 0
    v_mov_b32 v115, 0
    v_mov_b32 v116, 0
    v_mov_b32 v117, 0
    v_mov_b32 v118, 0
    v_mov_b32 v119, 0
    v_mov_b32 v120, 0
    v_mov_b32 v121, 0
    v_mov_b32 v122, 0
    v_mov_b32 v123, 0
    v_mov_b32 v124, 0
    v_mov_b32 v125, 0
    v_mov_b32 v126, 0
    v_mov_b32 v127, 0
    v_mov_b32 v128, 0
    v_mov_b32 v129, 0
    v_mov_b32 v130, 0
    v_mov_b32 v131, 0
    v_mov_b32 v132, 0
    v_mov_b32 v133, 0
    v_mov_b32 v134, 0
    v_mov_b32 v135, 0
    s_mov_b32 s52, 0
attn_slow2:
    buffer_load_dwordx4 v[152:155], v2, s[28:31], s52 offen offset:0 sc1
    buffer_load_dwordx4 v[156:159], v2, s[28:31], s52 offen offset:1024 sc1
    buffer_load_dwordx4 v[160:163], v2, s[28:31], s52 offen offset:2048 sc1
    buffer_load_dwordx4 v[164:167], v2, s[28:31], s52 offen offset:3072 sc1
    s_waitcnt vmcnt(0)
    v_mfma_f32_32x32x16_bf16 v[64:79], v[152:155], v[8:11], v[32:47]
    v_mfma_f32_32x32x16_bf16 v[64:79], v[156:159], v[12:15], v[64:79]
    v_mfma_f32_32x32x16_bf16 v[80:95], v[152:155], v[16:19], v[48:63]
    v_mfma_f32_32x32x16_bf16 v[80:95], v[156:159], v[20:23], v[80:95]
    s_nop 9
    v_exp_f32 v64, v64
    v_exp_f32 v65, v65
    v_exp_f32 v66, v66
    v_exp_f32 v67, v67
    v_exp_f32 v68, v68
    v_exp_f32 v69, v69
    v_exp_f32 v70, v70
    v_exp_f32 v71, v71
    v_exp_f32 v72, v72
    v_exp_f32 v73, v73
    v_exp_f32 v74, v74
    v_exp_f32 v75, v75
    v_exp_f32 v76, v76
    v_exp_f32 v77, v77
    v_exp_f32 v78, v78
    v_exp_f32 v79, v79
    v_exp_f32 v80, v80
    v_exp_f32 v81, v81
    v_exp_f32 v82, v82
    v_exp_f32 v83, v83
    v_exp_f32 v84, v84
    v_exp_f32 v85, v85
    v_exp_f32 v86, v86
    v_exp_f32 v87, v87
    v_exp_f32 v88, v88
    v_exp_f32 v89, v89
    v_exp_f32 v90, v90
    v_exp_f32 v91, v91
    v_exp_f32 v92, v92
    v_exp_f32 v93, v93
    v_exp_f32 v94, v94
    v_exp_f32 v95, v95
    v_cvt_pk_bf16_f32 v136, v64, v65
    v_cvt_pk_bf16_f32 v137, v66, v67
    v_cvt_pk_bf16_f32 v138, v68, v69
    v_cvt_pk_bf16_f32 v139, v70, v71
    v_cvt_pk_bf16_f32 v140, v72, v73
    v_cvt_pk_bf16_f32 v141, v74, v75
    v_cvt_pk_bf16_f32 v142, v76, v77
    v_cvt_pk_bf16_f32 v143, v78, v79
    v_cvt_pk_bf16_f32 v144, v80, v81
    v_cvt_pk_bf16_f32 v145, v82, v83
    v_cvt_pk_bf16_f32 v146, v84, v85
    v_cvt_pk_bf16_f32 v147, v86, v87
    v_cvt_pk_bf16_f32 v148, v88, v89
    v_cvt_pk_bf16_f32 v149, v90, v91
    v_cvt_pk_bf16_f32 v150, v92, v93
    v_cvt_pk_bf16_f32 v151, v94, v95
    v_mfma_f32_32x32x16_bf16 v[96:111], v[160:163], v[136:139], v[96:111]
    v_mfma_f32_32x32x16_bf16 v[96:111], v[164:167], v[140:143], v[96:111]
    v_smfmac_f32_16x16x64_bf16 v[128:131], v[24:27], v[136:143], v28
    v_mfma_f32_32x32x16_bf16 v[112:127], v[160:163], v[144:147], v[112:127]
    v_mfma_f32_32x32x16_bf16 v[112:127], v[164:167], v[148:151], v[112:127]
    v_smfmac_f32_16x16x64_bf16 v[132:135], v[24:27], v[144:151], v28
    s_add_u32 s52, s52, 4096
    s_cmp_lt_u32 s52, 0x40000
    s_cbranch_scc1 attn_slow2
    s_nop 1
    v_add_f32 v128, v128, v129
    s_nop 1
    v_add_f32 v132, v132, v133
    s_branch attn_fin
mlp_kernel_end:
    s_endpgm
.section .rodata,"a"
.p2align 6
.amdhsa_kernel pre_kernel
  .amdhsa_next_free_vgpr 112
  .amdhsa_next_free_sgpr 102
  .amdhsa_accum_offset 112
  .amdhsa_group_segment_fixed_size 0
  .amdhsa_kernarg_size 96
  .amdhsa_user_sgpr_count 2
  .amdhsa_user_sgpr_kernarg_segment_ptr 1
  .amdhsa_system_sgpr_workgroup_id_x 1
  .amdhsa_float_denorm_mode_32 3
  .amdhsa_float_denorm_mode_16_64 3
.end_amdhsa_kernel
.p2align 6
.amdhsa_kernel mlp_kernel
  .amdhsa_next_free_vgpr 434
  .amdhsa_next_free_sgpr 102
  .amdhsa_accum_offset 256
  .amdhsa_group_segment_fixed_size 0
  .amdhsa_kernarg_size 96
  .amdhsa_user_sgpr_count 2
  .amdhsa_user_sgpr_kernarg_segment_ptr 1
  .amdhsa_system_sgpr_workgroup_id_x 1
  .amdhsa_float_denorm_mode_32 3
  .amdhsa_float_denorm_mode_16_64 3
.end_amdhsa_kernel
```
